```python
import torch

def _softmax(x, axis=-1):
    return torch.softmax(x, dim=axis)
def _gelu(x):
    return torch.nn.functional.gelu(x, approximate="tanh")
def _silu(x):
    return torch.nn.functional.silu(x)
def _sigmoid(x):
    return torch.sigmoid(x)
def _layernorm(x, axis=-1, eps=1e-5):
    m = x.mean(dim=axis, keepdim=True)
    v = x.var(dim=axis, keepdim=True, unbiased=False)
    return (x - m) / torch.sqrt(v + eps)
def _scatter_add(tgt, idx, src, axis=0):
    return tgt.clone().index_add_(axis, idx, src)
def _segment_sum(src, seg, n):
    out = torch.zeros((n,) + src.shape[1:], dtype=src.dtype)
    return out.index_add_(0, seg, src)
def _pad(x, pw):
    flat = tuple(v for pair in reversed(pw) for v in pair)
    return torch.nn.functional.pad(x, flat)

kernel_name = 'recurrent_scan__mha_block_cached__swiglu_ffn__prompt'

def setup_inputs():

    _w = (lambda a: (lambda t: t.to(torch.bfloat16) if t.is_floating_point() else t)(torch.as_tensor(a)))
    def _A_setup():
        B, Sq, D = 1, 2048, 640
        H, Sk, Dh = 32, 2048, 192
        return {
            "x": _w((lambda *s: torch.randn(*s, dtype=torch.bfloat16) * 0.05)(B, Sq, D)),
            "k_cache": _w((lambda *s: torch.randn(*s, dtype=torch.bfloat16) * 0.8)(B, H, Sk, Dh)),
            "v_cache": _w((lambda *s: torch.randn(*s, dtype=torch.bfloat16) * 0.2)(B, H, Sk, Dh)),
            "wq": _w((lambda *s: torch.randn(*s, dtype=torch.bfloat16) * 0.8)(D, H * Dh) * (D ** -0.5)),
            "wo": _w((lambda *s: torch.randn(*s, dtype=torch.bfloat16) * 0.2)(H * Dh, D) * ((H * Dh) ** -0.5)),
        }
    _A_in = _A_setup()

    def _B_setup():
        B, S, D, F = 1, 2048, 640, 1536
        return {
            "x": _w((lambda *s: torch.randn(*s, dtype=torch.bfloat16) * 0.05)(B, S, D)),
            "w_gate": _w((lambda *s: torch.randn(*s, dtype=torch.bfloat16) * 0.1)(D, F)),
            "w_up": _w((lambda *s: torch.randn(*s, dtype=torch.bfloat16) * 0.1)(D, F)),
            "w_down": _w((lambda *s: torch.randn(*s, dtype=torch.bfloat16) * 0.1)(F, D)),
        }
    _B_in = _B_setup()

    return {
        "A_x": _A_in["x"],
        "A_k_cache": _A_in["k_cache"],
        "A_v_cache": _A_in["v_cache"],
        "A_wq": _A_in["wq"],
        "A_wo": _A_in["wo"],
        "B_x": _B_in["x"],
        "B_w_gate": _B_in["w_gate"],
        "B_w_up": _B_in["w_up"],
        "B_w_down": _B_in["w_down"],
    }

def reference(A_x, A_k_cache, A_v_cache, A_wq, A_wo, B_x, B_w_gate, B_w_up, B_w_down):
    def _A_ref(x, k_cache, v_cache, wq, wo):
        B, Sq, D = x.shape
        H, Dh = 32, 192
        q = (lambda x, *d: x.permute(*d))((x @ wq).reshape(B, Sq, H, Dh), 0, 2, 1, 3)
        scores = torch.einsum("bhqd,bhkd->bhqk", q, k_cache) * (Dh ** -0.5)
        p = _softmax(scores, axis=-1)
        o = torch.einsum("bhqk,bhkd->bhqd", p, v_cache)
        return (lambda x, *d: x.permute(*d))(o, 0, 2, 1, 3).reshape(B, Sq, H * Dh) @ wo

    def _B_ref(x, w_gate, w_up, w_down):
        g = _silu(x @ w_gate)
        u = x @ w_up
        return (g * u) @ w_down

    x = A_x
    xn = _layernorm(x, axis=-1)
    s = _A_ref(xn, A_k_cache, A_v_cache, A_wq, A_wo)
    g = _silu(_B_ref(xn, B_w_gate, B_w_up, B_w_down))
    return x + s * g
```

```asm
; @launch grid=(256,1,1) block=(256,1,1) lds=163840
.amdgcn_target "amdgcn-amd-amdhsa--gfx950"
.text
.globl recurrent_scan__mha_block_cached__swiglu_ffn__prompt_kernel
.p2align 8
.type recurrent_scan__mha_block_cached__swiglu_ffn__prompt_kernel,@function
recurrent_scan__mha_block_cached__swiglu_ffn__prompt_kernel:
s_cmp_ge_u32 s2, 256
s_cbranch_scc1 K_end
s_load_dwordx16 s[72:87], s[0:1], 0
s_load_dwordx8 s[88:95], s[0:1], 64
s_getpc_b64 s[96:97]
K_pc:
s_mov_b32 s98, K_codeend-K_pc
s_mov_b32 s99, 0x20000
v_lshrrev_b32 v1, 6, v0
v_and_b32 v2, 63, v0
v_readfirstlane_b32 s28, v1
s_and_b32 s29, s2, 7
s_lshl_b32 s29, s29, 2
s_bfe_u32 s40, s2, 0x20003
s_add_u32 s29, s29, s40
s_lshr_b32 s38, s2, 5
s_bfe_u32 s3, s29, 0x10002
s_lshl_b32 s3, s3, 1
s_bfe_u32 s40, s29, 0x10003
s_add_u32 s3, s3, s40
s_lshl_b32 s3, s3, 10
v_lshlrev_b32 v3, 4, v2
v_add_u32 v1, 1024, v3
s_lshr_b32 s40, s2, 4
s_lshl_b32 s40, s40, 2
s_add_u32 s40, s40, s28
s_and_b32 s40, s40, 15
s_lshl_b32 s40, s40, 13
v_lshlrev_b32 v63, 7, v2
v_add_u32 v63, s40, v63
s_waitcnt lgkmcnt(0)
s_and_b32 s40, s29, 1
s_cmp_eq_u32 s40, 1
s_cbranch_scc1 S_o0
s_mov_b32 s4, s72
s_mov_b32 s5, s73
s_mov_b32 s6, 2621440
s_mov_b32 s7, 0x20000
v_and_b32 v64, 15, v2
v_lshrrev_b32 v65, 4, v2
v_mul_u32_u24 v66, 1280, v64
v_lshl_add_u32 v66, v65, 4, v66
s_lshl_b32 s45, s38, 4
s_lshr_b32 s40, s29, 1
s_add_u32 s45, s45, s40
s_mul_i32 s40, s45, 20480
s_mul_i32 s41, s28, 320
s_add_u32 s40, s40, s41
buffer_load_dwordx4 v[80:83], v66, s[4:7], s40 offen offset:0
buffer_load_dwordx4 v[84:87], v66, s[4:7], s40 offen offset:64
buffer_load_dwordx4 v[88:91], v66, s[4:7], s40 offen offset:128
buffer_load_dwordx4 v[92:95], v66, s[4:7], s40 offen offset:192
buffer_load_dwordx4 v[96:99], v66, s[4:7], s40 offen offset:256
s_mul_i32 s42, s29, 384
s_add_u32 s12, s78, s42
s_addc_u32 s13, s79, 0
s_mov_b32 s15, 0x20000
s_sub_u32 s14, 7864320, s42
s_cmp_lt_u32 s28, 2
s_cselect_b32 s82, s84, s86
s_cselect_b32 s83, s85, s87
s_branch S_c0
S_o0:
s_mul_i32 s42, s29, 384
s_add_u32 s12, s78, s42
s_addc_u32 s13, s79, 0
s_mov_b32 s15, 0x20000
s_sub_u32 s14, 7864320, s42
s_cmp_lt_u32 s28, 2
s_cselect_b32 s82, s84, s86
s_cselect_b32 s83, s85, s87
buffer_load_dword v200, v63, s[96:99], 0 offen
S_c0:
s_add_u32 s56, s94, 83886080
s_addc_u32 s57, s95, 0
s_mov_b32 s58, 32768
s_mov_b32 s59, 0x20000
s_load_dwordx2 s[66:67], s[56:57], 0
v_lshrrev_b32 v28, 3, v2
v_and_b32 v29, 7, v2
v_bfe_u32 v30, v2, 4, 2
v_lshlrev_b32 v31, 1, v30
v_xor_b32 v31, v31, v29
v_lshlrev_b32 v31, 4, v31
v_lshrrev_b32 v32, 2, v28
v_lshlrev_b32 v32, 3, v32
v_and_b32 v33, 3, v28
v_add_u32 v32, v32, v33
s_lshr_b32 s42, s28, 1
s_lshl_b32 s42, s42, 5
s_and_b32 s43, s28, 1
s_lshl_b32 s43, s43, 2
s_add_u32 s42, s42, s43
v_add_u32 v32, s42, v32
v_mul_u32_u24 v32, 12288, v32
v_add_u32 v12, v32, v31
s_lshl_b32 s42, s28, 3
v_add_u32 v32, s42, v28
v_mul_u32_u24 v33, 384, v32
v_add_u32 v11, v33, v31
v_bfe_u32 v34, v32, 1, 3
v_xor_b32 v34, v34, v29
v_lshl_add_u32 v10, v34, 4, v33
s_and_b32 s43, s28, 1
s_lshl_b32 s43, s43, 5
v_lshrrev_b32 v32, 2, v28
v_lshlrev_b32 v32, 3, v32
v_and_b32 v33, 3, v28
v_add3_u32 v32, v32, v33, s43
v_mul_u32_u24 v32, 3072, v32
v_add_u32 v24, v32, v31
s_getreg_b32 s65, hwreg(HW_REG_XCC_ID)
s_xor_b32 s65, s65, 0
s_mov_b32 s33, s65
s_and_b32 s42, s29, 3
s_lshl_b32 s43, s42, 7
s_lshl_b32 s42, s42, 6
s_add_u32 s42, s42, 512
s_bitcmp0_b32 s65, 0
s_cselect_b32 s42, s43, s42
s_cselect_b32 s41, 128, 64
s_lshr_b32 s43, s29, 3
s_mul_i32 s43, s43, 768
s_add_u32 s42, s42, s43
s_lshl_b32 s64, s42, 6
s_add_u32 s64, s64, 786432
s_add_u32 s64, s64, s3
s_add_u32 s16, s82, s42
s_addc_u32 s17, s83, 0
s_mov_b32 s19, 0x20000
s_sub_u32 s18, 1966080, s42
v_and_b32 v28, 127, v24
v_mov_b32 v29, 0x10000000
v_cmp_gt_u32 vcc, s41, v28
s_nop 1
v_cndmask_b32 v13, v29, v24, vcc
s_lshl_b32 s36, s28, 11
s_lshl_b32 s37, s28, 12
s_mov_b32 s40, 0
s_add_u32 m0, s36, 0
s_nop 0
buffer_load_dwordx4 v12, s[12:15], s40 offen offset:0 lds
s_add_u32 m0, s36, 8064
s_nop 0
buffer_load_dwordx4 v12, s[12:15], s40 offen offset:128 lds
s_add_u32 m0, s36, 16128
s_nop 0
buffer_load_dwordx4 v12, s[12:15], s40 offen offset:256 lds
s_mov_b32 s40, 196608
s_add_u32 m0, s36, 1024
s_nop 0
buffer_load_dwordx4 v12, s[12:15], s40 offen offset:0 lds
s_add_u32 m0, s36, 9088
s_nop 0
buffer_load_dwordx4 v12, s[12:15], s40 offen offset:128 lds
s_add_u32 m0, s36, 17152
s_nop 0
buffer_load_dwordx4 v12, s[12:15], s40 offen offset:256 lds
s_mov_b32 s40, 0
s_add_u32 m0, s37, 24576
s_nop 0
buffer_load_dwordx4 v13, s[16:19], s40 offen lds
s_mov_b32 s40, 49152
s_add_u32 m0, s37, 25600
s_nop 0
buffer_load_dwordx4 v13, s[16:19], s40 offen lds
s_mov_b32 s40, 12288
s_add_u32 m0, s37, 26624
s_nop 0
buffer_load_dwordx4 v13, s[16:19], s40 offen lds
s_mov_b32 s40, 61440
s_add_u32 m0, s37, 27648
s_nop 0
buffer_load_dwordx4 v13, s[16:19], s40 offen lds
v_mov_b32 v28, 0x10000000
v_cmp_eq_u32 vcc, 0, v0
s_nop 1
v_cndmask_b32 v25, v28, v0, vcc
s_waitcnt lgkmcnt(0)
s_add_u32 s66, s66, 0x7f4a7c15
s_addc_u32 s67, s67, 0x9e3779b9
s_or_b32 s66, s66, 1
v_mov_b32 v26, s66
v_mov_b32 v27, s67
s_and_b32 s40, s29, 1
s_cmp_eq_u32 s40, 1
s_cbranch_scc1 S_pk1
s_mov_b32 s4, s94
s_mov_b32 s5, s95
s_mov_b32 s6, 2621440
s_mov_b32 s7, 0x20000
v_lshlrev_b32 v67, 4, v64
v_add_u32 v67, 81920, v67
s_lshl_b32 s40, s28, 2
v_add_u32 v68, s40, v67
s_waitcnt vmcnt(10)
v_lshlrev_b32 v104, 16, v80
v_and_b32 v105, 0xffff0000, v80
v_lshlrev_b32 v106, 16, v81
v_and_b32 v107, 0xffff0000, v81
v_lshlrev_b32 v108, 16, v82
v_and_b32 v109, 0xffff0000, v82
v_lshlrev_b32 v110, 16, v83
v_and_b32 v111, 0xffff0000, v83
v_lshlrev_b32 v112, 16, v84
v_and_b32 v113, 0xffff0000, v84
v_lshlrev_b32 v114, 16, v85
v_and_b32 v115, 0xffff0000, v85
v_lshlrev_b32 v116, 16, v86
v_and_b32 v117, 0xffff0000, v86
v_lshlrev_b32 v118, 16, v87
v_and_b32 v119, 0xffff0000, v87
v_lshlrev_b32 v120, 16, v88
v_and_b32 v121, 0xffff0000, v88
v_lshlrev_b32 v122, 16, v89
v_and_b32 v123, 0xffff0000, v89
v_lshlrev_b32 v124, 16, v90
v_and_b32 v125, 0xffff0000, v90
v_lshlrev_b32 v126, 16, v91
v_and_b32 v127, 0xffff0000, v91
v_lshlrev_b32 v128, 16, v92
v_and_b32 v129, 0xffff0000, v92
v_lshlrev_b32 v130, 16, v93
v_and_b32 v131, 0xffff0000, v93
v_lshlrev_b32 v132, 16, v94
v_and_b32 v133, 0xffff0000, v94
v_lshlrev_b32 v134, 16, v95
v_and_b32 v135, 0xffff0000, v95
v_lshlrev_b32 v136, 16, v96
v_and_b32 v137, 0xffff0000, v96
v_lshlrev_b32 v138, 16, v97
v_and_b32 v139, 0xffff0000, v97
v_lshlrev_b32 v140, 16, v98
v_and_b32 v141, 0xffff0000, v98
v_lshlrev_b32 v142, 16, v99
v_and_b32 v143, 0xffff0000, v99
v_pk_add_f32 v[70:71], v[104:105], v[106:107]
v_pk_add_f32 v[72:73], v[108:109], v[110:111]
v_pk_add_f32 v[70:71], v[70:71], v[112:113]
v_pk_add_f32 v[72:73], v[72:73], v[114:115]
v_pk_add_f32 v[70:71], v[70:71], v[116:117]
v_pk_add_f32 v[72:73], v[72:73], v[118:119]
v_pk_add_f32 v[70:71], v[70:71], v[120:121]
v_pk_add_f32 v[72:73], v[72:73], v[122:123]
v_pk_add_f32 v[70:71], v[70:71], v[124:125]
v_pk_add_f32 v[72:73], v[72:73], v[126:127]
v_pk_add_f32 v[70:71], v[70:71], v[128:129]
v_pk_add_f32 v[72:73], v[72:73], v[130:131]
v_pk_add_f32 v[70:71], v[70:71], v[132:133]
v_pk_add_f32 v[72:73], v[72:73], v[134:135]
v_pk_add_f32 v[70:71], v[70:71], v[136:137]
v_pk_add_f32 v[72:73], v[72:73], v[138:139]
v_pk_add_f32 v[70:71], v[70:71], v[140:141]
v_pk_add_f32 v[72:73], v[72:73], v[142:143]
v_pk_add_f32 v[70:71], v[70:71], v[72:73]
v_add_f32 v70, v70, v71
v_mov_b32 v71, v70
s_nop 1
v_permlane32_swap_b32 v70, v71
s_nop 1
v_add_f32 v70, v70, v71
v_mov_b32 v71, v70
s_nop 1
v_permlane16_swap_b32 v70, v71
s_nop 1
v_add_f32 v70, v70, v71
v_mul_f32 v70, 0xbbcccccd, v70
v_mov_b32 v71, v70
v_pk_add_f32 v[74:75], v[104:105], v[70:71]
v_pk_add_f32 v[76:77], v[106:107], v[70:71]
v_pk_mul_f32 v[72:73], v[74:75], v[74:75]
v_pk_mul_f32 v[78:79], v[76:77], v[76:77]
v_pk_add_f32 v[74:75], v[108:109], v[70:71]
v_pk_add_f32 v[76:77], v[110:111], v[70:71]
v_pk_fma_f32 v[72:73], v[74:75], v[74:75], v[72:73]
v_pk_fma_f32 v[78:79], v[76:77], v[76:77], v[78:79]
v_pk_add_f32 v[74:75], v[112:113], v[70:71]
v_pk_add_f32 v[76:77], v[114:115], v[70:71]
v_pk_fma_f32 v[72:73], v[74:75], v[74:75], v[72:73]
v_pk_fma_f32 v[78:79], v[76:77], v[76:77], v[78:79]
v_pk_add_f32 v[74:75], v[116:117], v[70:71]
v_pk_add_f32 v[76:77], v[118:119], v[70:71]
v_pk_fma_f32 v[72:73], v[74:75], v[74:75], v[72:73]
v_pk_fma_f32 v[78:79], v[76:77], v[76:77], v[78:79]
v_pk_add_f32 v[74:75], v[120:121], v[70:71]
v_pk_add_f32 v[76:77], v[122:123], v[70:71]
v_pk_fma_f32 v[72:73], v[74:75], v[74:75], v[72:73]
v_pk_fma_f32 v[78:79], v[76:77], v[76:77], v[78:79]
v_pk_add_f32 v[74:75], v[124:125], v[70:71]
v_pk_add_f32 v[76:77], v[126:127], v[70:71]
v_pk_fma_f32 v[72:73], v[74:75], v[74:75], v[72:73]
v_pk_fma_f32 v[78:79], v[76:77], v[76:77], v[78:79]
v_pk_add_f32 v[74:75], v[128:129], v[70:71]
v_pk_add_f32 v[76:77], v[130:131], v[70:71]
v_pk_fma_f32 v[72:73], v[74:75], v[74:75], v[72:73]
v_pk_fma_f32 v[78:79], v[76:77], v[76:77], v[78:79]
v_pk_add_f32 v[74:75], v[132:133], v[70:71]
v_pk_add_f32 v[76:77], v[134:135], v[70:71]
v_pk_fma_f32 v[72:73], v[74:75], v[74:75], v[72:73]
v_pk_fma_f32 v[78:79], v[76:77], v[76:77], v[78:79]
v_pk_add_f32 v[74:75], v[136:137], v[70:71]
v_pk_add_f32 v[76:77], v[138:139], v[70:71]
v_pk_fma_f32 v[72:73], v[74:75], v[74:75], v[72:73]
v_pk_fma_f32 v[78:79], v[76:77], v[76:77], v[78:79]
v_pk_add_f32 v[74:75], v[140:141], v[70:71]
v_pk_add_f32 v[76:77], v[142:143], v[70:71]
v_pk_fma_f32 v[72:73], v[74:75], v[74:75], v[72:73]
v_pk_fma_f32 v[78:79], v[76:77], v[76:77], v[78:79]
v_pk_add_f32 v[72:73], v[72:73], v[78:79]
v_add_f32 v71, v72, v73
v_mov_b32 v72, v71
s_nop 1
v_permlane32_swap_b32 v71, v72
s_nop 1
v_add_f32 v71, v71, v72
v_mov_b32 v72, v71
s_nop 1
v_permlane16_swap_b32 v71, v72
s_nop 1
v_add_f32 v71, v71, v72
ds_write_b32 v68, v70
ds_write_b32 v68, v71 offset:256
s_waitcnt lgkmcnt(0)
s_barrier
ds_read_b128 v[72:75], v67
ds_read_b128 v[76:79], v67 offset:256
s_waitcnt lgkmcnt(0)
v_add_f32 v70, v72, v73
v_add_f32 v71, v74, v75
v_add_f32 v70, v70, v71
v_mul_f32 v71, 0xbe800000, v70
v_add_f32 v76, v76, v77
v_add_f32 v78, v78, v79
v_add_f32 v76, v76, v78
v_add_f32 v72, v72, v71
v_add_f32 v73, v73, v71
v_add_f32 v74, v74, v71
v_add_f32 v75, v75, v71
v_mul_f32 v72, v72, v72
v_fmac_f32 v72, v73, v73
v_fmac_f32 v72, v74, v74
v_fmac_f32 v72, v75, v75
v_mul_f32 v76, 0x3acccccd, v76
v_fmac_f32 v76, 0x3e800000, v72
v_mov_b32 v72, v76
v_cvt_pk_bf16_f32 v73, v71, v72
v_lshlrev_b32 v71, 16, v73
v_and_b32 v72, 0xffff0000, v73
v_add_f32 v72, 0x3727c5ac, v72
v_cvt_pk_bf16_f32 v72, v72, v72
v_lshlrev_b32 v72, 16, v72
v_sqrt_f32 v72, v72
s_nop 0
v_cvt_pk_bf16_f32 v72, v72, v72
v_lshlrev_b32 v72, 16, v72
v_rcp_f32 v72, v72
s_lshr_b32 s40, s45, 2
s_mul_i32 s40, s40, 81920
s_and_b32 s41, s45, 3
s_lshl_b32 s41, s41, 10
s_add_u32 s40, s40, s41
s_mul_i32 s41, s28, 20480
s_add_u32 s40, s40, s41
v_sub_f32 v70, 0, v71
v_mov_b32 v71, v70
v_mov_b32 v73, v72
v_pk_add_f32 v[74:75], v[104:105], v[70:71]
v_cvt_pk_bf16_f32 v74, v74, v75
v_and_b32 v75, 0xffff0000, v74
v_lshlrev_b32 v74, 16, v74
v_pk_mul_f32 v[74:75], v[74:75], v[72:73]
v_cvt_pk_bf16_f32 v80, v74, v75
v_pk_add_f32 v[76:77], v[106:107], v[70:71]
v_cvt_pk_bf16_f32 v76, v76, v77
v_and_b32 v77, 0xffff0000, v76
v_lshlrev_b32 v76, 16, v76
v_pk_mul_f32 v[76:77], v[76:77], v[72:73]
v_cvt_pk_bf16_f32 v81, v76, v77
v_pk_add_f32 v[74:75], v[108:109], v[70:71]
v_cvt_pk_bf16_f32 v74, v74, v75
v_and_b32 v75, 0xffff0000, v74
v_lshlrev_b32 v74, 16, v74
v_pk_mul_f32 v[74:75], v[74:75], v[72:73]
v_cvt_pk_bf16_f32 v82, v74, v75
v_pk_add_f32 v[76:77], v[110:111], v[70:71]
v_cvt_pk_bf16_f32 v76, v76, v77
v_and_b32 v77, 0xffff0000, v76
v_lshlrev_b32 v76, 16, v76
v_pk_mul_f32 v[76:77], v[76:77], v[72:73]
v_cvt_pk_bf16_f32 v83, v76, v77
buffer_store_dwordx4 v[80:83], v3, s[4:7], s40 offen sc1
s_add_u32 s40, s40, 4096
v_pk_add_f32 v[74:75], v[112:113], v[70:71]
v_cvt_pk_bf16_f32 v74, v74, v75
v_and_b32 v75, 0xffff0000, v74
v_lshlrev_b32 v74, 16, v74
v_pk_mul_f32 v[74:75], v[74:75], v[72:73]
v_cvt_pk_bf16_f32 v84, v74, v75
v_pk_add_f32 v[76:77], v[114:115], v[70:71]
v_cvt_pk_bf16_f32 v76, v76, v77
v_and_b32 v77, 0xffff0000, v76
v_lshlrev_b32 v76, 16, v76
v_pk_mul_f32 v[76:77], v[76:77], v[72:73]
v_cvt_pk_bf16_f32 v85, v76, v77
v_pk_add_f32 v[74:75], v[116:117], v[70:71]
v_cvt_pk_bf16_f32 v74, v74, v75
v_and_b32 v75, 0xffff0000, v74
v_lshlrev_b32 v74, 16, v74
v_pk_mul_f32 v[74:75], v[74:75], v[72:73]
v_cvt_pk_bf16_f32 v86, v74, v75
v_pk_add_f32 v[76:77], v[118:119], v[70:71]
v_cvt_pk_bf16_f32 v76, v76, v77
v_and_b32 v77, 0xffff0000, v76
v_lshlrev_b32 v76, 16, v76
v_pk_mul_f32 v[76:77], v[76:77], v[72:73]
v_cvt_pk_bf16_f32 v87, v76, v77
buffer_store_dwordx4 v[84:87], v3, s[4:7], s40 offen sc1
s_add_u32 s40, s40, 4096
v_pk_add_f32 v[74:75], v[120:121], v[70:71]
v_cvt_pk_bf16_f32 v74, v74, v75
v_and_b32 v75, 0xffff0000, v74
v_lshlrev_b32 v74, 16, v74
v_pk_mul_f32 v[74:75], v[74:75], v[72:73]
v_cvt_pk_bf16_f32 v88, v74, v75
v_pk_add_f32 v[76:77], v[122:123], v[70:71]
v_cvt_pk_bf16_f32 v76, v76, v77
v_and_b32 v77, 0xffff0000, v76
v_lshlrev_b32 v76, 16, v76
v_pk_mul_f32 v[76:77], v[76:77], v[72:73]
v_cvt_pk_bf16_f32 v89, v76, v77
v_pk_add_f32 v[74:75], v[124:125], v[70:71]
v_cvt_pk_bf16_f32 v74, v74, v75
v_and_b32 v75, 0xffff0000, v74
v_lshlrev_b32 v74, 16, v74
v_pk_mul_f32 v[74:75], v[74:75], v[72:73]
v_cvt_pk_bf16_f32 v90, v74, v75
v_pk_add_f32 v[76:77], v[126:127], v[70:71]
v_cvt_pk_bf16_f32 v76, v76, v77
v_and_b32 v77, 0xffff0000, v76
v_lshlrev_b32 v76, 16, v76
v_pk_mul_f32 v[76:77], v[76:77], v[72:73]
v_cvt_pk_bf16_f32 v91, v76, v77
buffer_store_dwordx4 v[88:91], v3, s[4:7], s40 offen sc1
s_add_u32 s40, s40, 4096
v_pk_add_f32 v[74:75], v[128:129], v[70:71]
v_cvt_pk_bf16_f32 v74, v74, v75
v_and_b32 v75, 0xffff0000, v74
v_lshlrev_b32 v74, 16, v74
v_pk_mul_f32 v[74:75], v[74:75], v[72:73]
v_cvt_pk_bf16_f32 v92, v74, v75
v_pk_add_f32 v[76:77], v[130:131], v[70:71]
v_cvt_pk_bf16_f32 v76, v76, v77
v_and_b32 v77, 0xffff0000, v76
v_lshlrev_b32 v76, 16, v76
v_pk_mul_f32 v[76:77], v[76:77], v[72:73]
v_cvt_pk_bf16_f32 v93, v76, v77
v_pk_add_f32 v[74:75], v[132:133], v[70:71]
v_cvt_pk_bf16_f32 v74, v74, v75
v_and_b32 v75, 0xffff0000, v74
v_lshlrev_b32 v74, 16, v74
v_pk_mul_f32 v[74:75], v[74:75], v[72:73]
v_cvt_pk_bf16_f32 v94, v74, v75
v_pk_add_f32 v[76:77], v[134:135], v[70:71]
v_cvt_pk_bf16_f32 v76, v76, v77
v_and_b32 v77, 0xffff0000, v76
v_lshlrev_b32 v76, 16, v76
v_pk_mul_f32 v[76:77], v[76:77], v[72:73]
v_cvt_pk_bf16_f32 v95, v76, v77
buffer_store_dwordx4 v[92:95], v3, s[4:7], s40 offen sc1
s_add_u32 s40, s40, 4096
v_pk_add_f32 v[74:75], v[136:137], v[70:71]
v_cvt_pk_bf16_f32 v74, v74, v75
v_and_b32 v75, 0xffff0000, v74
v_lshlrev_b32 v74, 16, v74
v_pk_mul_f32 v[74:75], v[74:75], v[72:73]
v_cvt_pk_bf16_f32 v96, v74, v75
v_pk_add_f32 v[76:77], v[138:139], v[70:71]
v_cvt_pk_bf16_f32 v76, v76, v77
v_and_b32 v77, 0xffff0000, v76
v_lshlrev_b32 v76, 16, v76
v_pk_mul_f32 v[76:77], v[76:77], v[72:73]
v_cvt_pk_bf16_f32 v97, v76, v77
v_pk_add_f32 v[74:75], v[140:141], v[70:71]
v_cvt_pk_bf16_f32 v74, v74, v75
v_and_b32 v75, 0xffff0000, v74
v_lshlrev_b32 v74, 16, v74
v_pk_mul_f32 v[74:75], v[74:75], v[72:73]
v_cvt_pk_bf16_f32 v98, v74, v75
v_pk_add_f32 v[76:77], v[142:143], v[70:71]
v_cvt_pk_bf16_f32 v76, v76, v77
v_and_b32 v77, 0xffff0000, v76
v_lshlrev_b32 v76, 16, v76
v_pk_mul_f32 v[76:77], v[76:77], v[72:73]
v_cvt_pk_bf16_f32 v99, v76, v77
buffer_store_dwordx4 v[96:99], v3, s[4:7], s40 offen sc1
s_add_u32 s40, s40, 4096
s_lshr_b32 s41, s45, 2
s_lshl_b32 s41, s41, 7
s_and_b32 s40, s45, 3
s_lshl_b32 s40, s40, 3
s_add_u32 s41, s41, s40
s_add_u32 s41, s41, 24576
s_xor_b32 s40, s33, s2
s_or_b32 s40, s40, 0xfffffffe
s_and_b32 s40, s40, s66
v_mov_b32 v70, s40
v_mov_b32 v71, s67
s_waitcnt vmcnt(0)
s_barrier
buffer_store_dwordx2 v[70:71], v25, s[56:59], s41 offen sc1
S_pk1:
s_lshl_b32 s40, s38, 3
s_lshl_b32 s41, s28, 1
s_add_u32 s41, s41, s40
v_and_b32 v28, 1, v2
v_lshrrev_b32 v29, 1, v2
v_add_u32 v30, s41, v28
v_mul_u32_u24 v30, 12288, v30
v_lshl_add_u32 v30, v29, 7, v30
v_mov_b32 v31, 0x10000000
v_cmp_gt_u32 vcc, 6, v2
s_nop 1
v_cndmask_b32 v44, v31, v30, vcc
s_and_b32 s41, s28, 1
s_lshl_b32 s41, s41, 2
s_add_u32 s41, s41, s40
v_add_u32 v30, s41, v29
v_mul_u32_u24 v30, 3072, v30
v_mul_u32_u24 v28, 60, v28
v_add_u32 v30, v30, v28
v_cmp_gt_u32 vcc, 8, v2
s_nop 1
v_cndmask_b32 v45, v31, v30, vcc
s_lshl_b32 s43, s38, 5
s_add_u32 s43, s43, s29
s_cmp_lt_u32 s43, 192
s_cselect_b32 s60, s80, s88
s_cselect_b32 s61, s81, s89
s_mov_b32 s40, 7864320
s_cselect_b32 s62, s40, 1966080
s_mov_b32 s63, 0x20000
s_cselect_b32 s40, 0, 192
s_sub_u32 s40, s43, s40
s_mul_i32 s40, s40, 40960
s_mul_i32 s71, s28, 10240
s_add_u32 s70, s40, s71
s_add_u32 s71, s71, 122880
s_mul_i32 s69, s28, 480
s_add_u32 s69, s69, s43
s_mul_i32 s69, s69, 5120
s_cmp_lt_u32 s43, 240
s_cselect_b32 s69, s69, 0x10000000
v_lshrrev_b32 v28, 3, v2
v_mul_u32_u24 v28, 1280, v28
v_bfe_u32 v29, v2, 4, 2
v_lshlrev_b32 v29, 1, v29
v_and_b32 v30, 7, v2
v_xor_b32 v29, v29, v30
v_lshl_add_u32 v54, v29, 4, v28
v_lshrrev_b32 v28, 5, v2
v_mul_u32_u24 v28, 10240, v28
v_bfe_u32 v29, v2, 2, 3
v_lshl_add_u32 v28, v29, 7, v28
v_and_b32 v29, 3, v2
v_lshl_add_u32 v28, v29, 3, v28
v_bfe_u32 v29, v2, 3, 2
s_mul_i32 s40, s28, 10
s_add_u32 s41, s40, 0
s_and_b32 s42, s41, 3
s_lshr_b32 s41, s41, 2
s_lshl_b32 s41, s41, 10
s_add_u32 s41, s41, 122880
v_xor_b32 v30, s42, v29
v_lshl_add_u32 v30, v30, 5, v28
v_add_u32 v55, s41, v30
s_add_u32 s41, s40, 1
s_and_b32 s42, s41, 3
s_lshr_b32 s41, s41, 2
s_lshl_b32 s41, s41, 10
s_add_u32 s41, s41, 122880
v_xor_b32 v30, s42, v29
v_lshl_add_u32 v30, v30, 5, v28
v_add_u32 v56, s41, v30
s_add_u32 s41, s40, 2
s_and_b32 s42, s41, 3
s_lshr_b32 s41, s41, 2
s_lshl_b32 s41, s41, 10
s_add_u32 s41, s41, 122880
v_xor_b32 v30, s42, v29
v_lshl_add_u32 v30, v30, 5, v28
v_add_u32 v57, s41, v30
s_add_u32 s41, s40, 3
s_and_b32 s42, s41, 3
s_lshr_b32 s41, s41, 2
s_lshl_b32 s41, s41, 10
s_add_u32 s41, s41, 122880
v_xor_b32 v30, s42, v29
v_lshl_add_u32 v30, v30, 5, v28
v_add_u32 v58, s41, v30
v_add_u32 v59, 1227776, v3
s_lshr_b32 s39, s29, 3
s_and_b32 s40, s28, 1
s_mul_i32 s68, s40, 5120
s_lshr_b32 s44, s3, 10
s_lshr_b32 s41, s28, 1
s_lshl_b32 s42, s38, 2
s_add_u32 s43, s28, s42
s_mul_i32 s100, s29, 24576
s_add_u32 s100, s100, s3
s_lshr_b32 s40, s39, 1
s_xor_b32 s40, s40, s41
s_and_b32 s42, s29, 3
s_lshl_b32 s45, s42, 1
s_add_u32 s40, s40, s45
s_mul_i32 s40, s40, 1228800
s_add_u32 s101, s40, 4194304
s_mul_i32 s52, s28, 5120
s_lshl_b32 s43, s43, 2
s_add_u32 s43, s43, s44
s_mul_i32 s53, s43, 20480
s_mul_i32 s42, s42, 320
s_add_u32 s53, s53, s42
s_lshr_b32 s40, s39, 1
s_mul_i32 s40, s40, 160
s_add_u32 s53, s53, s40
s_lshl_b32 s55, s38, 3
s_and_b32 s40, s29, 7
s_add_u32 s55, s55, s40
s_mul_i32 s54, s55, 245760
s_mul_i32 s40, s28, 2560
s_add_u32 s54, s54, s40
s_lshl_b32 s49, s28, 2
s_add_u32 s49, s49, 118784
s_and_b32 s40, s29, 28
s_xor_b32 s41, s40, 4
s_add_u32 s78, s41, 0
s_add_u32 s79, s41, 1
s_add_u32 s80, s41, 2
s_add_u32 s81, s41, 3
s_add_u32 s84, s40, 0
s_cmp_ge_u32 s84, s29
s_addc_u32 s84, s84, 0
s_add_u32 s85, s40, 1
s_cmp_ge_u32 s85, s29
s_addc_u32 s85, s85, 0
s_add_u32 s86, s40, 2
s_cmp_ge_u32 s86, s29
s_addc_u32 s86, s86, 0
s_mov_b32 s87, 0
s_lshl_b32 s46, s38, 2
s_add_u32 s46, s46, s39
s_lshl_b32 s46, s46, 7
s_add_u32 s46, s46, 4096
s_lshl_b32 s47, s38, 5
s_add_u32 s47, s47, s29
s_lshl_b32 s47, s47, 3
s_add_u32 s47, s47, 2048
s_lshl_b32 s48, s55, 7
s_add_u32 s48, s48, 8192
v_lshrrev_b32 v28, 2, v2
v_and_b32 v29, 3, v2
v_bfe_u32 v30, v2, 3, 2
v_lshlrev_b32 v31, 7, v28
v_lshlrev_b32 v32, 1, v30
v_xor_b32 v32, v32, v29
v_lshl_add_u32 v14, v32, 4, v31
v_xor_b32 v15, 64, v14
v_add_u32 v16, 81920, v14
v_add_u32 v17, 81920, v15
v_lshl_add_u32 v32, v30, 5, v31
v_lshl_add_u32 v32, v29, 3, v32
v_add_u32 v6, 65536, v32
v_xor_b32 v7, 32, v6
v_xor_b32 v8, 64, v6
v_xor_b32 v9, 96, v6
v_subrev_u32 v18, 40960, v6
v_add_u32 v50, 40960, v6
v_subrev_u32 v19, 40960, v7
v_add_u32 v51, 40960, v7
v_subrev_u32 v20, 40960, v8
v_add_u32 v52, 40960, v8
v_subrev_u32 v21, 40960, v9
v_add_u32 v53, 40960, v9
v_add_u32 v23, 12288, v11
v_lshlrev_b32 v60, 3, v29
v_and_b32 v28, 15, v2
v_lshrrev_b32 v29, 4, v2
v_bfe_u32 v30, v2, 1, 3
v_xor_b32 v29, v29, v30
v_lshlrev_b32 v28, 7, v28
v_lshl_add_u32 v28, v29, 4, v28
v_add_u32 v4, 114688, v28
v_xor_b32 v5, 64, v4
v_and_b32 v61, 7, v2
v_lshlrev_b32 v61, 3, v61
s_lshl_b32 s41, s38, 2
s_add_u32 s41, s41, s28
s_mul_i32 s42, s41, 81920
s_add_u32 s20, s94, s42
s_addc_u32 s21, s95, 0
s_mov_b32 s22, 81920
s_mov_b32 s23, 0x20000
s_mul_i32 s42, s41, 983040
s_add_u32 s42, s42, 16777216
s_add_u32 s24, s94, s42
s_addc_u32 s25, s95, 0
s_mov_b32 s26, 983040
s_mov_b32 s27, 0x20000
s_lshl_b32 s44, s38, 9
s_add_u32 s44, s44, 24576
s_lshl_b32 s42, s28, 7
v_add_u32 v250, s42, v60
v_cmp_gt_u32 vcc, 4, v2
s_nop 1
v_cndmask_b32 v250, 0, v250, vcc
s_lshl_b32 s42, s28, 10
s_add_u32 s30, s42, 114688
s_add_u32 s31, s42, 65536
s_mul_i32 s42, s29, 786432
s_add_u32 s4, s74, s42
s_addc_u32 s5, s75, 0
s_mov_b32 s6, 786432
s_mov_b32 s7, 0x20000
s_add_u32 s8, s76, s42
s_addc_u32 s9, s77, 0
s_mov_b32 s10, 786432
s_mov_b32 s11, 0x20000
s_bitcmp0_b32 s29, 0
s_cbranch_scc1 S_e0
s_mov_b32 s40, 1572864
buffer_load_dword v46, v44, s[12:15], s40 offen
s_mov_b32 s40, 393216
buffer_load_dword v47, v45, s[16:19], s40 offen
s_mov_b32 s40, 2359296
buffer_load_dword v48, v44, s[12:15], s40 offen
s_mov_b32 s40, 589824
buffer_load_dword v49, v45, s[16:19], s40 offen
s_mov_b32 s40, 786432
s_add_u32 m0, s36, 40960
s_nop 0
buffer_load_dwordx4 v12, s[12:15], s40 offen offset:0 lds
s_add_u32 m0, s36, 49024
s_nop 0
buffer_load_dwordx4 v12, s[12:15], s40 offen offset:128 lds
s_add_u32 m0, s36, 57088
s_nop 0
buffer_load_dwordx4 v12, s[12:15], s40 offen offset:256 lds
s_mov_b32 s40, 983040
s_add_u32 m0, s36, 41984
s_nop 0
buffer_load_dwordx4 v12, s[12:15], s40 offen offset:0 lds
s_add_u32 m0, s36, 50048
s_nop 0
buffer_load_dwordx4 v12, s[12:15], s40 offen offset:128 lds
s_add_u32 m0, s36, 58112
s_nop 0
buffer_load_dwordx4 v12, s[12:15], s40 offen offset:256 lds
s_mov_b32 s40, 196608
s_add_u32 m0, s37, 65536
s_nop 0
buffer_load_dwordx4 v13, s[16:19], s40 offen lds
s_mov_b32 s40, 245760
s_add_u32 m0, s37, 66560
s_nop 0
buffer_load_dwordx4 v13, s[16:19], s40 offen lds
s_mov_b32 s40, 208896
s_add_u32 m0, s37, 67584
s_nop 0
buffer_load_dwordx4 v13, s[16:19], s40 offen lds
s_mov_b32 s40, 258048
s_add_u32 m0, s37, 68608
s_nop 0
buffer_load_dwordx4 v13, s[16:19], s40 offen lds
S_e0:
s_mov_b32 s42, 0
A_pl:
buffer_load_dwordx2 v[248:249], v250, s[56:59], s44 offen sc1
s_waitcnt vmcnt(0)
A_pl_chk:
v_readlane_b32 s65, v248, 4
v_or_b32 v248, 1, v248
v_cmp_ne_u64 vcc, v[26:27], v[248:249]
s_nop 4
s_cbranch_vccz A_pl_ok
s_sleep 8
s_add_u32 s42, s42, 1
s_cmp_lt_u32 s42, 0x40000
s_cbranch_scc1 A_pl
A_pl_ok:
s_xor_b32 s65, s65, s2
s_xor_b32 s33, s33, s65
s_bitcmp1_b32 s33, 0
s_cbranch_scc1 S_redo
S_rok:
s_xor_b32 s41, s3, 0
buffer_load_dwordx4 a[128:131], v3, s[20:23], s41 offen sc1
s_xor_b32 s41, s3, 1024
buffer_load_dwordx4 a[132:135], v3, s[20:23], s41 offen sc1
s_xor_b32 s41, s3, 2048
buffer_load_dwordx4 a[136:139], v3, s[20:23], s41 offen sc1
s_xor_b32 s41, s3, 3072
buffer_load_dwordx4 a[140:143], v3, s[20:23], s41 offen sc1
s_xor_b32 s41, s3, 4096
buffer_load_dwordx4 a[144:147], v3, s[20:23], s41 offen sc1
s_xor_b32 s41, s3, 5120
buffer_load_dwordx4 a[148:151], v3, s[20:23], s41 offen sc1
s_xor_b32 s41, s3, 6144
buffer_load_dwordx4 a[152:155], v3, s[20:23], s41 offen sc1
s_xor_b32 s41, s3, 7168
buffer_load_dwordx4 a[156:159], v3, s[20:23], s41 offen sc1
s_xor_b32 s41, s3, 8192
buffer_load_dwordx4 a[160:163], v3, s[20:23], s41 offen sc1
s_xor_b32 s41, s3, 9216
buffer_load_dwordx4 a[164:167], v3, s[20:23], s41 offen sc1
s_xor_b32 s41, s3, 10240
buffer_load_dwordx4 a[168:171], v3, s[20:23], s41 offen sc1
s_xor_b32 s41, s3, 11264
buffer_load_dwordx4 a[172:175], v3, s[20:23], s41 offen sc1
s_xor_b32 s41, s3, 12288
buffer_load_dwordx4 a[176:179], v3, s[20:23], s41 offen sc1
s_xor_b32 s41, s3, 13312
buffer_load_dwordx4 a[180:183], v3, s[20:23], s41 offen sc1
s_xor_b32 s41, s3, 14336
buffer_load_dwordx4 a[184:187], v3, s[20:23], s41 offen sc1
s_xor_b32 s41, s3, 15360
buffer_load_dwordx4 a[188:191], v3, s[20:23], s41 offen sc1
s_barrier
ds_read_b64_tr_b16 a[224:225], v14 offset:0
ds_read_b64_tr_b16 a[226:227], v14 offset:2048
ds_read_b64_tr_b16 a[228:229], v14 offset:4096
ds_read_b64_tr_b16 a[230:231], v14 offset:6144
ds_read_b64_tr_b16 a[232:233], v14 offset:8
ds_read_b64_tr_b16 a[234:235], v14 offset:2056
ds_read_b64_tr_b16 a[236:237], v14 offset:4104
ds_read_b64_tr_b16 a[238:239], v14 offset:6152
s_bitcmp1_b32 s29, 0
s_cbranch_scc1 S_o1
s_mov_b32 s40, 1572864
buffer_load_dword v46, v44, s[12:15], s40 offen
s_mov_b32 s40, 393216
buffer_load_dword v47, v45, s[16:19], s40 offen
s_mov_b32 s40, 2359296
buffer_load_dword v48, v44, s[12:15], s40 offen
s_mov_b32 s40, 589824
buffer_load_dword v49, v45, s[16:19], s40 offen
s_mov_b32 s40, 786432
s_add_u32 m0, s36, 40960
s_nop 0
buffer_load_dwordx4 v12, s[12:15], s40 offen offset:0 lds
s_add_u32 m0, s36, 49024
s_nop 0
buffer_load_dwordx4 v12, s[12:15], s40 offen offset:128 lds
s_add_u32 m0, s36, 57088
s_nop 0
buffer_load_dwordx4 v12, s[12:15], s40 offen offset:256 lds
s_mov_b32 s40, 983040
s_add_u32 m0, s36, 41984
s_nop 0
buffer_load_dwordx4 v12, s[12:15], s40 offen offset:0 lds
s_add_u32 m0, s36, 50048
s_nop 0
buffer_load_dwordx4 v12, s[12:15], s40 offen offset:128 lds
s_add_u32 m0, s36, 58112
s_nop 0
buffer_load_dwordx4 v12, s[12:15], s40 offen offset:256 lds
s_mov_b32 s40, 196608
s_add_u32 m0, s37, 65536
s_nop 0
buffer_load_dwordx4 v13, s[16:19], s40 offen lds
s_mov_b32 s40, 245760
s_add_u32 m0, s37, 66560
s_nop 0
buffer_load_dwordx4 v13, s[16:19], s40 offen lds
s_mov_b32 s40, 208896
s_add_u32 m0, s37, 67584
s_nop 0
buffer_load_dwordx4 v13, s[16:19], s40 offen lds
s_mov_b32 s40, 258048
s_add_u32 m0, s37, 68608
s_nop 0
buffer_load_dwordx4 v13, s[16:19], s40 offen lds
s_waitcnt vmcnt(22)
s_branch S_c2
S_o1:
s_waitcnt vmcnt(8)
S_c2:
s_waitcnt lgkmcnt(4)
s_bitcmp1_b32 s65, 0
s_cbranch_scc1 A_light
v_mfma_f32_16x16x32_bf16 v[64:67], a[224:227], a[128:131], 0
ds_read_b64_tr_b16 a[240:241], v15 offset:0
v_mfma_f32_16x16x32_bf16 v[64:67], a[228:231], a[144:147], v[64:67]
ds_read_b64_tr_b16 a[242:243], v15 offset:2048
v_mfma_f32_16x16x32_bf16 v[68:71], a[228:231], a[148:151], 0
s_mov_b32 s40, 3145728
v_mfma_f32_16x16x32_bf16 v[68:71], a[224:227], a[132:135], v[68:71]
buffer_load_dword v46, v44, s[12:15], s40 offen
v_mfma_f32_16x16x32_bf16 v[72:75], a[224:227], a[136:139], 0
ds_read_b64_tr_b16 a[244:245], v15 offset:4096
v_mfma_f32_16x16x32_bf16 v[72:75], a[228:231], a[152:155], v[72:75]
ds_read_b64_tr_b16 a[246:247], v15 offset:6144
v_mfma_f32_16x16x32_bf16 v[76:79], a[228:231], a[156:159], 0
s_mov_b32 s40, 786432
v_mfma_f32_16x16x32_bf16 v[76:79], a[224:227], a[140:143], v[76:79]
s_waitcnt lgkmcnt(4)
buffer_load_dword v47, v45, s[16:19], s40 offen
v_mfma_f32_16x16x32_bf16 v[80:83], a[232:235], a[128:131], 0
ds_read_b64_tr_b16 a[248:249], v15 offset:8
v_mfma_f32_16x16x32_bf16 v[80:83], a[236:239], a[144:147], v[80:83]
s_mov_b32 s40, 1572864
ds_read_b64_tr_b16 a[250:251], v15 offset:2056
v_mfma_f32_16x16x32_bf16 v[84:87], a[236:239], a[148:151], 0
s_add_u32 m0, s36, 81920
v_mfma_f32_16x16x32_bf16 v[84:87], a[232:235], a[132:135], v[84:87]
buffer_load_dwordx4 v12, s[12:15], s40 offen offset:0 lds
v_mfma_f32_16x16x32_bf16 v[88:91], a[232:235], a[136:139], 0
ds_read_b64_tr_b16 a[252:253], v15 offset:4104
v_mfma_f32_16x16x32_bf16 v[88:91], a[236:239], a[152:155], v[88:91]
ds_read_b64_tr_b16 a[254:255], v15 offset:6152
v_mfma_f32_16x16x32_bf16 v[92:95], a[236:239], a[156:159], 0
s_add_u32 m0, s36, 89984
v_mfma_f32_16x16x32_bf16 v[92:95], a[232:235], a[140:143], v[92:95]
s_waitcnt lgkmcnt(4)
buffer_load_dwordx4 v12, s[12:15], s40 offen offset:128 lds
v_mfma_f32_16x16x32_bf16 v[96:99], a[240:243], a[128:131], 0
ds_read_b64_tr_b16 a[224:225], v14 offset:8192
v_mfma_f32_16x16x32_bf16 v[96:99], a[244:247], a[144:147], v[96:99]
ds_read_b64_tr_b16 a[226:227], v14 offset:10240
v_mfma_f32_16x16x32_bf16 v[100:103], a[244:247], a[148:151], 0
s_add_u32 m0, s36, 98048
v_mfma_f32_16x16x32_bf16 v[100:103], a[240:243], a[132:135], v[100:103]
buffer_load_dwordx4 v12, s[12:15], s40 offen offset:256 lds
v_mfma_f32_16x16x32_bf16 v[104:107], a[240:243], a[136:139], 0
ds_read_b64_tr_b16 a[228:229], v14 offset:12288
v_mfma_f32_16x16x32_bf16 v[104:107], a[244:247], a[152:155], v[104:107]
s_mov_b32 s40, 1769472
ds_read_b64_tr_b16 a[230:231], v14 offset:14336
v_mfma_f32_16x16x32_bf16 v[108:111], a[244:247], a[156:159], 0
s_add_u32 m0, s36, 82944
v_mfma_f32_16x16x32_bf16 v[108:111], a[240:243], a[140:143], v[108:111]
s_waitcnt lgkmcnt(4)
buffer_load_dwordx4 v12, s[12:15], s40 offen offset:0 lds
v_mfma_f32_16x16x32_bf16 v[112:115], a[248:251], a[128:131], 0
ds_read_b64_tr_b16 a[232:233], v14 offset:8200
v_mfma_f32_16x16x32_bf16 v[112:115], a[252:255], a[144:147], v[112:115]
ds_read_b64_tr_b16 a[234:235], v14 offset:10248
v_mfma_f32_16x16x32_bf16 v[116:119], a[252:255], a[148:151], 0
s_add_u32 m0, s36, 91008
v_mfma_f32_16x16x32_bf16 v[116:119], a[248:251], a[132:135], v[116:119]
buffer_load_dwordx4 v12, s[12:15], s40 offen offset:128 lds
v_mfma_f32_16x16x32_bf16 v[120:123], a[248:251], a[136:139], 0
ds_read_b64_tr_b16 a[236:237], v14 offset:12296
v_mfma_f32_16x16x32_bf16 v[120:123], a[252:255], a[152:155], v[120:123]
ds_read_b64_tr_b16 a[238:239], v14 offset:14344
v_mfma_f32_16x16x32_bf16 v[124:127], a[252:255], a[156:159], 0
s_add_u32 m0, s36, 99072
v_mfma_f32_16x16x32_bf16 v[124:127], a[248:251], a[140:143], v[124:127]
s_waitcnt lgkmcnt(4)
buffer_load_dwordx4 v12, s[12:15], s40 offen offset:256 lds
v_mfma_f32_16x16x32_bf16 v[128:131], a[224:227], a[128:131], 0
ds_read_b64_tr_b16 a[240:241], v15 offset:8192
v_mfma_f32_16x16x32_bf16 v[128:131], a[228:231], a[144:147], v[128:131]
s_mov_b32 s40, 393216
ds_read_b64_tr_b16 a[242:243], v15 offset:10240
v_mfma_f32_16x16x32_bf16 v[132:135], a[228:231], a[148:151], 0
s_add_u32 m0, s37, 106496
v_mfma_f32_16x16x32_bf16 v[132:135], a[224:227], a[132:135], v[132:135]
buffer_load_dwordx4 v13, s[16:19], s40 offen lds
v_mfma_f32_16x16x32_bf16 v[136:139], a[224:227], a[136:139], 0
ds_read_b64_tr_b16 a[244:245], v15 offset:12288
v_mfma_f32_16x16x32_bf16 v[136:139], a[228:231], a[152:155], v[136:139]
s_mov_b32 s40, 442368
ds_read_b64_tr_b16 a[246:247], v15 offset:14336
v_mfma_f32_16x16x32_bf16 v[140:143], a[228:231], a[156:159], 0
s_add_u32 m0, s37, 107520
v_mfma_f32_16x16x32_bf16 v[140:143], a[224:227], a[140:143], v[140:143]
s_waitcnt lgkmcnt(4)
buffer_load_dwordx4 v13, s[16:19], s40 offen lds
v_mfma_f32_16x16x32_bf16 v[144:147], a[232:235], a[128:131], 0
ds_read_b64_tr_b16 a[248:249], v15 offset:8200
v_mfma_f32_16x16x32_bf16 v[144:147], a[236:239], a[144:147], v[144:147]
s_mov_b32 s40, 405504
ds_read_b64_tr_b16 a[250:251], v15 offset:10248
v_mfma_f32_16x16x32_bf16 v[148:151], a[236:239], a[148:151], 0
s_add_u32 m0, s37, 108544
v_mfma_f32_16x16x32_bf16 v[148:151], a[232:235], a[132:135], v[148:151]
buffer_load_dwordx4 v13, s[16:19], s40 offen lds
v_mfma_f32_16x16x32_bf16 v[152:155], a[232:235], a[136:139], 0
ds_read_b64_tr_b16 a[252:253], v15 offset:12296
v_mfma_f32_16x16x32_bf16 v[152:155], a[236:239], a[152:155], v[152:155]
s_mov_b32 s40, 454656
ds_read_b64_tr_b16 a[254:255], v15 offset:14344
v_mfma_f32_16x16x32_bf16 v[156:159], a[236:239], a[156:159], 0
s_add_u32 m0, s37, 109568
v_mfma_f32_16x16x32_bf16 v[156:159], a[232:235], a[140:143], v[156:159]
s_waitcnt lgkmcnt(4)
buffer_load_dwordx4 v13, s[16:19], s40 offen lds
v_mfma_f32_16x16x32_bf16 v[160:163], a[240:243], a[128:131], 0
ds_read_b64_tr_b16 a[224:225], v14 offset:16384
v_mfma_f32_16x16x32_bf16 v[160:163], a[244:247], a[144:147], v[160:163]
ds_read_b64_tr_b16 a[226:227], v14 offset:18432
v_mfma_f32_16x16x32_bf16 v[164:167], a[244:247], a[148:151], 0
s_xor_b32 s41, s3, 16384
v_mfma_f32_16x16x32_bf16 v[164:167], a[240:243], a[132:135], v[164:167]
buffer_load_dwordx4 a[192:195], v3, s[20:23], s41 offen sc1
v_mfma_f32_16x16x32_bf16 v[168:171], a[240:243], a[136:139], 0
ds_read_b64_tr_b16 a[228:229], v14 offset:20480
v_mfma_f32_16x16x32_bf16 v[168:171], a[244:247], a[152:155], v[168:171]
ds_read_b64_tr_b16 a[230:231], v14 offset:22528
v_mfma_f32_16x16x32_bf16 v[172:175], a[244:247], a[156:159], 0
s_xor_b32 s41, s3, 17408
v_mfma_f32_16x16x32_bf16 v[172:175], a[240:243], a[140:143], v[172:175]
s_waitcnt lgkmcnt(4)
buffer_load_dwordx4 a[196:199], v3, s[20:23], s41 offen sc1
v_mfma_f32_16x16x32_bf16 v[176:179], a[248:251], a[128:131], 0
ds_read_b64_tr_b16 a[232:233], v14 offset:16392
v_mfma_f32_16x16x32_bf16 v[176:179], a[252:255], a[144:147], v[176:179]
ds_read_b64_tr_b16 a[234:235], v14 offset:18440
v_mfma_f32_16x16x32_bf16 v[180:183], a[252:255], a[148:151], 0
s_xor_b32 s41, s3, 18432
v_mfma_f32_16x16x32_bf16 v[180:183], a[248:251], a[132:135], v[180:183]
buffer_load_dwordx4 a[200:203], v3, s[20:23], s41 offen sc1
v_mfma_f32_16x16x32_bf16 v[184:187], a[248:251], a[136:139], 0
ds_read_b64_tr_b16 a[236:237], v14 offset:20488
v_mfma_f32_16x16x32_bf16 v[184:187], a[252:255], a[152:155], v[184:187]
ds_read_b64_tr_b16 a[238:239], v14 offset:22536
v_mfma_f32_16x16x32_bf16 v[188:191], a[252:255], a[156:159], 0
s_xor_b32 s41, s3, 19456
v_mfma_f32_16x16x32_bf16 v[188:191], a[248:251], a[140:143], v[188:191]
s_waitcnt lgkmcnt(4)
buffer_load_dwordx4 a[204:207], v3, s[20:23], s41 offen sc1
v_mfma_f32_16x16x32_bf16 v[192:195], a[224:227], a[128:131], 0
ds_read_b64_tr_b16 a[240:241], v15 offset:16384
v_mfma_f32_16x16x32_bf16 v[192:195], a[228:231], a[144:147], v[192:195]
ds_read_b64_tr_b16 a[242:243], v15 offset:18432
v_mfma_f32_16x16x32_bf16 v[196:199], a[228:231], a[148:151], 0
s_xor_b32 s41, s3, 20480
v_mfma_f32_16x16x32_bf16 v[196:199], a[224:227], a[132:135], v[196:199]
buffer_load_dwordx4 a[208:211], v3, s[20:23], s41 offen sc1
v_mfma_f32_16x16x32_bf16 v[200:203], a[224:227], a[136:139], 0
ds_read_b64_tr_b16 a[244:245], v15 offset:20480
v_mfma_f32_16x16x32_bf16 v[200:203], a[228:231], a[152:155], v[200:203]
ds_read_b64_tr_b16 a[246:247], v15 offset:22528
v_mfma_f32_16x16x32_bf16 v[204:207], a[228:231], a[156:159], 0
s_xor_b32 s41, s3, 21504
v_mfma_f32_16x16x32_bf16 v[204:207], a[224:227], a[140:143], v[204:207]
s_waitcnt lgkmcnt(4)
buffer_load_dwordx4 a[212:215], v3, s[20:23], s41 offen sc1
v_mfma_f32_16x16x32_bf16 v[208:211], a[232:235], a[128:131], 0
ds_read_b64_tr_b16 a[248:249], v15 offset:16392
v_mfma_f32_16x16x32_bf16 v[208:211], a[236:239], a[144:147], v[208:211]
ds_read_b64_tr_b16 a[250:251], v15 offset:18440
v_mfma_f32_16x16x32_bf16 v[212:215], a[236:239], a[148:151], 0
s_xor_b32 s41, s3, 22528
v_mfma_f32_16x16x32_bf16 v[212:215], a[232:235], a[132:135], v[212:215]
buffer_load_dwordx4 a[216:219], v3, s[20:23], s41 offen sc1
v_mfma_f32_16x16x32_bf16 v[216:219], a[232:235], a[136:139], 0
ds_read_b64_tr_b16 a[252:253], v15 offset:20488
v_mfma_f32_16x16x32_bf16 v[216:219], a[236:239], a[152:155], v[216:219]
ds_read_b64_tr_b16 a[254:255], v15 offset:22536
v_mfma_f32_16x16x32_bf16 v[220:223], a[236:239], a[156:159], 0
s_xor_b32 s41, s3, 23552
v_mfma_f32_16x16x32_bf16 v[220:223], a[232:235], a[140:143], v[220:223]
s_waitcnt lgkmcnt(4)
buffer_load_dwordx4 a[220:223], v3, s[20:23], s41 offen sc1
v_mfma_f32_16x16x32_bf16 v[224:227], a[240:243], a[128:131], 0
ds_read_b64_tr_b16 a[224:225], v18 offset:0
v_mfma_f32_16x16x32_bf16 v[224:227], a[244:247], a[144:147], v[224:227]
ds_read_b64_tr_b16 a[226:227], v18 offset:2048
v_mfma_f32_16x16x32_bf16 v[228:231], a[244:247], a[148:151], 0
v_mfma_f32_16x16x32_bf16 v[228:231], a[240:243], a[132:135], v[228:231]
v_mfma_f32_16x16x32_bf16 v[232:235], a[240:243], a[136:139], 0
ds_read_b64_tr_b16 a[228:229], v18 offset:4096
v_mfma_f32_16x16x32_bf16 v[232:235], a[244:247], a[152:155], v[232:235]
ds_read_b64_tr_b16 a[230:231], v18 offset:6144
v_mfma_f32_16x16x32_bf16 v[236:239], a[244:247], a[156:159], 0
v_mfma_f32_16x16x32_bf16 v[236:239], a[240:243], a[140:143], v[236:239]
s_waitcnt lgkmcnt(4)
v_mfma_f32_16x16x32_bf16 v[240:243], a[248:251], a[128:131], 0
ds_read_b64_tr_b16 a[232:233], v19 offset:0
v_mfma_f32_16x16x32_bf16 v[240:243], a[252:255], a[144:147], v[240:243]
ds_read_b64_tr_b16 a[234:235], v19 offset:2048
v_mfma_f32_16x16x32_bf16 v[244:247], a[252:255], a[148:151], 0
v_mfma_f32_16x16x32_bf16 v[244:247], a[248:251], a[132:135], v[244:247]
v_mfma_f32_16x16x32_bf16 v[248:251], a[248:251], a[136:139], 0
ds_read_b64_tr_b16 a[236:237], v19 offset:4096
v_mfma_f32_16x16x32_bf16 v[248:251], a[252:255], a[152:155], v[248:251]
ds_read_b64_tr_b16 a[238:239], v19 offset:6144
v_mfma_f32_16x16x32_bf16 v[252:255], a[252:255], a[156:159], 0
v_mfma_f32_16x16x32_bf16 v[252:255], a[248:251], a[140:143], v[252:255]
s_waitcnt lgkmcnt(4)
v_mfma_f32_16x16x32_bf16 a[0:3], a[224:227], a[128:131], 0
ds_read_b64_tr_b16 a[240:241], v20 offset:0
v_mfma_f32_16x16x32_bf16 a[0:3], a[228:231], a[144:147], a[0:3]
ds_read_b64_tr_b16 a[242:243], v20 offset:2048
v_mfma_f32_16x16x32_bf16 a[4:7], a[228:231], a[148:151], 0
v_mfma_f32_16x16x32_bf16 a[4:7], a[224:227], a[132:135], a[4:7]
v_mfma_f32_16x16x32_bf16 a[8:11], a[224:227], a[136:139], 0
ds_read_b64_tr_b16 a[244:245], v20 offset:4096
v_mfma_f32_16x16x32_bf16 a[8:11], a[228:231], a[152:155], a[8:11]
ds_read_b64_tr_b16 a[246:247], v20 offset:6144
v_mfma_f32_16x16x32_bf16 a[12:15], a[228:231], a[156:159], 0
v_mfma_f32_16x16x32_bf16 a[12:15], a[224:227], a[140:143], a[12:15]
s_waitcnt lgkmcnt(4)
v_mfma_f32_16x16x32_bf16 a[16:19], a[232:235], a[128:131], 0
ds_read_b64_tr_b16 a[248:249], v21 offset:0
v_mfma_f32_16x16x32_bf16 a[16:19], a[236:239], a[144:147], a[16:19]
ds_read_b64_tr_b16 a[250:251], v21 offset:2048
v_mfma_f32_16x16x32_bf16 a[20:23], a[236:239], a[148:151], 0
v_mfma_f32_16x16x32_bf16 a[20:23], a[232:235], a[132:135], a[20:23]
v_mfma_f32_16x16x32_bf16 a[24:27], a[232:235], a[136:139], 0
ds_read_b64_tr_b16 a[252:253], v21 offset:4096
v_mfma_f32_16x16x32_bf16 a[24:27], a[236:239], a[152:155], a[24:27]
ds_read_b64_tr_b16 a[254:255], v21 offset:6144
v_mfma_f32_16x16x32_bf16 a[28:31], a[236:239], a[156:159], 0
v_mfma_f32_16x16x32_bf16 a[28:31], a[232:235], a[140:143], a[28:31]
s_waitcnt lgkmcnt(4)
v_mfma_f32_16x16x32_bf16 a[32:35], a[240:243], a[128:131], 0
ds_read_b64_tr_b16 a[224:225], v18 offset:8192
v_mfma_f32_16x16x32_bf16 a[32:35], a[244:247], a[144:147], a[32:35]
ds_read_b64_tr_b16 a[226:227], v18 offset:10240
v_mfma_f32_16x16x32_bf16 a[36:39], a[244:247], a[148:151], 0
v_mfma_f32_16x16x32_bf16 a[36:39], a[240:243], a[132:135], a[36:39]
v_mfma_f32_16x16x32_bf16 a[40:43], a[240:243], a[136:139], 0
ds_read_b64_tr_b16 a[228:229], v18 offset:12288
v_mfma_f32_16x16x32_bf16 a[40:43], a[244:247], a[152:155], a[40:43]
ds_read_b64_tr_b16 a[230:231], v18 offset:14336
v_mfma_f32_16x16x32_bf16 a[44:47], a[244:247], a[156:159], 0
ds_read_b64_tr_b16 a[232:233], v19 offset:8192
v_mfma_f32_16x16x32_bf16 a[44:47], a[240:243], a[140:143], a[44:47]
s_waitcnt lgkmcnt(5)
ds_read_b64_tr_b16 a[234:235], v19 offset:10240
v_mfma_f32_16x16x32_bf16 a[48:51], a[248:251], a[128:131], 0
v_mfma_f32_16x16x32_bf16 a[48:51], a[252:255], a[144:147], a[48:51]
v_mfma_f32_16x16x32_bf16 a[52:55], a[252:255], a[148:151], 0
ds_read_b64_tr_b16 a[236:237], v19 offset:12288
v_mfma_f32_16x16x32_bf16 a[52:55], a[248:251], a[132:135], a[52:55]
ds_read_b64_tr_b16 a[238:239], v19 offset:14336
v_mfma_f32_16x16x32_bf16 a[56:59], a[248:251], a[136:139], 0
v_mfma_f32_16x16x32_bf16 a[56:59], a[252:255], a[152:155], a[56:59]
v_mfma_f32_16x16x32_bf16 a[60:63], a[252:255], a[156:159], 0
ds_read_b64_tr_b16 a[240:241], v20 offset:8192
v_mfma_f32_16x16x32_bf16 a[60:63], a[248:251], a[140:143], a[60:63]
s_waitcnt lgkmcnt(5)
ds_read_b64_tr_b16 a[242:243], v20 offset:10240
v_mfma_f32_16x16x32_bf16 a[64:67], a[224:227], a[128:131], 0
v_mfma_f32_16x16x32_bf16 a[64:67], a[228:231], a[144:147], a[64:67]
v_mfma_f32_16x16x32_bf16 a[68:71], a[228:231], a[148:151], 0
ds_read_b64_tr_b16 a[244:245], v20 offset:12288
v_mfma_f32_16x16x32_bf16 a[68:71], a[224:227], a[132:135], a[68:71]
ds_read_b64_tr_b16 a[246:247], v20 offset:14336
v_mfma_f32_16x16x32_bf16 a[72:75], a[224:227], a[136:139], 0
v_mfma_f32_16x16x32_bf16 a[72:75], a[228:231], a[152:155], a[72:75]
v_mfma_f32_16x16x32_bf16 a[76:79], a[228:231], a[156:159], 0
ds_read_b64_tr_b16 a[248:249], v21 offset:8192
v_mfma_f32_16x16x32_bf16 a[76:79], a[224:227], a[140:143], a[76:79]
s_waitcnt lgkmcnt(5)
ds_read_b64_tr_b16 a[250:251], v21 offset:10240
v_mfma_f32_16x16x32_bf16 a[80:83], a[232:235], a[128:131], 0
v_mfma_f32_16x16x32_bf16 a[80:83], a[236:239], a[144:147], a[80:83]
v_mfma_f32_16x16x32_bf16 a[84:87], a[236:239], a[148:151], 0
ds_read_b64_tr_b16 a[252:253], v21 offset:12288
v_mfma_f32_16x16x32_bf16 a[84:87], a[232:235], a[132:135], a[84:87]
ds_read_b64_tr_b16 a[254:255], v21 offset:14336
v_mfma_f32_16x16x32_bf16 a[88:91], a[232:235], a[136:139], 0
v_mfma_f32_16x16x32_bf16 a[88:91], a[236:239], a[152:155], a[88:91]
v_mfma_f32_16x16x32_bf16 a[92:95], a[236:239], a[156:159], 0
v_mfma_f32_16x16x32_bf16 a[92:95], a[232:235], a[140:143], a[92:95]
s_waitcnt vmcnt(20) lgkmcnt(0)
v_mfma_f32_16x16x32_bf16 a[96:99], a[240:243], a[128:131], 0
s_barrier
v_mfma_f32_16x16x32_bf16 a[96:99], a[244:247], a[144:147], a[96:99]
ds_read_b64_tr_b16 a[224:225], v14 offset:40960
v_mfma_f32_16x16x32_bf16 a[100:103], a[244:247], a[148:151], 0
ds_read_b64_tr_b16 a[226:227], v14 offset:43008
v_mfma_f32_16x16x32_bf16 a[100:103], a[240:243], a[132:135], a[100:103]
ds_read_b64_tr_b16 a[228:229], v14 offset:45056
v_mfma_f32_16x16x32_bf16 a[104:107], a[240:243], a[136:139], 0
ds_read_b64_tr_b16 a[230:231], v14 offset:47104
v_mfma_f32_16x16x32_bf16 a[104:107], a[244:247], a[152:155], a[104:107]
ds_read_b64_tr_b16 a[232:233], v14 offset:40968
v_mfma_f32_16x16x32_bf16 a[108:111], a[244:247], a[156:159], 0
ds_read_b64_tr_b16 a[234:235], v14 offset:43016
v_mfma_f32_16x16x32_bf16 a[108:111], a[240:243], a[140:143], a[108:111]
ds_read_b64_tr_b16 a[236:237], v14 offset:45064
v_mfma_f32_16x16x32_bf16 a[112:115], a[248:251], a[128:131], 0
ds_read_b64_tr_b16 a[238:239], v14 offset:47112
v_mfma_f32_16x16x32_bf16 a[112:115], a[252:255], a[144:147], a[112:115]
v_mfma_f32_16x16x32_bf16 a[116:119], a[252:255], a[148:151], 0
v_mfma_f32_16x16x32_bf16 a[116:119], a[248:251], a[132:135], a[116:119]
v_mfma_f32_16x16x32_bf16 a[120:123], a[248:251], a[136:139], 0
v_mfma_f32_16x16x32_bf16 a[120:123], a[252:255], a[152:155], a[120:123]
v_mfma_f32_16x16x32_bf16 a[124:127], a[252:255], a[156:159], 0
v_mfma_f32_16x16x32_bf16 a[124:127], a[248:251], a[140:143], a[124:127]
s_waitcnt lgkmcnt(4)
v_mfma_f32_16x16x32_bf16 v[64:67], a[224:227], a[160:163], v[64:67]
ds_read_b64_tr_b16 a[240:241], v15 offset:40960
v_mfma_f32_16x16x32_bf16 v[64:67], a[228:231], a[176:179], v[64:67]
ds_read_b64_tr_b16 a[242:243], v15 offset:43008
v_mfma_f32_16x16x32_bf16 v[68:71], a[228:231], a[180:183], v[68:71]
s_mov_b32 s40, 3932160
v_mfma_f32_16x16x32_bf16 v[68:71], a[224:227], a[164:167], v[68:71]
buffer_load_dword v48, v44, s[12:15], s40 offen
v_mfma_f32_16x16x32_bf16 v[72:75], a[224:227], a[168:171], v[72:75]
ds_read_b64_tr_b16 a[244:245], v15 offset:45056
v_mfma_f32_16x16x32_bf16 v[72:75], a[228:231], a[184:187], v[72:75]
ds_read_b64_tr_b16 a[246:247], v15 offset:47104
v_mfma_f32_16x16x32_bf16 v[76:79], a[228:231], a[188:191], v[76:79]
s_mov_b32 s40, 983040
v_mfma_f32_16x16x32_bf16 v[76:79], a[224:227], a[172:175], v[76:79]
s_waitcnt lgkmcnt(4)
buffer_load_dword v49, v45, s[16:19], s40 offen
v_mfma_f32_16x16x32_bf16 v[80:83], a[232:235], a[160:163], v[80:83]
ds_read_b64_tr_b16 a[248:249], v15 offset:40968
v_mfma_f32_16x16x32_bf16 v[80:83], a[236:239], a[176:179], v[80:83]
s_mov_b32 s40, 2359296
ds_read_b64_tr_b16 a[250:251], v15 offset:43016
v_mfma_f32_16x16x32_bf16 v[84:87], a[236:239], a[180:183], v[84:87]
s_add_u32 m0, s36, 0
v_mfma_f32_16x16x32_bf16 v[84:87], a[232:235], a[164:167], v[84:87]
buffer_load_dwordx4 v12, s[12:15], s40 offen offset:0 lds
v_mfma_f32_16x16x32_bf16 v[88:91], a[232:235], a[168:171], v[88:91]
ds_read_b64_tr_b16 a[252:253], v15 offset:45064
v_mfma_f32_16x16x32_bf16 v[88:91], a[236:239], a[184:187], v[88:91]
ds_read_b64_tr_b16 a[254:255], v15 offset:47112
v_mfma_f32_16x16x32_bf16 v[92:95], a[236:239], a[188:191], v[92:95]
s_add_u32 m0, s36, 8064
v_mfma_f32_16x16x32_bf16 v[92:95], a[232:235], a[172:175], v[92:95]
s_waitcnt lgkmcnt(4)
buffer_load_dwordx4 v12, s[12:15], s40 offen offset:128 lds
v_mfma_f32_16x16x32_bf16 v[96:99], a[240:243], a[160:163], v[96:99]
ds_read_b64_tr_b16 a[224:225], v14 offset:49152
v_mfma_f32_16x16x32_bf16 v[96:99], a[244:247], a[176:179], v[96:99]
ds_read_b64_tr_b16 a[226:227], v14 offset:51200
v_mfma_f32_16x16x32_bf16 v[100:103], a[244:247], a[180:183], v[100:103]
s_add_u32 m0, s36, 16128
v_mfma_f32_16x16x32_bf16 v[100:103], a[240:243], a[164:167], v[100:103]
buffer_load_dwordx4 v12, s[12:15], s40 offen offset:256 lds
v_mfma_f32_16x16x32_bf16 v[104:107], a[240:243], a[168:171], v[104:107]
ds_read_b64_tr_b16 a[228:229], v14 offset:53248
v_mfma_f32_16x16x32_bf16 v[104:107], a[244:247], a[184:187], v[104:107]
s_mov_b32 s40, 2555904
ds_read_b64_tr_b16 a[230:231], v14 offset:55296
v_mfma_f32_16x16x32_bf16 v[108:111], a[244:247], a[188:191], v[108:111]
s_add_u32 m0, s36, 1024
v_mfma_f32_16x16x32_bf16 v[108:111], a[240:243], a[172:175], v[108:111]
s_waitcnt lgkmcnt(4)
buffer_load_dwordx4 v12, s[12:15], s40 offen offset:0 lds
v_mfma_f32_16x16x32_bf16 v[112:115], a[248:251], a[160:163], v[112:115]
ds_read_b64_tr_b16 a[232:233], v14 offset:49160
v_mfma_f32_16x16x32_bf16 v[112:115], a[252:255], a[176:179], v[112:115]
ds_read_b64_tr_b16 a[234:235], v14 offset:51208
v_mfma_f32_16x16x32_bf16 v[116:119], a[252:255], a[180:183], v[116:119]
s_add_u32 m0, s36, 9088
v_mfma_f32_16x16x32_bf16 v[116:119], a[248:251], a[164:167], v[116:119]
buffer_load_dwordx4 v12, s[12:15], s40 offen offset:128 lds
v_mfma_f32_16x16x32_bf16 v[120:123], a[248:251], a[168:171], v[120:123]
ds_read_b64_tr_b16 a[236:237], v14 offset:53256
v_mfma_f32_16x16x32_bf16 v[120:123], a[252:255], a[184:187], v[120:123]
ds_read_b64_tr_b16 a[238:239], v14 offset:55304
v_mfma_f32_16x16x32_bf16 v[124:127], a[252:255], a[188:191], v[124:127]
s_add_u32 m0, s36, 17152
v_mfma_f32_16x16x32_bf16 v[124:127], a[248:251], a[172:175], v[124:127]
s_waitcnt lgkmcnt(4)
buffer_load_dwordx4 v12, s[12:15], s40 offen offset:256 lds
v_mfma_f32_16x16x32_bf16 v[128:131], a[224:227], a[160:163], v[128:131]
ds_read_b64_tr_b16 a[240:241], v15 offset:49152
v_mfma_f32_16x16x32_bf16 v[128:131], a[228:231], a[176:179], v[128:131]
s_mov_b32 s40, 589824
ds_read_b64_tr_b16 a[242:243], v15 offset:51200
v_mfma_f32_16x16x32_bf16 v[132:135], a[228:231], a[180:183], v[132:135]
s_add_u32 m0, s37, 24576
v_mfma_f32_16x16x32_bf16 v[132:135], a[224:227], a[164:167], v[132:135]
buffer_load_dwordx4 v13, s[16:19], s40 offen lds
v_mfma_f32_16x16x32_bf16 v[136:139], a[224:227], a[168:171], v[136:139]
ds_read_b64_tr_b16 a[244:245], v15 offset:53248
v_mfma_f32_16x16x32_bf16 v[136:139], a[228:231], a[184:187], v[136:139]
s_mov_b32 s40, 638976
ds_read_b64_tr_b16 a[246:247], v15 offset:55296
v_mfma_f32_16x16x32_bf16 v[140:143], a[228:231], a[188:191], v[140:143]
s_add_u32 m0, s37, 25600
v_mfma_f32_16x16x32_bf16 v[140:143], a[224:227], a[172:175], v[140:143]
s_waitcnt lgkmcnt(4)
buffer_load_dwordx4 v13, s[16:19], s40 offen lds
v_mfma_f32_16x16x32_bf16 v[144:147], a[232:235], a[160:163], v[144:147]
ds_read_b64_tr_b16 a[248:249], v15 offset:49160
v_mfma_f32_16x16x32_bf16 v[144:147], a[236:239], a[176:179], v[144:147]
s_mov_b32 s40, 602112
ds_read_b64_tr_b16 a[250:251], v15 offset:51208
v_mfma_f32_16x16x32_bf16 v[148:151], a[236:239], a[180:183], v[148:151]
s_add_u32 m0, s37, 26624
v_mfma_f32_16x16x32_bf16 v[148:151], a[232:235], a[164:167], v[148:151]
buffer_load_dwordx4 v13, s[16:19], s40 offen lds
v_mfma_f32_16x16x32_bf16 v[152:155], a[232:235], a[168:171], v[152:155]
ds_read_b64_tr_b16 a[252:253], v15 offset:53256
v_mfma_f32_16x16x32_bf16 v[152:155], a[236:239], a[184:187], v[152:155]
s_mov_b32 s40, 651264
ds_read_b64_tr_b16 a[254:255], v15 offset:55304
v_mfma_f32_16x16x32_bf16 v[156:159], a[236:239], a[188:191], v[156:159]
s_add_u32 m0, s37, 27648
v_mfma_f32_16x16x32_bf16 v[156:159], a[232:235], a[172:175], v[156:159]
s_waitcnt lgkmcnt(4)
buffer_load_dwordx4 v13, s[16:19], s40 offen lds
v_mfma_f32_16x16x32_bf16 v[160:163], a[240:243], a[160:163], v[160:163]
ds_read_b64_tr_b16 a[224:225], v14 offset:57344
v_mfma_f32_16x16x32_bf16 v[160:163], a[244:247], a[176:179], v[160:163]
ds_read_b64_tr_b16 a[226:227], v14 offset:59392
v_mfma_f32_16x16x32_bf16 v[164:167], a[244:247], a[180:183], v[164:167]
s_xor_b32 s41, s3, 24576
v_mfma_f32_16x16x32_bf16 v[164:167], a[240:243], a[164:167], v[164:167]
buffer_load_dwordx4 a[128:131], v3, s[20:23], s41 offen sc1
v_mfma_f32_16x16x32_bf16 v[168:171], a[240:243], a[168:171], v[168:171]
ds_read_b64_tr_b16 a[228:229], v14 offset:61440
v_mfma_f32_16x16x32_bf16 v[168:171], a[244:247], a[184:187], v[168:171]
ds_read_b64_tr_b16 a[230:231], v14 offset:63488
v_mfma_f32_16x16x32_bf16 v[172:175], a[244:247], a[188:191], v[172:175]
s_xor_b32 s41, s3, 25600
v_mfma_f32_16x16x32_bf16 v[172:175], a[240:243], a[172:175], v[172:175]
s_waitcnt lgkmcnt(4)
buffer_load_dwordx4 a[132:135], v3, s[20:23], s41 offen sc1
v_mfma_f32_16x16x32_bf16 v[176:179], a[248:251], a[160:163], v[176:179]
ds_read_b64_tr_b16 a[232:233], v14 offset:57352
v_mfma_f32_16x16x32_bf16 v[176:179], a[252:255], a[176:179], v[176:179]
ds_read_b64_tr_b16 a[234:235], v14 offset:59400
v_mfma_f32_16x16x32_bf16 v[180:183], a[252:255], a[180:183], v[180:183]
s_xor_b32 s41, s3, 26624
v_mfma_f32_16x16x32_bf16 v[180:183], a[248:251], a[164:167], v[180:183]
buffer_load_dwordx4 a[136:139], v3, s[20:23], s41 offen sc1
v_mfma_f32_16x16x32_bf16 v[184:187], a[248:251], a[168:171], v[184:187]
ds_read_b64_tr_b16 a[236:237], v14 offset:61448
v_mfma_f32_16x16x32_bf16 v[184:187], a[252:255], a[184:187], v[184:187]
ds_read_b64_tr_b16 a[238:239], v14 offset:63496
v_mfma_f32_16x16x32_bf16 v[188:191], a[252:255], a[188:191], v[188:191]
s_xor_b32 s41, s3, 27648
v_mfma_f32_16x16x32_bf16 v[188:191], a[248:251], a[172:175], v[188:191]
s_waitcnt lgkmcnt(4)
buffer_load_dwordx4 a[140:143], v3, s[20:23], s41 offen sc1
v_mfma_f32_16x16x32_bf16 v[192:195], a[224:227], a[160:163], v[192:195]
ds_read_b64_tr_b16 a[240:241], v15 offset:57344
v_mfma_f32_16x16x32_bf16 v[192:195], a[228:231], a[176:179], v[192:195]
ds_read_b64_tr_b16 a[242:243], v15 offset:59392
v_mfma_f32_16x16x32_bf16 v[196:199], a[228:231], a[180:183], v[196:199]
s_xor_b32 s41, s3, 28672
v_mfma_f32_16x16x32_bf16 v[196:199], a[224:227], a[164:167], v[196:199]
buffer_load_dwordx4 a[144:147], v3, s[20:23], s41 offen sc1
v_mfma_f32_16x16x32_bf16 v[200:203], a[224:227], a[168:171], v[200:203]
ds_read_b64_tr_b16 a[244:245], v15 offset:61440
v_mfma_f32_16x16x32_bf16 v[200:203], a[228:231], a[184:187], v[200:203]
ds_read_b64_tr_b16 a[246:247], v15 offset:63488
v_mfma_f32_16x16x32_bf16 v[204:207], a[228:231], a[188:191], v[204:207]
s_xor_b32 s41, s3, 29696
v_mfma_f32_16x16x32_bf16 v[204:207], a[224:227], a[172:175], v[204:207]
s_waitcnt lgkmcnt(4)
buffer_load_dwordx4 a[148:151], v3, s[20:23], s41 offen sc1
v_mfma_f32_16x16x32_bf16 v[208:211], a[232:235], a[160:163], v[208:211]
ds_read_b64_tr_b16 a[248:249], v15 offset:57352
v_mfma_f32_16x16x32_bf16 v[208:211], a[236:239], a[176:179], v[208:211]
ds_read_b64_tr_b16 a[250:251], v15 offset:59400
v_mfma_f32_16x16x32_bf16 v[212:215], a[236:239], a[180:183], v[212:215]
s_xor_b32 s41, s3, 30720
v_mfma_f32_16x16x32_bf16 v[212:215], a[232:235], a[164:167], v[212:215]
buffer_load_dwordx4 a[152:155], v3, s[20:23], s41 offen sc1
v_mfma_f32_16x16x32_bf16 v[216:219], a[232:235], a[168:171], v[216:219]
ds_read_b64_tr_b16 a[252:253], v15 offset:61448
v_mfma_f32_16x16x32_bf16 v[216:219], a[236:239], a[184:187], v[216:219]
ds_read_b64_tr_b16 a[254:255], v15 offset:63496
v_mfma_f32_16x16x32_bf16 v[220:223], a[236:239], a[188:191], v[220:223]
s_xor_b32 s41, s3, 31744
v_mfma_f32_16x16x32_bf16 v[220:223], a[232:235], a[172:175], v[220:223]
s_waitcnt lgkmcnt(4)
buffer_load_dwordx4 a[156:159], v3, s[20:23], s41 offen sc1
v_mfma_f32_16x16x32_bf16 v[224:227], a[240:243], a[160:163], v[224:227]
ds_read_b64_tr_b16 a[224:225], v18 offset:40960
v_mfma_f32_16x16x32_bf16 v[224:227], a[244:247], a[176:179], v[224:227]
ds_read_b64_tr_b16 a[226:227], v18 offset:43008
v_mfma_f32_16x16x32_bf16 v[228:231], a[244:247], a[180:183], v[228:231]
s_add_u32 m0, s71, 0
v_mfma_f32_16x16x32_bf16 v[228:231], a[240:243], a[164:167], v[228:231]
buffer_load_dwordx4 v54, s[60:63], s70 offen offset:0 lds
v_mfma_f32_16x16x32_bf16 v[232:235], a[240:243], a[168:171], v[232:235]
ds_read_b64_tr_b16 a[228:229], v18 offset:45056
v_mfma_f32_16x16x32_bf16 v[232:235], a[244:247], a[184:187], v[232:235]
ds_read_b64_tr_b16 a[230:231], v18 offset:47104
v_mfma_f32_16x16x32_bf16 v[236:239], a[244:247], a[188:191], v[236:239]
s_add_u32 m0, s71, 896
v_mfma_f32_16x16x32_bf16 v[236:239], a[240:243], a[172:175], v[236:239]
s_waitcnt lgkmcnt(4)
buffer_load_dwordx4 v54, s[60:63], s70 offen offset:128 lds
v_mfma_f32_16x16x32_bf16 v[240:243], a[248:251], a[160:163], v[240:243]
ds_read_b64_tr_b16 a[232:233], v19 offset:40960
v_mfma_f32_16x16x32_bf16 v[240:243], a[252:255], a[176:179], v[240:243]
ds_read_b64_tr_b16 a[234:235], v19 offset:43008
v_mfma_f32_16x16x32_bf16 v[244:247], a[252:255], a[180:183], v[244:247]
s_add_u32 m0, s71, 1792
v_mfma_f32_16x16x32_bf16 v[244:247], a[248:251], a[164:167], v[244:247]
buffer_load_dwordx4 v54, s[60:63], s70 offen offset:256 lds
v_mfma_f32_16x16x32_bf16 v[248:251], a[248:251], a[168:171], v[248:251]
ds_read_b64_tr_b16 a[236:237], v19 offset:45056
v_mfma_f32_16x16x32_bf16 v[248:251], a[252:255], a[184:187], v[248:251]
ds_read_b64_tr_b16 a[238:239], v19 offset:47104
v_mfma_f32_16x16x32_bf16 v[252:255], a[252:255], a[188:191], v[252:255]
s_add_u32 m0, s71, 2688
v_mfma_f32_16x16x32_bf16 v[252:255], a[248:251], a[172:175], v[252:255]
s_waitcnt lgkmcnt(4)
buffer_load_dwordx4 v54, s[60:63], s70 offen offset:384 lds
v_mfma_f32_16x16x32_bf16 a[0:3], a[224:227], a[160:163], a[0:3]
ds_read_b64_tr_b16 a[240:241], v20 offset:40960
v_mfma_f32_16x16x32_bf16 a[0:3], a[228:231], a[176:179], a[0:3]
ds_read_b64_tr_b16 a[242:243], v20 offset:43008
v_mfma_f32_16x16x32_bf16 a[4:7], a[228:231], a[180:183], a[4:7]
s_add_u32 m0, s71, 3584
v_mfma_f32_16x16x32_bf16 a[4:7], a[224:227], a[164:167], a[4:7]
buffer_load_dwordx4 v54, s[60:63], s70 offen offset:512 lds
v_mfma_f32_16x16x32_bf16 a[8:11], a[224:227], a[168:171], a[8:11]
ds_read_b64_tr_b16 a[244:245], v20 offset:45056
v_mfma_f32_16x16x32_bf16 a[8:11], a[228:231], a[184:187], a[8:11]
ds_read_b64_tr_b16 a[246:247], v20 offset:47104
v_mfma_f32_16x16x32_bf16 a[12:15], a[228:231], a[188:191], a[12:15]
v_mfma_f32_16x16x32_bf16 a[12:15], a[224:227], a[172:175], a[12:15]
s_waitcnt lgkmcnt(4)
v_mfma_f32_16x16x32_bf16 a[16:19], a[232:235], a[160:163], a[16:19]
ds_read_b64_tr_b16 a[248:249], v21 offset:40960
v_mfma_f32_16x16x32_bf16 a[16:19], a[236:239], a[176:179], a[16:19]
ds_read_b64_tr_b16 a[250:251], v21 offset:43008
v_mfma_f32_16x16x32_bf16 a[20:23], a[236:239], a[180:183], a[20:23]
v_mfma_f32_16x16x32_bf16 a[20:23], a[232:235], a[164:167], a[20:23]
v_mfma_f32_16x16x32_bf16 a[24:27], a[232:235], a[168:171], a[24:27]
ds_read_b64_tr_b16 a[252:253], v21 offset:45056
v_mfma_f32_16x16x32_bf16 a[24:27], a[236:239], a[184:187], a[24:27]
ds_read_b64_tr_b16 a[254:255], v21 offset:47104
v_mfma_f32_16x16x32_bf16 a[28:31], a[236:239], a[188:191], a[28:31]
v_mfma_f32_16x16x32_bf16 a[28:31], a[232:235], a[172:175], a[28:31]
s_waitcnt lgkmcnt(4)
v_mfma_f32_16x16x32_bf16 a[32:35], a[240:243], a[160:163], a[32:35]
ds_read_b64_tr_b16 a[224:225], v18 offset:49152
v_mfma_f32_16x16x32_bf16 a[32:35], a[244:247], a[176:179], a[32:35]
ds_read_b64_tr_b16 a[226:227], v18 offset:51200
v_mfma_f32_16x16x32_bf16 a[36:39], a[244:247], a[180:183], a[36:39]
v_mfma_f32_16x16x32_bf16 a[36:39], a[240:243], a[164:167], a[36:39]
v_mfma_f32_16x16x32_bf16 a[40:43], a[240:243], a[168:171], a[40:43]
ds_read_b64_tr_b16 a[228:229], v18 offset:53248
v_mfma_f32_16x16x32_bf16 a[40:43], a[244:247], a[184:187], a[40:43]
ds_read_b64_tr_b16 a[230:231], v18 offset:55296
v_mfma_f32_16x16x32_bf16 a[44:47], a[244:247], a[188:191], a[44:47]
ds_read_b64_tr_b16 a[232:233], v19 offset:49152
v_mfma_f32_16x16x32_bf16 a[44:47], a[240:243], a[172:175], a[44:47]
s_waitcnt lgkmcnt(5)
ds_read_b64_tr_b16 a[234:235], v19 offset:51200
v_mfma_f32_16x16x32_bf16 a[48:51], a[248:251], a[160:163], a[48:51]
v_mfma_f32_16x16x32_bf16 a[48:51], a[252:255], a[176:179], a[48:51]
v_mfma_f32_16x16x32_bf16 a[52:55], a[252:255], a[180:183], a[52:55]
ds_read_b64_tr_b16 a[236:237], v19 offset:53248
v_mfma_f32_16x16x32_bf16 a[52:55], a[248:251], a[164:167], a[52:55]
ds_read_b64_tr_b16 a[238:239], v19 offset:55296
v_mfma_f32_16x16x32_bf16 a[56:59], a[248:251], a[168:171], a[56:59]
v_mfma_f32_16x16x32_bf16 a[56:59], a[252:255], a[184:187], a[56:59]
v_mfma_f32_16x16x32_bf16 a[60:63], a[252:255], a[188:191], a[60:63]
ds_read_b64_tr_b16 a[240:241], v20 offset:49152
v_mfma_f32_16x16x32_bf16 a[60:63], a[248:251], a[172:175], a[60:63]
s_waitcnt lgkmcnt(5)
ds_read_b64_tr_b16 a[242:243], v20 offset:51200
v_mfma_f32_16x16x32_bf16 a[64:67], a[224:227], a[160:163], a[64:67]
v_mfma_f32_16x16x32_bf16 a[64:67], a[228:231], a[176:179], a[64:67]
v_mfma_f32_16x16x32_bf16 a[68:71], a[228:231], a[180:183], a[68:71]
ds_read_b64_tr_b16 a[244:245], v20 offset:53248
v_mfma_f32_16x16x32_bf16 a[68:71], a[224:227], a[164:167], a[68:71]
ds_read_b64_tr_b16 a[246:247], v20 offset:55296
v_mfma_f32_16x16x32_bf16 a[72:75], a[224:227], a[168:171], a[72:75]
v_mfma_f32_16x16x32_bf16 a[72:75], a[228:231], a[184:187], a[72:75]
v_mfma_f32_16x16x32_bf16 a[76:79], a[228:231], a[188:191], a[76:79]
ds_read_b64_tr_b16 a[248:249], v21 offset:49152
v_mfma_f32_16x16x32_bf16 a[76:79], a[224:227], a[172:175], a[76:79]
s_waitcnt lgkmcnt(5)
ds_read_b64_tr_b16 a[250:251], v21 offset:51200
v_mfma_f32_16x16x32_bf16 a[80:83], a[232:235], a[160:163], a[80:83]
v_mfma_f32_16x16x32_bf16 a[80:83], a[236:239], a[176:179], a[80:83]
v_mfma_f32_16x16x32_bf16 a[84:87], a[236:239], a[180:183], a[84:87]
ds_read_b64_tr_b16 a[252:253], v21 offset:53248
v_mfma_f32_16x16x32_bf16 a[84:87], a[232:235], a[164:167], a[84:87]
ds_read_b64_tr_b16 a[254:255], v21 offset:55296
v_mfma_f32_16x16x32_bf16 a[88:91], a[232:235], a[168:171], a[88:91]
v_mfma_f32_16x16x32_bf16 a[88:91], a[236:239], a[184:187], a[88:91]
v_mfma_f32_16x16x32_bf16 a[92:95], a[236:239], a[188:191], a[92:95]
v_mfma_f32_16x16x32_bf16 a[92:95], a[232:235], a[172:175], a[92:95]
s_waitcnt vmcnt(25) lgkmcnt(0)
v_mfma_f32_16x16x32_bf16 a[96:99], a[240:243], a[160:163], a[96:99]
s_barrier
v_mfma_f32_16x16x32_bf16 a[96:99], a[244:247], a[176:179], a[96:99]
ds_read_b64_tr_b16 a[224:225], v16 offset:0
v_mfma_f32_16x16x32_bf16 a[100:103], a[244:247], a[180:183], a[100:103]
ds_read_b64_tr_b16 a[226:227], v16 offset:2048
v_mfma_f32_16x16x32_bf16 a[100:103], a[240:243], a[164:167], a[100:103]
ds_read_b64_tr_b16 a[228:229], v16 offset:4096
v_mfma_f32_16x16x32_bf16 a[104:107], a[240:243], a[168:171], a[104:107]
ds_read_b64_tr_b16 a[230:231], v16 offset:6144
v_mfma_f32_16x16x32_bf16 a[104:107], a[244:247], a[184:187], a[104:107]
ds_read_b64_tr_b16 a[232:233], v16 offset:8
v_mfma_f32_16x16x32_bf16 a[108:111], a[244:247], a[188:191], a[108:111]
ds_read_b64_tr_b16 a[234:235], v16 offset:2056
v_mfma_f32_16x16x32_bf16 a[108:111], a[240:243], a[172:175], a[108:111]
ds_read_b64_tr_b16 a[236:237], v16 offset:4104
v_mfma_f32_16x16x32_bf16 a[112:115], a[248:251], a[160:163], a[112:115]
ds_read_b64_tr_b16 a[238:239], v16 offset:6152
v_mfma_f32_16x16x32_bf16 a[112:115], a[252:255], a[176:179], a[112:115]
v_mfma_f32_16x16x32_bf16 a[116:119], a[252:255], a[180:183], a[116:119]
v_mfma_f32_16x16x32_bf16 a[116:119], a[248:251], a[164:167], a[116:119]
v_mfma_f32_16x16x32_bf16 a[120:123], a[248:251], a[168:171], a[120:123]
v_mfma_f32_16x16x32_bf16 a[120:123], a[252:255], a[184:187], a[120:123]
v_mfma_f32_16x16x32_bf16 a[124:127], a[252:255], a[188:191], a[124:127]
v_mfma_f32_16x16x32_bf16 a[124:127], a[248:251], a[172:175], a[124:127]
s_waitcnt lgkmcnt(4)
v_mfma_f32_16x16x32_bf16 v[64:67], a[224:227], a[192:195], v[64:67]
ds_read_b64_tr_b16 a[240:241], v17 offset:0
v_mfma_f32_16x16x32_bf16 v[64:67], a[228:231], a[208:211], v[64:67]
ds_read_b64_tr_b16 a[242:243], v17 offset:2048
v_mfma_f32_16x16x32_bf16 v[68:71], a[228:231], a[212:215], v[68:71]
s_mov_b32 s40, 4718592
v_mfma_f32_16x16x32_bf16 v[68:71], a[224:227], a[196:199], v[68:71]
buffer_load_dword v46, v44, s[12:15], s40 offen
v_mfma_f32_16x16x32_bf16 v[72:75], a[224:227], a[200:203], v[72:75]
ds_read_b64_tr_b16 a[244:245], v17 offset:4096
v_mfma_f32_16x16x32_bf16 v[72:75], a[228:231], a[216:219], v[72:75]
ds_read_b64_tr_b16 a[246:247], v17 offset:6144
v_mfma_f32_16x16x32_bf16 v[76:79], a[228:231], a[220:223], v[76:79]
s_mov_b32 s40, 1179648
v_mfma_f32_16x16x32_bf16 v[76:79], a[224:227], a[204:207], v[76:79]
s_waitcnt lgkmcnt(4)
buffer_load_dword v47, v45, s[16:19], s40 offen
v_mfma_f32_16x16x32_bf16 v[80:83], a[232:235], a[192:195], v[80:83]
ds_read_b64_tr_b16 a[248:249], v17 offset:8
v_mfma_f32_16x16x32_bf16 v[80:83], a[236:239], a[208:211], v[80:83]
s_mov_b32 s40, 3145728
ds_read_b64_tr_b16 a[250:251], v17 offset:2056
v_mfma_f32_16x16x32_bf16 v[84:87], a[236:239], a[212:215], v[84:87]
s_add_u32 m0, s36, 40960
v_mfma_f32_16x16x32_bf16 v[84:87], a[232:235], a[196:199], v[84:87]
buffer_load_dwordx4 v12, s[12:15], s40 offen offset:0 lds
v_mfma_f32_16x16x32_bf16 v[88:91], a[232:235], a[200:203], v[88:91]
ds_read_b64_tr_b16 a[252:253], v17 offset:4104
v_mfma_f32_16x16x32_bf16 v[88:91], a[236:239], a[216:219], v[88:91]
ds_read_b64_tr_b16 a[254:255], v17 offset:6152
v_mfma_f32_16x16x32_bf16 v[92:95], a[236:239], a[220:223], v[92:95]
s_add_u32 m0, s36, 49024
v_mfma_f32_16x16x32_bf16 v[92:95], a[232:235], a[204:207], v[92:95]
s_waitcnt lgkmcnt(4)
buffer_load_dwordx4 v12, s[12:15], s40 offen offset:128 lds
v_mfma_f32_16x16x32_bf16 v[96:99], a[240:243], a[192:195], v[96:99]
ds_read_b64_tr_b16 a[224:225], v16 offset:8192
v_mfma_f32_16x16x32_bf16 v[96:99], a[244:247], a[208:211], v[96:99]
ds_read_b64_tr_b16 a[226:227], v16 offset:10240
v_mfma_f32_16x16x32_bf16 v[100:103], a[244:247], a[212:215], v[100:103]
s_add_u32 m0, s36, 57088
v_mfma_f32_16x16x32_bf16 v[100:103], a[240:243], a[196:199], v[100:103]
buffer_load_dwordx4 v12, s[12:15], s40 offen offset:256 lds
v_mfma_f32_16x16x32_bf16 v[104:107], a[240:243], a[200:203], v[104:107]
ds_read_b64_tr_b16 a[228:229], v16 offset:12288
v_mfma_f32_16x16x32_bf16 v[104:107], a[244:247], a[216:219], v[104:107]
s_mov_b32 s40, 3342336
ds_read_b64_tr_b16 a[230:231], v16 offset:14336
v_mfma_f32_16x16x32_bf16 v[108:111], a[244:247], a[220:223], v[108:111]
s_add_u32 m0, s36, 41984
v_mfma_f32_16x16x32_bf16 v[108:111], a[240:243], a[204:207], v[108:111]
s_waitcnt lgkmcnt(4)
buffer_load_dwordx4 v12, s[12:15], s40 offen offset:0 lds
v_mfma_f32_16x16x32_bf16 v[112:115], a[248:251], a[192:195], v[112:115]
ds_read_b64_tr_b16 a[232:233], v16 offset:8200
v_mfma_f32_16x16x32_bf16 v[112:115], a[252:255], a[208:211], v[112:115]
ds_read_b64_tr_b16 a[234:235], v16 offset:10248
v_mfma_f32_16x16x32_bf16 v[116:119], a[252:255], a[212:215], v[116:119]
s_add_u32 m0, s36, 50048
v_mfma_f32_16x16x32_bf16 v[116:119], a[248:251], a[196:199], v[116:119]
buffer_load_dwordx4 v12, s[12:15], s40 offen offset:128 lds
v_mfma_f32_16x16x32_bf16 v[120:123], a[248:251], a[200:203], v[120:123]
ds_read_b64_tr_b16 a[236:237], v16 offset:12296
v_mfma_f32_16x16x32_bf16 v[120:123], a[252:255], a[216:219], v[120:123]
ds_read_b64_tr_b16 a[238:239], v16 offset:14344
v_mfma_f32_16x16x32_bf16 v[124:127], a[252:255], a[220:223], v[124:127]
s_add_u32 m0, s36, 58112
v_mfma_f32_16x16x32_bf16 v[124:127], a[248:251], a[204:207], v[124:127]
s_waitcnt lgkmcnt(4)
buffer_load_dwordx4 v12, s[12:15], s40 offen offset:256 lds
v_mfma_f32_16x16x32_bf16 v[128:131], a[224:227], a[192:195], v[128:131]
ds_read_b64_tr_b16 a[240:241], v17 offset:8192
v_mfma_f32_16x16x32_bf16 v[128:131], a[228:231], a[208:211], v[128:131]
s_mov_b32 s40, 786432
ds_read_b64_tr_b16 a[242:243], v17 offset:10240
v_mfma_f32_16x16x32_bf16 v[132:135], a[228:231], a[212:215], v[132:135]
s_add_u32 m0, s37, 65536
v_mfma_f32_16x16x32_bf16 v[132:135], a[224:227], a[196:199], v[132:135]
buffer_load_dwordx4 v13, s[16:19], s40 offen lds
v_mfma_f32_16x16x32_bf16 v[136:139], a[224:227], a[200:203], v[136:139]
ds_read_b64_tr_b16 a[244:245], v17 offset:12288
v_mfma_f32_16x16x32_bf16 v[136:139], a[228:231], a[216:219], v[136:139]
s_mov_b32 s40, 835584
ds_read_b64_tr_b16 a[246:247], v17 offset:14336
v_mfma_f32_16x16x32_bf16 v[140:143], a[228:231], a[220:223], v[140:143]
s_add_u32 m0, s37, 66560
v_mfma_f32_16x16x32_bf16 v[140:143], a[224:227], a[204:207], v[140:143]
s_waitcnt lgkmcnt(4)
buffer_load_dwordx4 v13, s[16:19], s40 offen lds
v_mfma_f32_16x16x32_bf16 v[144:147], a[232:235], a[192:195], v[144:147]
ds_read_b64_tr_b16 a[248:249], v17 offset:8200
v_mfma_f32_16x16x32_bf16 v[144:147], a[236:239], a[208:211], v[144:147]
s_mov_b32 s40, 798720
ds_read_b64_tr_b16 a[250:251], v17 offset:10248
v_mfma_f32_16x16x32_bf16 v[148:151], a[236:239], a[212:215], v[148:151]
s_add_u32 m0, s37, 67584
v_mfma_f32_16x16x32_bf16 v[148:151], a[232:235], a[196:199], v[148:151]
buffer_load_dwordx4 v13, s[16:19], s40 offen lds
v_mfma_f32_16x16x32_bf16 v[152:155], a[232:235], a[200:203], v[152:155]
ds_read_b64_tr_b16 a[252:253], v17 offset:12296
v_mfma_f32_16x16x32_bf16 v[152:155], a[236:239], a[216:219], v[152:155]
s_mov_b32 s40, 847872
ds_read_b64_tr_b16 a[254:255], v17 offset:14344
v_mfma_f32_16x16x32_bf16 v[156:159], a[236:239], a[220:223], v[156:159]
s_add_u32 m0, s37, 68608
v_mfma_f32_16x16x32_bf16 v[156:159], a[232:235], a[204:207], v[156:159]
s_waitcnt lgkmcnt(4)
buffer_load_dwordx4 v13, s[16:19], s40 offen lds
v_mfma_f32_16x16x32_bf16 v[160:163], a[240:243], a[192:195], v[160:163]
ds_read_b64_tr_b16 a[224:225], v16 offset:16384
v_mfma_f32_16x16x32_bf16 v[160:163], a[244:247], a[208:211], v[160:163]
ds_read_b64_tr_b16 a[226:227], v16 offset:18432
v_mfma_f32_16x16x32_bf16 v[164:167], a[244:247], a[212:215], v[164:167]
s_xor_b32 s41, s3, 32768
v_mfma_f32_16x16x32_bf16 v[164:167], a[240:243], a[196:199], v[164:167]
buffer_load_dwordx4 a[160:163], v3, s[20:23], s41 offen sc1
v_mfma_f32_16x16x32_bf16 v[168:171], a[240:243], a[200:203], v[168:171]
ds_read_b64_tr_b16 a[228:229], v16 offset:20480
v_mfma_f32_16x16x32_bf16 v[168:171], a[244:247], a[216:219], v[168:171]
ds_read_b64_tr_b16 a[230:231], v16 offset:22528
v_mfma_f32_16x16x32_bf16 v[172:175], a[244:247], a[220:223], v[172:175]
s_xor_b32 s41, s3, 33792
v_mfma_f32_16x16x32_bf16 v[172:175], a[240:243], a[204:207], v[172:175]
s_waitcnt lgkmcnt(4)
buffer_load_dwordx4 a[164:167], v3, s[20:23], s41 offen sc1
v_mfma_f32_16x16x32_bf16 v[176:179], a[248:251], a[192:195], v[176:179]
ds_read_b64_tr_b16 a[232:233], v16 offset:16392
v_mfma_f32_16x16x32_bf16 v[176:179], a[252:255], a[208:211], v[176:179]
ds_read_b64_tr_b16 a[234:235], v16 offset:18440
v_mfma_f32_16x16x32_bf16 v[180:183], a[252:255], a[212:215], v[180:183]
s_xor_b32 s41, s3, 34816
v_mfma_f32_16x16x32_bf16 v[180:183], a[248:251], a[196:199], v[180:183]
buffer_load_dwordx4 a[168:171], v3, s[20:23], s41 offen sc1
v_mfma_f32_16x16x32_bf16 v[184:187], a[248:251], a[200:203], v[184:187]
ds_read_b64_tr_b16 a[236:237], v16 offset:20488
v_mfma_f32_16x16x32_bf16 v[184:187], a[252:255], a[216:219], v[184:187]
ds_read_b64_tr_b16 a[238:239], v16 offset:22536
v_mfma_f32_16x16x32_bf16 v[188:191], a[252:255], a[220:223], v[188:191]
s_xor_b32 s41, s3, 35840
v_mfma_f32_16x16x32_bf16 v[188:191], a[248:251], a[204:207], v[188:191]
s_waitcnt lgkmcnt(4)
buffer_load_dwordx4 a[172:175], v3, s[20:23], s41 offen sc1
v_mfma_f32_16x16x32_bf16 v[192:195], a[224:227], a[192:195], v[192:195]
ds_read_b64_tr_b16 a[240:241], v17 offset:16384
v_mfma_f32_16x16x32_bf16 v[192:195], a[228:231], a[208:211], v[192:195]
ds_read_b64_tr_b16 a[242:243], v17 offset:18432
v_mfma_f32_16x16x32_bf16 v[196:199], a[228:231], a[212:215], v[196:199]
s_xor_b32 s41, s3, 36864
v_mfma_f32_16x16x32_bf16 v[196:199], a[224:227], a[196:199], v[196:199]
buffer_load_dwordx4 a[176:179], v3, s[20:23], s41 offen sc1
v_mfma_f32_16x16x32_bf16 v[200:203], a[224:227], a[200:203], v[200:203]
ds_read_b64_tr_b16 a[244:245], v17 offset:20480
v_mfma_f32_16x16x32_bf16 v[200:203], a[228:231], a[216:219], v[200:203]
ds_read_b64_tr_b16 a[246:247], v17 offset:22528
v_mfma_f32_16x16x32_bf16 v[204:207], a[228:231], a[220:223], v[204:207]
s_xor_b32 s41, s3, 37888
v_mfma_f32_16x16x32_bf16 v[204:207], a[224:227], a[204:207], v[204:207]
s_waitcnt lgkmcnt(4)
buffer_load_dwordx4 a[180:183], v3, s[20:23], s41 offen sc1
v_mfma_f32_16x16x32_bf16 v[208:211], a[232:235], a[192:195], v[208:211]
ds_read_b64_tr_b16 a[248:249], v17 offset:16392
v_mfma_f32_16x16x32_bf16 v[208:211], a[236:239], a[208:211], v[208:211]
ds_read_b64_tr_b16 a[250:251], v17 offset:18440
v_mfma_f32_16x16x32_bf16 v[212:215], a[236:239], a[212:215], v[212:215]
s_xor_b32 s41, s3, 38912
v_mfma_f32_16x16x32_bf16 v[212:215], a[232:235], a[196:199], v[212:215]
buffer_load_dwordx4 a[184:187], v3, s[20:23], s41 offen sc1
v_mfma_f32_16x16x32_bf16 v[216:219], a[232:235], a[200:203], v[216:219]
ds_read_b64_tr_b16 a[252:253], v17 offset:20488
v_mfma_f32_16x16x32_bf16 v[216:219], a[236:239], a[216:219], v[216:219]
ds_read_b64_tr_b16 a[254:255], v17 offset:22536
v_mfma_f32_16x16x32_bf16 v[220:223], a[236:239], a[220:223], v[220:223]
s_xor_b32 s41, s3, 39936
v_mfma_f32_16x16x32_bf16 v[220:223], a[232:235], a[204:207], v[220:223]
s_waitcnt lgkmcnt(4)
buffer_load_dwordx4 a[188:191], v3, s[20:23], s41 offen sc1
v_mfma_f32_16x16x32_bf16 v[224:227], a[240:243], a[192:195], v[224:227]
ds_read_b64_tr_b16 a[224:225], v50 offset:0
v_mfma_f32_16x16x32_bf16 v[224:227], a[244:247], a[208:211], v[224:227]
ds_read_b64_tr_b16 a[226:227], v50 offset:2048
v_mfma_f32_16x16x32_bf16 v[228:231], a[244:247], a[212:215], v[228:231]
s_add_u32 m0, s71, 4480
v_mfma_f32_16x16x32_bf16 v[228:231], a[240:243], a[196:199], v[228:231]
buffer_load_dwordx4 v54, s[60:63], s70 offen offset:640 lds
v_mfma_f32_16x16x32_bf16 v[232:235], a[240:243], a[200:203], v[232:235]
ds_read_b64_tr_b16 a[228:229], v50 offset:4096
v_mfma_f32_16x16x32_bf16 v[232:235], a[244:247], a[216:219], v[232:235]
ds_read_b64_tr_b16 a[230:231], v50 offset:6144
v_mfma_f32_16x16x32_bf16 v[236:239], a[244:247], a[220:223], v[236:239]
s_add_u32 m0, s71, 5376
v_mfma_f32_16x16x32_bf16 v[236:239], a[240:243], a[204:207], v[236:239]
s_waitcnt lgkmcnt(4)
buffer_load_dwordx4 v54, s[60:63], s70 offen offset:768 lds
v_mfma_f32_16x16x32_bf16 v[240:243], a[248:251], a[192:195], v[240:243]
ds_read_b64_tr_b16 a[232:233], v51 offset:0
v_mfma_f32_16x16x32_bf16 v[240:243], a[252:255], a[208:211], v[240:243]
ds_read_b64_tr_b16 a[234:235], v51 offset:2048
v_mfma_f32_16x16x32_bf16 v[244:247], a[252:255], a[212:215], v[244:247]
s_add_u32 m0, s71, 6272
v_mfma_f32_16x16x32_bf16 v[244:247], a[248:251], a[196:199], v[244:247]
buffer_load_dwordx4 v54, s[60:63], s70 offen offset:896 lds
v_mfma_f32_16x16x32_bf16 v[248:251], a[248:251], a[200:203], v[248:251]
ds_read_b64_tr_b16 a[236:237], v51 offset:4096
v_mfma_f32_16x16x32_bf16 v[248:251], a[252:255], a[216:219], v[248:251]
ds_read_b64_tr_b16 a[238:239], v51 offset:6144
v_mfma_f32_16x16x32_bf16 v[252:255], a[252:255], a[220:223], v[252:255]
s_add_u32 m0, s71, 7168
v_mfma_f32_16x16x32_bf16 v[252:255], a[248:251], a[204:207], v[252:255]
s_waitcnt lgkmcnt(4)
buffer_load_dwordx4 v54, s[60:63], s70 offen offset:1024 lds
v_mfma_f32_16x16x32_bf16 a[0:3], a[224:227], a[192:195], a[0:3]
ds_read_b64_tr_b16 a[240:241], v52 offset:0
v_mfma_f32_16x16x32_bf16 a[0:3], a[228:231], a[208:211], a[0:3]
ds_read_b64_tr_b16 a[242:243], v52 offset:2048
v_mfma_f32_16x16x32_bf16 a[4:7], a[228:231], a[212:215], a[4:7]
s_add_u32 m0, s71, 8064
v_mfma_f32_16x16x32_bf16 a[4:7], a[224:227], a[196:199], a[4:7]
buffer_load_dwordx4 v54, s[60:63], s70 offen offset:1152 lds
v_mfma_f32_16x16x32_bf16 a[8:11], a[224:227], a[200:203], a[8:11]
ds_read_b64_tr_b16 a[244:245], v52 offset:4096
v_mfma_f32_16x16x32_bf16 a[8:11], a[228:231], a[216:219], a[8:11]
ds_read_b64_tr_b16 a[246:247], v52 offset:6144
v_mfma_f32_16x16x32_bf16 a[12:15], a[228:231], a[220:223], a[12:15]
v_mfma_f32_16x16x32_bf16 a[12:15], a[224:227], a[204:207], a[12:15]
s_waitcnt lgkmcnt(4)
v_mfma_f32_16x16x32_bf16 a[16:19], a[232:235], a[192:195], a[16:19]
ds_read_b64_tr_b16 a[248:249], v53 offset:0
v_mfma_f32_16x16x32_bf16 a[16:19], a[236:239], a[208:211], a[16:19]
ds_read_b64_tr_b16 a[250:251], v53 offset:2048
v_mfma_f32_16x16x32_bf16 a[20:23], a[236:239], a[212:215], a[20:23]
v_mfma_f32_16x16x32_bf16 a[20:23], a[232:235], a[196:199], a[20:23]
v_mfma_f32_16x16x32_bf16 a[24:27], a[232:235], a[200:203], a[24:27]
ds_read_b64_tr_b16 a[252:253], v53 offset:4096
v_mfma_f32_16x16x32_bf16 a[24:27], a[236:239], a[216:219], a[24:27]
ds_read_b64_tr_b16 a[254:255], v53 offset:6144
v_mfma_f32_16x16x32_bf16 a[28:31], a[236:239], a[220:223], a[28:31]
v_mfma_f32_16x16x32_bf16 a[28:31], a[232:235], a[204:207], a[28:31]
s_waitcnt lgkmcnt(4)
v_mfma_f32_16x16x32_bf16 a[32:35], a[240:243], a[192:195], a[32:35]
ds_read_b64_tr_b16 a[224:225], v50 offset:8192
v_mfma_f32_16x16x32_bf16 a[32:35], a[244:247], a[208:211], a[32:35]
ds_read_b64_tr_b16 a[226:227], v50 offset:10240
v_mfma_f32_16x16x32_bf16 a[36:39], a[244:247], a[212:215], a[36:39]
v_mfma_f32_16x16x32_bf16 a[36:39], a[240:243], a[196:199], a[36:39]
v_mfma_f32_16x16x32_bf16 a[40:43], a[240:243], a[200:203], a[40:43]
ds_read_b64_tr_b16 a[228:229], v50 offset:12288
v_mfma_f32_16x16x32_bf16 a[40:43], a[244:247], a[216:219], a[40:43]
ds_read_b64_tr_b16 a[230:231], v50 offset:14336
v_mfma_f32_16x16x32_bf16 a[44:47], a[244:247], a[220:223], a[44:47]
ds_read_b64_tr_b16 a[232:233], v51 offset:8192
v_mfma_f32_16x16x32_bf16 a[44:47], a[240:243], a[204:207], a[44:47]
s_waitcnt lgkmcnt(5)
ds_read_b64_tr_b16 a[234:235], v51 offset:10240
v_mfma_f32_16x16x32_bf16 a[48:51], a[248:251], a[192:195], a[48:51]
v_mfma_f32_16x16x32_bf16 a[48:51], a[252:255], a[208:211], a[48:51]
v_mfma_f32_16x16x32_bf16 a[52:55], a[252:255], a[212:215], a[52:55]
ds_read_b64_tr_b16 a[236:237], v51 offset:12288
v_mfma_f32_16x16x32_bf16 a[52:55], a[248:251], a[196:199], a[52:55]
ds_read_b64_tr_b16 a[238:239], v51 offset:14336
v_mfma_f32_16x16x32_bf16 a[56:59], a[248:251], a[200:203], a[56:59]
v_mfma_f32_16x16x32_bf16 a[56:59], a[252:255], a[216:219], a[56:59]
v_mfma_f32_16x16x32_bf16 a[60:63], a[252:255], a[220:223], a[60:63]
ds_read_b64_tr_b16 a[240:241], v52 offset:8192
v_mfma_f32_16x16x32_bf16 a[60:63], a[248:251], a[204:207], a[60:63]
s_waitcnt lgkmcnt(5)
ds_read_b64_tr_b16 a[242:243], v52 offset:10240
v_mfma_f32_16x16x32_bf16 a[64:67], a[224:227], a[192:195], a[64:67]
v_mfma_f32_16x16x32_bf16 a[64:67], a[228:231], a[208:211], a[64:67]
v_mfma_f32_16x16x32_bf16 a[68:71], a[228:231], a[212:215], a[68:71]
ds_read_b64_tr_b16 a[244:245], v52 offset:12288
v_mfma_f32_16x16x32_bf16 a[68:71], a[224:227], a[196:199], a[68:71]
ds_read_b64_tr_b16 a[246:247], v52 offset:14336
v_mfma_f32_16x16x32_bf16 a[72:75], a[224:227], a[200:203], a[72:75]
v_mfma_f32_16x16x32_bf16 a[72:75], a[228:231], a[216:219], a[72:75]
v_mfma_f32_16x16x32_bf16 a[76:79], a[228:231], a[220:223], a[76:79]
ds_read_b64_tr_b16 a[248:249], v53 offset:8192
v_mfma_f32_16x16x32_bf16 a[76:79], a[224:227], a[204:207], a[76:79]
s_waitcnt lgkmcnt(5)
ds_read_b64_tr_b16 a[250:251], v53 offset:10240
v_mfma_f32_16x16x32_bf16 a[80:83], a[232:235], a[192:195], a[80:83]
v_mfma_f32_16x16x32_bf16 a[80:83], a[236:239], a[208:211], a[80:83]
v_mfma_f32_16x16x32_bf16 a[84:87], a[236:239], a[212:215], a[84:87]
ds_read_b64_tr_b16 a[252:253], v53 offset:12288
v_mfma_f32_16x16x32_bf16 a[84:87], a[232:235], a[196:199], a[84:87]
ds_read_b64_tr_b16 a[254:255], v53 offset:14336
v_mfma_f32_16x16x32_bf16 a[88:91], a[232:235], a[200:203], a[88:91]
v_mfma_f32_16x16x32_bf16 a[88:91], a[236:239], a[216:219], a[88:91]
v_mfma_f32_16x16x32_bf16 a[92:95], a[236:239], a[220:223], a[92:95]
v_mfma_f32_16x16x32_bf16 a[92:95], a[232:235], a[204:207], a[92:95]
s_waitcnt vmcnt(30) lgkmcnt(0)
v_mfma_f32_16x16x32_bf16 a[96:99], a[240:243], a[192:195], a[96:99]
s_barrier
v_mfma_f32_16x16x32_bf16 a[96:99], a[244:247], a[208:211], a[96:99]
ds_read_b64_tr_b16 a[224:225], v14 offset:0
v_mfma_f32_16x16x32_bf16 a[100:103], a[244:247], a[212:215], a[100:103]
ds_read_b64_tr_b16 a[226:227], v14 offset:2048
v_mfma_f32_16x16x32_bf16 a[100:103], a[240:243], a[196:199], a[100:103]
ds_read_b64_tr_b16 a[228:229], v14 offset:4096
v_mfma_f32_16x16x32_bf16 a[104:107], a[240:243], a[200:203], a[104:107]
ds_read_b64_tr_b16 a[230:231], v14 offset:6144
v_mfma_f32_16x16x32_bf16 a[104:107], a[244:247], a[216:219], a[104:107]
ds_read_b64_tr_b16 a[232:233], v14 offset:8
v_mfma_f32_16x16x32_bf16 a[108:111], a[244:247], a[220:223], a[108:111]
ds_read_b64_tr_b16 a[234:235], v14 offset:2056
v_mfma_f32_16x16x32_bf16 a[108:111], a[240:243], a[204:207], a[108:111]
ds_read_b64_tr_b16 a[236:237], v14 offset:4104
v_mfma_f32_16x16x32_bf16 a[112:115], a[248:251], a[192:195], a[112:115]
ds_read_b64_tr_b16 a[238:239], v14 offset:6152
v_mfma_f32_16x16x32_bf16 a[112:115], a[252:255], a[208:211], a[112:115]
v_mfma_f32_16x16x32_bf16 a[116:119], a[252:255], a[212:215], a[116:119]
v_mfma_f32_16x16x32_bf16 a[116:119], a[248:251], a[196:199], a[116:119]
v_mfma_f32_16x16x32_bf16 a[120:123], a[248:251], a[200:203], a[120:123]
v_mfma_f32_16x16x32_bf16 a[120:123], a[252:255], a[216:219], a[120:123]
v_mfma_f32_16x16x32_bf16 a[124:127], a[252:255], a[220:223], a[124:127]
v_mfma_f32_16x16x32_bf16 a[124:127], a[248:251], a[204:207], a[124:127]
s_waitcnt lgkmcnt(4)
v_mfma_f32_16x16x32_bf16 v[64:67], a[224:227], a[128:131], v[64:67]
ds_read_b64_tr_b16 a[240:241], v15 offset:0
v_mfma_f32_16x16x32_bf16 v[64:67], a[228:231], a[144:147], v[64:67]
ds_read_b64_tr_b16 a[242:243], v15 offset:2048
v_mfma_f32_16x16x32_bf16 v[68:71], a[228:231], a[148:151], v[68:71]
s_mov_b32 s40, 5505024
v_mfma_f32_16x16x32_bf16 v[68:71], a[224:227], a[132:135], v[68:71]
buffer_load_dword v48, v44, s[12:15], s40 offen
v_mfma_f32_16x16x32_bf16 v[72:75], a[224:227], a[136:139], v[72:75]
ds_read_b64_tr_b16 a[244:245], v15 offset:4096
v_mfma_f32_16x16x32_bf16 v[72:75], a[228:231], a[152:155], v[72:75]
ds_read_b64_tr_b16 a[246:247], v15 offset:6144
v_mfma_f32_16x16x32_bf16 v[76:79], a[228:231], a[156:159], v[76:79]
s_mov_b32 s40, 1376256
v_mfma_f32_16x16x32_bf16 v[76:79], a[224:227], a[140:143], v[76:79]
s_waitcnt lgkmcnt(4)
buffer_load_dword v49, v45, s[16:19], s40 offen
v_mfma_f32_16x16x32_bf16 v[80:83], a[232:235], a[128:131], v[80:83]
ds_read_b64_tr_b16 a[248:249], v15 offset:8
v_mfma_f32_16x16x32_bf16 v[80:83], a[236:239], a[144:147], v[80:83]
s_mov_b32 s40, 3932160
ds_read_b64_tr_b16 a[250:251], v15 offset:2056
v_mfma_f32_16x16x32_bf16 v[84:87], a[236:239], a[148:151], v[84:87]
s_add_u32 m0, s36, 81920
v_mfma_f32_16x16x32_bf16 v[84:87], a[232:235], a[132:135], v[84:87]
buffer_load_dwordx4 v12, s[12:15], s40 offen offset:0 lds
v_mfma_f32_16x16x32_bf16 v[88:91], a[232:235], a[136:139], v[88:91]
ds_read_b64_tr_b16 a[252:253], v15 offset:4104
v_mfma_f32_16x16x32_bf16 v[88:91], a[236:239], a[152:155], v[88:91]
ds_read_b64_tr_b16 a[254:255], v15 offset:6152
v_mfma_f32_16x16x32_bf16 v[92:95], a[236:239], a[156:159], v[92:95]
s_add_u32 m0, s36, 89984
v_mfma_f32_16x16x32_bf16 v[92:95], a[232:235], a[140:143], v[92:95]
s_waitcnt lgkmcnt(4)
buffer_load_dwordx4 v12, s[12:15], s40 offen offset:128 lds
v_mfma_f32_16x16x32_bf16 v[96:99], a[240:243], a[128:131], v[96:99]
ds_read_b64_tr_b16 a[224:225], v14 offset:8192
v_mfma_f32_16x16x32_bf16 v[96:99], a[244:247], a[144:147], v[96:99]
ds_read_b64_tr_b16 a[226:227], v14 offset:10240
v_mfma_f32_16x16x32_bf16 v[100:103], a[244:247], a[148:151], v[100:103]
s_add_u32 m0, s36, 98048
v_mfma_f32_16x16x32_bf16 v[100:103], a[240:243], a[132:135], v[100:103]
buffer_load_dwordx4 v12, s[12:15], s40 offen offset:256 lds
v_mfma_f32_16x16x32_bf16 v[104:107], a[240:243], a[136:139], v[104:107]
ds_read_b64_tr_b16 a[228:229], v14 offset:12288
v_mfma_f32_16x16x32_bf16 v[104:107], a[244:247], a[152:155], v[104:107]
s_mov_b32 s40, 4128768
ds_read_b64_tr_b16 a[230:231], v14 offset:14336
v_mfma_f32_16x16x32_bf16 v[108:111], a[244:247], a[156:159], v[108:111]
s_add_u32 m0, s36, 82944
v_mfma_f32_16x16x32_bf16 v[108:111], a[240:243], a[140:143], v[108:111]
s_waitcnt lgkmcnt(4)
buffer_load_dwordx4 v12, s[12:15], s40 offen offset:0 lds
v_mfma_f32_16x16x32_bf16 v[112:115], a[248:251], a[128:131], v[112:115]
ds_read_b64_tr_b16 a[232:233], v14 offset:8200
v_mfma_f32_16x16x32_bf16 v[112:115], a[252:255], a[144:147], v[112:115]
ds_read_b64_tr_b16 a[234:235], v14 offset:10248
v_mfma_f32_16x16x32_bf16 v[116:119], a[252:255], a[148:151], v[116:119]
s_add_u32 m0, s36, 91008
v_mfma_f32_16x16x32_bf16 v[116:119], a[248:251], a[132:135], v[116:119]
buffer_load_dwordx4 v12, s[12:15], s40 offen offset:128 lds
v_mfma_f32_16x16x32_bf16 v[120:123], a[248:251], a[136:139], v[120:123]
ds_read_b64_tr_b16 a[236:237], v14 offset:12296
v_mfma_f32_16x16x32_bf16 v[120:123], a[252:255], a[152:155], v[120:123]
ds_read_b64_tr_b16 a[238:239], v14 offset:14344
v_mfma_f32_16x16x32_bf16 v[124:127], a[252:255], a[156:159], v[124:127]
s_add_u32 m0, s36, 99072
v_mfma_f32_16x16x32_bf16 v[124:127], a[248:251], a[140:143], v[124:127]
s_waitcnt lgkmcnt(4)
buffer_load_dwordx4 v12, s[12:15], s40 offen offset:256 lds
v_mfma_f32_16x16x32_bf16 v[128:131], a[224:227], a[128:131], v[128:131]
ds_read_b64_tr_b16 a[240:241], v15 offset:8192
v_mfma_f32_16x16x32_bf16 v[128:131], a[228:231], a[144:147], v[128:131]
s_mov_b32 s40, 983040
ds_read_b64_tr_b16 a[242:243], v15 offset:10240
v_mfma_f32_16x16x32_bf16 v[132:135], a[228:231], a[148:151], v[132:135]
s_add_u32 m0, s37, 106496
v_mfma_f32_16x16x32_bf16 v[132:135], a[224:227], a[132:135], v[132:135]
buffer_load_dwordx4 v13, s[16:19], s40 offen lds
v_mfma_f32_16x16x32_bf16 v[136:139], a[224:227], a[136:139], v[136:139]
ds_read_b64_tr_b16 a[244:245], v15 offset:12288
v_mfma_f32_16x16x32_bf16 v[136:139], a[228:231], a[152:155], v[136:139]
s_mov_b32 s40, 1032192
ds_read_b64_tr_b16 a[246:247], v15 offset:14336
v_mfma_f32_16x16x32_bf16 v[140:143], a[228:231], a[156:159], v[140:143]
s_add_u32 m0, s37, 107520
v_mfma_f32_16x16x32_bf16 v[140:143], a[224:227], a[140:143], v[140:143]
s_waitcnt lgkmcnt(4)
buffer_load_dwordx4 v13, s[16:19], s40 offen lds
v_mfma_f32_16x16x32_bf16 v[144:147], a[232:235], a[128:131], v[144:147]
ds_read_b64_tr_b16 a[248:249], v15 offset:8200
v_mfma_f32_16x16x32_bf16 v[144:147], a[236:239], a[144:147], v[144:147]
s_mov_b32 s40, 995328
ds_read_b64_tr_b16 a[250:251], v15 offset:10248
v_mfma_f32_16x16x32_bf16 v[148:151], a[236:239], a[148:151], v[148:151]
s_add_u32 m0, s37, 108544
v_mfma_f32_16x16x32_bf16 v[148:151], a[232:235], a[132:135], v[148:151]
buffer_load_dwordx4 v13, s[16:19], s40 offen lds
v_mfma_f32_16x16x32_bf16 v[152:155], a[232:235], a[136:139], v[152:155]
ds_read_b64_tr_b16 a[252:253], v15 offset:12296
v_mfma_f32_16x16x32_bf16 v[152:155], a[236:239], a[152:155], v[152:155]
s_mov_b32 s40, 1044480
ds_read_b64_tr_b16 a[254:255], v15 offset:14344
v_mfma_f32_16x16x32_bf16 v[156:159], a[236:239], a[156:159], v[156:159]
s_add_u32 m0, s37, 109568
v_mfma_f32_16x16x32_bf16 v[156:159], a[232:235], a[140:143], v[156:159]
s_waitcnt lgkmcnt(4)
buffer_load_dwordx4 v13, s[16:19], s40 offen lds
v_mfma_f32_16x16x32_bf16 v[160:163], a[240:243], a[128:131], v[160:163]
ds_read_b64_tr_b16 a[224:225], v14 offset:16384
v_mfma_f32_16x16x32_bf16 v[160:163], a[244:247], a[144:147], v[160:163]
ds_read_b64_tr_b16 a[226:227], v14 offset:18432
v_mfma_f32_16x16x32_bf16 v[164:167], a[244:247], a[148:151], v[164:167]
s_xor_b32 s41, s3, 40960
v_mfma_f32_16x16x32_bf16 v[164:167], a[240:243], a[132:135], v[164:167]
buffer_load_dwordx4 a[192:195], v3, s[20:23], s41 offen sc1
v_mfma_f32_16x16x32_bf16 v[168:171], a[240:243], a[136:139], v[168:171]
ds_read_b64_tr_b16 a[228:229], v14 offset:20480
v_mfma_f32_16x16x32_bf16 v[168:171], a[244:247], a[152:155], v[168:171]
ds_read_b64_tr_b16 a[230:231], v14 offset:22528
v_mfma_f32_16x16x32_bf16 v[172:175], a[244:247], a[156:159], v[172:175]
s_xor_b32 s41, s3, 41984
v_mfma_f32_16x16x32_bf16 v[172:175], a[240:243], a[140:143], v[172:175]
s_waitcnt lgkmcnt(4)
buffer_load_dwordx4 a[196:199], v3, s[20:23], s41 offen sc1
v_mfma_f32_16x16x32_bf16 v[176:179], a[248:251], a[128:131], v[176:179]
ds_read_b64_tr_b16 a[232:233], v14 offset:16392
v_mfma_f32_16x16x32_bf16 v[176:179], a[252:255], a[144:147], v[176:179]
ds_read_b64_tr_b16 a[234:235], v14 offset:18440
v_mfma_f32_16x16x32_bf16 v[180:183], a[252:255], a[148:151], v[180:183]
s_xor_b32 s41, s3, 43008
v_mfma_f32_16x16x32_bf16 v[180:183], a[248:251], a[132:135], v[180:183]
buffer_load_dwordx4 a[200:203], v3, s[20:23], s41 offen sc1
v_mfma_f32_16x16x32_bf16 v[184:187], a[248:251], a[136:139], v[184:187]
ds_read_b64_tr_b16 a[236:237], v14 offset:20488
v_mfma_f32_16x16x32_bf16 v[184:187], a[252:255], a[152:155], v[184:187]
ds_read_b64_tr_b16 a[238:239], v14 offset:22536
v_mfma_f32_16x16x32_bf16 v[188:191], a[252:255], a[156:159], v[188:191]
s_xor_b32 s41, s3, 44032
v_mfma_f32_16x16x32_bf16 v[188:191], a[248:251], a[140:143], v[188:191]
s_waitcnt lgkmcnt(4)
buffer_load_dwordx4 a[204:207], v3, s[20:23], s41 offen sc1
v_mfma_f32_16x16x32_bf16 v[192:195], a[224:227], a[128:131], v[192:195]
ds_read_b64_tr_b16 a[240:241], v15 offset:16384
v_mfma_f32_16x16x32_bf16 v[192:195], a[228:231], a[144:147], v[192:195]
ds_read_b64_tr_b16 a[242:243], v15 offset:18432
v_mfma_f32_16x16x32_bf16 v[196:199], a[228:231], a[148:151], v[196:199]
s_xor_b32 s41, s3, 45056
v_mfma_f32_16x16x32_bf16 v[196:199], a[224:227], a[132:135], v[196:199]
buffer_load_dwordx4 a[208:211], v3, s[20:23], s41 offen sc1
v_mfma_f32_16x16x32_bf16 v[200:203], a[224:227], a[136:139], v[200:203]
ds_read_b64_tr_b16 a[244:245], v15 offset:20480
v_mfma_f32_16x16x32_bf16 v[200:203], a[228:231], a[152:155], v[200:203]
ds_read_b64_tr_b16 a[246:247], v15 offset:22528
v_mfma_f32_16x16x32_bf16 v[204:207], a[228:231], a[156:159], v[204:207]
s_xor_b32 s41, s3, 46080
v_mfma_f32_16x16x32_bf16 v[204:207], a[224:227], a[140:143], v[204:207]
s_waitcnt lgkmcnt(4)
buffer_load_dwordx4 a[212:215], v3, s[20:23], s41 offen sc1
v_mfma_f32_16x16x32_bf16 v[208:211], a[232:235], a[128:131], v[208:211]
ds_read_b64_tr_b16 a[248:249], v15 offset:16392
v_mfma_f32_16x16x32_bf16 v[208:211], a[236:239], a[144:147], v[208:211]
ds_read_b64_tr_b16 a[250:251], v15 offset:18440
v_mfma_f32_16x16x32_bf16 v[212:215], a[236:239], a[148:151], v[212:215]
s_xor_b32 s41, s3, 47104
v_mfma_f32_16x16x32_bf16 v[212:215], a[232:235], a[132:135], v[212:215]
buffer_load_dwordx4 a[216:219], v3, s[20:23], s41 offen sc1
v_mfma_f32_16x16x32_bf16 v[216:219], a[232:235], a[136:139], v[216:219]
ds_read_b64_tr_b16 a[252:253], v15 offset:20488
v_mfma_f32_16x16x32_bf16 v[216:219], a[236:239], a[152:155], v[216:219]
ds_read_b64_tr_b16 a[254:255], v15 offset:22536
v_mfma_f32_16x16x32_bf16 v[220:223], a[236:239], a[156:159], v[220:223]
s_xor_b32 s41, s3, 48128
v_mfma_f32_16x16x32_bf16 v[220:223], a[232:235], a[140:143], v[220:223]
s_waitcnt lgkmcnt(4)
buffer_load_dwordx4 a[220:223], v3, s[20:23], s41 offen sc1
v_mfma_f32_16x16x32_bf16 v[224:227], a[240:243], a[128:131], v[224:227]
ds_read_b64_tr_b16 a[224:225], v18 offset:0
v_mfma_f32_16x16x32_bf16 v[224:227], a[244:247], a[144:147], v[224:227]
ds_read_b64_tr_b16 a[226:227], v18 offset:2048
v_mfma_f32_16x16x32_bf16 v[228:231], a[244:247], a[148:151], v[228:231]
v_mfma_f32_16x16x32_bf16 v[228:231], a[240:243], a[132:135], v[228:231]
v_mfma_f32_16x16x32_bf16 v[232:235], a[240:243], a[136:139], v[232:235]
ds_read_b64_tr_b16 a[228:229], v18 offset:4096
v_mfma_f32_16x16x32_bf16 v[232:235], a[244:247], a[152:155], v[232:235]
ds_read_b64_tr_b16 a[230:231], v18 offset:6144
v_mfma_f32_16x16x32_bf16 v[236:239], a[244:247], a[156:159], v[236:239]
v_mfma_f32_16x16x32_bf16 v[236:239], a[240:243], a[140:143], v[236:239]
s_waitcnt lgkmcnt(4)
v_mfma_f32_16x16x32_bf16 v[240:243], a[248:251], a[128:131], v[240:243]
ds_read_b64_tr_b16 a[232:233], v19 offset:0
v_mfma_f32_16x16x32_bf16 v[240:243], a[252:255], a[144:147], v[240:243]
ds_read_b64_tr_b16 a[234:235], v19 offset:2048
v_mfma_f32_16x16x32_bf16 v[244:247], a[252:255], a[148:151], v[244:247]
v_mfma_f32_16x16x32_bf16 v[244:247], a[248:251], a[132:135], v[244:247]
v_mfma_f32_16x16x32_bf16 v[248:251], a[248:251], a[136:139], v[248:251]
ds_read_b64_tr_b16 a[236:237], v19 offset:4096
v_mfma_f32_16x16x32_bf16 v[248:251], a[252:255], a[152:155], v[248:251]
ds_read_b64_tr_b16 a[238:239], v19 offset:6144
v_mfma_f32_16x16x32_bf16 v[252:255], a[252:255], a[156:159], v[252:255]
v_mfma_f32_16x16x32_bf16 v[252:255], a[248:251], a[140:143], v[252:255]
s_waitcnt lgkmcnt(4)
v_mfma_f32_16x16x32_bf16 a[0:3], a[224:227], a[128:131], a[0:3]
ds_read_b64_tr_b16 a[240:241], v20 offset:0
v_mfma_f32_16x16x32_bf16 a[0:3], a[228:231], a[144:147], a[0:3]
ds_read_b64_tr_b16 a[242:243], v20 offset:2048
v_mfma_f32_16x16x32_bf16 a[4:7], a[228:231], a[148:151], a[4:7]
v_mfma_f32_16x16x32_bf16 a[4:7], a[224:227], a[132:135], a[4:7]
v_mfma_f32_16x16x32_bf16 a[8:11], a[224:227], a[136:139], a[8:11]
ds_read_b64_tr_b16 a[244:245], v20 offset:4096
v_mfma_f32_16x16x32_bf16 a[8:11], a[228:231], a[152:155], a[8:11]
ds_read_b64_tr_b16 a[246:247], v20 offset:6144
v_mfma_f32_16x16x32_bf16 a[12:15], a[228:231], a[156:159], a[12:15]
v_mfma_f32_16x16x32_bf16 a[12:15], a[224:227], a[140:143], a[12:15]
s_waitcnt lgkmcnt(4)
v_mfma_f32_16x16x32_bf16 a[16:19], a[232:235], a[128:131], a[16:19]
ds_read_b64_tr_b16 a[248:249], v21 offset:0
v_mfma_f32_16x16x32_bf16 a[16:19], a[236:239], a[144:147], a[16:19]
ds_read_b64_tr_b16 a[250:251], v21 offset:2048
v_mfma_f32_16x16x32_bf16 a[20:23], a[236:239], a[148:151], a[20:23]
v_mfma_f32_16x16x32_bf16 a[20:23], a[232:235], a[132:135], a[20:23]
v_mfma_f32_16x16x32_bf16 a[24:27], a[232:235], a[136:139], a[24:27]
ds_read_b64_tr_b16 a[252:253], v21 offset:4096
v_mfma_f32_16x16x32_bf16 a[24:27], a[236:239], a[152:155], a[24:27]
ds_read_b64_tr_b16 a[254:255], v21 offset:6144
v_mfma_f32_16x16x32_bf16 a[28:31], a[236:239], a[156:159], a[28:31]
v_mfma_f32_16x16x32_bf16 a[28:31], a[232:235], a[140:143], a[28:31]
s_waitcnt lgkmcnt(4)
v_mfma_f32_16x16x32_bf16 a[32:35], a[240:243], a[128:131], a[32:35]
ds_read_b64_tr_b16 a[224:225], v18 offset:8192
v_mfma_f32_16x16x32_bf16 a[32:35], a[244:247], a[144:147], a[32:35]
ds_read_b64_tr_b16 a[226:227], v18 offset:10240
v_mfma_f32_16x16x32_bf16 a[36:39], a[244:247], a[148:151], a[36:39]
v_mfma_f32_16x16x32_bf16 a[36:39], a[240:243], a[132:135], a[36:39]
v_mfma_f32_16x16x32_bf16 a[40:43], a[240:243], a[136:139], a[40:43]
ds_read_b64_tr_b16 a[228:229], v18 offset:12288
v_mfma_f32_16x16x32_bf16 a[40:43], a[244:247], a[152:155], a[40:43]
ds_read_b64_tr_b16 a[230:231], v18 offset:14336
v_mfma_f32_16x16x32_bf16 a[44:47], a[244:247], a[156:159], a[44:47]
ds_read_b64_tr_b16 a[232:233], v19 offset:8192
v_mfma_f32_16x16x32_bf16 a[44:47], a[240:243], a[140:143], a[44:47]
s_waitcnt lgkmcnt(5)
ds_read_b64_tr_b16 a[234:235], v19 offset:10240
v_mfma_f32_16x16x32_bf16 a[48:51], a[248:251], a[128:131], a[48:51]
v_mfma_f32_16x16x32_bf16 a[48:51], a[252:255], a[144:147], a[48:51]
v_mfma_f32_16x16x32_bf16 a[52:55], a[252:255], a[148:151], a[52:55]
ds_read_b64_tr_b16 a[236:237], v19 offset:12288
v_mfma_f32_16x16x32_bf16 a[52:55], a[248:251], a[132:135], a[52:55]
ds_read_b64_tr_b16 a[238:239], v19 offset:14336
v_mfma_f32_16x16x32_bf16 a[56:59], a[248:251], a[136:139], a[56:59]
v_mfma_f32_16x16x32_bf16 a[56:59], a[252:255], a[152:155], a[56:59]
v_mfma_f32_16x16x32_bf16 a[60:63], a[252:255], a[156:159], a[60:63]
ds_read_b64_tr_b16 a[240:241], v20 offset:8192
v_mfma_f32_16x16x32_bf16 a[60:63], a[248:251], a[140:143], a[60:63]
s_waitcnt lgkmcnt(5)
ds_read_b64_tr_b16 a[242:243], v20 offset:10240
v_mfma_f32_16x16x32_bf16 a[64:67], a[224:227], a[128:131], a[64:67]
v_mfma_f32_16x16x32_bf16 a[64:67], a[228:231], a[144:147], a[64:67]
v_mfma_f32_16x16x32_bf16 a[68:71], a[228:231], a[148:151], a[68:71]
ds_read_b64_tr_b16 a[244:245], v20 offset:12288
v_mfma_f32_16x16x32_bf16 a[68:71], a[224:227], a[132:135], a[68:71]
ds_read_b64_tr_b16 a[246:247], v20 offset:14336
v_mfma_f32_16x16x32_bf16 a[72:75], a[224:227], a[136:139], a[72:75]
v_mfma_f32_16x16x32_bf16 a[72:75], a[228:231], a[152:155], a[72:75]
v_mfma_f32_16x16x32_bf16 a[76:79], a[228:231], a[156:159], a[76:79]
ds_read_b64_tr_b16 a[248:249], v21 offset:8192
v_mfma_f32_16x16x32_bf16 a[76:79], a[224:227], a[140:143], a[76:79]
s_waitcnt lgkmcnt(5)
ds_read_b64_tr_b16 a[250:251], v21 offset:10240
v_mfma_f32_16x16x32_bf16 a[80:83], a[232:235], a[128:131], a[80:83]
v_mfma_f32_16x16x32_bf16 a[80:83], a[236:239], a[144:147], a[80:83]
v_mfma_f32_16x16x32_bf16 a[84:87], a[236:239], a[148:151], a[84:87]
ds_read_b64_tr_b16 a[252:253], v21 offset:12288
v_mfma_f32_16x16x32_bf16 a[84:87], a[232:235], a[132:135], a[84:87]
ds_read_b64_tr_b16 a[254:255], v21 offset:14336
v_mfma_f32_16x16x32_bf16 a[88:91], a[232:235], a[136:139], a[88:91]
v_mfma_f32_16x16x32_bf16 a[88:91], a[236:239], a[152:155], a[88:91]
v_mfma_f32_16x16x32_bf16 a[92:95], a[236:239], a[156:159], a[92:95]
v_mfma_f32_16x16x32_bf16 a[92:95], a[232:235], a[140:143], a[92:95]
s_waitcnt vmcnt(25) lgkmcnt(0)
v_mfma_f32_16x16x32_bf16 a[96:99], a[240:243], a[128:131], a[96:99]
s_barrier
v_mfma_f32_16x16x32_bf16 a[96:99], a[244:247], a[144:147], a[96:99]
ds_read_b64_tr_b16 a[224:225], v14 offset:40960
v_mfma_f32_16x16x32_bf16 a[100:103], a[244:247], a[148:151], a[100:103]
ds_read_b64_tr_b16 a[226:227], v14 offset:43008
v_mfma_f32_16x16x32_bf16 a[100:103], a[240:243], a[132:135], a[100:103]
ds_read_b64_tr_b16 a[228:229], v14 offset:45056
v_mfma_f32_16x16x32_bf16 a[104:107], a[240:243], a[136:139], a[104:107]
ds_read_b64_tr_b16 a[230:231], v14 offset:47104
v_mfma_f32_16x16x32_bf16 a[104:107], a[244:247], a[152:155], a[104:107]
ds_read_b64_tr_b16 a[232:233], v14 offset:40968
v_mfma_f32_16x16x32_bf16 a[108:111], a[244:247], a[156:159], a[108:111]
ds_read_b64_tr_b16 a[234:235], v14 offset:43016
v_mfma_f32_16x16x32_bf16 a[108:111], a[240:243], a[140:143], a[108:111]
ds_read_b64_tr_b16 a[236:237], v14 offset:45064
v_mfma_f32_16x16x32_bf16 a[112:115], a[248:251], a[128:131], a[112:115]
ds_read_b64_tr_b16 a[238:239], v14 offset:47112
v_mfma_f32_16x16x32_bf16 a[112:115], a[252:255], a[144:147], a[112:115]
v_mfma_f32_16x16x32_bf16 a[116:119], a[252:255], a[148:151], a[116:119]
v_mfma_f32_16x16x32_bf16 a[116:119], a[248:251], a[132:135], a[116:119]
v_mfma_f32_16x16x32_bf16 a[120:123], a[248:251], a[136:139], a[120:123]
v_mfma_f32_16x16x32_bf16 a[120:123], a[252:255], a[152:155], a[120:123]
v_mfma_f32_16x16x32_bf16 a[124:127], a[252:255], a[156:159], a[124:127]
v_mfma_f32_16x16x32_bf16 a[124:127], a[248:251], a[140:143], a[124:127]
s_waitcnt lgkmcnt(4)
v_mfma_f32_16x16x32_bf16 v[64:67], a[224:227], a[160:163], v[64:67]
ds_read_b64_tr_b16 a[240:241], v15 offset:40960
v_mfma_f32_16x16x32_bf16 v[64:67], a[228:231], a[176:179], v[64:67]
ds_read_b64_tr_b16 a[242:243], v15 offset:43008
v_mfma_f32_16x16x32_bf16 v[68:71], a[228:231], a[180:183], v[68:71]
s_mov_b32 s40, 6291456
v_mfma_f32_16x16x32_bf16 v[68:71], a[224:227], a[164:167], v[68:71]
buffer_load_dword v46, v44, s[12:15], s40 offen
v_mfma_f32_16x16x32_bf16 v[72:75], a[224:227], a[168:171], v[72:75]
ds_read_b64_tr_b16 a[244:245], v15 offset:45056
v_mfma_f32_16x16x32_bf16 v[72:75], a[228:231], a[184:187], v[72:75]
ds_read_b64_tr_b16 a[246:247], v15 offset:47104
v_mfma_f32_16x16x32_bf16 v[76:79], a[228:231], a[188:191], v[76:79]
s_mov_b32 s40, 1572864
v_mfma_f32_16x16x32_bf16 v[76:79], a[224:227], a[172:175], v[76:79]
s_waitcnt lgkmcnt(4)
buffer_load_dword v47, v45, s[16:19], s40 offen
v_mfma_f32_16x16x32_bf16 v[80:83], a[232:235], a[160:163], v[80:83]
ds_read_b64_tr_b16 a[248:249], v15 offset:40968
v_mfma_f32_16x16x32_bf16 v[80:83], a[236:239], a[176:179], v[80:83]
s_mov_b32 s40, 4718592
ds_read_b64_tr_b16 a[250:251], v15 offset:43016
v_mfma_f32_16x16x32_bf16 v[84:87], a[236:239], a[180:183], v[84:87]
s_add_u32 m0, s36, 0
v_mfma_f32_16x16x32_bf16 v[84:87], a[232:235], a[164:167], v[84:87]
buffer_load_dwordx4 v12, s[12:15], s40 offen offset:0 lds
v_mfma_f32_16x16x32_bf16 v[88:91], a[232:235], a[168:171], v[88:91]
ds_read_b64_tr_b16 a[252:253], v15 offset:45064
v_mfma_f32_16x16x32_bf16 v[88:91], a[236:239], a[184:187], v[88:91]
ds_read_b64_tr_b16 a[254:255], v15 offset:47112
v_mfma_f32_16x16x32_bf16 v[92:95], a[236:239], a[188:191], v[92:95]
s_add_u32 m0, s36, 8064
v_mfma_f32_16x16x32_bf16 v[92:95], a[232:235], a[172:175], v[92:95]
s_waitcnt lgkmcnt(4)
buffer_load_dwordx4 v12, s[12:15], s40 offen offset:128 lds
v_mfma_f32_16x16x32_bf16 v[96:99], a[240:243], a[160:163], v[96:99]
ds_read_b64_tr_b16 a[224:225], v14 offset:49152
v_mfma_f32_16x16x32_bf16 v[96:99], a[244:247], a[176:179], v[96:99]
ds_read_b64_tr_b16 a[226:227], v14 offset:51200
v_mfma_f32_16x16x32_bf16 v[100:103], a[244:247], a[180:183], v[100:103]
s_add_u32 m0, s36, 16128
v_mfma_f32_16x16x32_bf16 v[100:103], a[240:243], a[164:167], v[100:103]
buffer_load_dwordx4 v12, s[12:15], s40 offen offset:256 lds
v_mfma_f32_16x16x32_bf16 v[104:107], a[240:243], a[168:171], v[104:107]
ds_read_b64_tr_b16 a[228:229], v14 offset:53248
v_mfma_f32_16x16x32_bf16 v[104:107], a[244:247], a[184:187], v[104:107]
s_mov_b32 s40, 4915200
ds_read_b64_tr_b16 a[230:231], v14 offset:55296
v_mfma_f32_16x16x32_bf16 v[108:111], a[244:247], a[188:191], v[108:111]
s_add_u32 m0, s36, 1024
v_mfma_f32_16x16x32_bf16 v[108:111], a[240:243], a[172:175], v[108:111]
s_waitcnt lgkmcnt(4)
buffer_load_dwordx4 v12, s[12:15], s40 offen offset:0 lds
v_mfma_f32_16x16x32_bf16 v[112:115], a[248:251], a[160:163], v[112:115]
ds_read_b64_tr_b16 a[232:233], v14 offset:49160
v_mfma_f32_16x16x32_bf16 v[112:115], a[252:255], a[176:179], v[112:115]
ds_read_b64_tr_b16 a[234:235], v14 offset:51208
v_mfma_f32_16x16x32_bf16 v[116:119], a[252:255], a[180:183], v[116:119]
s_add_u32 m0, s36, 9088
v_mfma_f32_16x16x32_bf16 v[116:119], a[248:251], a[164:167], v[116:119]
buffer_load_dwordx4 v12, s[12:15], s40 offen offset:128 lds
v_mfma_f32_16x16x32_bf16 v[120:123], a[248:251], a[168:171], v[120:123]
ds_read_b64_tr_b16 a[236:237], v14 offset:53256
v_mfma_f32_16x16x32_bf16 v[120:123], a[252:255], a[184:187], v[120:123]
ds_read_b64_tr_b16 a[238:239], v14 offset:55304
v_mfma_f32_16x16x32_bf16 v[124:127], a[252:255], a[188:191], v[124:127]
s_add_u32 m0, s36, 17152
v_mfma_f32_16x16x32_bf16 v[124:127], a[248:251], a[172:175], v[124:127]
s_waitcnt lgkmcnt(4)
buffer_load_dwordx4 v12, s[12:15], s40 offen offset:256 lds
v_mfma_f32_16x16x32_bf16 v[128:131], a[224:227], a[160:163], v[128:131]
ds_read_b64_tr_b16 a[240:241], v15 offset:49152
v_mfma_f32_16x16x32_bf16 v[128:131], a[228:231], a[176:179], v[128:131]
s_mov_b32 s40, 1179648
ds_read_b64_tr_b16 a[242:243], v15 offset:51200
v_mfma_f32_16x16x32_bf16 v[132:135], a[228:231], a[180:183], v[132:135]
s_add_u32 m0, s37, 24576
v_mfma_f32_16x16x32_bf16 v[132:135], a[224:227], a[164:167], v[132:135]
buffer_load_dwordx4 v13, s[16:19], s40 offen lds
v_mfma_f32_16x16x32_bf16 v[136:139], a[224:227], a[168:171], v[136:139]
ds_read_b64_tr_b16 a[244:245], v15 offset:53248
v_mfma_f32_16x16x32_bf16 v[136:139], a[228:231], a[184:187], v[136:139]
s_mov_b32 s40, 1228800
ds_read_b64_tr_b16 a[246:247], v15 offset:55296
v_mfma_f32_16x16x32_bf16 v[140:143], a[228:231], a[188:191], v[140:143]
s_add_u32 m0, s37, 25600
v_mfma_f32_16x16x32_bf16 v[140:143], a[224:227], a[172:175], v[140:143]
s_waitcnt lgkmcnt(4)
buffer_load_dwordx4 v13, s[16:19], s40 offen lds
v_mfma_f32_16x16x32_bf16 v[144:147], a[232:235], a[160:163], v[144:147]
ds_read_b64_tr_b16 a[248:249], v15 offset:49160
v_mfma_f32_16x16x32_bf16 v[144:147], a[236:239], a[176:179], v[144:147]
s_mov_b32 s40, 1191936
ds_read_b64_tr_b16 a[250:251], v15 offset:51208
v_mfma_f32_16x16x32_bf16 v[148:151], a[236:239], a[180:183], v[148:151]
s_add_u32 m0, s37, 26624
v_mfma_f32_16x16x32_bf16 v[148:151], a[232:235], a[164:167], v[148:151]
buffer_load_dwordx4 v13, s[16:19], s40 offen lds
v_mfma_f32_16x16x32_bf16 v[152:155], a[232:235], a[168:171], v[152:155]
ds_read_b64_tr_b16 a[252:253], v15 offset:53256
v_mfma_f32_16x16x32_bf16 v[152:155], a[236:239], a[184:187], v[152:155]
s_mov_b32 s40, 1241088
ds_read_b64_tr_b16 a[254:255], v15 offset:55304
v_mfma_f32_16x16x32_bf16 v[156:159], a[236:239], a[188:191], v[156:159]
s_add_u32 m0, s37, 27648
v_mfma_f32_16x16x32_bf16 v[156:159], a[232:235], a[172:175], v[156:159]
s_waitcnt lgkmcnt(4)
buffer_load_dwordx4 v13, s[16:19], s40 offen lds
v_mfma_f32_16x16x32_bf16 v[160:163], a[240:243], a[160:163], v[160:163]
ds_read_b64_tr_b16 a[224:225], v14 offset:57344
v_mfma_f32_16x16x32_bf16 v[160:163], a[244:247], a[176:179], v[160:163]
ds_read_b64_tr_b16 a[226:227], v14 offset:59392
v_mfma_f32_16x16x32_bf16 v[164:167], a[244:247], a[180:183], v[164:167]
s_xor_b32 s41, s3, 49152
v_mfma_f32_16x16x32_bf16 v[164:167], a[240:243], a[164:167], v[164:167]
buffer_load_dwordx4 a[128:131], v3, s[20:23], s41 offen sc1
v_mfma_f32_16x16x32_bf16 v[168:171], a[240:243], a[168:171], v[168:171]
ds_read_b64_tr_b16 a[228:229], v14 offset:61440
v_mfma_f32_16x16x32_bf16 v[168:171], a[244:247], a[184:187], v[168:171]
ds_read_b64_tr_b16 a[230:231], v14 offset:63488
v_mfma_f32_16x16x32_bf16 v[172:175], a[244:247], a[188:191], v[172:175]
s_xor_b32 s41, s3, 50176
v_mfma_f32_16x16x32_bf16 v[172:175], a[240:243], a[172:175], v[172:175]
s_waitcnt lgkmcnt(4)
buffer_load_dwordx4 a[132:135], v3, s[20:23], s41 offen sc1
v_mfma_f32_16x16x32_bf16 v[176:179], a[248:251], a[160:163], v[176:179]
ds_read_b64_tr_b16 a[232:233], v14 offset:57352
v_mfma_f32_16x16x32_bf16 v[176:179], a[252:255], a[176:179], v[176:179]
ds_read_b64_tr_b16 a[234:235], v14 offset:59400
v_mfma_f32_16x16x32_bf16 v[180:183], a[252:255], a[180:183], v[180:183]
s_xor_b32 s41, s3, 51200
v_mfma_f32_16x16x32_bf16 v[180:183], a[248:251], a[164:167], v[180:183]
buffer_load_dwordx4 a[136:139], v3, s[20:23], s41 offen sc1
v_mfma_f32_16x16x32_bf16 v[184:187], a[248:251], a[168:171], v[184:187]
ds_read_b64_tr_b16 a[236:237], v14 offset:61448
v_mfma_f32_16x16x32_bf16 v[184:187], a[252:255], a[184:187], v[184:187]
ds_read_b64_tr_b16 a[238:239], v14 offset:63496
v_mfma_f32_16x16x32_bf16 v[188:191], a[252:255], a[188:191], v[188:191]
s_xor_b32 s41, s3, 52224
v_mfma_f32_16x16x32_bf16 v[188:191], a[248:251], a[172:175], v[188:191]
s_waitcnt lgkmcnt(4)
buffer_load_dwordx4 a[140:143], v3, s[20:23], s41 offen sc1
v_mfma_f32_16x16x32_bf16 v[192:195], a[224:227], a[160:163], v[192:195]
ds_read_b64_tr_b16 a[240:241], v15 offset:57344
v_mfma_f32_16x16x32_bf16 v[192:195], a[228:231], a[176:179], v[192:195]
ds_read_b64_tr_b16 a[242:243], v15 offset:59392
v_mfma_f32_16x16x32_bf16 v[196:199], a[228:231], a[180:183], v[196:199]
s_xor_b32 s41, s3, 53248
v_mfma_f32_16x16x32_bf16 v[196:199], a[224:227], a[164:167], v[196:199]
buffer_load_dwordx4 a[144:147], v3, s[20:23], s41 offen sc1
v_mfma_f32_16x16x32_bf16 v[200:203], a[224:227], a[168:171], v[200:203]
ds_read_b64_tr_b16 a[244:245], v15 offset:61440
v_mfma_f32_16x16x32_bf16 v[200:203], a[228:231], a[184:187], v[200:203]
ds_read_b64_tr_b16 a[246:247], v15 offset:63488
v_mfma_f32_16x16x32_bf16 v[204:207], a[228:231], a[188:191], v[204:207]
s_xor_b32 s41, s3, 54272
v_mfma_f32_16x16x32_bf16 v[204:207], a[224:227], a[172:175], v[204:207]
s_waitcnt lgkmcnt(4)
buffer_load_dwordx4 a[148:151], v3, s[20:23], s41 offen sc1
v_mfma_f32_16x16x32_bf16 v[208:211], a[232:235], a[160:163], v[208:211]
ds_read_b64_tr_b16 a[248:249], v15 offset:57352
v_mfma_f32_16x16x32_bf16 v[208:211], a[236:239], a[176:179], v[208:211]
ds_read_b64_tr_b16 a[250:251], v15 offset:59400
v_mfma_f32_16x16x32_bf16 v[212:215], a[236:239], a[180:183], v[212:215]
s_xor_b32 s41, s3, 55296
v_mfma_f32_16x16x32_bf16 v[212:215], a[232:235], a[164:167], v[212:215]
buffer_load_dwordx4 a[152:155], v3, s[20:23], s41 offen sc1
v_mfma_f32_16x16x32_bf16 v[216:219], a[232:235], a[168:171], v[216:219]
ds_read_b64_tr_b16 a[252:253], v15 offset:61448
v_mfma_f32_16x16x32_bf16 v[216:219], a[236:239], a[184:187], v[216:219]
ds_read_b64_tr_b16 a[254:255], v15 offset:63496
v_mfma_f32_16x16x32_bf16 v[220:223], a[236:239], a[188:191], v[220:223]
s_xor_b32 s41, s3, 56320
v_mfma_f32_16x16x32_bf16 v[220:223], a[232:235], a[172:175], v[220:223]
s_waitcnt lgkmcnt(4)
buffer_load_dwordx4 a[156:159], v3, s[20:23], s41 offen sc1
v_mfma_f32_16x16x32_bf16 v[224:227], a[240:243], a[160:163], v[224:227]
ds_read_b64_tr_b16 a[224:225], v18 offset:40960
v_mfma_f32_16x16x32_bf16 v[224:227], a[244:247], a[176:179], v[224:227]
ds_read_b64_tr_b16 a[226:227], v18 offset:43008
v_mfma_f32_16x16x32_bf16 v[228:231], a[244:247], a[180:183], v[228:231]
v_mfma_f32_16x16x32_bf16 v[228:231], a[240:243], a[164:167], v[228:231]
v_mfma_f32_16x16x32_bf16 v[232:235], a[240:243], a[168:171], v[232:235]
ds_read_b64_tr_b16 a[228:229], v18 offset:45056
v_mfma_f32_16x16x32_bf16 v[232:235], a[244:247], a[184:187], v[232:235]
ds_read_b64_tr_b16 a[230:231], v18 offset:47104
v_mfma_f32_16x16x32_bf16 v[236:239], a[244:247], a[188:191], v[236:239]
v_mfma_f32_16x16x32_bf16 v[236:239], a[240:243], a[172:175], v[236:239]
s_waitcnt lgkmcnt(4)
v_mfma_f32_16x16x32_bf16 v[240:243], a[248:251], a[160:163], v[240:243]
ds_read_b64_tr_b16 a[232:233], v19 offset:40960
v_mfma_f32_16x16x32_bf16 v[240:243], a[252:255], a[176:179], v[240:243]
ds_read_b64_tr_b16 a[234:235], v19 offset:43008
v_mfma_f32_16x16x32_bf16 v[244:247], a[252:255], a[180:183], v[244:247]
v_mfma_f32_16x16x32_bf16 v[244:247], a[248:251], a[164:167], v[244:247]
v_mfma_f32_16x16x32_bf16 v[248:251], a[248:251], a[168:171], v[248:251]
ds_read_b64_tr_b16 a[236:237], v19 offset:45056
v_mfma_f32_16x16x32_bf16 v[248:251], a[252:255], a[184:187], v[248:251]
ds_read_b64_tr_b16 a[238:239], v19 offset:47104
v_mfma_f32_16x16x32_bf16 v[252:255], a[252:255], a[188:191], v[252:255]
v_mfma_f32_16x16x32_bf16 v[252:255], a[248:251], a[172:175], v[252:255]
s_waitcnt lgkmcnt(4)
v_mfma_f32_16x16x32_bf16 a[0:3], a[224:227], a[160:163], a[0:3]
ds_read_b64_tr_b16 a[240:241], v20 offset:40960
v_mfma_f32_16x16x32_bf16 a[0:3], a[228:231], a[176:179], a[0:3]
ds_read_b64_tr_b16 a[242:243], v20 offset:43008
v_mfma_f32_16x16x32_bf16 a[4:7], a[228:231], a[180:183], a[4:7]
v_mfma_f32_16x16x32_bf16 a[4:7], a[224:227], a[164:167], a[4:7]
v_mfma_f32_16x16x32_bf16 a[8:11], a[224:227], a[168:171], a[8:11]
ds_read_b64_tr_b16 a[244:245], v20 offset:45056
v_mfma_f32_16x16x32_bf16 a[8:11], a[228:231], a[184:187], a[8:11]
ds_read_b64_tr_b16 a[246:247], v20 offset:47104
v_mfma_f32_16x16x32_bf16 a[12:15], a[228:231], a[188:191], a[12:15]
v_mfma_f32_16x16x32_bf16 a[12:15], a[224:227], a[172:175], a[12:15]
s_waitcnt lgkmcnt(4)
v_mfma_f32_16x16x32_bf16 a[16:19], a[232:235], a[160:163], a[16:19]
ds_read_b64_tr_b16 a[248:249], v21 offset:40960
v_mfma_f32_16x16x32_bf16 a[16:19], a[236:239], a[176:179], a[16:19]
ds_read_b64_tr_b16 a[250:251], v21 offset:43008
v_mfma_f32_16x16x32_bf16 a[20:23], a[236:239], a[180:183], a[20:23]
v_mfma_f32_16x16x32_bf16 a[20:23], a[232:235], a[164:167], a[20:23]
v_mfma_f32_16x16x32_bf16 a[24:27], a[232:235], a[168:171], a[24:27]
ds_read_b64_tr_b16 a[252:253], v21 offset:45056
v_mfma_f32_16x16x32_bf16 a[24:27], a[236:239], a[184:187], a[24:27]
ds_read_b64_tr_b16 a[254:255], v21 offset:47104
v_mfma_f32_16x16x32_bf16 a[28:31], a[236:239], a[188:191], a[28:31]
v_mfma_f32_16x16x32_bf16 a[28:31], a[232:235], a[172:175], a[28:31]
s_waitcnt lgkmcnt(4)
v_mfma_f32_16x16x32_bf16 a[32:35], a[240:243], a[160:163], a[32:35]
ds_read_b64_tr_b16 a[224:225], v18 offset:49152
v_mfma_f32_16x16x32_bf16 a[32:35], a[244:247], a[176:179], a[32:35]
ds_read_b64_tr_b16 a[226:227], v18 offset:51200
v_mfma_f32_16x16x32_bf16 a[36:39], a[244:247], a[180:183], a[36:39]
v_mfma_f32_16x16x32_bf16 a[36:39], a[240:243], a[164:167], a[36:39]
v_mfma_f32_16x16x32_bf16 a[40:43], a[240:243], a[168:171], a[40:43]
ds_read_b64_tr_b16 a[228:229], v18 offset:53248
v_mfma_f32_16x16x32_bf16 a[40:43], a[244:247], a[184:187], a[40:43]
ds_read_b64_tr_b16 a[230:231], v18 offset:55296
v_mfma_f32_16x16x32_bf16 a[44:47], a[244:247], a[188:191], a[44:47]
ds_read_b64_tr_b16 a[232:233], v19 offset:49152
v_mfma_f32_16x16x32_bf16 a[44:47], a[240:243], a[172:175], a[44:47]
s_waitcnt lgkmcnt(5)
ds_read_b64_tr_b16 a[234:235], v19 offset:51200
v_mfma_f32_16x16x32_bf16 a[48:51], a[248:251], a[160:163], a[48:51]
v_mfma_f32_16x16x32_bf16 a[48:51], a[252:255], a[176:179], a[48:51]
v_mfma_f32_16x16x32_bf16 a[52:55], a[252:255], a[180:183], a[52:55]
ds_read_b64_tr_b16 a[236:237], v19 offset:53248
v_mfma_f32_16x16x32_bf16 a[52:55], a[248:251], a[164:167], a[52:55]
ds_read_b64_tr_b16 a[238:239], v19 offset:55296
v_mfma_f32_16x16x32_bf16 a[56:59], a[248:251], a[168:171], a[56:59]
v_mfma_f32_16x16x32_bf16 a[56:59], a[252:255], a[184:187], a[56:59]
v_mfma_f32_16x16x32_bf16 a[60:63], a[252:255], a[188:191], a[60:63]
ds_read_b64_tr_b16 a[240:241], v20 offset:49152
v_mfma_f32_16x16x32_bf16 a[60:63], a[248:251], a[172:175], a[60:63]
s_waitcnt lgkmcnt(5)
ds_read_b64_tr_b16 a[242:243], v20 offset:51200
v_mfma_f32_16x16x32_bf16 a[64:67], a[224:227], a[160:163], a[64:67]
v_mfma_f32_16x16x32_bf16 a[64:67], a[228:231], a[176:179], a[64:67]
v_mfma_f32_16x16x32_bf16 a[68:71], a[228:231], a[180:183], a[68:71]
ds_read_b64_tr_b16 a[244:245], v20 offset:53248
v_mfma_f32_16x16x32_bf16 a[68:71], a[224:227], a[164:167], a[68:71]
ds_read_b64_tr_b16 a[246:247], v20 offset:55296
v_mfma_f32_16x16x32_bf16 a[72:75], a[224:227], a[168:171], a[72:75]
v_mfma_f32_16x16x32_bf16 a[72:75], a[228:231], a[184:187], a[72:75]
v_mfma_f32_16x16x32_bf16 a[76:79], a[228:231], a[188:191], a[76:79]
ds_read_b64_tr_b16 a[248:249], v21 offset:49152
v_mfma_f32_16x16x32_bf16 a[76:79], a[224:227], a[172:175], a[76:79]
s_waitcnt lgkmcnt(5)
ds_read_b64_tr_b16 a[250:251], v21 offset:51200
v_mfma_f32_16x16x32_bf16 a[80:83], a[232:235], a[160:163], a[80:83]
v_mfma_f32_16x16x32_bf16 a[80:83], a[236:239], a[176:179], a[80:83]
v_mfma_f32_16x16x32_bf16 a[84:87], a[236:239], a[180:183], a[84:87]
ds_read_b64_tr_b16 a[252:253], v21 offset:53248
v_mfma_f32_16x16x32_bf16 a[84:87], a[232:235], a[164:167], a[84:87]
ds_read_b64_tr_b16 a[254:255], v21 offset:55296
v_mfma_f32_16x16x32_bf16 a[88:91], a[232:235], a[168:171], a[88:91]
v_mfma_f32_16x16x32_bf16 a[88:91], a[236:239], a[184:187], a[88:91]
v_mfma_f32_16x16x32_bf16 a[92:95], a[236:239], a[188:191], a[92:95]
v_mfma_f32_16x16x32_bf16 a[92:95], a[232:235], a[172:175], a[92:95]
s_waitcnt vmcnt(20) lgkmcnt(0)
v_mfma_f32_16x16x32_bf16 a[96:99], a[240:243], a[160:163], a[96:99]
s_barrier
v_mfma_f32_16x16x32_bf16 a[96:99], a[244:247], a[176:179], a[96:99]
s_add_u32 s60, s94, 4194304
ds_read_b64_tr_b16 a[224:225], v16 offset:0
v_mfma_f32_16x16x32_bf16 a[100:103], a[244:247], a[180:183], a[100:103]
s_addc_u32 s61, s95, 0
ds_read_b64_tr_b16 a[226:227], v16 offset:2048
v_mfma_f32_16x16x32_bf16 a[100:103], a[240:243], a[164:167], a[100:103]
s_mov_b32 s62, 9830400
ds_read_b64_tr_b16 a[228:229], v16 offset:4096
v_mfma_f32_16x16x32_bf16 a[104:107], a[240:243], a[168:171], a[104:107]
s_mov_b32 s63, 0x20000
ds_read_b64_tr_b16 a[230:231], v16 offset:6144
v_mfma_f32_16x16x32_bf16 a[104:107], a[244:247], a[184:187], a[104:107]
ds_read_b64_tr_b16 a[232:233], v16 offset:8
v_mfma_f32_16x16x32_bf16 a[108:111], a[244:247], a[188:191], a[108:111]
ds_read_b64_tr_b16 a[234:235], v16 offset:2056
v_mfma_f32_16x16x32_bf16 a[108:111], a[240:243], a[172:175], a[108:111]
ds_read_b64_tr_b16 a[236:237], v16 offset:4104
v_mfma_f32_16x16x32_bf16 a[112:115], a[248:251], a[160:163], a[112:115]
ds_read_b64_tr_b16 a[238:239], v16 offset:6152
v_mfma_f32_16x16x32_bf16 a[112:115], a[252:255], a[176:179], a[112:115]
v_mfma_f32_16x16x32_bf16 a[116:119], a[252:255], a[180:183], a[116:119]
v_mfma_f32_16x16x32_bf16 a[116:119], a[248:251], a[164:167], a[116:119]
v_mfma_f32_16x16x32_bf16 a[120:123], a[248:251], a[168:171], a[120:123]
v_mfma_f32_16x16x32_bf16 a[120:123], a[252:255], a[184:187], a[120:123]
v_mfma_f32_16x16x32_bf16 a[124:127], a[252:255], a[188:191], a[124:127]
v_mfma_f32_16x16x32_bf16 a[124:127], a[248:251], a[172:175], a[124:127]
s_waitcnt lgkmcnt(4)
v_mfma_f32_16x16x32_bf16 v[64:67], a[224:227], a[192:195], v[64:67]
ds_read_b64_tr_b16 a[240:241], v17 offset:0
v_mfma_f32_16x16x32_bf16 v[64:67], a[228:231], a[208:211], v[64:67]
ds_read_b64_tr_b16 a[242:243], v17 offset:2048
v_mfma_f32_16x16x32_bf16 v[68:71], a[228:231], a[212:215], v[68:71]
s_mov_b32 s40, 7077888
ds_read_b64_tr_b16 v[28:29], v55 offset:0
v_mfma_f32_16x16x32_bf16 v[68:71], a[224:227], a[196:199], v[68:71]
buffer_load_dword v48, v44, s[12:15], s40 offen
v_mfma_f32_16x16x32_bf16 v[72:75], a[224:227], a[200:203], v[72:75]
ds_read_b64_tr_b16 a[244:245], v17 offset:4096
v_mfma_f32_16x16x32_bf16 v[72:75], a[228:231], a[216:219], v[72:75]
ds_read_b64_tr_b16 a[246:247], v17 offset:6144
v_mfma_f32_16x16x32_bf16 v[76:79], a[228:231], a[220:223], v[76:79]
s_mov_b32 s40, 1769472
ds_read_b64_tr_b16 v[30:31], v55 offset:20480
v_mfma_f32_16x16x32_bf16 v[76:79], a[224:227], a[204:207], v[76:79]
s_waitcnt lgkmcnt(6)
buffer_load_dword v49, v45, s[16:19], s40 offen
v_mfma_f32_16x16x32_bf16 v[80:83], a[232:235], a[192:195], v[80:83]
ds_read_b64_tr_b16 a[248:249], v17 offset:8
v_mfma_f32_16x16x32_bf16 v[80:83], a[236:239], a[208:211], v[80:83]
s_mov_b32 s40, 5505024
ds_read_b64_tr_b16 a[250:251], v17 offset:2056
v_mfma_f32_16x16x32_bf16 v[84:87], a[236:239], a[212:215], v[84:87]
s_add_u32 m0, s36, 40960
ds_read_b64_tr_b16 v[32:33], v56 offset:0
v_mfma_f32_16x16x32_bf16 v[84:87], a[232:235], a[196:199], v[84:87]
buffer_load_dwordx4 v12, s[12:15], s40 offen offset:0 lds
v_mfma_f32_16x16x32_bf16 v[88:91], a[232:235], a[200:203], v[88:91]
ds_read_b64_tr_b16 a[252:253], v17 offset:4104
v_mfma_f32_16x16x32_bf16 v[88:91], a[236:239], a[216:219], v[88:91]
ds_read_b64_tr_b16 a[254:255], v17 offset:6152
v_mfma_f32_16x16x32_bf16 v[92:95], a[236:239], a[220:223], v[92:95]
s_add_u32 m0, s36, 49024
ds_read_b64_tr_b16 v[34:35], v56 offset:20480
v_mfma_f32_16x16x32_bf16 v[92:95], a[232:235], a[204:207], v[92:95]
s_waitcnt lgkmcnt(7)
buffer_load_dwordx4 v12, s[12:15], s40 offen offset:128 lds
v_mfma_f32_16x16x32_bf16 v[96:99], a[240:243], a[192:195], v[96:99]
ds_read_b64_tr_b16 a[224:225], v16 offset:8192
v_mfma_f32_16x16x32_bf16 v[96:99], a[244:247], a[208:211], v[96:99]
ds_read_b64_tr_b16 a[226:227], v16 offset:10240
v_mfma_f32_16x16x32_bf16 v[100:103], a[244:247], a[212:215], v[100:103]
s_add_u32 m0, s36, 57088
ds_read_b64_tr_b16 v[36:37], v57 offset:0
v_mfma_f32_16x16x32_bf16 v[100:103], a[240:243], a[196:199], v[100:103]
buffer_load_dwordx4 v12, s[12:15], s40 offen offset:256 lds
v_mfma_f32_16x16x32_bf16 v[104:107], a[240:243], a[200:203], v[104:107]
ds_read_b64_tr_b16 a[228:229], v16 offset:12288
v_mfma_f32_16x16x32_bf16 v[104:107], a[244:247], a[216:219], v[104:107]
s_mov_b32 s40, 5701632
ds_read_b64_tr_b16 a[230:231], v16 offset:14336
v_mfma_f32_16x16x32_bf16 v[108:111], a[244:247], a[220:223], v[108:111]
s_add_u32 m0, s36, 41984
ds_read_b64_tr_b16 v[38:39], v57 offset:20480
v_mfma_f32_16x16x32_bf16 v[108:111], a[240:243], a[204:207], v[108:111]
s_waitcnt lgkmcnt(7)
buffer_load_dwordx4 v12, s[12:15], s40 offen offset:0 lds
v_mfma_f32_16x16x32_bf16 v[112:115], a[248:251], a[192:195], v[112:115]
ds_read_b64_tr_b16 a[232:233], v16 offset:8200
v_mfma_f32_16x16x32_bf16 v[112:115], a[252:255], a[208:211], v[112:115]
ds_read_b64_tr_b16 a[234:235], v16 offset:10248
v_mfma_f32_16x16x32_bf16 v[116:119], a[252:255], a[212:215], v[116:119]
s_add_u32 m0, s36, 50048
ds_read_b64_tr_b16 v[40:41], v58 offset:0
v_mfma_f32_16x16x32_bf16 v[116:119], a[248:251], a[196:199], v[116:119]
buffer_load_dwordx4 v12, s[12:15], s40 offen offset:128 lds
v_mfma_f32_16x16x32_bf16 v[120:123], a[248:251], a[200:203], v[120:123]
ds_read_b64_tr_b16 a[236:237], v16 offset:12296
v_mfma_f32_16x16x32_bf16 v[120:123], a[252:255], a[216:219], v[120:123]
ds_read_b64_tr_b16 a[238:239], v16 offset:14344
v_mfma_f32_16x16x32_bf16 v[124:127], a[252:255], a[220:223], v[124:127]
s_add_u32 m0, s36, 58112
ds_read_b64_tr_b16 v[42:43], v58 offset:20480
v_mfma_f32_16x16x32_bf16 v[124:127], a[248:251], a[204:207], v[124:127]
s_waitcnt lgkmcnt(7)
buffer_load_dwordx4 v12, s[12:15], s40 offen offset:256 lds
v_mfma_f32_16x16x32_bf16 v[128:131], a[224:227], a[192:195], v[128:131]
ds_read_b64_tr_b16 a[240:241], v17 offset:8192
v_mfma_f32_16x16x32_bf16 v[128:131], a[228:231], a[208:211], v[128:131]
s_mov_b32 s40, 1376256
ds_read_b64_tr_b16 a[242:243], v17 offset:10240
v_mfma_f32_16x16x32_bf16 v[132:135], a[228:231], a[212:215], v[132:135]
s_add_u32 m0, s37, 65536
v_mfma_f32_16x16x32_bf16 v[132:135], a[224:227], a[196:199], v[132:135]
buffer_load_dwordx4 v13, s[16:19], s40 offen lds
v_mfma_f32_16x16x32_bf16 v[136:139], a[224:227], a[200:203], v[136:139]
ds_read_b64_tr_b16 a[244:245], v17 offset:12288
v_mfma_f32_16x16x32_bf16 v[136:139], a[228:231], a[216:219], v[136:139]
s_mov_b32 s40, 1425408
ds_read_b64_tr_b16 a[246:247], v17 offset:14336
v_mfma_f32_16x16x32_bf16 v[140:143], a[228:231], a[220:223], v[140:143]
s_add_u32 m0, s37, 66560
v_mfma_f32_16x16x32_bf16 v[140:143], a[224:227], a[204:207], v[140:143]
s_waitcnt lgkmcnt(5)
buffer_load_dwordx4 v13, s[16:19], s40 offen lds
v_mfma_f32_16x16x32_bf16 v[144:147], a[232:235], a[192:195], v[144:147]
ds_read_b64_tr_b16 a[248:249], v17 offset:8200
v_mfma_f32_16x16x32_bf16 v[144:147], a[236:239], a[208:211], v[144:147]
s_mov_b32 s40, 1388544
ds_read_b64_tr_b16 a[250:251], v17 offset:10248
v_mfma_f32_16x16x32_bf16 v[148:151], a[236:239], a[212:215], v[148:151]
s_add_u32 m0, s37, 67584
v_mfma_f32_16x16x32_bf16 v[148:151], a[232:235], a[196:199], v[148:151]
buffer_load_dwordx4 v13, s[16:19], s40 offen lds
v_mfma_f32_16x16x32_bf16 v[152:155], a[232:235], a[200:203], v[152:155]
ds_read_b64_tr_b16 a[252:253], v17 offset:12296
v_mfma_f32_16x16x32_bf16 v[152:155], a[236:239], a[216:219], v[152:155]
s_mov_b32 s40, 1437696
ds_read_b64_tr_b16 a[254:255], v17 offset:14344
v_mfma_f32_16x16x32_bf16 v[156:159], a[236:239], a[220:223], v[156:159]
s_add_u32 m0, s37, 68608
v_mfma_f32_16x16x32_bf16 v[156:159], a[232:235], a[204:207], v[156:159]
s_waitcnt lgkmcnt(4)
buffer_load_dwordx4 v13, s[16:19], s40 offen lds
v_mfma_f32_16x16x32_bf16 v[160:163], a[240:243], a[192:195], v[160:163]
ds_read_b64_tr_b16 a[224:225], v16 offset:16384
v_mfma_f32_16x16x32_bf16 v[160:163], a[244:247], a[208:211], v[160:163]
ds_read_b64_tr_b16 a[226:227], v16 offset:18432
v_mfma_f32_16x16x32_bf16 v[164:167], a[244:247], a[212:215], v[164:167]
s_xor_b32 s41, s3, 57344
v_mfma_f32_16x16x32_bf16 v[164:167], a[240:243], a[196:199], v[164:167]
buffer_load_dwordx4 a[160:163], v3, s[20:23], s41 offen sc1
v_mfma_f32_16x16x32_bf16 v[168:171], a[240:243], a[200:203], v[168:171]
ds_read_b64_tr_b16 a[228:229], v16 offset:20480
v_mfma_f32_16x16x32_bf16 v[168:171], a[244:247], a[216:219], v[168:171]
ds_read_b64_tr_b16 a[230:231], v16 offset:22528
v_mfma_f32_16x16x32_bf16 v[172:175], a[244:247], a[220:223], v[172:175]
s_xor_b32 s41, s3, 58368
v_mfma_f32_16x16x32_bf16 v[172:175], a[240:243], a[204:207], v[172:175]
s_waitcnt lgkmcnt(4)
buffer_load_dwordx4 a[164:167], v3, s[20:23], s41 offen sc1
v_mfma_f32_16x16x32_bf16 v[176:179], a[248:251], a[192:195], v[176:179]
ds_read_b64_tr_b16 a[232:233], v16 offset:16392
v_mfma_f32_16x16x32_bf16 v[176:179], a[252:255], a[208:211], v[176:179]
ds_read_b64_tr_b16 a[234:235], v16 offset:18440
v_mfma_f32_16x16x32_bf16 v[180:183], a[252:255], a[212:215], v[180:183]
s_xor_b32 s41, s3, 59392
v_mfma_f32_16x16x32_bf16 v[180:183], a[248:251], a[196:199], v[180:183]
buffer_load_dwordx4 a[168:171], v3, s[20:23], s41 offen sc1
v_mfma_f32_16x16x32_bf16 v[184:187], a[248:251], a[200:203], v[184:187]
ds_read_b64_tr_b16 a[236:237], v16 offset:20488
v_mfma_f32_16x16x32_bf16 v[184:187], a[252:255], a[216:219], v[184:187]
ds_read_b64_tr_b16 a[238:239], v16 offset:22536
v_mfma_f32_16x16x32_bf16 v[188:191], a[252:255], a[220:223], v[188:191]
s_xor_b32 s41, s3, 60416
v_mfma_f32_16x16x32_bf16 v[188:191], a[248:251], a[204:207], v[188:191]
s_waitcnt lgkmcnt(4)
buffer_load_dwordx4 a[172:175], v3, s[20:23], s41 offen sc1
v_mfma_f32_16x16x32_bf16 v[192:195], a[224:227], a[192:195], v[192:195]
ds_read_b64_tr_b16 a[240:241], v17 offset:16384
v_mfma_f32_16x16x32_bf16 v[192:195], a[228:231], a[208:211], v[192:195]
ds_read_b64_tr_b16 a[242:243], v17 offset:18432
v_mfma_f32_16x16x32_bf16 v[196:199], a[228:231], a[212:215], v[196:199]
s_xor_b32 s41, s3, 61440
v_mfma_f32_16x16x32_bf16 v[196:199], a[224:227], a[196:199], v[196:199]
buffer_load_dwordx4 a[176:179], v3, s[20:23], s41 offen sc1
v_mfma_f32_16x16x32_bf16 v[200:203], a[224:227], a[200:203], v[200:203]
ds_read_b64_tr_b16 a[244:245], v17 offset:20480
v_mfma_f32_16x16x32_bf16 v[200:203], a[228:231], a[216:219], v[200:203]
ds_read_b64_tr_b16 a[246:247], v17 offset:22528
v_mfma_f32_16x16x32_bf16 v[204:207], a[228:231], a[220:223], v[204:207]
s_xor_b32 s41, s3, 62464
v_mfma_f32_16x16x32_bf16 v[204:207], a[224:227], a[204:207], v[204:207]
s_waitcnt lgkmcnt(4)
buffer_load_dwordx4 a[180:183], v3, s[20:23], s41 offen sc1
v_mfma_f32_16x16x32_bf16 v[208:211], a[232:235], a[192:195], v[208:211]
ds_read_b64_tr_b16 a[248:249], v17 offset:16392
v_mfma_f32_16x16x32_bf16 v[208:211], a[236:239], a[208:211], v[208:211]
ds_read_b64_tr_b16 a[250:251], v17 offset:18440
v_mfma_f32_16x16x32_bf16 v[212:215], a[236:239], a[212:215], v[212:215]
s_xor_b32 s41, s3, 63488
v_mfma_f32_16x16x32_bf16 v[212:215], a[232:235], a[196:199], v[212:215]
buffer_load_dwordx4 a[184:187], v3, s[20:23], s41 offen sc1
v_mfma_f32_16x16x32_bf16 v[216:219], a[232:235], a[200:203], v[216:219]
ds_read_b64_tr_b16 a[252:253], v17 offset:20488
v_mfma_f32_16x16x32_bf16 v[216:219], a[236:239], a[216:219], v[216:219]
ds_read_b64_tr_b16 a[254:255], v17 offset:22536
v_mfma_f32_16x16x32_bf16 v[220:223], a[236:239], a[220:223], v[220:223]
s_xor_b32 s41, s3, 64512
v_mfma_f32_16x16x32_bf16 v[220:223], a[232:235], a[204:207], v[220:223]
s_waitcnt lgkmcnt(4)
buffer_load_dwordx4 a[188:191], v3, s[20:23], s41 offen sc1
v_mfma_f32_16x16x32_bf16 v[224:227], a[240:243], a[192:195], v[224:227]
ds_read_b64_tr_b16 a[224:225], v50 offset:0
v_mfma_f32_16x16x32_bf16 v[224:227], a[244:247], a[208:211], v[224:227]
ds_read_b64_tr_b16 a[226:227], v50 offset:2048
v_mfma_f32_16x16x32_bf16 v[228:231], a[244:247], a[212:215], v[228:231]
v_mfma_f32_16x16x32_bf16 v[228:231], a[240:243], a[196:199], v[228:231]
v_mfma_f32_16x16x32_bf16 v[232:235], a[240:243], a[200:203], v[232:235]
ds_read_b64_tr_b16 a[228:229], v50 offset:4096
v_mfma_f32_16x16x32_bf16 v[232:235], a[244:247], a[216:219], v[232:235]
ds_read_b64_tr_b16 a[230:231], v50 offset:6144
v_mfma_f32_16x16x32_bf16 v[236:239], a[244:247], a[220:223], v[236:239]
v_mfma_f32_16x16x32_bf16 v[236:239], a[240:243], a[204:207], v[236:239]
s_waitcnt lgkmcnt(4)
v_mfma_f32_16x16x32_bf16 v[240:243], a[248:251], a[192:195], v[240:243]
ds_read_b64_tr_b16 a[232:233], v51 offset:0
v_mfma_f32_16x16x32_bf16 v[240:243], a[252:255], a[208:211], v[240:243]
ds_read_b64_tr_b16 a[234:235], v51 offset:2048
v_mfma_f32_16x16x32_bf16 v[244:247], a[252:255], a[212:215], v[244:247]
v_mfma_f32_16x16x32_bf16 v[244:247], a[248:251], a[196:199], v[244:247]
v_mfma_f32_16x16x32_bf16 v[248:251], a[248:251], a[200:203], v[248:251]
ds_read_b64_tr_b16 a[236:237], v51 offset:4096
v_mfma_f32_16x16x32_bf16 v[248:251], a[252:255], a[216:219], v[248:251]
ds_read_b64_tr_b16 a[238:239], v51 offset:6144
v_mfma_f32_16x16x32_bf16 v[252:255], a[252:255], a[220:223], v[252:255]
v_mfma_f32_16x16x32_bf16 v[252:255], a[248:251], a[204:207], v[252:255]
s_waitcnt lgkmcnt(4)
v_mfma_f32_16x16x32_bf16 a[0:3], a[224:227], a[192:195], a[0:3]
ds_read_b64_tr_b16 a[240:241], v52 offset:0
v_mfma_f32_16x16x32_bf16 a[0:3], a[228:231], a[208:211], a[0:3]
ds_read_b64_tr_b16 a[242:243], v52 offset:2048
v_mfma_f32_16x16x32_bf16 a[4:7], a[228:231], a[212:215], a[4:7]
v_mfma_f32_16x16x32_bf16 a[4:7], a[224:227], a[196:199], a[4:7]
v_mfma_f32_16x16x32_bf16 a[8:11], a[224:227], a[200:203], a[8:11]
ds_read_b64_tr_b16 a[244:245], v52 offset:4096
v_mfma_f32_16x16x32_bf16 a[8:11], a[228:231], a[216:219], a[8:11]
ds_read_b64_tr_b16 a[246:247], v52 offset:6144
v_mfma_f32_16x16x32_bf16 a[12:15], a[228:231], a[220:223], a[12:15]
v_mfma_f32_16x16x32_bf16 a[12:15], a[224:227], a[204:207], a[12:15]
s_waitcnt lgkmcnt(4)
v_mfma_f32_16x16x32_bf16 a[16:19], a[232:235], a[192:195], a[16:19]
ds_read_b64_tr_b16 a[248:249], v53 offset:0
v_mfma_f32_16x16x32_bf16 a[16:19], a[236:239], a[208:211], a[16:19]
ds_read_b64_tr_b16 a[250:251], v53 offset:2048
v_mfma_f32_16x16x32_bf16 a[20:23], a[236:239], a[212:215], a[20:23]
v_mfma_f32_16x16x32_bf16 a[20:23], a[232:235], a[196:199], a[20:23]
v_mfma_f32_16x16x32_bf16 a[24:27], a[232:235], a[200:203], a[24:27]
ds_read_b64_tr_b16 a[252:253], v53 offset:4096
v_mfma_f32_16x16x32_bf16 a[24:27], a[236:239], a[216:219], a[24:27]
ds_read_b64_tr_b16 a[254:255], v53 offset:6144
v_mfma_f32_16x16x32_bf16 a[28:31], a[236:239], a[220:223], a[28:31]
buffer_store_dwordx4 v[28:31], v3, s[60:63], s69 offen offset:0 sc1
v_mfma_f32_16x16x32_bf16 a[28:31], a[232:235], a[204:207], a[28:31]
s_waitcnt lgkmcnt(4)
v_mfma_f32_16x16x32_bf16 a[32:35], a[240:243], a[192:195], a[32:35]
ds_read_b64_tr_b16 a[224:225], v50 offset:8192
v_mfma_f32_16x16x32_bf16 a[32:35], a[244:247], a[208:211], a[32:35]
ds_read_b64_tr_b16 a[226:227], v50 offset:10240
v_mfma_f32_16x16x32_bf16 a[36:39], a[244:247], a[212:215], a[36:39]
v_mfma_f32_16x16x32_bf16 a[36:39], a[240:243], a[196:199], a[36:39]
v_mfma_f32_16x16x32_bf16 a[40:43], a[240:243], a[200:203], a[40:43]
ds_read_b64_tr_b16 a[228:229], v50 offset:12288
v_mfma_f32_16x16x32_bf16 a[40:43], a[244:247], a[216:219], a[40:43]
ds_read_b64_tr_b16 a[230:231], v50 offset:14336
v_mfma_f32_16x16x32_bf16 a[44:47], a[244:247], a[220:223], a[44:47]
ds_read_b64_tr_b16 a[232:233], v51 offset:8192
v_mfma_f32_16x16x32_bf16 a[44:47], a[240:243], a[204:207], a[44:47]
s_waitcnt lgkmcnt(5)
ds_read_b64_tr_b16 a[234:235], v51 offset:10240
v_mfma_f32_16x16x32_bf16 a[48:51], a[248:251], a[192:195], a[48:51]
buffer_store_dwordx4 v[32:35], v3, s[60:63], s69 offen offset:1024 sc1
v_mfma_f32_16x16x32_bf16 a[48:51], a[252:255], a[208:211], a[48:51]
v_mfma_f32_16x16x32_bf16 a[52:55], a[252:255], a[212:215], a[52:55]
ds_read_b64_tr_b16 a[236:237], v51 offset:12288
v_mfma_f32_16x16x32_bf16 a[52:55], a[248:251], a[196:199], a[52:55]
ds_read_b64_tr_b16 a[238:239], v51 offset:14336
v_mfma_f32_16x16x32_bf16 a[56:59], a[248:251], a[200:203], a[56:59]
v_mfma_f32_16x16x32_bf16 a[56:59], a[252:255], a[216:219], a[56:59]
v_mfma_f32_16x16x32_bf16 a[60:63], a[252:255], a[220:223], a[60:63]
ds_read_b64_tr_b16 a[240:241], v52 offset:8192
v_mfma_f32_16x16x32_bf16 a[60:63], a[248:251], a[204:207], a[60:63]
s_waitcnt lgkmcnt(5)
ds_read_b64_tr_b16 a[242:243], v52 offset:10240
v_mfma_f32_16x16x32_bf16 a[64:67], a[224:227], a[192:195], a[64:67]
buffer_store_dwordx4 v[36:39], v3, s[60:63], s69 offen offset:2048 sc1
v_mfma_f32_16x16x32_bf16 a[64:67], a[228:231], a[208:211], a[64:67]
v_mfma_f32_16x16x32_bf16 a[68:71], a[228:231], a[212:215], a[68:71]
ds_read_b64_tr_b16 a[244:245], v52 offset:12288
v_mfma_f32_16x16x32_bf16 a[68:71], a[224:227], a[196:199], a[68:71]
ds_read_b64_tr_b16 a[246:247], v52 offset:14336
v_mfma_f32_16x16x32_bf16 a[72:75], a[224:227], a[200:203], a[72:75]
v_mfma_f32_16x16x32_bf16 a[72:75], a[228:231], a[216:219], a[72:75]
v_mfma_f32_16x16x32_bf16 a[76:79], a[228:231], a[220:223], a[76:79]
ds_read_b64_tr_b16 a[248:249], v53 offset:8192
v_mfma_f32_16x16x32_bf16 a[76:79], a[224:227], a[204:207], a[76:79]
s_waitcnt lgkmcnt(5)
ds_read_b64_tr_b16 a[250:251], v53 offset:10240
v_mfma_f32_16x16x32_bf16 a[80:83], a[232:235], a[192:195], a[80:83]
buffer_store_dwordx4 v[40:43], v3, s[60:63], s69 offen offset:3072 sc1
v_mfma_f32_16x16x32_bf16 a[80:83], a[236:239], a[208:211], a[80:83]
v_mfma_f32_16x16x32_bf16 a[84:87], a[236:239], a[212:215], a[84:87]
ds_read_b64_tr_b16 a[252:253], v53 offset:12288
v_mfma_f32_16x16x32_bf16 a[84:87], a[232:235], a[196:199], a[84:87]
ds_read_b64_tr_b16 a[254:255], v53 offset:14336
v_mfma_f32_16x16x32_bf16 a[88:91], a[232:235], a[200:203], a[88:91]
v_mfma_f32_16x16x32_bf16 a[88:91], a[236:239], a[216:219], a[88:91]
v_mfma_f32_16x16x32_bf16 a[92:95], a[236:239], a[220:223], a[92:95]
v_mfma_f32_16x16x32_bf16 a[92:95], a[232:235], a[204:207], a[92:95]
s_waitcnt vmcnt(24) lgkmcnt(0)
v_mfma_f32_16x16x32_bf16 a[96:99], a[240:243], a[192:195], a[96:99]
s_barrier
v_mfma_f32_16x16x32_bf16 a[96:99], a[244:247], a[208:211], a[96:99]
ds_read_b64_tr_b16 a[224:225], v14 offset:0
v_mfma_f32_16x16x32_bf16 a[100:103], a[244:247], a[212:215], a[100:103]
ds_read_b64_tr_b16 a[226:227], v14 offset:2048
v_mfma_f32_16x16x32_bf16 a[100:103], a[240:243], a[196:199], a[100:103]
ds_read_b64_tr_b16 a[228:229], v14 offset:4096
v_mfma_f32_16x16x32_bf16 a[104:107], a[240:243], a[200:203], a[104:107]
ds_read_b64_tr_b16 a[230:231], v14 offset:6144
v_mfma_f32_16x16x32_bf16 a[104:107], a[244:247], a[216:219], a[104:107]
ds_read_b64_tr_b16 a[232:233], v14 offset:8
v_mfma_f32_16x16x32_bf16 a[108:111], a[244:247], a[220:223], a[108:111]
ds_read_b64_tr_b16 a[234:235], v14 offset:2056
v_mfma_f32_16x16x32_bf16 a[108:111], a[240:243], a[204:207], a[108:111]
ds_read_b64_tr_b16 a[236:237], v14 offset:4104
v_mfma_f32_16x16x32_bf16 a[112:115], a[248:251], a[192:195], a[112:115]
ds_read_b64_tr_b16 a[238:239], v14 offset:6152
v_mfma_f32_16x16x32_bf16 a[112:115], a[252:255], a[208:211], a[112:115]
v_mfma_f32_16x16x32_bf16 a[116:119], a[252:255], a[212:215], a[116:119]
v_mfma_f32_16x16x32_bf16 a[116:119], a[248:251], a[196:199], a[116:119]
v_mfma_f32_16x16x32_bf16 a[120:123], a[248:251], a[200:203], a[120:123]
v_mfma_f32_16x16x32_bf16 a[120:123], a[252:255], a[216:219], a[120:123]
v_mfma_f32_16x16x32_bf16 a[124:127], a[252:255], a[220:223], a[124:127]
v_mfma_f32_16x16x32_bf16 a[124:127], a[248:251], a[204:207], a[124:127]
s_waitcnt lgkmcnt(4)
v_mfma_f32_16x16x32_bf16 v[64:67], a[224:227], a[128:131], v[64:67]
ds_read_b64_tr_b16 a[240:241], v15 offset:0
v_mfma_f32_16x16x32_bf16 v[64:67], a[228:231], a[144:147], v[64:67]
s_mov_b32 s40, 6291456
ds_read_b64_tr_b16 a[242:243], v15 offset:2048
v_mfma_f32_16x16x32_bf16 v[68:71], a[228:231], a[148:151], v[68:71]
s_add_u32 m0, s36, 81920
ds_read_b64_tr_b16 v[28:29], v55 offset:1024
v_mfma_f32_16x16x32_bf16 v[68:71], a[224:227], a[132:135], v[68:71]
buffer_load_dwordx4 v12, s[12:15], s40 offen offset:0 lds
v_mfma_f32_16x16x32_bf16 v[72:75], a[224:227], a[136:139], v[72:75]
ds_read_b64_tr_b16 a[244:245], v15 offset:4096
v_mfma_f32_16x16x32_bf16 v[72:75], a[228:231], a[152:155], v[72:75]
ds_read_b64_tr_b16 a[246:247], v15 offset:6144
v_mfma_f32_16x16x32_bf16 v[76:79], a[228:231], a[156:159], v[76:79]
s_add_u32 m0, s36, 89984
ds_read_b64_tr_b16 v[30:31], v55 offset:21504
v_mfma_f32_16x16x32_bf16 v[76:79], a[224:227], a[140:143], v[76:79]
s_waitcnt lgkmcnt(6)
buffer_load_dwordx4 v12, s[12:15], s40 offen offset:128 lds
v_mfma_f32_16x16x32_bf16 v[80:83], a[232:235], a[128:131], v[80:83]
ds_read_b64_tr_b16 a[248:249], v15 offset:8
v_mfma_f32_16x16x32_bf16 v[80:83], a[236:239], a[144:147], v[80:83]
ds_read_b64_tr_b16 a[250:251], v15 offset:2056
v_mfma_f32_16x16x32_bf16 v[84:87], a[236:239], a[148:151], v[84:87]
s_add_u32 m0, s36, 98048
ds_read_b64_tr_b16 v[32:33], v56 offset:1024
v_mfma_f32_16x16x32_bf16 v[84:87], a[232:235], a[132:135], v[84:87]
buffer_load_dwordx4 v12, s[12:15], s40 offen offset:256 lds
v_mfma_f32_16x16x32_bf16 v[88:91], a[232:235], a[136:139], v[88:91]
ds_read_b64_tr_b16 a[252:253], v15 offset:4104
v_mfma_f32_16x16x32_bf16 v[88:91], a[236:239], a[152:155], v[88:91]
s_mov_b32 s40, 6488064
ds_read_b64_tr_b16 a[254:255], v15 offset:6152
v_mfma_f32_16x16x32_bf16 v[92:95], a[236:239], a[156:159], v[92:95]
s_add_u32 m0, s36, 82944
ds_read_b64_tr_b16 v[34:35], v56 offset:21504
v_mfma_f32_16x16x32_bf16 v[92:95], a[232:235], a[140:143], v[92:95]
s_waitcnt lgkmcnt(7)
buffer_load_dwordx4 v12, s[12:15], s40 offen offset:0 lds
v_mfma_f32_16x16x32_bf16 v[96:99], a[240:243], a[128:131], v[96:99]
ds_read_b64_tr_b16 a[224:225], v14 offset:8192
v_mfma_f32_16x16x32_bf16 v[96:99], a[244:247], a[144:147], v[96:99]
ds_read_b64_tr_b16 a[226:227], v14 offset:10240
v_mfma_f32_16x16x32_bf16 v[100:103], a[244:247], a[148:151], v[100:103]
s_add_u32 m0, s36, 91008
ds_read_b64_tr_b16 v[36:37], v57 offset:1024
v_mfma_f32_16x16x32_bf16 v[100:103], a[240:243], a[132:135], v[100:103]
buffer_load_dwordx4 v12, s[12:15], s40 offen offset:128 lds
v_mfma_f32_16x16x32_bf16 v[104:107], a[240:243], a[136:139], v[104:107]
ds_read_b64_tr_b16 a[228:229], v14 offset:12288
v_mfma_f32_16x16x32_bf16 v[104:107], a[244:247], a[152:155], v[104:107]
ds_read_b64_tr_b16 a[230:231], v14 offset:14336
v_mfma_f32_16x16x32_bf16 v[108:111], a[244:247], a[156:159], v[108:111]
s_add_u32 m0, s36, 99072
ds_read_b64_tr_b16 v[38:39], v57 offset:21504
v_mfma_f32_16x16x32_bf16 v[108:111], a[240:243], a[140:143], v[108:111]
s_waitcnt lgkmcnt(7)
buffer_load_dwordx4 v12, s[12:15], s40 offen offset:256 lds
v_mfma_f32_16x16x32_bf16 v[112:115], a[248:251], a[128:131], v[112:115]
ds_read_b64_tr_b16 a[232:233], v14 offset:8200
v_mfma_f32_16x16x32_bf16 v[112:115], a[252:255], a[144:147], v[112:115]
s_mov_b32 s40, 1572864
ds_read_b64_tr_b16 a[234:235], v14 offset:10248
v_mfma_f32_16x16x32_bf16 v[116:119], a[252:255], a[148:151], v[116:119]
s_add_u32 m0, s37, 106496
v_mfma_f32_16x16x32_bf16 v[116:119], a[248:251], a[132:135], v[116:119]
buffer_load_dwordx4 v13, s[16:19], s40 offen lds
v_mfma_f32_16x16x32_bf16 v[120:123], a[248:251], a[136:139], v[120:123]
ds_read_b64_tr_b16 a[236:237], v14 offset:12296
v_mfma_f32_16x16x32_bf16 v[120:123], a[252:255], a[152:155], v[120:123]
s_mov_b32 s40, 1622016
ds_read_b64_tr_b16 a[238:239], v14 offset:14344
v_mfma_f32_16x16x32_bf16 v[124:127], a[252:255], a[156:159], v[124:127]
s_add_u32 m0, s37, 107520
v_mfma_f32_16x16x32_bf16 v[124:127], a[248:251], a[140:143], v[124:127]
s_waitcnt lgkmcnt(5)
buffer_load_dwordx4 v13, s[16:19], s40 offen lds
v_mfma_f32_16x16x32_bf16 v[128:131], a[224:227], a[128:131], v[128:131]
ds_read_b64_tr_b16 a[240:241], v15 offset:8192
v_mfma_f32_16x16x32_bf16 v[128:131], a[228:231], a[144:147], v[128:131]
s_mov_b32 s40, 1585152
ds_read_b64_tr_b16 a[242:243], v15 offset:10240
v_mfma_f32_16x16x32_bf16 v[132:135], a[228:231], a[148:151], v[132:135]
s_add_u32 m0, s37, 108544
v_mfma_f32_16x16x32_bf16 v[132:135], a[224:227], a[132:135], v[132:135]
buffer_load_dwordx4 v13, s[16:19], s40 offen lds
v_mfma_f32_16x16x32_bf16 v[136:139], a[224:227], a[136:139], v[136:139]
ds_read_b64_tr_b16 a[244:245], v15 offset:12288
v_mfma_f32_16x16x32_bf16 v[136:139], a[228:231], a[152:155], v[136:139]
s_mov_b32 s40, 1634304
ds_read_b64_tr_b16 a[246:247], v15 offset:14336
v_mfma_f32_16x16x32_bf16 v[140:143], a[228:231], a[156:159], v[140:143]
s_add_u32 m0, s37, 109568
v_mfma_f32_16x16x32_bf16 v[140:143], a[224:227], a[140:143], v[140:143]
s_waitcnt lgkmcnt(4)
buffer_load_dwordx4 v13, s[16:19], s40 offen lds
v_mfma_f32_16x16x32_bf16 v[144:147], a[232:235], a[128:131], v[144:147]
ds_read_b64_tr_b16 a[248:249], v15 offset:8200
v_mfma_f32_16x16x32_bf16 v[144:147], a[236:239], a[144:147], v[144:147]
ds_read_b64_tr_b16 a[250:251], v15 offset:10248
v_mfma_f32_16x16x32_bf16 v[148:151], a[236:239], a[148:151], v[148:151]
s_xor_b32 s41, s3, 65536
v_mfma_f32_16x16x32_bf16 v[148:151], a[232:235], a[132:135], v[148:151]
buffer_load_dwordx4 a[192:195], v3, s[20:23], s41 offen sc1
v_mfma_f32_16x16x32_bf16 v[152:155], a[232:235], a[136:139], v[152:155]
ds_read_b64_tr_b16 a[252:253], v15 offset:12296
v_mfma_f32_16x16x32_bf16 v[152:155], a[236:239], a[152:155], v[152:155]
ds_read_b64_tr_b16 a[254:255], v15 offset:14344
v_mfma_f32_16x16x32_bf16 v[156:159], a[236:239], a[156:159], v[156:159]
s_xor_b32 s41, s3, 66560
v_mfma_f32_16x16x32_bf16 v[156:159], a[232:235], a[140:143], v[156:159]
s_waitcnt lgkmcnt(4)
buffer_load_dwordx4 a[196:199], v3, s[20:23], s41 offen sc1
v_mfma_f32_16x16x32_bf16 v[160:163], a[240:243], a[128:131], v[160:163]
ds_read_b64_tr_b16 a[224:225], v14 offset:16384
v_mfma_f32_16x16x32_bf16 v[160:163], a[244:247], a[144:147], v[160:163]
ds_read_b64_tr_b16 a[226:227], v14 offset:18432
v_mfma_f32_16x16x32_bf16 v[164:167], a[244:247], a[148:151], v[164:167]
s_xor_b32 s41, s3, 67584
v_mfma_f32_16x16x32_bf16 v[164:167], a[240:243], a[132:135], v[164:167]
buffer_load_dwordx4 a[200:203], v3, s[20:23], s41 offen sc1
v_mfma_f32_16x16x32_bf16 v[168:171], a[240:243], a[136:139], v[168:171]
ds_read_b64_tr_b16 a[228:229], v14 offset:20480
v_mfma_f32_16x16x32_bf16 v[168:171], a[244:247], a[152:155], v[168:171]
ds_read_b64_tr_b16 a[230:231], v14 offset:22528
v_mfma_f32_16x16x32_bf16 v[172:175], a[244:247], a[156:159], v[172:175]
s_xor_b32 s41, s3, 68608
v_mfma_f32_16x16x32_bf16 v[172:175], a[240:243], a[140:143], v[172:175]
s_waitcnt lgkmcnt(4)
buffer_load_dwordx4 a[204:207], v3, s[20:23], s41 offen sc1
v_mfma_f32_16x16x32_bf16 v[176:179], a[248:251], a[128:131], v[176:179]
ds_read_b64_tr_b16 a[232:233], v14 offset:16392
v_mfma_f32_16x16x32_bf16 v[176:179], a[252:255], a[144:147], v[176:179]
ds_read_b64_tr_b16 a[234:235], v14 offset:18440
v_mfma_f32_16x16x32_bf16 v[180:183], a[252:255], a[148:151], v[180:183]
s_xor_b32 s41, s3, 69632
v_mfma_f32_16x16x32_bf16 v[180:183], a[248:251], a[132:135], v[180:183]
buffer_load_dwordx4 a[208:211], v3, s[20:23], s41 offen sc1
v_mfma_f32_16x16x32_bf16 v[184:187], a[248:251], a[136:139], v[184:187]
ds_read_b64_tr_b16 a[236:237], v14 offset:20488
v_mfma_f32_16x16x32_bf16 v[184:187], a[252:255], a[152:155], v[184:187]
ds_read_b64_tr_b16 a[238:239], v14 offset:22536
v_mfma_f32_16x16x32_bf16 v[188:191], a[252:255], a[156:159], v[188:191]
s_xor_b32 s41, s3, 70656
v_mfma_f32_16x16x32_bf16 v[188:191], a[248:251], a[140:143], v[188:191]
s_waitcnt lgkmcnt(4)
buffer_load_dwordx4 a[212:215], v3, s[20:23], s41 offen sc1
v_mfma_f32_16x16x32_bf16 v[192:195], a[224:227], a[128:131], v[192:195]
ds_read_b64_tr_b16 a[240:241], v15 offset:16384
v_mfma_f32_16x16x32_bf16 v[192:195], a[228:231], a[144:147], v[192:195]
ds_read_b64_tr_b16 a[242:243], v15 offset:18432
v_mfma_f32_16x16x32_bf16 v[196:199], a[228:231], a[148:151], v[196:199]
s_xor_b32 s41, s3, 71680
v_mfma_f32_16x16x32_bf16 v[196:199], a[224:227], a[132:135], v[196:199]
buffer_load_dwordx4 a[216:219], v3, s[20:23], s41 offen sc1
v_mfma_f32_16x16x32_bf16 v[200:203], a[224:227], a[136:139], v[200:203]
ds_read_b64_tr_b16 a[244:245], v15 offset:20480
v_mfma_f32_16x16x32_bf16 v[200:203], a[228:231], a[152:155], v[200:203]
ds_read_b64_tr_b16 a[246:247], v15 offset:22528
v_mfma_f32_16x16x32_bf16 v[204:207], a[228:231], a[156:159], v[204:207]
s_xor_b32 s41, s3, 72704
v_mfma_f32_16x16x32_bf16 v[204:207], a[224:227], a[140:143], v[204:207]
s_waitcnt lgkmcnt(4)
buffer_load_dwordx4 a[220:223], v3, s[20:23], s41 offen sc1
v_mfma_f32_16x16x32_bf16 v[208:211], a[232:235], a[128:131], v[208:211]
ds_read_b64_tr_b16 a[248:249], v15 offset:16392
v_mfma_f32_16x16x32_bf16 v[208:211], a[236:239], a[144:147], v[208:211]
ds_read_b64_tr_b16 a[250:251], v15 offset:18440
v_mfma_f32_16x16x32_bf16 v[212:215], a[236:239], a[148:151], v[212:215]
v_mfma_f32_16x16x32_bf16 v[212:215], a[232:235], a[132:135], v[212:215]
v_mfma_f32_16x16x32_bf16 v[216:219], a[232:235], a[136:139], v[216:219]
ds_read_b64_tr_b16 a[252:253], v15 offset:20488
v_mfma_f32_16x16x32_bf16 v[216:219], a[236:239], a[152:155], v[216:219]
ds_read_b64_tr_b16 a[254:255], v15 offset:22536
v_mfma_f32_16x16x32_bf16 v[220:223], a[236:239], a[156:159], v[220:223]
v_mfma_f32_16x16x32_bf16 v[220:223], a[232:235], a[140:143], v[220:223]
s_waitcnt lgkmcnt(4)
v_mfma_f32_16x16x32_bf16 v[224:227], a[240:243], a[128:131], v[224:227]
ds_read_b64_tr_b16 a[224:225], v18 offset:0
v_mfma_f32_16x16x32_bf16 v[224:227], a[244:247], a[144:147], v[224:227]
ds_read_b64_tr_b16 a[226:227], v18 offset:2048
v_mfma_f32_16x16x32_bf16 v[228:231], a[244:247], a[148:151], v[228:231]
v_mfma_f32_16x16x32_bf16 v[228:231], a[240:243], a[132:135], v[228:231]
v_mfma_f32_16x16x32_bf16 v[232:235], a[240:243], a[136:139], v[232:235]
ds_read_b64_tr_b16 a[228:229], v18 offset:4096
v_mfma_f32_16x16x32_bf16 v[232:235], a[244:247], a[152:155], v[232:235]
ds_read_b64_tr_b16 a[230:231], v18 offset:6144
v_mfma_f32_16x16x32_bf16 v[236:239], a[244:247], a[156:159], v[236:239]
v_mfma_f32_16x16x32_bf16 v[236:239], a[240:243], a[140:143], v[236:239]
s_waitcnt lgkmcnt(4)
v_mfma_f32_16x16x32_bf16 v[240:243], a[248:251], a[128:131], v[240:243]
ds_read_b64_tr_b16 a[232:233], v19 offset:0
v_mfma_f32_16x16x32_bf16 v[240:243], a[252:255], a[144:147], v[240:243]
ds_read_b64_tr_b16 a[234:235], v19 offset:2048
v_mfma_f32_16x16x32_bf16 v[244:247], a[252:255], a[148:151], v[244:247]
v_mfma_f32_16x16x32_bf16 v[244:247], a[248:251], a[132:135], v[244:247]
v_mfma_f32_16x16x32_bf16 v[248:251], a[248:251], a[136:139], v[248:251]
ds_read_b64_tr_b16 a[236:237], v19 offset:4096
v_mfma_f32_16x16x32_bf16 v[248:251], a[252:255], a[152:155], v[248:251]
ds_read_b64_tr_b16 a[238:239], v19 offset:6144
v_mfma_f32_16x16x32_bf16 v[252:255], a[252:255], a[156:159], v[252:255]
v_mfma_f32_16x16x32_bf16 v[252:255], a[248:251], a[140:143], v[252:255]
s_waitcnt lgkmcnt(4)
v_mfma_f32_16x16x32_bf16 a[0:3], a[224:227], a[128:131], a[0:3]
ds_read_b64_tr_b16 a[240:241], v20 offset:0
v_mfma_f32_16x16x32_bf16 a[0:3], a[228:231], a[144:147], a[0:3]
ds_read_b64_tr_b16 a[242:243], v20 offset:2048
v_mfma_f32_16x16x32_bf16 a[4:7], a[228:231], a[148:151], a[4:7]
v_mfma_f32_16x16x32_bf16 a[4:7], a[224:227], a[132:135], a[4:7]
v_mfma_f32_16x16x32_bf16 a[8:11], a[224:227], a[136:139], a[8:11]
ds_read_b64_tr_b16 a[244:245], v20 offset:4096
v_mfma_f32_16x16x32_bf16 a[8:11], a[228:231], a[152:155], a[8:11]
ds_read_b64_tr_b16 a[246:247], v20 offset:6144
v_mfma_f32_16x16x32_bf16 a[12:15], a[228:231], a[156:159], a[12:15]
v_mfma_f32_16x16x32_bf16 a[12:15], a[224:227], a[140:143], a[12:15]
s_waitcnt lgkmcnt(4)
v_mfma_f32_16x16x32_bf16 a[16:19], a[232:235], a[128:131], a[16:19]
ds_read_b64_tr_b16 a[248:249], v21 offset:0
v_mfma_f32_16x16x32_bf16 a[16:19], a[236:239], a[144:147], a[16:19]
ds_read_b64_tr_b16 a[250:251], v21 offset:2048
v_mfma_f32_16x16x32_bf16 a[20:23], a[236:239], a[148:151], a[20:23]
v_mfma_f32_16x16x32_bf16 a[20:23], a[232:235], a[132:135], a[20:23]
v_mfma_f32_16x16x32_bf16 a[24:27], a[232:235], a[136:139], a[24:27]
ds_read_b64_tr_b16 a[252:253], v21 offset:4096
v_mfma_f32_16x16x32_bf16 a[24:27], a[236:239], a[152:155], a[24:27]
ds_read_b64_tr_b16 a[254:255], v21 offset:6144
v_mfma_f32_16x16x32_bf16 a[28:31], a[236:239], a[156:159], a[28:31]
buffer_store_dwordx4 v[28:31], v1, s[60:63], s69 offen offset:3072 sc1
v_mfma_f32_16x16x32_bf16 a[28:31], a[232:235], a[140:143], a[28:31]
s_waitcnt lgkmcnt(4)
v_mfma_f32_16x16x32_bf16 a[32:35], a[240:243], a[128:131], a[32:35]
ds_read_b64_tr_b16 a[224:225], v18 offset:8192
v_mfma_f32_16x16x32_bf16 a[32:35], a[244:247], a[144:147], a[32:35]
ds_read_b64_tr_b16 a[226:227], v18 offset:10240
v_mfma_f32_16x16x32_bf16 a[36:39], a[244:247], a[148:151], a[36:39]
v_mfma_f32_16x16x32_bf16 a[36:39], a[240:243], a[132:135], a[36:39]
v_mfma_f32_16x16x32_bf16 a[40:43], a[240:243], a[136:139], a[40:43]
ds_read_b64_tr_b16 a[228:229], v18 offset:12288
v_mfma_f32_16x16x32_bf16 a[40:43], a[244:247], a[152:155], a[40:43]
ds_read_b64_tr_b16 a[230:231], v18 offset:14336
v_mfma_f32_16x16x32_bf16 a[44:47], a[244:247], a[156:159], a[44:47]
ds_read_b64_tr_b16 a[232:233], v19 offset:8192
v_mfma_f32_16x16x32_bf16 a[44:47], a[240:243], a[140:143], a[44:47]
s_waitcnt lgkmcnt(5)
ds_read_b64_tr_b16 a[234:235], v19 offset:10240
v_mfma_f32_16x16x32_bf16 a[48:51], a[248:251], a[128:131], a[48:51]
s_add_u32 s69, s69, 1024
v_mfma_f32_16x16x32_bf16 a[48:51], a[252:255], a[144:147], a[48:51]
buffer_store_dwordx4 v[32:35], v59, s[60:63], s69 offen offset:0 sc1
v_mfma_f32_16x16x32_bf16 a[52:55], a[252:255], a[148:151], a[52:55]
ds_read_b64_tr_b16 a[236:237], v19 offset:12288
v_mfma_f32_16x16x32_bf16 a[52:55], a[248:251], a[132:135], a[52:55]
ds_read_b64_tr_b16 a[238:239], v19 offset:14336
v_mfma_f32_16x16x32_bf16 a[56:59], a[248:251], a[136:139], a[56:59]
v_mfma_f32_16x16x32_bf16 a[56:59], a[252:255], a[152:155], a[56:59]
v_mfma_f32_16x16x32_bf16 a[60:63], a[252:255], a[156:159], a[60:63]
ds_read_b64_tr_b16 a[240:241], v20 offset:8192
v_mfma_f32_16x16x32_bf16 a[60:63], a[248:251], a[140:143], a[60:63]
s_waitcnt lgkmcnt(5)
ds_read_b64_tr_b16 a[242:243], v20 offset:10240
v_mfma_f32_16x16x32_bf16 a[64:67], a[224:227], a[128:131], a[64:67]
buffer_store_dwordx4 v[36:39], v59, s[60:63], s69 offen offset:1024 sc1
v_mfma_f32_16x16x32_bf16 a[64:67], a[228:231], a[144:147], a[64:67]
v_mfma_f32_16x16x32_bf16 a[68:71], a[228:231], a[148:151], a[68:71]
ds_read_b64_tr_b16 a[244:245], v20 offset:12288
v_mfma_f32_16x16x32_bf16 a[68:71], a[224:227], a[132:135], a[68:71]
ds_read_b64_tr_b16 a[246:247], v20 offset:14336
v_mfma_f32_16x16x32_bf16 a[72:75], a[224:227], a[136:139], a[72:75]
v_mfma_f32_16x16x32_bf16 a[72:75], a[228:231], a[152:155], a[72:75]
v_mfma_f32_16x16x32_bf16 a[76:79], a[228:231], a[156:159], a[76:79]
ds_read_b64_tr_b16 a[248:249], v21 offset:8192
v_mfma_f32_16x16x32_bf16 a[76:79], a[224:227], a[140:143], a[76:79]
s_waitcnt lgkmcnt(5)
ds_read_b64_tr_b16 a[250:251], v21 offset:10240
v_mfma_f32_16x16x32_bf16 a[80:83], a[232:235], a[128:131], a[80:83]
v_mfma_f32_16x16x32_bf16 a[80:83], a[236:239], a[144:147], a[80:83]
v_mfma_f32_16x16x32_bf16 a[84:87], a[236:239], a[148:151], a[84:87]
ds_read_b64_tr_b16 a[252:253], v21 offset:12288
v_mfma_f32_16x16x32_bf16 a[84:87], a[232:235], a[132:135], a[84:87]
ds_read_b64_tr_b16 a[254:255], v21 offset:14336
v_mfma_f32_16x16x32_bf16 a[88:91], a[232:235], a[136:139], a[88:91]
v_mfma_f32_16x16x32_bf16 a[88:91], a[236:239], a[152:155], a[88:91]
v_mfma_f32_16x16x32_bf16 a[92:95], a[236:239], a[156:159], a[92:95]
v_mfma_f32_16x16x32_bf16 a[92:95], a[232:235], a[140:143], a[92:95]
s_waitcnt vmcnt(25) lgkmcnt(0)
v_mfma_f32_16x16x32_bf16 a[96:99], a[240:243], a[128:131], a[96:99]
s_barrier
v_mfma_f32_16x16x32_bf16 a[96:99], a[244:247], a[144:147], a[96:99]
ds_read_b64_tr_b16 a[224:225], v14 offset:40960
v_mfma_f32_16x16x32_bf16 a[100:103], a[244:247], a[148:151], a[100:103]
ds_read_b64_tr_b16 a[226:227], v14 offset:43008
v_mfma_f32_16x16x32_bf16 a[100:103], a[240:243], a[132:135], a[100:103]
ds_read_b64_tr_b16 a[228:229], v14 offset:45056
v_mfma_f32_16x16x32_bf16 a[104:107], a[240:243], a[136:139], a[104:107]
ds_read_b64_tr_b16 a[230:231], v14 offset:47104
v_mfma_f32_16x16x32_bf16 a[104:107], a[244:247], a[152:155], a[104:107]
ds_read_b64_tr_b16 a[232:233], v14 offset:40968
v_mfma_f32_16x16x32_bf16 a[108:111], a[244:247], a[156:159], a[108:111]
ds_read_b64_tr_b16 a[234:235], v14 offset:43016
v_mfma_f32_16x16x32_bf16 a[108:111], a[240:243], a[140:143], a[108:111]
ds_read_b64_tr_b16 a[236:237], v14 offset:45064
v_mfma_f32_16x16x32_bf16 a[112:115], a[248:251], a[128:131], a[112:115]
ds_read_b64_tr_b16 a[238:239], v14 offset:47112
v_mfma_f32_16x16x32_bf16 a[112:115], a[252:255], a[144:147], a[112:115]
v_mfma_f32_16x16x32_bf16 a[116:119], a[252:255], a[148:151], a[116:119]
v_mfma_f32_16x16x32_bf16 a[116:119], a[248:251], a[132:135], a[116:119]
v_mfma_f32_16x16x32_bf16 a[120:123], a[248:251], a[136:139], a[120:123]
v_mfma_f32_16x16x32_bf16 a[120:123], a[252:255], a[152:155], a[120:123]
v_mfma_f32_16x16x32_bf16 a[124:127], a[252:255], a[156:159], a[124:127]
v_mfma_f32_16x16x32_bf16 a[124:127], a[248:251], a[140:143], a[124:127]
s_waitcnt lgkmcnt(4)
v_mfma_f32_16x16x32_bf16 v[64:67], a[224:227], a[160:163], v[64:67]
ds_read_b64_tr_b16 a[240:241], v15 offset:40960
v_mfma_f32_16x16x32_bf16 v[64:67], a[228:231], a[176:179], v[64:67]
s_mov_b32 s40, 7077888
ds_read_b64_tr_b16 a[242:243], v15 offset:43008
v_mfma_f32_16x16x32_bf16 v[68:71], a[228:231], a[180:183], v[68:71]
s_add_u32 m0, s36, 0
ds_read_b64_tr_b16 v[40:41], v58 offset:1024
v_mfma_f32_16x16x32_bf16 v[68:71], a[224:227], a[164:167], v[68:71]
buffer_load_dwordx4 v12, s[12:15], s40 offen offset:0 lds
v_mfma_f32_16x16x32_bf16 v[72:75], a[224:227], a[168:171], v[72:75]
ds_read_b64_tr_b16 a[244:245], v15 offset:45056
v_mfma_f32_16x16x32_bf16 v[72:75], a[228:231], a[184:187], v[72:75]
ds_read_b64_tr_b16 a[246:247], v15 offset:47104
v_mfma_f32_16x16x32_bf16 v[76:79], a[228:231], a[188:191], v[76:79]
s_add_u32 m0, s36, 8064
ds_read_b64_tr_b16 v[42:43], v58 offset:21504
v_mfma_f32_16x16x32_bf16 v[76:79], a[224:227], a[172:175], v[76:79]
s_waitcnt lgkmcnt(6)
buffer_load_dwordx4 v12, s[12:15], s40 offen offset:128 lds
v_mfma_f32_16x16x32_bf16 v[80:83], a[232:235], a[160:163], v[80:83]
ds_read_b64_tr_b16 a[248:249], v15 offset:40968
v_mfma_f32_16x16x32_bf16 v[80:83], a[236:239], a[176:179], v[80:83]
ds_read_b64_tr_b16 a[250:251], v15 offset:43016
v_mfma_f32_16x16x32_bf16 v[84:87], a[236:239], a[180:183], v[84:87]
s_add_u32 m0, s36, 16128
ds_read_b64_tr_b16 v[28:29], v55 offset:2048
v_mfma_f32_16x16x32_bf16 v[84:87], a[232:235], a[164:167], v[84:87]
buffer_load_dwordx4 v12, s[12:15], s40 offen offset:256 lds
v_mfma_f32_16x16x32_bf16 v[88:91], a[232:235], a[168:171], v[88:91]
ds_read_b64_tr_b16 a[252:253], v15 offset:45064
v_mfma_f32_16x16x32_bf16 v[88:91], a[236:239], a[184:187], v[88:91]
s_mov_b32 s40, 7274496
ds_read_b64_tr_b16 a[254:255], v15 offset:47112
v_mfma_f32_16x16x32_bf16 v[92:95], a[236:239], a[188:191], v[92:95]
s_add_u32 m0, s36, 1024
ds_read_b64_tr_b16 v[30:31], v55 offset:22528
v_mfma_f32_16x16x32_bf16 v[92:95], a[232:235], a[172:175], v[92:95]
s_waitcnt lgkmcnt(7)
buffer_load_dwordx4 v12, s[12:15], s40 offen offset:0 lds
v_mfma_f32_16x16x32_bf16 v[96:99], a[240:243], a[160:163], v[96:99]
ds_read_b64_tr_b16 a[224:225], v14 offset:49152
v_mfma_f32_16x16x32_bf16 v[96:99], a[244:247], a[176:179], v[96:99]
ds_read_b64_tr_b16 a[226:227], v14 offset:51200
v_mfma_f32_16x16x32_bf16 v[100:103], a[244:247], a[180:183], v[100:103]
s_add_u32 m0, s36, 9088
ds_read_b64_tr_b16 v[32:33], v56 offset:2048
v_mfma_f32_16x16x32_bf16 v[100:103], a[240:243], a[164:167], v[100:103]
buffer_load_dwordx4 v12, s[12:15], s40 offen offset:128 lds
v_mfma_f32_16x16x32_bf16 v[104:107], a[240:243], a[168:171], v[104:107]
ds_read_b64_tr_b16 a[228:229], v14 offset:53248
v_mfma_f32_16x16x32_bf16 v[104:107], a[244:247], a[184:187], v[104:107]
ds_read_b64_tr_b16 a[230:231], v14 offset:55296
v_mfma_f32_16x16x32_bf16 v[108:111], a[244:247], a[188:191], v[108:111]
s_add_u32 m0, s36, 17152
ds_read_b64_tr_b16 v[34:35], v56 offset:22528
v_mfma_f32_16x16x32_bf16 v[108:111], a[240:243], a[172:175], v[108:111]
s_waitcnt lgkmcnt(7)
buffer_load_dwordx4 v12, s[12:15], s40 offen offset:256 lds
v_mfma_f32_16x16x32_bf16 v[112:115], a[248:251], a[160:163], v[112:115]
ds_read_b64_tr_b16 a[232:233], v14 offset:49160
v_mfma_f32_16x16x32_bf16 v[112:115], a[252:255], a[176:179], v[112:115]
s_mov_b32 s40, 1769472
ds_read_b64_tr_b16 a[234:235], v14 offset:51208
v_mfma_f32_16x16x32_bf16 v[116:119], a[252:255], a[180:183], v[116:119]
s_add_u32 m0, s37, 24576
v_mfma_f32_16x16x32_bf16 v[116:119], a[248:251], a[164:167], v[116:119]
buffer_load_dwordx4 v13, s[16:19], s40 offen lds
v_mfma_f32_16x16x32_bf16 v[120:123], a[248:251], a[168:171], v[120:123]
ds_read_b64_tr_b16 a[236:237], v14 offset:53256
v_mfma_f32_16x16x32_bf16 v[120:123], a[252:255], a[184:187], v[120:123]
s_mov_b32 s40, 1818624
ds_read_b64_tr_b16 a[238:239], v14 offset:55304
v_mfma_f32_16x16x32_bf16 v[124:127], a[252:255], a[188:191], v[124:127]
s_add_u32 m0, s37, 25600
v_mfma_f32_16x16x32_bf16 v[124:127], a[248:251], a[172:175], v[124:127]
s_waitcnt lgkmcnt(5)
buffer_load_dwordx4 v13, s[16:19], s40 offen lds
v_mfma_f32_16x16x32_bf16 v[128:131], a[224:227], a[160:163], v[128:131]
ds_read_b64_tr_b16 a[240:241], v15 offset:49152
v_mfma_f32_16x16x32_bf16 v[128:131], a[228:231], a[176:179], v[128:131]
s_mov_b32 s40, 1781760
ds_read_b64_tr_b16 a[242:243], v15 offset:51200
v_mfma_f32_16x16x32_bf16 v[132:135], a[228:231], a[180:183], v[132:135]
s_add_u32 m0, s37, 26624
v_mfma_f32_16x16x32_bf16 v[132:135], a[224:227], a[164:167], v[132:135]
buffer_load_dwordx4 v13, s[16:19], s40 offen lds
v_mfma_f32_16x16x32_bf16 v[136:139], a[224:227], a[168:171], v[136:139]
ds_read_b64_tr_b16 a[244:245], v15 offset:53248
v_mfma_f32_16x16x32_bf16 v[136:139], a[228:231], a[184:187], v[136:139]
s_mov_b32 s40, 1830912
ds_read_b64_tr_b16 a[246:247], v15 offset:55296
v_mfma_f32_16x16x32_bf16 v[140:143], a[228:231], a[188:191], v[140:143]
s_add_u32 m0, s37, 27648
v_mfma_f32_16x16x32_bf16 v[140:143], a[224:227], a[172:175], v[140:143]
s_waitcnt lgkmcnt(4)
buffer_load_dwordx4 v13, s[16:19], s40 offen lds
v_mfma_f32_16x16x32_bf16 v[144:147], a[232:235], a[160:163], v[144:147]
ds_read_b64_tr_b16 a[248:249], v15 offset:49160
v_mfma_f32_16x16x32_bf16 v[144:147], a[236:239], a[176:179], v[144:147]
ds_read_b64_tr_b16 a[250:251], v15 offset:51208
v_mfma_f32_16x16x32_bf16 v[148:151], a[236:239], a[180:183], v[148:151]
s_xor_b32 s41, s3, 73728
v_mfma_f32_16x16x32_bf16 v[148:151], a[232:235], a[164:167], v[148:151]
buffer_load_dwordx4 a[128:131], v3, s[20:23], s41 offen sc1
v_mfma_f32_16x16x32_bf16 v[152:155], a[232:235], a[168:171], v[152:155]
ds_read_b64_tr_b16 a[252:253], v15 offset:53256
v_mfma_f32_16x16x32_bf16 v[152:155], a[236:239], a[184:187], v[152:155]
ds_read_b64_tr_b16 a[254:255], v15 offset:55304
v_mfma_f32_16x16x32_bf16 v[156:159], a[236:239], a[188:191], v[156:159]
s_xor_b32 s41, s3, 74752
v_mfma_f32_16x16x32_bf16 v[156:159], a[232:235], a[172:175], v[156:159]
s_waitcnt lgkmcnt(4)
buffer_load_dwordx4 a[132:135], v3, s[20:23], s41 offen sc1
v_mfma_f32_16x16x32_bf16 v[160:163], a[240:243], a[160:163], v[160:163]
ds_read_b64_tr_b16 a[224:225], v14 offset:57344
v_mfma_f32_16x16x32_bf16 v[160:163], a[244:247], a[176:179], v[160:163]
ds_read_b64_tr_b16 a[226:227], v14 offset:59392
v_mfma_f32_16x16x32_bf16 v[164:167], a[244:247], a[180:183], v[164:167]
s_xor_b32 s41, s3, 75776
v_mfma_f32_16x16x32_bf16 v[164:167], a[240:243], a[164:167], v[164:167]
buffer_load_dwordx4 a[136:139], v3, s[20:23], s41 offen sc1
v_mfma_f32_16x16x32_bf16 v[168:171], a[240:243], a[168:171], v[168:171]
ds_read_b64_tr_b16 a[228:229], v14 offset:61440
v_mfma_f32_16x16x32_bf16 v[168:171], a[244:247], a[184:187], v[168:171]
ds_read_b64_tr_b16 a[230:231], v14 offset:63488
v_mfma_f32_16x16x32_bf16 v[172:175], a[244:247], a[188:191], v[172:175]
s_xor_b32 s41, s3, 76800
v_mfma_f32_16x16x32_bf16 v[172:175], a[240:243], a[172:175], v[172:175]
s_waitcnt lgkmcnt(4)
buffer_load_dwordx4 a[140:143], v3, s[20:23], s41 offen sc1
v_mfma_f32_16x16x32_bf16 v[176:179], a[248:251], a[160:163], v[176:179]
ds_read_b64_tr_b16 a[232:233], v14 offset:57352
v_mfma_f32_16x16x32_bf16 v[176:179], a[252:255], a[176:179], v[176:179]
ds_read_b64_tr_b16 a[234:235], v14 offset:59400
v_mfma_f32_16x16x32_bf16 v[180:183], a[252:255], a[180:183], v[180:183]
s_xor_b32 s41, s3, 77824
v_mfma_f32_16x16x32_bf16 v[180:183], a[248:251], a[164:167], v[180:183]
buffer_load_dwordx4 a[144:147], v3, s[20:23], s41 offen sc1
v_mfma_f32_16x16x32_bf16 v[184:187], a[248:251], a[168:171], v[184:187]
ds_read_b64_tr_b16 a[236:237], v14 offset:61448
v_mfma_f32_16x16x32_bf16 v[184:187], a[252:255], a[184:187], v[184:187]
ds_read_b64_tr_b16 a[238:239], v14 offset:63496
v_mfma_f32_16x16x32_bf16 v[188:191], a[252:255], a[188:191], v[188:191]
s_xor_b32 s41, s3, 78848
v_mfma_f32_16x16x32_bf16 v[188:191], a[248:251], a[172:175], v[188:191]
s_waitcnt lgkmcnt(4)
buffer_load_dwordx4 a[148:151], v3, s[20:23], s41 offen sc1
v_mfma_f32_16x16x32_bf16 v[192:195], a[224:227], a[160:163], v[192:195]
ds_read_b64_tr_b16 a[240:241], v15 offset:57344
v_mfma_f32_16x16x32_bf16 v[192:195], a[228:231], a[176:179], v[192:195]
ds_read_b64_tr_b16 a[242:243], v15 offset:59392
v_mfma_f32_16x16x32_bf16 v[196:199], a[228:231], a[180:183], v[196:199]
s_xor_b32 s41, s3, 79872
v_mfma_f32_16x16x32_bf16 v[196:199], a[224:227], a[164:167], v[196:199]
buffer_load_dwordx4 a[152:155], v3, s[20:23], s41 offen sc1
v_mfma_f32_16x16x32_bf16 v[200:203], a[224:227], a[168:171], v[200:203]
ds_read_b64_tr_b16 a[244:245], v15 offset:61440
v_mfma_f32_16x16x32_bf16 v[200:203], a[228:231], a[184:187], v[200:203]
ds_read_b64_tr_b16 a[246:247], v15 offset:63488
v_mfma_f32_16x16x32_bf16 v[204:207], a[228:231], a[188:191], v[204:207]
s_xor_b32 s41, s3, 80896
v_mfma_f32_16x16x32_bf16 v[204:207], a[224:227], a[172:175], v[204:207]
s_waitcnt lgkmcnt(4)
buffer_load_dwordx4 a[156:159], v3, s[20:23], s41 offen sc1
v_mfma_f32_16x16x32_bf16 v[208:211], a[232:235], a[160:163], v[208:211]
ds_read_b64_tr_b16 a[248:249], v15 offset:57352
v_mfma_f32_16x16x32_bf16 v[208:211], a[236:239], a[176:179], v[208:211]
ds_read_b64_tr_b16 a[250:251], v15 offset:59400
v_mfma_f32_16x16x32_bf16 v[212:215], a[236:239], a[180:183], v[212:215]
v_mfma_f32_16x16x32_bf16 v[212:215], a[232:235], a[164:167], v[212:215]
v_mfma_f32_16x16x32_bf16 v[216:219], a[232:235], a[168:171], v[216:219]
ds_read_b64_tr_b16 a[252:253], v15 offset:61448
v_mfma_f32_16x16x32_bf16 v[216:219], a[236:239], a[184:187], v[216:219]
ds_read_b64_tr_b16 a[254:255], v15 offset:63496
v_mfma_f32_16x16x32_bf16 v[220:223], a[236:239], a[188:191], v[220:223]
v_mfma_f32_16x16x32_bf16 v[220:223], a[232:235], a[172:175], v[220:223]
s_waitcnt lgkmcnt(4)
v_mfma_f32_16x16x32_bf16 v[224:227], a[240:243], a[160:163], v[224:227]
ds_read_b64_tr_b16 a[224:225], v18 offset:40960
v_mfma_f32_16x16x32_bf16 v[224:227], a[244:247], a[176:179], v[224:227]
ds_read_b64_tr_b16 a[226:227], v18 offset:43008
v_mfma_f32_16x16x32_bf16 v[228:231], a[244:247], a[180:183], v[228:231]
v_mfma_f32_16x16x32_bf16 v[228:231], a[240:243], a[164:167], v[228:231]
v_mfma_f32_16x16x32_bf16 v[232:235], a[240:243], a[168:171], v[232:235]
ds_read_b64_tr_b16 a[228:229], v18 offset:45056
v_mfma_f32_16x16x32_bf16 v[232:235], a[244:247], a[184:187], v[232:235]
ds_read_b64_tr_b16 a[230:231], v18 offset:47104
v_mfma_f32_16x16x32_bf16 v[236:239], a[244:247], a[188:191], v[236:239]
v_mfma_f32_16x16x32_bf16 v[236:239], a[240:243], a[172:175], v[236:239]
s_waitcnt lgkmcnt(4)
v_mfma_f32_16x16x32_bf16 v[240:243], a[248:251], a[160:163], v[240:243]
ds_read_b64_tr_b16 a[232:233], v19 offset:40960
v_mfma_f32_16x16x32_bf16 v[240:243], a[252:255], a[176:179], v[240:243]
ds_read_b64_tr_b16 a[234:235], v19 offset:43008
v_mfma_f32_16x16x32_bf16 v[244:247], a[252:255], a[180:183], v[244:247]
v_mfma_f32_16x16x32_bf16 v[244:247], a[248:251], a[164:167], v[244:247]
v_mfma_f32_16x16x32_bf16 v[248:251], a[248:251], a[168:171], v[248:251]
ds_read_b64_tr_b16 a[236:237], v19 offset:45056
v_mfma_f32_16x16x32_bf16 v[248:251], a[252:255], a[184:187], v[248:251]
ds_read_b64_tr_b16 a[238:239], v19 offset:47104
v_mfma_f32_16x16x32_bf16 v[252:255], a[252:255], a[188:191], v[252:255]
v_mfma_f32_16x16x32_bf16 v[252:255], a[248:251], a[172:175], v[252:255]
s_waitcnt lgkmcnt(4)
v_mfma_f32_16x16x32_bf16 a[0:3], a[224:227], a[160:163], a[0:3]
ds_read_b64_tr_b16 a[240:241], v20 offset:40960
v_mfma_f32_16x16x32_bf16 a[0:3], a[228:231], a[176:179], a[0:3]
ds_read_b64_tr_b16 a[242:243], v20 offset:43008
v_mfma_f32_16x16x32_bf16 a[4:7], a[228:231], a[180:183], a[4:7]
v_mfma_f32_16x16x32_bf16 a[4:7], a[224:227], a[164:167], a[4:7]
v_mfma_f32_16x16x32_bf16 a[8:11], a[224:227], a[168:171], a[8:11]
ds_read_b64_tr_b16 a[244:245], v20 offset:45056
v_mfma_f32_16x16x32_bf16 a[8:11], a[228:231], a[184:187], a[8:11]
ds_read_b64_tr_b16 a[246:247], v20 offset:47104
v_mfma_f32_16x16x32_bf16 a[12:15], a[228:231], a[188:191], a[12:15]
v_mfma_f32_16x16x32_bf16 a[12:15], a[224:227], a[172:175], a[12:15]
s_waitcnt lgkmcnt(4)
v_mfma_f32_16x16x32_bf16 a[16:19], a[232:235], a[160:163], a[16:19]
ds_read_b64_tr_b16 a[248:249], v21 offset:40960
v_mfma_f32_16x16x32_bf16 a[16:19], a[236:239], a[176:179], a[16:19]
ds_read_b64_tr_b16 a[250:251], v21 offset:43008
v_mfma_f32_16x16x32_bf16 a[20:23], a[236:239], a[180:183], a[20:23]
v_mfma_f32_16x16x32_bf16 a[20:23], a[232:235], a[164:167], a[20:23]
v_mfma_f32_16x16x32_bf16 a[24:27], a[232:235], a[168:171], a[24:27]
ds_read_b64_tr_b16 a[252:253], v21 offset:45056
v_mfma_f32_16x16x32_bf16 a[24:27], a[236:239], a[184:187], a[24:27]
ds_read_b64_tr_b16 a[254:255], v21 offset:47104
v_mfma_f32_16x16x32_bf16 a[28:31], a[236:239], a[188:191], a[28:31]
buffer_store_dwordx4 v[40:43], v59, s[60:63], s69 offen offset:2048 sc1
v_mfma_f32_16x16x32_bf16 a[28:31], a[232:235], a[172:175], a[28:31]
s_waitcnt lgkmcnt(4)
v_mfma_f32_16x16x32_bf16 a[32:35], a[240:243], a[160:163], a[32:35]
ds_read_b64_tr_b16 a[224:225], v18 offset:49152
v_mfma_f32_16x16x32_bf16 a[32:35], a[244:247], a[176:179], a[32:35]
ds_read_b64_tr_b16 a[226:227], v18 offset:51200
v_mfma_f32_16x16x32_bf16 a[36:39], a[244:247], a[180:183], a[36:39]
v_mfma_f32_16x16x32_bf16 a[36:39], a[240:243], a[164:167], a[36:39]
v_mfma_f32_16x16x32_bf16 a[40:43], a[240:243], a[168:171], a[40:43]
ds_read_b64_tr_b16 a[228:229], v18 offset:53248
v_mfma_f32_16x16x32_bf16 a[40:43], a[244:247], a[184:187], a[40:43]
ds_read_b64_tr_b16 a[230:231], v18 offset:55296
v_mfma_f32_16x16x32_bf16 a[44:47], a[244:247], a[188:191], a[44:47]
ds_read_b64_tr_b16 a[232:233], v19 offset:49152
v_mfma_f32_16x16x32_bf16 a[44:47], a[240:243], a[172:175], a[44:47]
s_waitcnt lgkmcnt(5)
ds_read_b64_tr_b16 a[234:235], v19 offset:51200
v_mfma_f32_16x16x32_bf16 a[48:51], a[248:251], a[160:163], a[48:51]
buffer_store_dwordx4 v[28:31], v59, s[60:63], s69 offen offset:3072 sc1
v_mfma_f32_16x16x32_bf16 a[48:51], a[252:255], a[176:179], a[48:51]
v_mfma_f32_16x16x32_bf16 a[52:55], a[252:255], a[180:183], a[52:55]
ds_read_b64_tr_b16 a[236:237], v19 offset:53248
v_mfma_f32_16x16x32_bf16 a[52:55], a[248:251], a[164:167], a[52:55]
ds_read_b64_tr_b16 a[238:239], v19 offset:55296
v_mfma_f32_16x16x32_bf16 a[56:59], a[248:251], a[168:171], a[56:59]
v_mfma_f32_16x16x32_bf16 a[56:59], a[252:255], a[184:187], a[56:59]
v_mfma_f32_16x16x32_bf16 a[60:63], a[252:255], a[188:191], a[60:63]
ds_read_b64_tr_b16 a[240:241], v20 offset:49152
v_mfma_f32_16x16x32_bf16 a[60:63], a[248:251], a[172:175], a[60:63]
s_waitcnt lgkmcnt(5)
ds_read_b64_tr_b16 a[242:243], v20 offset:51200
v_mfma_f32_16x16x32_bf16 a[64:67], a[224:227], a[160:163], a[64:67]
s_add_u32 s69, s69, 1024
v_mfma_f32_16x16x32_bf16 a[64:67], a[228:231], a[176:179], a[64:67]
buffer_store_dwordx4 v[32:35], v59, s[60:63], s69 offen offset:3072 sc1
v_mfma_f32_16x16x32_bf16 a[68:71], a[228:231], a[180:183], a[68:71]
ds_read_b64_tr_b16 a[244:245], v20 offset:53248
v_mfma_f32_16x16x32_bf16 a[68:71], a[224:227], a[164:167], a[68:71]
ds_read_b64_tr_b16 a[246:247], v20 offset:55296
v_mfma_f32_16x16x32_bf16 a[72:75], a[224:227], a[168:171], a[72:75]
v_mfma_f32_16x16x32_bf16 a[72:75], a[228:231], a[184:187], a[72:75]
v_mfma_f32_16x16x32_bf16 a[76:79], a[228:231], a[188:191], a[76:79]
ds_read_b64_tr_b16 a[248:249], v21 offset:49152
v_mfma_f32_16x16x32_bf16 a[76:79], a[224:227], a[172:175], a[76:79]
s_waitcnt lgkmcnt(5)
ds_read_b64_tr_b16 a[250:251], v21 offset:51200
v_mfma_f32_16x16x32_bf16 a[80:83], a[232:235], a[160:163], a[80:83]
v_mfma_f32_16x16x32_bf16 a[80:83], a[236:239], a[176:179], a[80:83]
v_mfma_f32_16x16x32_bf16 a[84:87], a[236:239], a[180:183], a[84:87]
ds_read_b64_tr_b16 a[252:253], v21 offset:53248
v_mfma_f32_16x16x32_bf16 a[84:87], a[232:235], a[164:167], a[84:87]
ds_read_b64_tr_b16 a[254:255], v21 offset:55296
v_mfma_f32_16x16x32_bf16 a[88:91], a[232:235], a[168:171], a[88:91]
v_mfma_f32_16x16x32_bf16 a[88:91], a[236:239], a[184:187], a[88:91]
v_mfma_f32_16x16x32_bf16 a[92:95], a[236:239], a[188:191], a[92:95]
v_mfma_f32_16x16x32_bf16 a[92:95], a[232:235], a[172:175], a[92:95]
s_waitcnt vmcnt(24) lgkmcnt(0)
v_mfma_f32_16x16x32_bf16 a[96:99], a[240:243], a[160:163], a[96:99]
s_barrier
v_mfma_f32_16x16x32_bf16 a[96:99], a[244:247], a[176:179], a[96:99]
ds_read_b64_tr_b16 a[224:225], v50 offset:0
v_mfma_f32_16x16x32_bf16 a[100:103], a[244:247], a[180:183], a[100:103]
ds_read_b64_tr_b16 a[226:227], v50 offset:2048
v_mfma_f32_16x16x32_bf16 a[100:103], a[240:243], a[164:167], a[100:103]
ds_read_b64_tr_b16 a[228:229], v50 offset:4096
v_mfma_f32_16x16x32_bf16 a[104:107], a[240:243], a[168:171], a[104:107]
ds_read_b64_tr_b16 a[230:231], v50 offset:6144
v_mfma_f32_16x16x32_bf16 a[104:107], a[244:247], a[184:187], a[104:107]
ds_read_b64_tr_b16 a[232:233], v51 offset:0
v_mfma_f32_16x16x32_bf16 a[108:111], a[244:247], a[188:191], a[108:111]
ds_read_b64_tr_b16 a[234:235], v51 offset:2048
v_mfma_f32_16x16x32_bf16 a[108:111], a[240:243], a[172:175], a[108:111]
ds_read_b64_tr_b16 a[236:237], v51 offset:4096
v_mfma_f32_16x16x32_bf16 a[112:115], a[248:251], a[160:163], a[112:115]
ds_read_b64_tr_b16 a[238:239], v51 offset:6144
v_mfma_f32_16x16x32_bf16 a[112:115], a[252:255], a[176:179], a[112:115]
v_mfma_f32_16x16x32_bf16 a[116:119], a[252:255], a[180:183], a[116:119]
v_mfma_f32_16x16x32_bf16 a[116:119], a[248:251], a[164:167], a[116:119]
v_mfma_f32_16x16x32_bf16 a[120:123], a[248:251], a[168:171], a[120:123]
v_mfma_f32_16x16x32_bf16 a[120:123], a[252:255], a[184:187], a[120:123]
v_mfma_f32_16x16x32_bf16 a[124:127], a[252:255], a[188:191], a[124:127]
v_mfma_f32_16x16x32_bf16 a[124:127], a[248:251], a[172:175], a[124:127]
s_waitcnt lgkmcnt(4)
v_mfma_f32_16x16x32_bf16 a[0:3], a[224:227], a[192:195], a[0:3]
ds_read_b64_tr_b16 a[240:241], v52 offset:0
v_mfma_f32_16x16x32_bf16 a[0:3], a[228:231], a[208:211], a[0:3]
s_mov_b32 s44, 0xbfb8aa3b
ds_read_b64_tr_b16 a[242:243], v52 offset:2048
v_mfma_f32_16x16x32_bf16 a[4:7], a[228:231], a[212:215], a[4:7]
ds_read_b64_tr_b16 a[244:245], v52 offset:4096
v_mfma_f32_16x16x32_bf16 a[4:7], a[224:227], a[196:199], a[4:7]
ds_read_b64_tr_b16 a[246:247], v52 offset:6144
v_mfma_f32_16x16x32_bf16 a[8:11], a[224:227], a[200:203], a[8:11]
ds_read_b64_tr_b16 a[248:249], v53 offset:0
v_mfma_f32_16x16x32_bf16 a[8:11], a[228:231], a[216:219], a[8:11]
ds_read_b64_tr_b16 a[250:251], v53 offset:2048
v_mfma_f32_16x16x32_bf16 a[12:15], a[228:231], a[220:223], a[12:15]
ds_read_b64_tr_b16 a[252:253], v53 offset:4096
v_mfma_f32_16x16x32_bf16 a[12:15], a[224:227], a[204:207], a[12:15]
s_waitcnt lgkmcnt(7)
ds_read_b64_tr_b16 a[254:255], v53 offset:6144
v_mfma_f32_16x16x32_bf16 a[16:19], a[232:235], a[192:195], a[16:19]
ds_read_b64_tr_b16 a[160:161], v50 offset:8192
v_mfma_f32_16x16x32_bf16 a[16:19], a[236:239], a[208:211], a[16:19]
ds_read_b64_tr_b16 a[162:163], v50 offset:10240
v_mfma_f32_16x16x32_bf16 a[20:23], a[236:239], a[212:215], a[20:23]
v_mfma_f32_16x16x32_bf16 a[20:23], a[232:235], a[196:199], a[20:23]
v_mfma_f32_16x16x32_bf16 a[24:27], a[232:235], a[200:203], a[24:27]
ds_read_b64_tr_b16 a[164:165], v50 offset:12288
v_mfma_f32_16x16x32_bf16 a[24:27], a[236:239], a[216:219], a[24:27]
ds_read_b64_tr_b16 a[166:167], v50 offset:14336
v_mfma_f32_16x16x32_bf16 a[28:31], a[236:239], a[220:223], a[28:31]
v_mfma_f32_16x16x32_bf16 a[28:31], a[232:235], a[204:207], a[28:31]
s_waitcnt lgkmcnt(8)
v_mfma_f32_16x16x32_bf16 a[32:35], a[240:243], a[192:195], a[32:35]
ds_read_b64_tr_b16 a[168:169], v51 offset:8192
v_mfma_f32_16x16x32_bf16 a[32:35], a[244:247], a[208:211], a[32:35]
ds_read_b64_tr_b16 a[170:171], v51 offset:10240
v_mfma_f32_16x16x32_bf16 a[36:39], a[244:247], a[212:215], a[36:39]
v_mfma_f32_16x16x32_bf16 a[36:39], a[240:243], a[196:199], a[36:39]
v_mfma_f32_16x16x32_bf16 a[40:43], a[240:243], a[200:203], a[40:43]
ds_read_b64_tr_b16 a[172:173], v51 offset:12288
v_mfma_f32_16x16x32_bf16 a[40:43], a[244:247], a[216:219], a[40:43]
ds_read_b64_tr_b16 a[174:175], v51 offset:14336
v_mfma_f32_16x16x32_bf16 a[44:47], a[244:247], a[220:223], a[44:47]
v_mfma_f32_16x16x32_bf16 a[44:47], a[240:243], a[204:207], a[44:47]
s_waitcnt lgkmcnt(8)
v_mfma_f32_16x16x32_bf16 a[48:51], a[248:251], a[192:195], a[48:51]
ds_read_b64_tr_b16 a[176:177], v52 offset:8192
v_mfma_f32_16x16x32_bf16 a[48:51], a[252:255], a[208:211], a[48:51]
ds_read_b64_tr_b16 a[178:179], v52 offset:10240
v_mfma_f32_16x16x32_bf16 a[52:55], a[252:255], a[212:215], a[52:55]
v_mfma_f32_16x16x32_bf16 a[52:55], a[248:251], a[196:199], a[52:55]
v_mfma_f32_16x16x32_bf16 a[56:59], a[248:251], a[200:203], a[56:59]
ds_read_b64_tr_b16 a[180:181], v52 offset:12288
v_mfma_f32_16x16x32_bf16 a[56:59], a[252:255], a[216:219], a[56:59]
ds_read_b64_tr_b16 a[182:183], v52 offset:14336
v_mfma_f32_16x16x32_bf16 a[60:63], a[252:255], a[220:223], a[60:63]
v_mfma_f32_16x16x32_bf16 a[60:63], a[248:251], a[204:207], a[60:63]
s_waitcnt lgkmcnt(8)
v_mfma_f32_16x16x32_bf16 a[64:67], a[160:163], a[192:195], a[64:67]
ds_read_b64_tr_b16 a[184:185], v53 offset:8192
v_mfma_f32_16x16x32_bf16 a[64:67], a[164:167], a[208:211], a[64:67]
ds_read_b64_tr_b16 a[186:187], v53 offset:10240
v_mfma_f32_16x16x32_bf16 a[68:71], a[164:167], a[212:215], a[68:71]
v_mfma_f32_16x16x32_bf16 a[68:71], a[160:163], a[196:199], a[68:71]
v_mfma_f32_16x16x32_bf16 a[72:75], a[160:163], a[200:203], a[72:75]
ds_read_b64_tr_b16 a[188:189], v53 offset:12288
v_mfma_f32_16x16x32_bf16 a[72:75], a[164:167], a[216:219], a[72:75]
ds_read_b64_tr_b16 a[190:191], v53 offset:14336
v_mfma_f32_16x16x32_bf16 a[76:79], a[164:167], a[220:223], a[76:79]
v_mfma_f32_16x16x32_bf16 a[76:79], a[160:163], a[204:207], a[76:79]
s_waitcnt lgkmcnt(8)
v_mfma_f32_16x16x32_bf16 a[80:83], a[168:171], a[192:195], a[80:83]
v_mfma_f32_16x16x32_bf16 a[80:83], a[172:175], a[208:211], a[80:83]
v_mfma_f32_16x16x32_bf16 a[84:87], a[172:175], a[212:215], a[84:87]
v_mfma_f32_16x16x32_bf16 a[84:87], a[168:171], a[196:199], a[84:87]
v_mfma_f32_16x16x32_bf16 a[88:91], a[168:171], a[200:203], a[88:91]
v_mfma_f32_16x16x32_bf16 a[88:91], a[172:175], a[216:219], a[88:91]
v_mfma_f32_16x16x32_bf16 a[92:95], a[172:175], a[220:223], a[92:95]
v_mfma_f32_16x16x32_bf16 a[92:95], a[168:171], a[204:207], a[92:95]
s_waitcnt vmcnt(3) lgkmcnt(0)
v_mfma_f32_16x16x32_bf16 a[96:99], a[176:179], a[192:195], a[96:99]
s_barrier
v_mfma_f32_16x16x32_bf16 a[96:99], a[180:183], a[208:211], a[96:99]
ds_read_b64_tr_b16 a[224:225], v18 offset:0
v_mfma_f32_16x16x32_bf16 a[100:103], a[180:183], a[212:215], a[100:103]
ds_read_b64_tr_b16 a[226:227], v18 offset:2048
v_mfma_f32_16x16x32_bf16 a[100:103], a[176:179], a[196:199], a[100:103]
ds_read_b64_tr_b16 a[228:229], v18 offset:4096
v_mfma_f32_16x16x32_bf16 a[104:107], a[176:179], a[200:203], a[104:107]
ds_read_b64_tr_b16 a[230:231], v18 offset:6144
v_mfma_f32_16x16x32_bf16 a[104:107], a[180:183], a[216:219], a[104:107]
ds_read_b64_tr_b16 a[232:233], v19 offset:0
v_mfma_f32_16x16x32_bf16 a[108:111], a[180:183], a[220:223], a[108:111]
ds_read_b64_tr_b16 a[234:235], v19 offset:2048
v_mfma_f32_16x16x32_bf16 a[108:111], a[176:179], a[204:207], a[108:111]
ds_read_b64_tr_b16 a[236:237], v19 offset:4096
v_mfma_f32_16x16x32_bf16 a[112:115], a[184:187], a[192:195], a[112:115]
ds_read_b64_tr_b16 a[238:239], v19 offset:6144
v_mfma_f32_16x16x32_bf16 a[112:115], a[188:191], a[208:211], a[112:115]
ds_read_b64_tr_b16 a[240:241], v20 offset:0
v_mfma_f32_16x16x32_bf16 a[116:119], a[188:191], a[212:215], a[116:119]
ds_read_b64_tr_b16 a[242:243], v20 offset:2048
v_mfma_f32_16x16x32_bf16 a[116:119], a[184:187], a[196:199], a[116:119]
ds_read_b64_tr_b16 a[244:245], v20 offset:4096
v_mfma_f32_16x16x32_bf16 a[120:123], a[184:187], a[200:203], a[120:123]
ds_read_b64_tr_b16 a[246:247], v20 offset:6144
v_mfma_f32_16x16x32_bf16 a[120:123], a[188:191], a[216:219], a[120:123]
s_mov_b32 s32, 0
ds_read_b64_tr_b16 a[248:249], v21 offset:0
v_mfma_f32_16x16x32_bf16 a[124:127], a[188:191], a[220:223], a[124:127]
s_add_u32 m0, s30, 0
ds_read_b64_tr_b16 a[250:251], v21 offset:2048
v_mfma_f32_16x16x32_bf16 a[124:127], a[184:187], a[204:207], a[124:127]
s_waitcnt lgkmcnt(9)
buffer_load_dwordx4 v10, s[4:7], s32 offen offset:0 lds
v_mfma_f32_16x16x32_bf16 a[0:3], a[224:227], a[128:131], a[0:3]
ds_read_b64_tr_b16 a[252:253], v21 offset:4096
v_mfma_f32_16x16x32_bf16 a[0:3], a[228:231], a[144:147], a[0:3]
ds_read_b64_tr_b16 a[254:255], v21 offset:6144
v_mfma_f32_16x16x32_bf16 a[4:7], a[228:231], a[148:151], a[4:7]
v_mfma_f32_16x16x32_bf16 a[4:7], a[224:227], a[132:135], a[4:7]
v_mfma_f32_16x16x32_bf16 a[8:11], a[224:227], a[136:139], a[8:11]
ds_read_b64_tr_b16 a[160:161], v18 offset:8192
v_mfma_f32_16x16x32_bf16 a[8:11], a[228:231], a[152:155], a[8:11]
s_add_u32 m0, s30, 3968
ds_read_b64_tr_b16 a[162:163], v18 offset:10240
v_mfma_f32_16x16x32_bf16 a[12:15], a[228:231], a[156:159], a[12:15]
buffer_load_dwordx4 v10, s[4:7], s32 offen offset:128 lds
v_mfma_f32_16x16x32_bf16 a[12:15], a[224:227], a[140:143], a[12:15]
s_waitcnt lgkmcnt(9)
v_mfma_f32_16x16x32_bf16 a[16:19], a[232:235], a[128:131], a[16:19]
ds_read_b64_tr_b16 a[164:165], v18 offset:12288
v_mfma_f32_16x16x32_bf16 a[16:19], a[236:239], a[144:147], a[16:19]
ds_read_b64_tr_b16 a[166:167], v18 offset:14336
v_mfma_f32_16x16x32_bf16 a[20:23], a[236:239], a[148:151], a[20:23]
v_mfma_f32_16x16x32_bf16 a[20:23], a[232:235], a[132:135], a[20:23]
v_mfma_f32_16x16x32_bf16 a[24:27], a[232:235], a[136:139], a[24:27]
ds_read_b64_tr_b16 a[168:169], v19 offset:8192
v_mfma_f32_16x16x32_bf16 a[24:27], a[236:239], a[152:155], a[24:27]
s_add_u32 m0, s30, 7936
ds_read_b64_tr_b16 a[170:171], v19 offset:10240
v_mfma_f32_16x16x32_bf16 a[28:31], a[236:239], a[156:159], a[28:31]
buffer_load_dwordx4 v10, s[4:7], s32 offen offset:256 lds
v_mfma_f32_16x16x32_bf16 a[28:31], a[232:235], a[140:143], a[28:31]
s_waitcnt lgkmcnt(9)
v_mfma_f32_16x16x32_bf16 a[32:35], a[240:243], a[128:131], a[32:35]
ds_read_b64_tr_b16 a[172:173], v19 offset:12288
v_mfma_f32_16x16x32_bf16 a[32:35], a[244:247], a[144:147], a[32:35]
ds_read_b64_tr_b16 a[174:175], v19 offset:14336
v_mfma_f32_16x16x32_bf16 a[36:39], a[244:247], a[148:151], a[36:39]
v_mfma_f32_16x16x32_bf16 a[36:39], a[240:243], a[132:135], a[36:39]
v_mfma_f32_16x16x32_bf16 a[40:43], a[240:243], a[136:139], a[40:43]
s_mov_b32 s32, 12288
ds_read_b64_tr_b16 a[176:177], v20 offset:8192
v_mfma_f32_16x16x32_bf16 a[40:43], a[244:247], a[152:155], a[40:43]
s_add_u32 m0, s30, 12288
ds_read_b64_tr_b16 a[178:179], v20 offset:10240
v_mfma_f32_16x16x32_bf16 a[44:47], a[244:247], a[156:159], a[44:47]
buffer_load_dwordx4 v10, s[4:7], s32 offen offset:0 lds
v_mfma_f32_16x16x32_bf16 a[44:47], a[240:243], a[140:143], a[44:47]
s_waitcnt lgkmcnt(9)
v_mfma_f32_16x16x32_bf16 a[48:51], a[248:251], a[128:131], a[48:51]
ds_read_b64_tr_b16 a[180:181], v20 offset:12288
v_mfma_f32_16x16x32_bf16 a[48:51], a[252:255], a[144:147], a[48:51]
ds_read_b64_tr_b16 a[182:183], v20 offset:14336
v_mfma_f32_16x16x32_bf16 a[52:55], a[252:255], a[148:151], a[52:55]
v_mfma_f32_16x16x32_bf16 a[52:55], a[248:251], a[132:135], a[52:55]
v_mfma_f32_16x16x32_bf16 a[56:59], a[248:251], a[136:139], a[56:59]
ds_read_b64_tr_b16 a[184:185], v21 offset:8192
v_mfma_f32_16x16x32_bf16 a[56:59], a[252:255], a[152:155], a[56:59]
s_add_u32 m0, s30, 16256
ds_read_b64_tr_b16 a[186:187], v21 offset:10240
v_mfma_f32_16x16x32_bf16 a[60:63], a[252:255], a[156:159], a[60:63]
buffer_load_dwordx4 v10, s[4:7], s32 offen offset:128 lds
v_mfma_f32_16x16x32_bf16 a[60:63], a[248:251], a[140:143], a[60:63]
s_waitcnt lgkmcnt(9)
v_mfma_f32_16x16x32_bf16 a[64:67], a[160:163], a[128:131], a[64:67]
ds_read_b64_tr_b16 a[188:189], v21 offset:12288
v_mfma_f32_16x16x32_bf16 a[64:67], a[164:167], a[144:147], a[64:67]
ds_read_b64_tr_b16 a[190:191], v21 offset:14336
v_mfma_f32_16x16x32_bf16 a[68:71], a[164:167], a[148:151], a[68:71]
v_mfma_f32_16x16x32_bf16 a[68:71], a[160:163], a[132:135], a[68:71]
v_mfma_f32_16x16x32_bf16 a[72:75], a[160:163], a[136:139], a[72:75]
s_add_u32 m0, s30, 20224
ds_read_b64_tr_b16 a[224:225], v16 offset:0
v_mfma_f32_16x16x32_bf16 a[72:75], a[164:167], a[152:155], a[72:75]
buffer_load_dwordx4 v10, s[4:7], s32 offen offset:256 lds
v_mfma_f32_16x16x32_bf16 a[76:79], a[164:167], a[156:159], a[76:79]
ds_read_b64_tr_b16 a[226:227], v16 offset:2048
v_mfma_f32_16x16x32_bf16 a[76:79], a[160:163], a[140:143], a[76:79]
s_waitcnt lgkmcnt(9)
v_mfma_f32_16x16x32_bf16 a[80:83], a[168:171], a[128:131], a[80:83]
ds_read_b64_tr_b16 a[228:229], v16 offset:4096
v_mfma_f32_16x16x32_bf16 a[80:83], a[172:175], a[144:147], a[80:83]
v_mfma_f32_16x16x32_bf16 a[84:87], a[172:175], a[148:151], a[84:87]
ds_read_b64_tr_b16 a[230:231], v16 offset:6144
v_mfma_f32_16x16x32_bf16 a[84:87], a[168:171], a[132:135], a[84:87]
s_mov_b32 s32, 24576
v_mfma_f32_16x16x32_bf16 a[88:91], a[168:171], a[136:139], a[88:91]
s_add_u32 m0, s30, 24576
ds_read_b64_tr_b16 a[232:233], v14 offset:0
v_mfma_f32_16x16x32_bf16 a[88:91], a[172:175], a[152:155], a[88:91]
buffer_load_dwordx4 v10, s[4:7], s32 offen offset:0 lds
v_mfma_f32_16x16x32_bf16 a[92:95], a[172:175], a[156:159], a[92:95]
ds_read_b64_tr_b16 a[234:235], v14 offset:2048
v_mfma_f32_16x16x32_bf16 a[92:95], a[168:171], a[140:143], a[92:95]
s_waitcnt lgkmcnt(9)
v_mfma_f32_16x16x32_bf16 a[96:99], a[176:179], a[128:131], a[96:99]
ds_read_b64_tr_b16 a[236:237], v14 offset:4096
v_mfma_f32_16x16x32_bf16 a[96:99], a[180:183], a[144:147], a[96:99]
v_mfma_f32_16x16x32_bf16 a[100:103], a[180:183], a[148:151], a[100:103]
ds_read_b64_tr_b16 a[238:239], v14 offset:6144
v_mfma_f32_16x16x32_bf16 a[100:103], a[176:179], a[132:135], a[100:103]
v_mfma_f32_16x16x32_bf16 a[104:107], a[176:179], a[136:139], a[104:107]
s_add_u32 m0, s30, 28544
ds_read_b64_tr_b16 a[240:241], v16 offset:8
v_mfma_f32_16x16x32_bf16 a[104:107], a[180:183], a[152:155], a[104:107]
buffer_load_dwordx4 v10, s[4:7], s32 offen offset:128 lds
v_mfma_f32_16x16x32_bf16 a[108:111], a[180:183], a[156:159], a[108:111]
ds_read_b64_tr_b16 a[242:243], v16 offset:2056
v_mfma_f32_16x16x32_bf16 a[108:111], a[176:179], a[140:143], a[108:111]
s_waitcnt lgkmcnt(9)
v_mfma_f32_16x16x32_bf16 a[112:115], a[184:187], a[128:131], a[112:115]
ds_read_b64_tr_b16 a[244:245], v16 offset:4104
v_mfma_f32_16x16x32_bf16 a[112:115], a[188:191], a[144:147], a[112:115]
v_mfma_f32_16x16x32_bf16 a[116:119], a[188:191], a[148:151], a[116:119]
ds_read_b64_tr_b16 a[246:247], v16 offset:6152
v_mfma_f32_16x16x32_bf16 a[116:119], a[184:187], a[132:135], a[116:119]
v_mfma_f32_16x16x32_bf16 a[120:123], a[184:187], a[136:139], a[120:123]
s_add_u32 m0, s30, 32512
ds_read_b64_tr_b16 a[248:249], v14 offset:8
v_mfma_f32_16x16x32_bf16 a[120:123], a[188:191], a[152:155], a[120:123]
buffer_load_dwordx4 v10, s[4:7], s32 offen offset:256 lds
v_mfma_f32_16x16x32_bf16 a[124:127], a[188:191], a[156:159], a[124:127]
ds_read_b64_tr_b16 a[250:251], v14 offset:2056
v_mfma_f32_16x16x32_bf16 a[124:127], a[184:187], a[140:143], a[124:127]
s_waitcnt lgkmcnt(6)
v_mfma_f32_16x16x32_bf16 v[64:67], a[224:227], a[192:195], v[64:67]
ds_read_b64_tr_b16 a[252:253], v14 offset:4104
v_mfma_f32_16x16x32_bf16 v[64:67], a[228:231], a[208:211], v[64:67]
v_mfma_f32_16x16x32_bf16 v[64:67], a[232:235], a[128:131], v[64:67]
ds_read_b64_tr_b16 a[254:255], v14 offset:6152
v_mfma_f32_16x16x32_bf16 v[64:67], a[236:239], a[144:147], v[64:67]
s_mov_b32 s32, 36864
v_mfma_f32_16x16x32_bf16 v[68:71], a[236:239], a[148:151], v[68:71]
s_add_u32 m0, s30, 36864
ds_read_b64_tr_b16 a[160:161], v17 offset:0
v_mfma_f32_16x16x32_bf16 v[68:71], a[232:235], a[132:135], v[68:71]
buffer_load_dwordx4 v10, s[4:7], s32 offen offset:0 lds
v_mfma_f32_16x16x32_bf16 v[68:71], a[228:231], a[212:215], v[68:71]
ds_read_b64_tr_b16 a[162:163], v17 offset:2048
v_accvgpr_read_b32 v28, a0
v_mfma_f32_16x16x32_bf16 v[68:71], a[224:227], a[196:199], v[68:71]
v_accvgpr_read_b32 v29, a1
v_accvgpr_read_b32 v30, a2
v_mfma_f32_16x16x32_bf16 v[72:75], a[224:227], a[200:203], v[72:75]
ds_read_b64_tr_b16 a[164:165], v17 offset:4096
v_accvgpr_read_b32 v31, a3
v_mfma_f32_16x16x32_bf16 v[72:75], a[228:231], a[216:219], v[72:75]
v_mul_f32 v36, s44, v28
v_mul_f32 v37, s44, v29
v_mfma_f32_16x16x32_bf16 v[72:75], a[232:235], a[136:139], v[72:75]
ds_read_b64_tr_b16 a[166:167], v17 offset:6144
v_mul_f32 v38, s44, v30
v_mfma_f32_16x16x32_bf16 v[72:75], a[236:239], a[152:155], v[72:75]
v_mul_f32 v39, s44, v31
v_accvgpr_read_b32 v44, a16
v_mfma_f32_16x16x32_bf16 v[76:79], a[236:239], a[156:159], v[76:79]
s_add_u32 m0, s30, 40832
ds_read_b64_tr_b16 a[168:169], v15 offset:0
v_accvgpr_read_b32 v45, a17
v_mfma_f32_16x16x32_bf16 v[76:79], a[232:235], a[140:143], v[76:79]
buffer_load_dwordx4 v10, s[4:7], s32 offen offset:128 lds
v_accvgpr_read_b32 v46, a18
v_mfma_f32_16x16x32_bf16 v[76:79], a[228:231], a[220:223], v[76:79]
ds_read_b64_tr_b16 a[170:171], v15 offset:2048
v_accvgpr_read_b32 v47, a19
v_mfma_f32_16x16x32_bf16 v[76:79], a[224:227], a[204:207], v[76:79]
s_waitcnt lgkmcnt(6)
v_exp_f32 v36, v36
v_mfma_f32_16x16x32_bf16 v[80:83], a[240:243], a[192:195], v[80:83]
ds_read_b64_tr_b16 a[172:173], v15 offset:4096
v_mul_f32 v52, s44, v44
v_mfma_f32_16x16x32_bf16 v[80:83], a[244:247], a[208:211], v[80:83]
v_exp_f32 v37, v37
v_mfma_f32_16x16x32_bf16 v[80:83], a[248:251], a[128:131], v[80:83]
ds_read_b64_tr_b16 a[174:175], v15 offset:6144
v_mul_f32 v53, s44, v45
v_mfma_f32_16x16x32_bf16 v[80:83], a[252:255], a[144:147], v[80:83]
v_exp_f32 v38, v38
v_mfma_f32_16x16x32_bf16 v[84:87], a[252:255], a[148:151], v[84:87]
s_add_u32 m0, s30, 44800
ds_read_b64_tr_b16 a[176:177], v17 offset:8
v_mul_f32 v54, s44, v46
v_mfma_f32_16x16x32_bf16 v[84:87], a[248:251], a[132:135], v[84:87]
buffer_load_dwordx4 v10, s[4:7], s32 offen offset:256 lds
v_mul_f32 v55, s44, v47
v_mfma_f32_16x16x32_bf16 v[84:87], a[244:247], a[212:215], v[84:87]
ds_read_b64_tr_b16 a[178:179], v17 offset:2056
v_mfma_f32_16x16x32_bf16 v[84:87], a[240:243], a[196:199], v[84:87]
v_exp_f32 v39, v39
v_mfma_f32_16x16x32_bf16 v[88:91], a[240:243], a[200:203], v[88:91]
ds_read_b64_tr_b16 a[180:181], v17 offset:4104
v_accvgpr_read_b32 v32, a64
v_mfma_f32_16x16x32_bf16 v[88:91], a[244:247], a[216:219], v[88:91]
v_exp_f32 v52, v52
v_mfma_f32_16x16x32_bf16 v[88:91], a[248:251], a[136:139], v[88:91]
ds_read_b64_tr_b16 a[182:183], v17 offset:6152
v_accvgpr_read_b32 v33, a65
v_mfma_f32_16x16x32_bf16 v[88:91], a[252:255], a[152:155], v[88:91]
s_mov_b32 s33, 0
v_exp_f32 v53, v53
v_mfma_f32_16x16x32_bf16 v[92:95], a[252:255], a[156:159], v[92:95]
s_add_u32 m0, s31, 0
ds_read_b64_tr_b16 a[184:185], v15 offset:8
v_accvgpr_read_b32 v34, a66
v_mfma_f32_16x16x32_bf16 v[92:95], a[248:251], a[140:143], v[92:95]
buffer_load_dwordx4 v11, s[8:11], s33 offen offset:0 lds
v_accvgpr_read_b32 v35, a67
v_mfma_f32_16x16x32_bf16 v[92:95], a[244:247], a[220:223], v[92:95]
ds_read_b64_tr_b16 a[186:187], v15 offset:2056
v_add_f32 v36, 1.0, v36
v_mfma_f32_16x16x32_bf16 v[92:95], a[240:243], a[204:207], v[92:95]
s_waitcnt lgkmcnt(6)
v_exp_f32 v54, v54
v_mfma_f32_16x16x32_bf16 v[96:99], a[160:163], a[192:195], v[96:99]
ds_read_b64_tr_b16 a[188:189], v15 offset:4104
v_add_f32 v37, 1.0, v37
v_mfma_f32_16x16x32_bf16 v[96:99], a[164:167], a[208:211], v[96:99]
v_exp_f32 v55, v55
v_mfma_f32_16x16x32_bf16 v[96:99], a[168:171], a[128:131], v[96:99]
ds_read_b64_tr_b16 a[190:191], v15 offset:6152
v_add_f32 v38, 1.0, v38
v_mfma_f32_16x16x32_bf16 v[96:99], a[172:175], a[144:147], v[96:99]
v_add_f32 v39, 1.0, v39
v_accvgpr_read_b32 v48, a80
v_mfma_f32_16x16x32_bf16 v[100:103], a[172:175], a[148:151], v[100:103]
s_add_u32 m0, s31, 4096
ds_read_b64_tr_b16 a[224:225], v16 offset:8192
v_accvgpr_read_b32 v49, a81
v_mfma_f32_16x16x32_bf16 v[100:103], a[168:171], a[132:135], v[100:103]
buffer_load_dwordx4 v23, s[8:11], s33 offen offset:0 lds
v_accvgpr_read_b32 v50, a82
v_mfma_f32_16x16x32_bf16 v[100:103], a[164:167], a[212:215], v[100:103]
ds_read_b64_tr_b16 a[226:227], v16 offset:10240
v_accvgpr_read_b32 v51, a83
v_mfma_f32_16x16x32_bf16 v[100:103], a[160:163], a[196:199], v[100:103]
v_rcp_f32 v36, v36
v_mfma_f32_16x16x32_bf16 v[104:107], a[160:163], a[200:203], v[104:107]
ds_read_b64_tr_b16 a[228:229], v16 offset:12288
v_add_f32 v52, 1.0, v52
v_mfma_f32_16x16x32_bf16 v[104:107], a[164:167], a[216:219], v[104:107]
v_rcp_f32 v37, v37
v_mfma_f32_16x16x32_bf16 v[104:107], a[168:171], a[136:139], v[104:107]
ds_read_b64_tr_b16 a[230:231], v16 offset:14336
v_add_f32 v53, 1.0, v53
v_mfma_f32_16x16x32_bf16 v[104:107], a[172:175], a[152:155], v[104:107]
v_rcp_f32 v38, v38
v_mfma_f32_16x16x32_bf16 v[108:111], a[172:175], a[156:159], v[108:111]
s_add_u32 m0, s31, 8064
ds_read_b64_tr_b16 a[232:233], v14 offset:8192
v_add_f32 v54, 1.0, v54
v_mfma_f32_16x16x32_bf16 v[108:111], a[168:171], a[140:143], v[108:111]
buffer_load_dwordx4 v11, s[8:11], s33 offen offset:128 lds
v_add_f32 v55, 1.0, v55
v_mfma_f32_16x16x32_bf16 v[108:111], a[164:167], a[220:223], v[108:111]
ds_read_b64_tr_b16 a[234:235], v14 offset:10240
v_mfma_f32_16x16x32_bf16 v[108:111], a[160:163], a[204:207], v[108:111]
s_waitcnt lgkmcnt(6)
v_rcp_f32 v39, v39
v_mfma_f32_16x16x32_bf16 v[112:115], a[176:179], a[192:195], v[112:115]
ds_read_b64_tr_b16 a[236:237], v14 offset:12288
v_mul_f32 v28, v28, v32
v_mfma_f32_16x16x32_bf16 v[112:115], a[180:183], a[208:211], v[112:115]
v_rcp_f32 v52, v52
v_mfma_f32_16x16x32_bf16 v[112:115], a[184:187], a[128:131], v[112:115]
ds_read_b64_tr_b16 a[238:239], v14 offset:14336
v_mul_f32 v29, v29, v33
v_mfma_f32_16x16x32_bf16 v[112:115], a[188:191], a[144:147], v[112:115]
v_rcp_f32 v53, v53
v_mfma_f32_16x16x32_bf16 v[116:119], a[188:191], a[148:151], v[116:119]
s_add_u32 m0, s31, 12160
ds_read_b64_tr_b16 a[240:241], v16 offset:8200
v_mul_f32 v30, v30, v34
v_mfma_f32_16x16x32_bf16 v[116:119], a[184:187], a[132:135], v[116:119]
buffer_load_dwordx4 v23, s[8:11], s33 offen offset:128 lds
v_mul_f32 v31, v31, v35
v_mfma_f32_16x16x32_bf16 v[116:119], a[180:183], a[212:215], v[116:119]
ds_read_b64_tr_b16 a[242:243], v16 offset:10248
v_mul_f32 v28, v28, v36
v_mfma_f32_16x16x32_bf16 v[116:119], a[176:179], a[196:199], v[116:119]
v_rcp_f32 v54, v54
v_mfma_f32_16x16x32_bf16 v[120:123], a[176:179], a[200:203], v[120:123]
ds_read_b64_tr_b16 a[244:245], v16 offset:12296
v_mul_f32 v29, v29, v37
v_mfma_f32_16x16x32_bf16 v[120:123], a[180:183], a[216:219], v[120:123]
v_rcp_f32 v55, v55
v_mfma_f32_16x16x32_bf16 v[120:123], a[184:187], a[136:139], v[120:123]
ds_read_b64_tr_b16 a[246:247], v16 offset:14344
v_mul_f32 v30, v30, v38
v_mfma_f32_16x16x32_bf16 v[120:123], a[188:191], a[152:155], v[120:123]
v_mul_f32 v31, v31, v39
v_cvt_pk_bf16_f32 v56, v28, v29
v_mfma_f32_16x16x32_bf16 v[124:127], a[188:191], a[156:159], v[124:127]
ds_read_b64_tr_b16 a[248:249], v14 offset:8200
v_mul_f32 v44, v44, v48
v_mfma_f32_16x16x32_bf16 v[124:127], a[184:187], a[140:143], v[124:127]
v_cvt_pk_bf16_f32 v57, v30, v31
v_mul_f32 v45, v45, v49
v_mfma_f32_16x16x32_bf16 v[124:127], a[180:183], a[220:223], v[124:127]
ds_read_b64_tr_b16 a[250:251], v14 offset:10248
v_mul_f32 v46, v46, v50
v_mfma_f32_16x16x32_bf16 v[124:127], a[176:179], a[204:207], v[124:127]
s_waitcnt lgkmcnt(6)
v_mul_f32 v47, v47, v51
v_mul_f32 v44, v44, v52
v_mfma_f32_16x16x32_bf16 v[128:131], a[224:227], a[192:195], v[128:131]
ds_read_b64_tr_b16 a[252:253], v14 offset:12296
v_mul_f32 v45, v45, v53
v_mfma_f32_16x16x32_bf16 v[128:131], a[228:231], a[208:211], v[128:131]
v_mul_f32 v46, v46, v54
v_mul_f32 v47, v47, v55
v_mfma_f32_16x16x32_bf16 v[128:131], a[232:235], a[128:131], v[128:131]
ds_read_b64_tr_b16 a[254:255], v14 offset:14344
v_cvt_pk_bf16_f32 v58, v44, v45
v_mfma_f32_16x16x32_bf16 v[128:131], a[236:239], a[144:147], v[128:131]
v_cvt_pk_bf16_f32 v59, v46, v47
v_accvgpr_read_b32 v28, a4
v_mfma_f32_16x16x32_bf16 v[132:135], a[236:239], a[148:151], v[132:135]
ds_read_b64_tr_b16 a[160:161], v17 offset:8192
v_accvgpr_read_b32 v29, a5
v_mfma_f32_16x16x32_bf16 v[132:135], a[232:235], a[132:135], v[132:135]
s_xor_b32 s42, s64, 0
buffer_store_dwordx4 v[56:59], v3, s[24:27], s42 offen sc1
v_accvgpr_read_b32 v30, a6
v_mfma_f32_16x16x32_bf16 v[132:135], a[228:231], a[212:215], v[132:135]
ds_read_b64_tr_b16 a[162:163], v17 offset:10240
v_accvgpr_read_b32 v31, a7
v_mfma_f32_16x16x32_bf16 v[132:135], a[224:227], a[196:199], v[132:135]
v_mul_f32 v36, s44, v28
v_mul_f32 v37, s44, v29
v_mfma_f32_16x16x32_bf16 v[136:139], a[224:227], a[200:203], v[136:139]
ds_read_b64_tr_b16 a[164:165], v17 offset:12288
v_mul_f32 v38, s44, v30
v_mfma_f32_16x16x32_bf16 v[136:139], a[228:231], a[216:219], v[136:139]
v_mul_f32 v39, s44, v31
v_accvgpr_read_b32 v44, a20
v_mfma_f32_16x16x32_bf16 v[136:139], a[232:235], a[136:139], v[136:139]
ds_read_b64_tr_b16 a[166:167], v17 offset:14336
v_accvgpr_read_b32 v45, a21
v_mfma_f32_16x16x32_bf16 v[136:139], a[236:239], a[152:155], v[136:139]
v_exp_f32 v36, v36
v_mfma_f32_16x16x32_bf16 v[140:143], a[236:239], a[156:159], v[140:143]
ds_read_b64_tr_b16 a[168:169], v15 offset:8192
v_accvgpr_read_b32 v46, a22
v_mfma_f32_16x16x32_bf16 v[140:143], a[232:235], a[140:143], v[140:143]
v_exp_f32 v37, v37
v_mfma_f32_16x16x32_bf16 v[140:143], a[228:231], a[220:223], v[140:143]
ds_read_b64_tr_b16 a[170:171], v15 offset:10240
v_accvgpr_read_b32 v47, a23
v_mfma_f32_16x16x32_bf16 v[140:143], a[224:227], a[204:207], v[140:143]
s_waitcnt lgkmcnt(6)
v_exp_f32 v38, v38
v_mfma_f32_16x16x32_bf16 v[144:147], a[240:243], a[192:195], v[144:147]
ds_read_b64_tr_b16 a[172:173], v15 offset:12288
v_mul_f32 v52, s44, v44
v_mfma_f32_16x16x32_bf16 v[144:147], a[244:247], a[208:211], v[144:147]
v_exp_f32 v39, v39
v_mfma_f32_16x16x32_bf16 v[144:147], a[248:251], a[128:131], v[144:147]
ds_read_b64_tr_b16 a[174:175], v15 offset:14336
v_accvgpr_read_b32 v32, a68
v_mfma_f32_16x16x32_bf16 v[144:147], a[252:255], a[144:147], v[144:147]
v_accvgpr_read_b32 v33, a69
v_mul_f32 v53, s44, v45
v_mfma_f32_16x16x32_bf16 v[148:151], a[252:255], a[148:151], v[148:151]
ds_read_b64_tr_b16 a[176:177], v17 offset:8200
v_accvgpr_read_b32 v34, a70
v_mfma_f32_16x16x32_bf16 v[148:151], a[248:251], a[132:135], v[148:151]
v_mul_f32 v54, s44, v46
v_accvgpr_read_b32 v35, a71
v_mfma_f32_16x16x32_bf16 v[148:151], a[244:247], a[212:215], v[148:151]
ds_read_b64_tr_b16 a[178:179], v17 offset:10248
v_mul_f32 v55, s44, v47
v_mfma_f32_16x16x32_bf16 v[148:151], a[240:243], a[196:199], v[148:151]
v_exp_f32 v52, v52
v_mfma_f32_16x16x32_bf16 v[152:155], a[240:243], a[200:203], v[152:155]
ds_read_b64_tr_b16 a[180:181], v17 offset:12296
v_add_f32 v36, 1.0, v36
v_mfma_f32_16x16x32_bf16 v[152:155], a[244:247], a[216:219], v[152:155]
v_exp_f32 v53, v53
v_mfma_f32_16x16x32_bf16 v[152:155], a[248:251], a[136:139], v[152:155]
ds_read_b64_tr_b16 a[182:183], v17 offset:14344
v_add_f32 v37, 1.0, v37
v_mfma_f32_16x16x32_bf16 v[152:155], a[252:255], a[152:155], v[152:155]
v_exp_f32 v54, v54
v_mfma_f32_16x16x32_bf16 v[156:159], a[252:255], a[156:159], v[156:159]
ds_read_b64_tr_b16 a[184:185], v15 offset:8200
v_add_f32 v38, 1.0, v38
v_mfma_f32_16x16x32_bf16 v[156:159], a[248:251], a[140:143], v[156:159]
v_exp_f32 v55, v55
v_mfma_f32_16x16x32_bf16 v[156:159], a[244:247], a[220:223], v[156:159]
ds_read_b64_tr_b16 a[186:187], v15 offset:10248
v_add_f32 v39, 1.0, v39
v_mfma_f32_16x16x32_bf16 v[156:159], a[240:243], a[204:207], v[156:159]
s_waitcnt lgkmcnt(6)
v_rcp_f32 v36, v36
v_mfma_f32_16x16x32_bf16 v[160:163], a[160:163], a[192:195], v[160:163]
ds_read_b64_tr_b16 a[188:189], v15 offset:12296
v_accvgpr_read_b32 v48, a84
v_mfma_f32_16x16x32_bf16 v[160:163], a[164:167], a[208:211], v[160:163]
v_rcp_f32 v37, v37
v_mfma_f32_16x16x32_bf16 v[160:163], a[168:171], a[128:131], v[160:163]
ds_read_b64_tr_b16 a[190:191], v15 offset:14344
v_accvgpr_read_b32 v49, a85
v_mfma_f32_16x16x32_bf16 v[160:163], a[172:175], a[144:147], v[160:163]
v_rcp_f32 v38, v38
v_mfma_f32_16x16x32_bf16 v[164:167], a[172:175], a[148:151], v[164:167]
ds_read_b64_tr_b16 a[224:225], v16 offset:16384
v_accvgpr_read_b32 v50, a86
v_mfma_f32_16x16x32_bf16 v[164:167], a[168:171], a[132:135], v[164:167]
v_rcp_f32 v39, v39
v_mfma_f32_16x16x32_bf16 v[164:167], a[164:167], a[212:215], v[164:167]
ds_read_b64_tr_b16 a[226:227], v16 offset:18432
v_accvgpr_read_b32 v51, a87
v_mfma_f32_16x16x32_bf16 v[164:167], a[160:163], a[196:199], v[164:167]
v_mul_f32 v28, v28, v32
v_add_f32 v52, 1.0, v52
v_mfma_f32_16x16x32_bf16 v[168:171], a[160:163], a[200:203], v[168:171]
ds_read_b64_tr_b16 a[228:229], v16 offset:20480
v_mul_f32 v29, v29, v33
v_mfma_f32_16x16x32_bf16 v[168:171], a[164:167], a[216:219], v[168:171]
v_add_f32 v53, 1.0, v53
v_mul_f32 v30, v30, v34
v_mfma_f32_16x16x32_bf16 v[168:171], a[168:171], a[136:139], v[168:171]
ds_read_b64_tr_b16 a[230:231], v16 offset:22528
v_add_f32 v54, 1.0, v54
v_mfma_f32_16x16x32_bf16 v[168:171], a[172:175], a[152:155], v[168:171]
v_mul_f32 v31, v31, v35
v_add_f32 v55, 1.0, v55
v_mfma_f32_16x16x32_bf16 v[172:175], a[172:175], a[156:159], v[172:175]
ds_read_b64_tr_b16 a[232:233], v14 offset:16384
v_mul_f32 v28, v28, v36
v_mfma_f32_16x16x32_bf16 v[172:175], a[168:171], a[140:143], v[172:175]
v_rcp_f32 v52, v52
v_mfma_f32_16x16x32_bf16 v[172:175], a[164:167], a[220:223], v[172:175]
ds_read_b64_tr_b16 a[234:235], v14 offset:18432
v_mul_f32 v29, v29, v37
v_mfma_f32_16x16x32_bf16 v[172:175], a[160:163], a[204:207], v[172:175]
s_waitcnt lgkmcnt(6)
v_rcp_f32 v53, v53
v_mfma_f32_16x16x32_bf16 v[176:179], a[176:179], a[192:195], v[176:179]
ds_read_b64_tr_b16 a[236:237], v14 offset:20480
v_mul_f32 v30, v30, v38
v_mfma_f32_16x16x32_bf16 v[176:179], a[180:183], a[208:211], v[176:179]
v_rcp_f32 v54, v54
v_mfma_f32_16x16x32_bf16 v[176:179], a[184:187], a[128:131], v[176:179]
ds_read_b64_tr_b16 a[238:239], v14 offset:22528
v_mul_f32 v31, v31, v39
v_mfma_f32_16x16x32_bf16 v[176:179], a[188:191], a[144:147], v[176:179]
v_rcp_f32 v55, v55
v_mfma_f32_16x16x32_bf16 v[180:183], a[188:191], a[148:151], v[180:183]
ds_read_b64_tr_b16 a[240:241], v16 offset:16392
v_cvt_pk_bf16_f32 v40, v28, v29
v_mfma_f32_16x16x32_bf16 v[180:183], a[184:187], a[132:135], v[180:183]
v_mul_f32 v44, v44, v48
v_cvt_pk_bf16_f32 v41, v30, v31
v_mfma_f32_16x16x32_bf16 v[180:183], a[180:183], a[212:215], v[180:183]
ds_read_b64_tr_b16 a[242:243], v16 offset:18440
v_mul_f32 v45, v45, v49
v_mfma_f32_16x16x32_bf16 v[180:183], a[176:179], a[196:199], v[180:183]
v_mul_f32 v46, v46, v50
v_mul_f32 v47, v47, v51
v_mfma_f32_16x16x32_bf16 v[184:187], a[176:179], a[200:203], v[184:187]
ds_read_b64_tr_b16 a[244:245], v16 offset:20488
v_mul_f32 v44, v44, v52
v_mfma_f32_16x16x32_bf16 v[184:187], a[180:183], a[216:219], v[184:187]
v_mul_f32 v45, v45, v53
v_mul_f32 v46, v46, v54
v_mfma_f32_16x16x32_bf16 v[184:187], a[184:187], a[136:139], v[184:187]
ds_read_b64_tr_b16 a[246:247], v16 offset:22536
v_mul_f32 v47, v47, v55
v_mfma_f32_16x16x32_bf16 v[184:187], a[188:191], a[152:155], v[184:187]
v_cvt_pk_bf16_f32 v42, v44, v45
v_cvt_pk_bf16_f32 v43, v46, v47
v_mfma_f32_16x16x32_bf16 v[188:191], a[188:191], a[156:159], v[188:191]
ds_read_b64_tr_b16 a[248:249], v14 offset:16392
v_accvgpr_read_b32 v28, a8
v_mfma_f32_16x16x32_bf16 v[188:191], a[184:187], a[140:143], v[188:191]
s_xor_b32 s42, s64, 1024
buffer_store_dwordx4 v[40:43], v3, s[24:27], s42 offen sc1
v_accvgpr_read_b32 v29, a9
v_mfma_f32_16x16x32_bf16 v[188:191], a[180:183], a[220:223], v[188:191]
ds_read_b64_tr_b16 a[250:251], v14 offset:18440
v_accvgpr_read_b32 v30, a10
v_mfma_f32_16x16x32_bf16 v[188:191], a[176:179], a[204:207], v[188:191]
s_waitcnt lgkmcnt(6)
v_accvgpr_read_b32 v31, a11
v_mul_f32 v36, s44, v28
v_mfma_f32_16x16x32_bf16 v[192:195], a[224:227], a[192:195], v[192:195]
ds_read_b64_tr_b16 a[252:253], v14 offset:20488
v_mul_f32 v37, s44, v29
v_mfma_f32_16x16x32_bf16 v[192:195], a[228:231], a[208:211], v[192:195]
v_mul_f32 v38, s44, v30
v_mul_f32 v39, s44, v31
v_mfma_f32_16x16x32_bf16 v[192:195], a[232:235], a[128:131], v[192:195]
ds_read_b64_tr_b16 a[254:255], v14 offset:22536
v_accvgpr_read_b32 v44, a24
v_mfma_f32_16x16x32_bf16 v[192:195], a[236:239], a[144:147], v[192:195]
v_exp_f32 v36, v36
v_mfma_f32_16x16x32_bf16 v[196:199], a[236:239], a[148:151], v[196:199]
ds_read_b64_tr_b16 a[160:161], v17 offset:16384
v_accvgpr_read_b32 v45, a25
v_mfma_f32_16x16x32_bf16 v[196:199], a[232:235], a[132:135], v[196:199]
v_exp_f32 v37, v37
v_mfma_f32_16x16x32_bf16 v[196:199], a[228:231], a[212:215], v[196:199]
ds_read_b64_tr_b16 a[162:163], v17 offset:18432
v_accvgpr_read_b32 v46, a26
v_mfma_f32_16x16x32_bf16 v[196:199], a[224:227], a[196:199], v[196:199]
v_exp_f32 v38, v38
v_mfma_f32_16x16x32_bf16 v[200:203], a[224:227], a[200:203], v[200:203]
ds_read_b64_tr_b16 a[164:165], v17 offset:20480
v_accvgpr_read_b32 v47, a27
v_mfma_f32_16x16x32_bf16 v[200:203], a[228:231], a[216:219], v[200:203]
v_exp_f32 v39, v39
v_mfma_f32_16x16x32_bf16 v[200:203], a[232:235], a[136:139], v[200:203]
ds_read_b64_tr_b16 a[166:167], v17 offset:22528
v_accvgpr_read_b32 v32, a72
v_mfma_f32_16x16x32_bf16 v[200:203], a[236:239], a[152:155], v[200:203]
v_mul_f32 v52, s44, v44
v_accvgpr_read_b32 v33, a73
v_mfma_f32_16x16x32_bf16 v[204:207], a[236:239], a[156:159], v[204:207]
ds_read_b64_tr_b16 a[168:169], v15 offset:16384
v_mul_f32 v53, s44, v45
v_mfma_f32_16x16x32_bf16 v[204:207], a[232:235], a[140:143], v[204:207]
v_accvgpr_read_b32 v34, a74
v_mul_f32 v54, s44, v46
v_mfma_f32_16x16x32_bf16 v[204:207], a[228:231], a[220:223], v[204:207]
ds_read_b64_tr_b16 a[170:171], v15 offset:18432
v_accvgpr_read_b32 v35, a75
v_mfma_f32_16x16x32_bf16 v[204:207], a[224:227], a[204:207], v[204:207]
s_waitcnt lgkmcnt(6)
v_mul_f32 v55, s44, v47
v_add_f32 v36, 1.0, v36
v_mfma_f32_16x16x32_bf16 v[208:211], a[240:243], a[192:195], v[208:211]
ds_read_b64_tr_b16 a[172:173], v15 offset:20480
v_add_f32 v37, 1.0, v37
v_mfma_f32_16x16x32_bf16 v[208:211], a[244:247], a[208:211], v[208:211]
v_exp_f32 v52, v52
v_mfma_f32_16x16x32_bf16 v[208:211], a[248:251], a[128:131], v[208:211]
ds_read_b64_tr_b16 a[174:175], v15 offset:22528
v_add_f32 v38, 1.0, v38
v_mfma_f32_16x16x32_bf16 v[208:211], a[252:255], a[144:147], v[208:211]
v_exp_f32 v53, v53
v_mfma_f32_16x16x32_bf16 v[212:215], a[252:255], a[148:151], v[212:215]
ds_read_b64_tr_b16 a[176:177], v17 offset:16392
v_add_f32 v39, 1.0, v39
v_mfma_f32_16x16x32_bf16 v[212:215], a[248:251], a[132:135], v[212:215]
v_exp_f32 v54, v54
v_mfma_f32_16x16x32_bf16 v[212:215], a[244:247], a[212:215], v[212:215]
ds_read_b64_tr_b16 a[178:179], v17 offset:18440
v_mfma_f32_16x16x32_bf16 v[212:215], a[240:243], a[196:199], v[212:215]
v_exp_f32 v55, v55
v_mfma_f32_16x16x32_bf16 v[216:219], a[240:243], a[200:203], v[216:219]
ds_read_b64_tr_b16 a[180:181], v17 offset:20488
v_accvgpr_read_b32 v48, a88
v_mfma_f32_16x16x32_bf16 v[216:219], a[244:247], a[216:219], v[216:219]
v_rcp_f32 v36, v36
v_mfma_f32_16x16x32_bf16 v[216:219], a[248:251], a[136:139], v[216:219]
ds_read_b64_tr_b16 a[182:183], v17 offset:22536
v_accvgpr_read_b32 v49, a89
v_mfma_f32_16x16x32_bf16 v[216:219], a[252:255], a[152:155], v[216:219]
v_rcp_f32 v37, v37
v_mfma_f32_16x16x32_bf16 v[220:223], a[252:255], a[156:159], v[220:223]
ds_read_b64_tr_b16 a[184:185], v15 offset:16392
v_accvgpr_read_b32 v50, a90
v_mfma_f32_16x16x32_bf16 v[220:223], a[248:251], a[140:143], v[220:223]
v_rcp_f32 v38, v38
v_mfma_f32_16x16x32_bf16 v[220:223], a[244:247], a[220:223], v[220:223]
ds_read_b64_tr_b16 a[186:187], v15 offset:18440
v_accvgpr_read_b32 v51, a91
v_mfma_f32_16x16x32_bf16 v[220:223], a[240:243], a[204:207], v[220:223]
s_waitcnt lgkmcnt(6)
v_rcp_f32 v39, v39
v_mfma_f32_16x16x32_bf16 v[224:227], a[160:163], a[192:195], v[224:227]
ds_read_b64_tr_b16 a[188:189], v15 offset:20488
v_mul_f32 v28, v28, v32
v_mfma_f32_16x16x32_bf16 v[224:227], a[164:167], a[208:211], v[224:227]
v_add_f32 v52, 1.0, v52
v_mul_f32 v29, v29, v33
v_mfma_f32_16x16x32_bf16 v[224:227], a[168:171], a[128:131], v[224:227]
ds_read_b64_tr_b16 a[190:191], v15 offset:22536
v_add_f32 v53, 1.0, v53
v_mfma_f32_16x16x32_bf16 v[224:227], a[172:175], a[144:147], v[224:227]
v_mul_f32 v30, v30, v34
v_add_f32 v54, 1.0, v54
v_mfma_f32_16x16x32_bf16 v[228:231], a[172:175], a[148:151], v[228:231]
v_mul_f32 v31, v31, v35
v_add_f32 v55, 1.0, v55
v_mfma_f32_16x16x32_bf16 v[228:231], a[168:171], a[132:135], v[228:231]
v_rcp_f32 v52, v52
v_mfma_f32_16x16x32_bf16 v[228:231], a[164:167], a[212:215], v[228:231]
v_rcp_f32 v53, v53
v_mfma_f32_16x16x32_bf16 v[228:231], a[160:163], a[196:199], v[228:231]
v_rcp_f32 v54, v54
v_mfma_f32_16x16x32_bf16 v[232:235], a[160:163], a[200:203], v[232:235]
v_rcp_f32 v55, v55
v_mfma_f32_16x16x32_bf16 v[232:235], a[164:167], a[216:219], v[232:235]
v_mul_f32 v28, v28, v36
v_mul_f32 v29, v29, v37
v_mfma_f32_16x16x32_bf16 v[232:235], a[168:171], a[136:139], v[232:235]
v_mul_f32 v30, v30, v38
v_mul_f32 v31, v31, v39
v_mfma_f32_16x16x32_bf16 v[232:235], a[172:175], a[152:155], v[232:235]
v_cvt_pk_bf16_f32 v56, v28, v29
v_mul_f32 v44, v44, v48
v_mfma_f32_16x16x32_bf16 v[236:239], a[172:175], a[156:159], v[236:239]
v_cvt_pk_bf16_f32 v57, v30, v31
v_mul_f32 v45, v45, v49
v_mfma_f32_16x16x32_bf16 v[236:239], a[168:171], a[140:143], v[236:239]
v_mul_f32 v46, v46, v50
v_mul_f32 v47, v47, v51
v_mfma_f32_16x16x32_bf16 v[236:239], a[164:167], a[220:223], v[236:239]
v_mul_f32 v44, v44, v52
v_mul_f32 v45, v45, v53
v_mfma_f32_16x16x32_bf16 v[236:239], a[160:163], a[204:207], v[236:239]
s_waitcnt lgkmcnt(0)
v_mul_f32 v46, v46, v54
v_mul_f32 v47, v47, v55
v_mfma_f32_16x16x32_bf16 v[240:243], a[176:179], a[192:195], v[240:243]
v_cvt_pk_bf16_f32 v58, v44, v45
v_cvt_pk_bf16_f32 v59, v46, v47
v_mfma_f32_16x16x32_bf16 v[240:243], a[180:183], a[208:211], v[240:243]
s_xor_b32 s42, s64, 2048
buffer_store_dwordx4 v[56:59], v3, s[24:27], s42 offen sc1
v_mfma_f32_16x16x32_bf16 v[240:243], a[184:187], a[128:131], v[240:243]
v_mfma_f32_16x16x32_bf16 v[240:243], a[188:191], a[144:147], v[240:243]
v_mfma_f32_16x16x32_bf16 v[244:247], a[188:191], a[148:151], v[244:247]
v_mfma_f32_16x16x32_bf16 v[244:247], a[184:187], a[132:135], v[244:247]
v_mfma_f32_16x16x32_bf16 v[244:247], a[180:183], a[212:215], v[244:247]
v_mfma_f32_16x16x32_bf16 v[244:247], a[176:179], a[196:199], v[244:247]
v_mfma_f32_16x16x32_bf16 v[248:251], a[176:179], a[200:203], v[248:251]
v_mfma_f32_16x16x32_bf16 v[248:251], a[180:183], a[216:219], v[248:251]
v_mfma_f32_16x16x32_bf16 v[248:251], a[184:187], a[136:139], v[248:251]
v_mfma_f32_16x16x32_bf16 v[248:251], a[188:191], a[152:155], v[248:251]
v_mfma_f32_16x16x32_bf16 v[252:255], a[188:191], a[156:159], v[252:255]
v_mfma_f32_16x16x32_bf16 v[252:255], a[184:187], a[140:143], v[252:255]
v_mfma_f32_16x16x32_bf16 v[252:255], a[180:183], a[220:223], v[252:255]
v_mfma_f32_16x16x32_bf16 v[252:255], a[176:179], a[204:207], v[252:255]
v_accvgpr_read_b32 v28, a12
v_accvgpr_read_b32 v29, a13
v_accvgpr_read_b32 v30, a14
v_accvgpr_read_b32 v31, a15
v_mul_f32 v36, s44, v28
v_mul_f32 v37, s44, v29
v_mul_f32 v38, s44, v30
v_mul_f32 v39, s44, v31
v_exp_f32 v36, v36
v_exp_f32 v37, v37
v_exp_f32 v38, v38
v_exp_f32 v39, v39
v_accvgpr_read_b32 v32, a76
v_accvgpr_read_b32 v33, a77
v_accvgpr_read_b32 v34, a78
v_accvgpr_read_b32 v35, a79
v_add_f32 v36, 1.0, v36
v_add_f32 v37, 1.0, v37
v_add_f32 v38, 1.0, v38
v_add_f32 v39, 1.0, v39
v_rcp_f32 v36, v36
v_rcp_f32 v37, v37
v_rcp_f32 v38, v38
v_rcp_f32 v39, v39
v_pk_mul_f32 v[28:29], v[28:29], v[32:33]
v_pk_mul_f32 v[30:31], v[30:31], v[34:35]
v_pk_mul_f32 v[28:29], v[28:29], v[36:37]
v_pk_mul_f32 v[30:31], v[30:31], v[38:39]
v_cvt_pk_bf16_f32 v40, v28, v29
v_cvt_pk_bf16_f32 v41, v30, v31
v_accvgpr_read_b32 v28, a28
v_accvgpr_read_b32 v29, a29
v_accvgpr_read_b32 v30, a30
v_accvgpr_read_b32 v31, a31
v_mul_f32 v36, s44, v28
v_mul_f32 v37, s44, v29
v_mul_f32 v38, s44, v30
v_mul_f32 v39, s44, v31
v_exp_f32 v36, v36
v_exp_f32 v37, v37
v_exp_f32 v38, v38
v_exp_f32 v39, v39
v_accvgpr_read_b32 v32, a92
v_accvgpr_read_b32 v33, a93
v_accvgpr_read_b32 v34, a94
v_accvgpr_read_b32 v35, a95
v_add_f32 v36, 1.0, v36
v_add_f32 v37, 1.0, v37
v_add_f32 v38, 1.0, v38
v_add_f32 v39, 1.0, v39
v_rcp_f32 v36, v36
v_rcp_f32 v37, v37
v_rcp_f32 v38, v38
v_rcp_f32 v39, v39
v_pk_mul_f32 v[28:29], v[28:29], v[32:33]
v_pk_mul_f32 v[30:31], v[30:31], v[34:35]
v_pk_mul_f32 v[28:29], v[28:29], v[36:37]
v_pk_mul_f32 v[30:31], v[30:31], v[38:39]
v_cvt_pk_bf16_f32 v42, v28, v29
v_cvt_pk_bf16_f32 v43, v30, v31
s_xor_b32 s42, s64, 3072
buffer_store_dwordx4 v[40:43], v3, s[24:27], s42 offen sc1
v_accvgpr_read_b32 v28, a32
v_accvgpr_read_b32 v29, a33
v_accvgpr_read_b32 v30, a34
v_accvgpr_read_b32 v31, a35
v_mul_f32 v36, s44, v28
v_mul_f32 v37, s44, v29
v_mul_f32 v38, s44, v30
v_mul_f32 v39, s44, v31
v_exp_f32 v36, v36
v_exp_f32 v37, v37
v_exp_f32 v38, v38
v_exp_f32 v39, v39
v_accvgpr_read_b32 v32, a96
v_accvgpr_read_b32 v33, a97
v_accvgpr_read_b32 v34, a98
v_accvgpr_read_b32 v35, a99
v_add_f32 v36, 1.0, v36
v_add_f32 v37, 1.0, v37
v_add_f32 v38, 1.0, v38
v_add_f32 v39, 1.0, v39
v_rcp_f32 v36, v36
v_rcp_f32 v37, v37
v_rcp_f32 v38, v38
v_rcp_f32 v39, v39
v_pk_mul_f32 v[28:29], v[28:29], v[32:33]
v_pk_mul_f32 v[30:31], v[30:31], v[34:35]
v_pk_mul_f32 v[28:29], v[28:29], v[36:37]
v_pk_mul_f32 v[30:31], v[30:31], v[38:39]
v_cvt_pk_bf16_f32 v56, v28, v29
v_cvt_pk_bf16_f32 v57, v30, v31
v_accvgpr_read_b32 v28, a48
v_accvgpr_read_b32 v29, a49
v_accvgpr_read_b32 v30, a50
v_accvgpr_read_b32 v31, a51
v_mul_f32 v36, s44, v28
v_mul_f32 v37, s44, v29
v_mul_f32 v38, s44, v30
v_mul_f32 v39, s44, v31
v_exp_f32 v36, v36
v_exp_f32 v37, v37
v_exp_f32 v38, v38
v_exp_f32 v39, v39
v_accvgpr_read_b32 v32, a112
v_accvgpr_read_b32 v33, a113
v_accvgpr_read_b32 v34, a114
v_accvgpr_read_b32 v35, a115
v_add_f32 v36, 1.0, v36
v_add_f32 v37, 1.0, v37
v_add_f32 v38, 1.0, v38
v_add_f32 v39, 1.0, v39
v_rcp_f32 v36, v36
v_rcp_f32 v37, v37
v_rcp_f32 v38, v38
v_rcp_f32 v39, v39
v_pk_mul_f32 v[28:29], v[28:29], v[32:33]
v_pk_mul_f32 v[30:31], v[30:31], v[34:35]
v_pk_mul_f32 v[28:29], v[28:29], v[36:37]
v_pk_mul_f32 v[30:31], v[30:31], v[38:39]
v_cvt_pk_bf16_f32 v58, v28, v29
v_cvt_pk_bf16_f32 v59, v30, v31
s_xor_b32 s42, s64, 4096
buffer_store_dwordx4 v[56:59], v3, s[24:27], s42 offen sc1
v_accvgpr_read_b32 v28, a36
v_accvgpr_read_b32 v29, a37
v_accvgpr_read_b32 v30, a38
v_accvgpr_read_b32 v31, a39
v_mul_f32 v36, s44, v28
v_mul_f32 v37, s44, v29
v_mul_f32 v38, s44, v30
v_mul_f32 v39, s44, v31
v_exp_f32 v36, v36
v_exp_f32 v37, v37
v_exp_f32 v38, v38
v_exp_f32 v39, v39
v_accvgpr_read_b32 v32, a100
v_accvgpr_read_b32 v33, a101
v_accvgpr_read_b32 v34, a102
v_accvgpr_read_b32 v35, a103
v_add_f32 v36, 1.0, v36
v_add_f32 v37, 1.0, v37
v_add_f32 v38, 1.0, v38
v_add_f32 v39, 1.0, v39
v_rcp_f32 v36, v36
v_rcp_f32 v37, v37
v_rcp_f32 v38, v38
v_rcp_f32 v39, v39
v_pk_mul_f32 v[28:29], v[28:29], v[32:33]
v_pk_mul_f32 v[30:31], v[30:31], v[34:35]
v_pk_mul_f32 v[28:29], v[28:29], v[36:37]
v_pk_mul_f32 v[30:31], v[30:31], v[38:39]
v_cvt_pk_bf16_f32 v40, v28, v29
v_cvt_pk_bf16_f32 v41, v30, v31
v_accvgpr_read_b32 v28, a52
v_accvgpr_read_b32 v29, a53
v_accvgpr_read_b32 v30, a54
v_accvgpr_read_b32 v31, a55
v_mul_f32 v36, s44, v28
v_mul_f32 v37, s44, v29
v_mul_f32 v38, s44, v30
v_mul_f32 v39, s44, v31
v_exp_f32 v36, v36
v_exp_f32 v37, v37
v_exp_f32 v38, v38
v_exp_f32 v39, v39
v_accvgpr_read_b32 v32, a116
v_accvgpr_read_b32 v33, a117
v_accvgpr_read_b32 v34, a118
v_accvgpr_read_b32 v35, a119
v_add_f32 v36, 1.0, v36
v_add_f32 v37, 1.0, v37
v_add_f32 v38, 1.0, v38
v_add_f32 v39, 1.0, v39
v_rcp_f32 v36, v36
v_rcp_f32 v37, v37
v_rcp_f32 v38, v38
v_rcp_f32 v39, v39
v_pk_mul_f32 v[28:29], v[28:29], v[32:33]
v_pk_mul_f32 v[30:31], v[30:31], v[34:35]
v_pk_mul_f32 v[28:29], v[28:29], v[36:37]
v_pk_mul_f32 v[30:31], v[30:31], v[38:39]
v_cvt_pk_bf16_f32 v42, v28, v29
v_cvt_pk_bf16_f32 v43, v30, v31
s_xor_b32 s42, s64, 5120
buffer_store_dwordx4 v[40:43], v3, s[24:27], s42 offen sc1
v_accvgpr_read_b32 v28, a40
v_accvgpr_read_b32 v29, a41
v_accvgpr_read_b32 v30, a42
v_accvgpr_read_b32 v31, a43
v_mul_f32 v36, s44, v28
v_mul_f32 v37, s44, v29
v_mul_f32 v38, s44, v30
v_mul_f32 v39, s44, v31
v_exp_f32 v36, v36
v_exp_f32 v37, v37
v_exp_f32 v38, v38
v_exp_f32 v39, v39
v_accvgpr_read_b32 v32, a104
v_accvgpr_read_b32 v33, a105
v_accvgpr_read_b32 v34, a106
v_accvgpr_read_b32 v35, a107
v_add_f32 v36, 1.0, v36
v_add_f32 v37, 1.0, v37
v_add_f32 v38, 1.0, v38
v_add_f32 v39, 1.0, v39
v_rcp_f32 v36, v36
v_rcp_f32 v37, v37
v_rcp_f32 v38, v38
v_rcp_f32 v39, v39
v_pk_mul_f32 v[28:29], v[28:29], v[32:33]
v_pk_mul_f32 v[30:31], v[30:31], v[34:35]
v_pk_mul_f32 v[28:29], v[28:29], v[36:37]
v_pk_mul_f32 v[30:31], v[30:31], v[38:39]
v_cvt_pk_bf16_f32 v56, v28, v29
v_cvt_pk_bf16_f32 v57, v30, v31
v_accvgpr_read_b32 v28, a56
v_accvgpr_read_b32 v29, a57
v_accvgpr_read_b32 v30, a58
v_accvgpr_read_b32 v31, a59
v_mul_f32 v36, s44, v28
v_mul_f32 v37, s44, v29
v_mul_f32 v38, s44, v30
v_mul_f32 v39, s44, v31
v_exp_f32 v36, v36
v_exp_f32 v37, v37
v_exp_f32 v38, v38
v_exp_f32 v39, v39
v_accvgpr_read_b32 v32, a120
v_accvgpr_read_b32 v33, a121
v_accvgpr_read_b32 v34, a122
v_accvgpr_read_b32 v35, a123
v_add_f32 v36, 1.0, v36
v_add_f32 v37, 1.0, v37
v_add_f32 v38, 1.0, v38
v_add_f32 v39, 1.0, v39
v_rcp_f32 v36, v36
v_rcp_f32 v37, v37
v_rcp_f32 v38, v38
v_rcp_f32 v39, v39
v_pk_mul_f32 v[28:29], v[28:29], v[32:33]
v_pk_mul_f32 v[30:31], v[30:31], v[34:35]
v_pk_mul_f32 v[28:29], v[28:29], v[36:37]
v_pk_mul_f32 v[30:31], v[30:31], v[38:39]
v_cvt_pk_bf16_f32 v58, v28, v29
v_cvt_pk_bf16_f32 v59, v30, v31
s_xor_b32 s42, s64, 6144
buffer_store_dwordx4 v[56:59], v3, s[24:27], s42 offen sc1
v_accvgpr_read_b32 v28, a44
v_accvgpr_read_b32 v29, a45
v_accvgpr_read_b32 v30, a46
v_accvgpr_read_b32 v31, a47
v_mul_f32 v36, s44, v28
v_mul_f32 v37, s44, v29
v_mul_f32 v38, s44, v30
v_mul_f32 v39, s44, v31
v_exp_f32 v36, v36
v_exp_f32 v37, v37
v_exp_f32 v38, v38
v_exp_f32 v39, v39
v_accvgpr_read_b32 v32, a108
v_accvgpr_read_b32 v33, a109
v_accvgpr_read_b32 v34, a110
v_accvgpr_read_b32 v35, a111
v_add_f32 v36, 1.0, v36
v_add_f32 v37, 1.0, v37
v_add_f32 v38, 1.0, v38
v_add_f32 v39, 1.0, v39
v_rcp_f32 v36, v36
v_rcp_f32 v37, v37
v_rcp_f32 v38, v38
v_rcp_f32 v39, v39
v_pk_mul_f32 v[28:29], v[28:29], v[32:33]
v_pk_mul_f32 v[30:31], v[30:31], v[34:35]
v_pk_mul_f32 v[28:29], v[28:29], v[36:37]
v_pk_mul_f32 v[30:31], v[30:31], v[38:39]
v_cvt_pk_bf16_f32 v40, v28, v29
v_cvt_pk_bf16_f32 v41, v30, v31
v_accvgpr_read_b32 v28, a60
v_accvgpr_read_b32 v29, a61
v_accvgpr_read_b32 v30, a62
v_accvgpr_read_b32 v31, a63
v_mul_f32 v36, s44, v28
v_mul_f32 v37, s44, v29
v_mul_f32 v38, s44, v30
v_mul_f32 v39, s44, v31
v_exp_f32 v36, v36
v_exp_f32 v37, v37
v_exp_f32 v38, v38
v_exp_f32 v39, v39
v_accvgpr_read_b32 v32, a124
v_accvgpr_read_b32 v33, a125
v_accvgpr_read_b32 v34, a126
v_accvgpr_read_b32 v35, a127
v_add_f32 v36, 1.0, v36
v_add_f32 v37, 1.0, v37
v_add_f32 v38, 1.0, v38
v_add_f32 v39, 1.0, v39
v_rcp_f32 v36, v36
v_rcp_f32 v37, v37
v_rcp_f32 v38, v38
v_rcp_f32 v39, v39
v_pk_mul_f32 v[28:29], v[28:29], v[32:33]
v_pk_mul_f32 v[30:31], v[30:31], v[34:35]
v_pk_mul_f32 v[28:29], v[28:29], v[36:37]
v_pk_mul_f32 v[30:31], v[30:31], v[38:39]
v_cvt_pk_bf16_f32 v42, v28, v29
v_cvt_pk_bf16_f32 v43, v30, v31
s_xor_b32 s42, s64, 7168
buffer_store_dwordx4 v[40:43], v3, s[24:27], s42 offen sc1
s_branch A_done
A_light:
v_mfma_f32_16x16x32_bf16 v[64:67], a[224:227], a[128:131], 0
ds_read_b64_tr_b16 a[240:241], v15 offset:0
v_mfma_f32_16x16x32_bf16 v[64:67], a[228:231], a[144:147], v[64:67]
ds_read_b64_tr_b16 a[242:243], v15 offset:2048
v_mfma_f32_16x16x32_bf16 v[68:71], a[228:231], a[148:151], 0
s_mov_b32 s40, 3145728
v_mfma_f32_16x16x32_bf16 v[68:71], a[224:227], a[132:135], v[68:71]
buffer_load_dword v46, v44, s[12:15], s40 offen
v_mfma_f32_16x16x32_bf16 v[72:75], a[224:227], a[136:139], 0
ds_read_b64_tr_b16 a[244:245], v15 offset:4096
v_mfma_f32_16x16x32_bf16 v[72:75], a[228:231], a[152:155], v[72:75]
ds_read_b64_tr_b16 a[246:247], v15 offset:6144
v_mfma_f32_16x16x32_bf16 v[76:79], a[228:231], a[156:159], 0
s_mov_b32 s40, 786432
v_mfma_f32_16x16x32_bf16 v[76:79], a[224:227], a[140:143], v[76:79]
s_waitcnt lgkmcnt(4)
buffer_load_dword v47, v45, s[16:19], s40 offen
v_mfma_f32_16x16x32_bf16 v[80:83], a[232:235], a[128:131], 0
ds_read_b64_tr_b16 a[248:249], v15 offset:8
v_mfma_f32_16x16x32_bf16 v[80:83], a[236:239], a[144:147], v[80:83]
s_mov_b32 s40, 1572864
ds_read_b64_tr_b16 a[250:251], v15 offset:2056
v_mfma_f32_16x16x32_bf16 v[84:87], a[236:239], a[148:151], 0
s_add_u32 m0, s36, 81920
v_mfma_f32_16x16x32_bf16 v[84:87], a[232:235], a[132:135], v[84:87]
buffer_load_dwordx4 v12, s[12:15], s40 offen offset:0 lds
v_mfma_f32_16x16x32_bf16 v[88:91], a[232:235], a[136:139], 0
ds_read_b64_tr_b16 a[252:253], v15 offset:4104
v_mfma_f32_16x16x32_bf16 v[88:91], a[236:239], a[152:155], v[88:91]
ds_read_b64_tr_b16 a[254:255], v15 offset:6152
v_mfma_f32_16x16x32_bf16 v[92:95], a[236:239], a[156:159], 0
s_add_u32 m0, s36, 89984
v_mfma_f32_16x16x32_bf16 v[92:95], a[232:235], a[140:143], v[92:95]
s_waitcnt lgkmcnt(4)
buffer_load_dwordx4 v12, s[12:15], s40 offen offset:128 lds
v_mfma_f32_16x16x32_bf16 v[96:99], a[240:243], a[128:131], 0
ds_read_b64_tr_b16 a[224:225], v14 offset:8192
v_mfma_f32_16x16x32_bf16 v[96:99], a[244:247], a[144:147], v[96:99]
ds_read_b64_tr_b16 a[226:227], v14 offset:10240
v_mfma_f32_16x16x32_bf16 v[100:103], a[244:247], a[148:151], 0
s_add_u32 m0, s36, 98048
v_mfma_f32_16x16x32_bf16 v[100:103], a[240:243], a[132:135], v[100:103]
buffer_load_dwordx4 v12, s[12:15], s40 offen offset:256 lds
v_mfma_f32_16x16x32_bf16 v[104:107], a[240:243], a[136:139], 0
ds_read_b64_tr_b16 a[228:229], v14 offset:12288
v_mfma_f32_16x16x32_bf16 v[104:107], a[244:247], a[152:155], v[104:107]
s_mov_b32 s40, 1769472
ds_read_b64_tr_b16 a[230:231], v14 offset:14336
v_mfma_f32_16x16x32_bf16 v[108:111], a[244:247], a[156:159], 0
s_add_u32 m0, s36, 82944
v_mfma_f32_16x16x32_bf16 v[108:111], a[240:243], a[140:143], v[108:111]
s_waitcnt lgkmcnt(4)
buffer_load_dwordx4 v12, s[12:15], s40 offen offset:0 lds
v_mfma_f32_16x16x32_bf16 v[112:115], a[248:251], a[128:131], 0
ds_read_b64_tr_b16 a[232:233], v14 offset:8200
v_mfma_f32_16x16x32_bf16 v[112:115], a[252:255], a[144:147], v[112:115]
ds_read_b64_tr_b16 a[234:235], v14 offset:10248
v_mfma_f32_16x16x32_bf16 v[116:119], a[252:255], a[148:151], 0
s_add_u32 m0, s36, 91008
v_mfma_f32_16x16x32_bf16 v[116:119], a[248:251], a[132:135], v[116:119]
buffer_load_dwordx4 v12, s[12:15], s40 offen offset:128 lds
v_mfma_f32_16x16x32_bf16 v[120:123], a[248:251], a[136:139], 0
ds_read_b64_tr_b16 a[236:237], v14 offset:12296
v_mfma_f32_16x16x32_bf16 v[120:123], a[252:255], a[152:155], v[120:123]
ds_read_b64_tr_b16 a[238:239], v14 offset:14344
v_mfma_f32_16x16x32_bf16 v[124:127], a[252:255], a[156:159], 0
s_add_u32 m0, s36, 99072
v_mfma_f32_16x16x32_bf16 v[124:127], a[248:251], a[140:143], v[124:127]
s_waitcnt lgkmcnt(4)
buffer_load_dwordx4 v12, s[12:15], s40 offen offset:256 lds
v_mfma_f32_16x16x32_bf16 v[128:131], a[224:227], a[128:131], 0
ds_read_b64_tr_b16 a[240:241], v15 offset:8192
v_mfma_f32_16x16x32_bf16 v[128:131], a[228:231], a[144:147], v[128:131]
s_mov_b32 s40, 393216
ds_read_b64_tr_b16 a[242:243], v15 offset:10240
v_mfma_f32_16x16x32_bf16 v[132:135], a[228:231], a[148:151], 0
s_add_u32 m0, s37, 106496
v_mfma_f32_16x16x32_bf16 v[132:135], a[224:227], a[132:135], v[132:135]
buffer_load_dwordx4 v13, s[16:19], s40 offen lds
v_mfma_f32_16x16x32_bf16 v[136:139], a[224:227], a[136:139], 0
ds_read_b64_tr_b16 a[244:245], v15 offset:12288
v_mfma_f32_16x16x32_bf16 v[136:139], a[228:231], a[152:155], v[136:139]
s_mov_b32 s40, 442368
ds_read_b64_tr_b16 a[246:247], v15 offset:14336
v_mfma_f32_16x16x32_bf16 v[140:143], a[228:231], a[156:159], 0
s_add_u32 m0, s37, 107520
v_mfma_f32_16x16x32_bf16 v[140:143], a[224:227], a[140:143], v[140:143]
s_waitcnt lgkmcnt(4)
buffer_load_dwordx4 v13, s[16:19], s40 offen lds
v_mfma_f32_16x16x32_bf16 v[144:147], a[232:235], a[128:131], 0
ds_read_b64_tr_b16 a[248:249], v15 offset:8200
v_mfma_f32_16x16x32_bf16 v[144:147], a[236:239], a[144:147], v[144:147]
s_mov_b32 s40, 405504
ds_read_b64_tr_b16 a[250:251], v15 offset:10248
v_mfma_f32_16x16x32_bf16 v[148:151], a[236:239], a[148:151], 0
s_add_u32 m0, s37, 108544
v_mfma_f32_16x16x32_bf16 v[148:151], a[232:235], a[132:135], v[148:151]
buffer_load_dwordx4 v13, s[16:19], s40 offen lds
v_mfma_f32_16x16x32_bf16 v[152:155], a[232:235], a[136:139], 0
ds_read_b64_tr_b16 a[252:253], v15 offset:12296
v_mfma_f32_16x16x32_bf16 v[152:155], a[236:239], a[152:155], v[152:155]
s_mov_b32 s40, 454656
ds_read_b64_tr_b16 a[254:255], v15 offset:14344
v_mfma_f32_16x16x32_bf16 v[156:159], a[236:239], a[156:159], 0
s_add_u32 m0, s37, 109568
v_mfma_f32_16x16x32_bf16 v[156:159], a[232:235], a[140:143], v[156:159]
s_waitcnt lgkmcnt(4)
buffer_load_dwordx4 v13, s[16:19], s40 offen lds
v_mfma_f32_16x16x32_bf16 v[160:163], a[240:243], a[128:131], 0
ds_read_b64_tr_b16 a[224:225], v14 offset:16384
v_mfma_f32_16x16x32_bf16 v[160:163], a[244:247], a[144:147], v[160:163]
ds_read_b64_tr_b16 a[226:227], v14 offset:18432
v_mfma_f32_16x16x32_bf16 v[164:167], a[244:247], a[148:151], 0
s_xor_b32 s41, s3, 16384
v_mfma_f32_16x16x32_bf16 v[164:167], a[240:243], a[132:135], v[164:167]
buffer_load_dwordx4 a[192:195], v3, s[20:23], s41 offen sc1
v_mfma_f32_16x16x32_bf16 v[168:171], a[240:243], a[136:139], 0
ds_read_b64_tr_b16 a[228:229], v14 offset:20480
v_mfma_f32_16x16x32_bf16 v[168:171], a[244:247], a[152:155], v[168:171]
ds_read_b64_tr_b16 a[230:231], v14 offset:22528
v_mfma_f32_16x16x32_bf16 v[172:175], a[244:247], a[156:159], 0
s_xor_b32 s41, s3, 17408
v_mfma_f32_16x16x32_bf16 v[172:175], a[240:243], a[140:143], v[172:175]
s_waitcnt lgkmcnt(4)
buffer_load_dwordx4 a[196:199], v3, s[20:23], s41 offen sc1
v_mfma_f32_16x16x32_bf16 v[176:179], a[248:251], a[128:131], 0
ds_read_b64_tr_b16 a[232:233], v14 offset:16392
v_mfma_f32_16x16x32_bf16 v[176:179], a[252:255], a[144:147], v[176:179]
ds_read_b64_tr_b16 a[234:235], v14 offset:18440
v_mfma_f32_16x16x32_bf16 v[180:183], a[252:255], a[148:151], 0
s_xor_b32 s41, s3, 18432
v_mfma_f32_16x16x32_bf16 v[180:183], a[248:251], a[132:135], v[180:183]
buffer_load_dwordx4 a[200:203], v3, s[20:23], s41 offen sc1
v_mfma_f32_16x16x32_bf16 v[184:187], a[248:251], a[136:139], 0
ds_read_b64_tr_b16 a[236:237], v14 offset:20488
v_mfma_f32_16x16x32_bf16 v[184:187], a[252:255], a[152:155], v[184:187]
ds_read_b64_tr_b16 a[238:239], v14 offset:22536
v_mfma_f32_16x16x32_bf16 v[188:191], a[252:255], a[156:159], 0
s_xor_b32 s41, s3, 19456
v_mfma_f32_16x16x32_bf16 v[188:191], a[248:251], a[140:143], v[188:191]
s_waitcnt lgkmcnt(4)
buffer_load_dwordx4 a[204:207], v3, s[20:23], s41 offen sc1
v_mfma_f32_16x16x32_bf16 v[192:195], a[224:227], a[128:131], 0
ds_read_b64_tr_b16 a[240:241], v15 offset:16384
v_mfma_f32_16x16x32_bf16 v[192:195], a[228:231], a[144:147], v[192:195]
ds_read_b64_tr_b16 a[242:243], v15 offset:18432
v_mfma_f32_16x16x32_bf16 v[196:199], a[228:231], a[148:151], 0
s_xor_b32 s41, s3, 20480
v_mfma_f32_16x16x32_bf16 v[196:199], a[224:227], a[132:135], v[196:199]
buffer_load_dwordx4 a[208:211], v3, s[20:23], s41 offen sc1
v_mfma_f32_16x16x32_bf16 v[200:203], a[224:227], a[136:139], 0
ds_read_b64_tr_b16 a[244:245], v15 offset:20480
v_mfma_f32_16x16x32_bf16 v[200:203], a[228:231], a[152:155], v[200:203]
ds_read_b64_tr_b16 a[246:247], v15 offset:22528
v_mfma_f32_16x16x32_bf16 v[204:207], a[228:231], a[156:159], 0
s_xor_b32 s41, s3, 21504
v_mfma_f32_16x16x32_bf16 v[204:207], a[224:227], a[140:143], v[204:207]
s_waitcnt lgkmcnt(4)
buffer_load_dwordx4 a[212:215], v3, s[20:23], s41 offen sc1
v_mfma_f32_16x16x32_bf16 v[208:211], a[232:235], a[128:131], 0
ds_read_b64_tr_b16 a[248:249], v15 offset:16392
v_mfma_f32_16x16x32_bf16 v[208:211], a[236:239], a[144:147], v[208:211]
ds_read_b64_tr_b16 a[250:251], v15 offset:18440
v_mfma_f32_16x16x32_bf16 v[212:215], a[236:239], a[148:151], 0
s_xor_b32 s41, s3, 22528
v_mfma_f32_16x16x32_bf16 v[212:215], a[232:235], a[132:135], v[212:215]
buffer_load_dwordx4 a[216:219], v3, s[20:23], s41 offen sc1
v_mfma_f32_16x16x32_bf16 v[216:219], a[232:235], a[136:139], 0
ds_read_b64_tr_b16 a[252:253], v15 offset:20488
v_mfma_f32_16x16x32_bf16 v[216:219], a[236:239], a[152:155], v[216:219]
ds_read_b64_tr_b16 a[254:255], v15 offset:22536
v_mfma_f32_16x16x32_bf16 v[220:223], a[236:239], a[156:159], 0
s_xor_b32 s41, s3, 23552
v_mfma_f32_16x16x32_bf16 v[220:223], a[232:235], a[140:143], v[220:223]
s_waitcnt lgkmcnt(4)
buffer_load_dwordx4 a[220:223], v3, s[20:23], s41 offen sc1
v_mfma_f32_16x16x32_bf16 v[224:227], a[240:243], a[128:131], 0
ds_read_b64_tr_b16 a[224:225], v18 offset:0
v_mfma_f32_16x16x32_bf16 v[224:227], a[244:247], a[144:147], v[224:227]
ds_read_b64_tr_b16 a[226:227], v18 offset:2048
v_mfma_f32_16x16x32_bf16 v[228:231], a[244:247], a[148:151], 0
v_mfma_f32_16x16x32_bf16 v[228:231], a[240:243], a[132:135], v[228:231]
v_mfma_f32_16x16x32_bf16 v[232:235], a[240:243], a[136:139], 0
ds_read_b64_tr_b16 a[228:229], v18 offset:4096
v_mfma_f32_16x16x32_bf16 v[232:235], a[244:247], a[152:155], v[232:235]
ds_read_b64_tr_b16 a[230:231], v18 offset:6144
v_mfma_f32_16x16x32_bf16 v[236:239], a[244:247], a[156:159], 0
ds_read_b64_tr_b16 a[232:233], v19 offset:0
v_mfma_f32_16x16x32_bf16 v[236:239], a[240:243], a[140:143], v[236:239]
s_waitcnt lgkmcnt(5)
ds_read_b64_tr_b16 a[234:235], v19 offset:2048
v_mfma_f32_16x16x32_bf16 v[240:243], a[248:251], a[128:131], 0
v_mfma_f32_16x16x32_bf16 v[240:243], a[252:255], a[144:147], v[240:243]
v_mfma_f32_16x16x32_bf16 v[244:247], a[252:255], a[148:151], 0
ds_read_b64_tr_b16 a[236:237], v19 offset:4096
v_mfma_f32_16x16x32_bf16 v[244:247], a[248:251], a[132:135], v[244:247]
ds_read_b64_tr_b16 a[238:239], v19 offset:6144
v_mfma_f32_16x16x32_bf16 v[248:251], a[248:251], a[136:139], 0
v_mfma_f32_16x16x32_bf16 v[248:251], a[252:255], a[152:155], v[248:251]
v_mfma_f32_16x16x32_bf16 v[252:255], a[252:255], a[156:159], 0
ds_read_b64_tr_b16 a[240:241], v18 offset:8192
v_mfma_f32_16x16x32_bf16 v[252:255], a[248:251], a[140:143], v[252:255]
s_waitcnt lgkmcnt(5)
ds_read_b64_tr_b16 a[242:243], v18 offset:10240
v_mfma_f32_16x16x32_bf16 a[0:3], a[224:227], a[128:131], 0
v_mfma_f32_16x16x32_bf16 a[0:3], a[228:231], a[144:147], a[0:3]
v_mfma_f32_16x16x32_bf16 a[4:7], a[228:231], a[148:151], 0
ds_read_b64_tr_b16 a[244:245], v18 offset:12288
v_mfma_f32_16x16x32_bf16 a[4:7], a[224:227], a[132:135], a[4:7]
ds_read_b64_tr_b16 a[246:247], v18 offset:14336
v_mfma_f32_16x16x32_bf16 a[8:11], a[224:227], a[136:139], 0
v_mfma_f32_16x16x32_bf16 a[8:11], a[228:231], a[152:155], a[8:11]
v_mfma_f32_16x16x32_bf16 a[12:15], a[228:231], a[156:159], 0
ds_read_b64_tr_b16 a[248:249], v19 offset:8192
v_mfma_f32_16x16x32_bf16 a[12:15], a[224:227], a[140:143], a[12:15]
s_waitcnt lgkmcnt(5)
ds_read_b64_tr_b16 a[250:251], v19 offset:10240
v_mfma_f32_16x16x32_bf16 a[16:19], a[232:235], a[128:131], 0
v_mfma_f32_16x16x32_bf16 a[16:19], a[236:239], a[144:147], a[16:19]
v_mfma_f32_16x16x32_bf16 a[20:23], a[236:239], a[148:151], 0
ds_read_b64_tr_b16 a[252:253], v19 offset:12288
v_mfma_f32_16x16x32_bf16 a[20:23], a[232:235], a[132:135], a[20:23]
ds_read_b64_tr_b16 a[254:255], v19 offset:14336
v_mfma_f32_16x16x32_bf16 a[24:27], a[232:235], a[136:139], 0
v_mfma_f32_16x16x32_bf16 a[24:27], a[236:239], a[152:155], a[24:27]
v_mfma_f32_16x16x32_bf16 a[28:31], a[236:239], a[156:159], 0
v_mfma_f32_16x16x32_bf16 a[28:31], a[232:235], a[140:143], a[28:31]
s_waitcnt vmcnt(20) lgkmcnt(0)
v_mfma_f32_16x16x32_bf16 a[32:35], a[240:243], a[128:131], 0
s_barrier
v_mfma_f32_16x16x32_bf16 a[32:35], a[244:247], a[144:147], a[32:35]
ds_read_b64_tr_b16 a[224:225], v14 offset:40960
v_mfma_f32_16x16x32_bf16 a[36:39], a[244:247], a[148:151], 0
ds_read_b64_tr_b16 a[226:227], v14 offset:43008
v_mfma_f32_16x16x32_bf16 a[36:39], a[240:243], a[132:135], a[36:39]
ds_read_b64_tr_b16 a[228:229], v14 offset:45056
v_mfma_f32_16x16x32_bf16 a[40:43], a[240:243], a[136:139], 0
ds_read_b64_tr_b16 a[230:231], v14 offset:47104
v_mfma_f32_16x16x32_bf16 a[40:43], a[244:247], a[152:155], a[40:43]
ds_read_b64_tr_b16 a[232:233], v14 offset:40968
v_mfma_f32_16x16x32_bf16 a[44:47], a[244:247], a[156:159], 0
ds_read_b64_tr_b16 a[234:235], v14 offset:43016
v_mfma_f32_16x16x32_bf16 a[44:47], a[240:243], a[140:143], a[44:47]
ds_read_b64_tr_b16 a[236:237], v14 offset:45064
v_mfma_f32_16x16x32_bf16 a[48:51], a[248:251], a[128:131], 0
ds_read_b64_tr_b16 a[238:239], v14 offset:47112
v_mfma_f32_16x16x32_bf16 a[48:51], a[252:255], a[144:147], a[48:51]
v_mfma_f32_16x16x32_bf16 a[52:55], a[252:255], a[148:151], 0
v_mfma_f32_16x16x32_bf16 a[52:55], a[248:251], a[132:135], a[52:55]
v_mfma_f32_16x16x32_bf16 a[56:59], a[248:251], a[136:139], 0
v_mfma_f32_16x16x32_bf16 a[56:59], a[252:255], a[152:155], a[56:59]
v_mfma_f32_16x16x32_bf16 a[60:63], a[252:255], a[156:159], 0
v_mfma_f32_16x16x32_bf16 a[60:63], a[248:251], a[140:143], a[60:63]
s_waitcnt lgkmcnt(4)
v_mfma_f32_16x16x32_bf16 v[64:67], a[224:227], a[160:163], v[64:67]
ds_read_b64_tr_b16 a[240:241], v15 offset:40960
v_mfma_f32_16x16x32_bf16 v[64:67], a[228:231], a[176:179], v[64:67]
ds_read_b64_tr_b16 a[242:243], v15 offset:43008
v_mfma_f32_16x16x32_bf16 v[68:71], a[228:231], a[180:183], v[68:71]
s_mov_b32 s40, 3932160
v_mfma_f32_16x16x32_bf16 v[68:71], a[224:227], a[164:167], v[68:71]
buffer_load_dword v48, v44, s[12:15], s40 offen
v_mfma_f32_16x16x32_bf16 v[72:75], a[224:227], a[168:171], v[72:75]
ds_read_b64_tr_b16 a[244:245], v15 offset:45056
v_mfma_f32_16x16x32_bf16 v[72:75], a[228:231], a[184:187], v[72:75]
ds_read_b64_tr_b16 a[246:247], v15 offset:47104
v_mfma_f32_16x16x32_bf16 v[76:79], a[228:231], a[188:191], v[76:79]
s_mov_b32 s40, 983040
v_mfma_f32_16x16x32_bf16 v[76:79], a[224:227], a[172:175], v[76:79]
s_waitcnt lgkmcnt(4)
buffer_load_dword v49, v45, s[16:19], s40 offen
v_mfma_f32_16x16x32_bf16 v[80:83], a[232:235], a[160:163], v[80:83]
ds_read_b64_tr_b16 a[248:249], v15 offset:40968
v_mfma_f32_16x16x32_bf16 v[80:83], a[236:239], a[176:179], v[80:83]
s_mov_b32 s40, 2359296
ds_read_b64_tr_b16 a[250:251], v15 offset:43016
v_mfma_f32_16x16x32_bf16 v[84:87], a[236:239], a[180:183], v[84:87]
s_add_u32 m0, s36, 0
v_mfma_f32_16x16x32_bf16 v[84:87], a[232:235], a[164:167], v[84:87]
buffer_load_dwordx4 v12, s[12:15], s40 offen offset:0 lds
v_mfma_f32_16x16x32_bf16 v[88:91], a[232:235], a[168:171], v[88:91]
ds_read_b64_tr_b16 a[252:253], v15 offset:45064
v_mfma_f32_16x16x32_bf16 v[88:91], a[236:239], a[184:187], v[88:91]
ds_read_b64_tr_b16 a[254:255], v15 offset:47112
v_mfma_f32_16x16x32_bf16 v[92:95], a[236:239], a[188:191], v[92:95]
s_add_u32 m0, s36, 8064
v_mfma_f32_16x16x32_bf16 v[92:95], a[232:235], a[172:175], v[92:95]
s_waitcnt lgkmcnt(4)
buffer_load_dwordx4 v12, s[12:15], s40 offen offset:128 lds
v_mfma_f32_16x16x32_bf16 v[96:99], a[240:243], a[160:163], v[96:99]
ds_read_b64_tr_b16 a[224:225], v14 offset:49152
v_mfma_f32_16x16x32_bf16 v[96:99], a[244:247], a[176:179], v[96:99]
ds_read_b64_tr_b16 a[226:227], v14 offset:51200
v_mfma_f32_16x16x32_bf16 v[100:103], a[244:247], a[180:183], v[100:103]
s_add_u32 m0, s36, 16128
v_mfma_f32_16x16x32_bf16 v[100:103], a[240:243], a[164:167], v[100:103]
buffer_load_dwordx4 v12, s[12:15], s40 offen offset:256 lds
v_mfma_f32_16x16x32_bf16 v[104:107], a[240:243], a[168:171], v[104:107]
ds_read_b64_tr_b16 a[228:229], v14 offset:53248
v_mfma_f32_16x16x32_bf16 v[104:107], a[244:247], a[184:187], v[104:107]
s_mov_b32 s40, 2555904
ds_read_b64_tr_b16 a[230:231], v14 offset:55296
v_mfma_f32_16x16x32_bf16 v[108:111], a[244:247], a[188:191], v[108:111]
s_add_u32 m0, s36, 1024
v_mfma_f32_16x16x32_bf16 v[108:111], a[240:243], a[172:175], v[108:111]
s_waitcnt lgkmcnt(4)
buffer_load_dwordx4 v12, s[12:15], s40 offen offset:0 lds
v_mfma_f32_16x16x32_bf16 v[112:115], a[248:251], a[160:163], v[112:115]
ds_read_b64_tr_b16 a[232:233], v14 offset:49160
v_mfma_f32_16x16x32_bf16 v[112:115], a[252:255], a[176:179], v[112:115]
ds_read_b64_tr_b16 a[234:235], v14 offset:51208
v_mfma_f32_16x16x32_bf16 v[116:119], a[252:255], a[180:183], v[116:119]
s_add_u32 m0, s36, 9088
v_mfma_f32_16x16x32_bf16 v[116:119], a[248:251], a[164:167], v[116:119]
buffer_load_dwordx4 v12, s[12:15], s40 offen offset:128 lds
v_mfma_f32_16x16x32_bf16 v[120:123], a[248:251], a[168:171], v[120:123]
ds_read_b64_tr_b16 a[236:237], v14 offset:53256
v_mfma_f32_16x16x32_bf16 v[120:123], a[252:255], a[184:187], v[120:123]
ds_read_b64_tr_b16 a[238:239], v14 offset:55304
v_mfma_f32_16x16x32_bf16 v[124:127], a[252:255], a[188:191], v[124:127]
s_add_u32 m0, s36, 17152
v_mfma_f32_16x16x32_bf16 v[124:127], a[248:251], a[172:175], v[124:127]
s_waitcnt lgkmcnt(4)
buffer_load_dwordx4 v12, s[12:15], s40 offen offset:256 lds
v_mfma_f32_16x16x32_bf16 v[128:131], a[224:227], a[160:163], v[128:131]
ds_read_b64_tr_b16 a[240:241], v15 offset:49152
v_mfma_f32_16x16x32_bf16 v[128:131], a[228:231], a[176:179], v[128:131]
s_mov_b32 s40, 589824
ds_read_b64_tr_b16 a[242:243], v15 offset:51200
v_mfma_f32_16x16x32_bf16 v[132:135], a[228:231], a[180:183], v[132:135]
s_add_u32 m0, s37, 24576
v_mfma_f32_16x16x32_bf16 v[132:135], a[224:227], a[164:167], v[132:135]
buffer_load_dwordx4 v13, s[16:19], s40 offen lds
v_mfma_f32_16x16x32_bf16 v[136:139], a[224:227], a[168:171], v[136:139]
ds_read_b64_tr_b16 a[244:245], v15 offset:53248
v_mfma_f32_16x16x32_bf16 v[136:139], a[228:231], a[184:187], v[136:139]
s_mov_b32 s40, 638976
ds_read_b64_tr_b16 a[246:247], v15 offset:55296
v_mfma_f32_16x16x32_bf16 v[140:143], a[228:231], a[188:191], v[140:143]
s_add_u32 m0, s37, 25600
v_mfma_f32_16x16x32_bf16 v[140:143], a[224:227], a[172:175], v[140:143]
s_waitcnt lgkmcnt(4)
buffer_load_dwordx4 v13, s[16:19], s40 offen lds
v_mfma_f32_16x16x32_bf16 v[144:147], a[232:235], a[160:163], v[144:147]
ds_read_b64_tr_b16 a[248:249], v15 offset:49160
v_mfma_f32_16x16x32_bf16 v[144:147], a[236:239], a[176:179], v[144:147]
s_mov_b32 s40, 602112
ds_read_b64_tr_b16 a[250:251], v15 offset:51208
v_mfma_f32_16x16x32_bf16 v[148:151], a[236:239], a[180:183], v[148:151]
s_add_u32 m0, s37, 26624
v_mfma_f32_16x16x32_bf16 v[148:151], a[232:235], a[164:167], v[148:151]
buffer_load_dwordx4 v13, s[16:19], s40 offen lds
v_mfma_f32_16x16x32_bf16 v[152:155], a[232:235], a[168:171], v[152:155]
ds_read_b64_tr_b16 a[252:253], v15 offset:53256
v_mfma_f32_16x16x32_bf16 v[152:155], a[236:239], a[184:187], v[152:155]
s_mov_b32 s40, 651264
ds_read_b64_tr_b16 a[254:255], v15 offset:55304
v_mfma_f32_16x16x32_bf16 v[156:159], a[236:239], a[188:191], v[156:159]
s_add_u32 m0, s37, 27648
v_mfma_f32_16x16x32_bf16 v[156:159], a[232:235], a[172:175], v[156:159]
s_waitcnt lgkmcnt(4)
buffer_load_dwordx4 v13, s[16:19], s40 offen lds
v_mfma_f32_16x16x32_bf16 v[160:163], a[240:243], a[160:163], v[160:163]
ds_read_b64_tr_b16 a[224:225], v14 offset:57344
v_mfma_f32_16x16x32_bf16 v[160:163], a[244:247], a[176:179], v[160:163]
ds_read_b64_tr_b16 a[226:227], v14 offset:59392
v_mfma_f32_16x16x32_bf16 v[164:167], a[244:247], a[180:183], v[164:167]
s_xor_b32 s41, s3, 24576
v_mfma_f32_16x16x32_bf16 v[164:167], a[240:243], a[164:167], v[164:167]
buffer_load_dwordx4 a[128:131], v3, s[20:23], s41 offen sc1
v_mfma_f32_16x16x32_bf16 v[168:171], a[240:243], a[168:171], v[168:171]
ds_read_b64_tr_b16 a[228:229], v14 offset:61440
v_mfma_f32_16x16x32_bf16 v[168:171], a[244:247], a[184:187], v[168:171]
ds_read_b64_tr_b16 a[230:231], v14 offset:63488
v_mfma_f32_16x16x32_bf16 v[172:175], a[244:247], a[188:191], v[172:175]
s_xor_b32 s41, s3, 25600
v_mfma_f32_16x16x32_bf16 v[172:175], a[240:243], a[172:175], v[172:175]
s_waitcnt lgkmcnt(4)
buffer_load_dwordx4 a[132:135], v3, s[20:23], s41 offen sc1
v_mfma_f32_16x16x32_bf16 v[176:179], a[248:251], a[160:163], v[176:179]
ds_read_b64_tr_b16 a[232:233], v14 offset:57352
v_mfma_f32_16x16x32_bf16 v[176:179], a[252:255], a[176:179], v[176:179]
ds_read_b64_tr_b16 a[234:235], v14 offset:59400
v_mfma_f32_16x16x32_bf16 v[180:183], a[252:255], a[180:183], v[180:183]
s_xor_b32 s41, s3, 26624
v_mfma_f32_16x16x32_bf16 v[180:183], a[248:251], a[164:167], v[180:183]
buffer_load_dwordx4 a[136:139], v3, s[20:23], s41 offen sc1
v_mfma_f32_16x16x32_bf16 v[184:187], a[248:251], a[168:171], v[184:187]
ds_read_b64_tr_b16 a[236:237], v14 offset:61448
v_mfma_f32_16x16x32_bf16 v[184:187], a[252:255], a[184:187], v[184:187]
ds_read_b64_tr_b16 a[238:239], v14 offset:63496
v_mfma_f32_16x16x32_bf16 v[188:191], a[252:255], a[188:191], v[188:191]
s_xor_b32 s41, s3, 27648
v_mfma_f32_16x16x32_bf16 v[188:191], a[248:251], a[172:175], v[188:191]
s_waitcnt lgkmcnt(4)
buffer_load_dwordx4 a[140:143], v3, s[20:23], s41 offen sc1
v_mfma_f32_16x16x32_bf16 v[192:195], a[224:227], a[160:163], v[192:195]
ds_read_b64_tr_b16 a[240:241], v15 offset:57344
v_mfma_f32_16x16x32_bf16 v[192:195], a[228:231], a[176:179], v[192:195]
ds_read_b64_tr_b16 a[242:243], v15 offset:59392
v_mfma_f32_16x16x32_bf16 v[196:199], a[228:231], a[180:183], v[196:199]
s_xor_b32 s41, s3, 28672
v_mfma_f32_16x16x32_bf16 v[196:199], a[224:227], a[164:167], v[196:199]
buffer_load_dwordx4 a[144:147], v3, s[20:23], s41 offen sc1
v_mfma_f32_16x16x32_bf16 v[200:203], a[224:227], a[168:171], v[200:203]
ds_read_b64_tr_b16 a[244:245], v15 offset:61440
v_mfma_f32_16x16x32_bf16 v[200:203], a[228:231], a[184:187], v[200:203]
ds_read_b64_tr_b16 a[246:247], v15 offset:63488
v_mfma_f32_16x16x32_bf16 v[204:207], a[228:231], a[188:191], v[204:207]
s_xor_b32 s41, s3, 29696
v_mfma_f32_16x16x32_bf16 v[204:207], a[224:227], a[172:175], v[204:207]
s_waitcnt lgkmcnt(4)
buffer_load_dwordx4 a[148:151], v3, s[20:23], s41 offen sc1
v_mfma_f32_16x16x32_bf16 v[208:211], a[232:235], a[160:163], v[208:211]
ds_read_b64_tr_b16 a[248:249], v15 offset:57352
v_mfma_f32_16x16x32_bf16 v[208:211], a[236:239], a[176:179], v[208:211]
ds_read_b64_tr_b16 a[250:251], v15 offset:59400
v_mfma_f32_16x16x32_bf16 v[212:215], a[236:239], a[180:183], v[212:215]
s_xor_b32 s41, s3, 30720
v_mfma_f32_16x16x32_bf16 v[212:215], a[232:235], a[164:167], v[212:215]
buffer_load_dwordx4 a[152:155], v3, s[20:23], s41 offen sc1
v_mfma_f32_16x16x32_bf16 v[216:219], a[232:235], a[168:171], v[216:219]
ds_read_b64_tr_b16 a[252:253], v15 offset:61448
v_mfma_f32_16x16x32_bf16 v[216:219], a[236:239], a[184:187], v[216:219]
ds_read_b64_tr_b16 a[254:255], v15 offset:63496
v_mfma_f32_16x16x32_bf16 v[220:223], a[236:239], a[188:191], v[220:223]
s_xor_b32 s41, s3, 31744
v_mfma_f32_16x16x32_bf16 v[220:223], a[232:235], a[172:175], v[220:223]
s_waitcnt lgkmcnt(4)
buffer_load_dwordx4 a[156:159], v3, s[20:23], s41 offen sc1
v_mfma_f32_16x16x32_bf16 v[224:227], a[240:243], a[160:163], v[224:227]
ds_read_b64_tr_b16 a[224:225], v18 offset:40960
v_mfma_f32_16x16x32_bf16 v[224:227], a[244:247], a[176:179], v[224:227]
ds_read_b64_tr_b16 a[226:227], v18 offset:43008
v_mfma_f32_16x16x32_bf16 v[228:231], a[244:247], a[180:183], v[228:231]
s_add_u32 m0, s71, 0
v_mfma_f32_16x16x32_bf16 v[228:231], a[240:243], a[164:167], v[228:231]
buffer_load_dwordx4 v54, s[60:63], s70 offen offset:0 lds
v_mfma_f32_16x16x32_bf16 v[232:235], a[240:243], a[168:171], v[232:235]
ds_read_b64_tr_b16 a[228:229], v18 offset:45056
v_mfma_f32_16x16x32_bf16 v[232:235], a[244:247], a[184:187], v[232:235]
ds_read_b64_tr_b16 a[230:231], v18 offset:47104
v_mfma_f32_16x16x32_bf16 v[236:239], a[244:247], a[188:191], v[236:239]
ds_read_b64_tr_b16 a[232:233], v19 offset:40960
v_mfma_f32_16x16x32_bf16 v[236:239], a[240:243], a[172:175], v[236:239]
s_waitcnt lgkmcnt(5)
ds_read_b64_tr_b16 a[234:235], v19 offset:43008
v_mfma_f32_16x16x32_bf16 v[240:243], a[248:251], a[160:163], v[240:243]
s_add_u32 m0, s71, 896
v_mfma_f32_16x16x32_bf16 v[240:243], a[252:255], a[176:179], v[240:243]
buffer_load_dwordx4 v54, s[60:63], s70 offen offset:128 lds
v_mfma_f32_16x16x32_bf16 v[244:247], a[252:255], a[180:183], v[244:247]
ds_read_b64_tr_b16 a[236:237], v19 offset:45056
v_mfma_f32_16x16x32_bf16 v[244:247], a[248:251], a[164:167], v[244:247]
ds_read_b64_tr_b16 a[238:239], v19 offset:47104
v_mfma_f32_16x16x32_bf16 v[248:251], a[248:251], a[168:171], v[248:251]
s_add_u32 m0, s71, 1792
v_mfma_f32_16x16x32_bf16 v[248:251], a[252:255], a[184:187], v[248:251]
buffer_load_dwordx4 v54, s[60:63], s70 offen offset:256 lds
v_mfma_f32_16x16x32_bf16 v[252:255], a[252:255], a[188:191], v[252:255]
ds_read_b64_tr_b16 a[240:241], v18 offset:49152
v_mfma_f32_16x16x32_bf16 v[252:255], a[248:251], a[172:175], v[252:255]
s_waitcnt lgkmcnt(5)
ds_read_b64_tr_b16 a[242:243], v18 offset:51200
v_mfma_f32_16x16x32_bf16 a[0:3], a[224:227], a[160:163], a[0:3]
s_add_u32 m0, s71, 2688
v_mfma_f32_16x16x32_bf16 a[0:3], a[228:231], a[176:179], a[0:3]
buffer_load_dwordx4 v54, s[60:63], s70 offen offset:384 lds
v_mfma_f32_16x16x32_bf16 a[4:7], a[228:231], a[180:183], a[4:7]
ds_read_b64_tr_b16 a[244:245], v18 offset:53248
v_mfma_f32_16x16x32_bf16 a[4:7], a[224:227], a[164:167], a[4:7]
ds_read_b64_tr_b16 a[246:247], v18 offset:55296
v_mfma_f32_16x16x32_bf16 a[8:11], a[224:227], a[168:171], a[8:11]
s_add_u32 m0, s71, 3584
v_mfma_f32_16x16x32_bf16 a[8:11], a[228:231], a[184:187], a[8:11]
buffer_load_dwordx4 v54, s[60:63], s70 offen offset:512 lds
v_mfma_f32_16x16x32_bf16 a[12:15], a[228:231], a[188:191], a[12:15]
ds_read_b64_tr_b16 a[248:249], v19 offset:49152
v_mfma_f32_16x16x32_bf16 a[12:15], a[224:227], a[172:175], a[12:15]
s_waitcnt lgkmcnt(5)
ds_read_b64_tr_b16 a[250:251], v19 offset:51200
v_mfma_f32_16x16x32_bf16 a[16:19], a[232:235], a[160:163], a[16:19]
v_mfma_f32_16x16x32_bf16 a[16:19], a[236:239], a[176:179], a[16:19]
v_mfma_f32_16x16x32_bf16 a[20:23], a[236:239], a[180:183], a[20:23]
ds_read_b64_tr_b16 a[252:253], v19 offset:53248
v_mfma_f32_16x16x32_bf16 a[20:23], a[232:235], a[164:167], a[20:23]
ds_read_b64_tr_b16 a[254:255], v19 offset:55296
v_mfma_f32_16x16x32_bf16 a[24:27], a[232:235], a[168:171], a[24:27]
v_mfma_f32_16x16x32_bf16 a[24:27], a[236:239], a[184:187], a[24:27]
v_mfma_f32_16x16x32_bf16 a[28:31], a[236:239], a[188:191], a[28:31]
v_mfma_f32_16x16x32_bf16 a[28:31], a[232:235], a[172:175], a[28:31]
s_waitcnt vmcnt(25) lgkmcnt(0)
v_mfma_f32_16x16x32_bf16 a[32:35], a[240:243], a[160:163], a[32:35]
s_barrier
v_mfma_f32_16x16x32_bf16 a[32:35], a[244:247], a[176:179], a[32:35]
ds_read_b64_tr_b16 a[224:225], v16 offset:0
v_mfma_f32_16x16x32_bf16 a[36:39], a[244:247], a[180:183], a[36:39]
ds_read_b64_tr_b16 a[226:227], v16 offset:2048
v_mfma_f32_16x16x32_bf16 a[36:39], a[240:243], a[164:167], a[36:39]
ds_read_b64_tr_b16 a[228:229], v16 offset:4096
v_mfma_f32_16x16x32_bf16 a[40:43], a[240:243], a[168:171], a[40:43]
ds_read_b64_tr_b16 a[230:231], v16 offset:6144
v_mfma_f32_16x16x32_bf16 a[40:43], a[244:247], a[184:187], a[40:43]
ds_read_b64_tr_b16 a[232:233], v16 offset:8
v_mfma_f32_16x16x32_bf16 a[44:47], a[244:247], a[188:191], a[44:47]
ds_read_b64_tr_b16 a[234:235], v16 offset:2056
v_mfma_f32_16x16x32_bf16 a[44:47], a[240:243], a[172:175], a[44:47]
ds_read_b64_tr_b16 a[236:237], v16 offset:4104
v_mfma_f32_16x16x32_bf16 a[48:51], a[248:251], a[160:163], a[48:51]
ds_read_b64_tr_b16 a[238:239], v16 offset:6152
v_mfma_f32_16x16x32_bf16 a[48:51], a[252:255], a[176:179], a[48:51]
v_mfma_f32_16x16x32_bf16 a[52:55], a[252:255], a[180:183], a[52:55]
v_mfma_f32_16x16x32_bf16 a[52:55], a[248:251], a[164:167], a[52:55]
v_mfma_f32_16x16x32_bf16 a[56:59], a[248:251], a[168:171], a[56:59]
v_mfma_f32_16x16x32_bf16 a[56:59], a[252:255], a[184:187], a[56:59]
v_mfma_f32_16x16x32_bf16 a[60:63], a[252:255], a[188:191], a[60:63]
v_mfma_f32_16x16x32_bf16 a[60:63], a[248:251], a[172:175], a[60:63]
s_waitcnt lgkmcnt(4)
v_mfma_f32_16x16x32_bf16 v[64:67], a[224:227], a[192:195], v[64:67]
ds_read_b64_tr_b16 a[240:241], v17 offset:0
v_mfma_f32_16x16x32_bf16 v[64:67], a[228:231], a[208:211], v[64:67]
ds_read_b64_tr_b16 a[242:243], v17 offset:2048
v_mfma_f32_16x16x32_bf16 v[68:71], a[228:231], a[212:215], v[68:71]
s_mov_b32 s40, 4718592
v_mfma_f32_16x16x32_bf16 v[68:71], a[224:227], a[196:199], v[68:71]
buffer_load_dword v46, v44, s[12:15], s40 offen
v_mfma_f32_16x16x32_bf16 v[72:75], a[224:227], a[200:203], v[72:75]
ds_read_b64_tr_b16 a[244:245], v17 offset:4096
v_mfma_f32_16x16x32_bf16 v[72:75], a[228:231], a[216:219], v[72:75]
ds_read_b64_tr_b16 a[246:247], v17 offset:6144
v_mfma_f32_16x16x32_bf16 v[76:79], a[228:231], a[220:223], v[76:79]
s_mov_b32 s40, 1179648
v_mfma_f32_16x16x32_bf16 v[76:79], a[224:227], a[204:207], v[76:79]
s_waitcnt lgkmcnt(4)
buffer_load_dword v47, v45, s[16:19], s40 offen
v_mfma_f32_16x16x32_bf16 v[80:83], a[232:235], a[192:195], v[80:83]
ds_read_b64_tr_b16 a[248:249], v17 offset:8
v_mfma_f32_16x16x32_bf16 v[80:83], a[236:239], a[208:211], v[80:83]
s_mov_b32 s40, 3145728
ds_read_b64_tr_b16 a[250:251], v17 offset:2056
v_mfma_f32_16x16x32_bf16 v[84:87], a[236:239], a[212:215], v[84:87]
s_add_u32 m0, s36, 40960
v_mfma_f32_16x16x32_bf16 v[84:87], a[232:235], a[196:199], v[84:87]
buffer_load_dwordx4 v12, s[12:15], s40 offen offset:0 lds
v_mfma_f32_16x16x32_bf16 v[88:91], a[232:235], a[200:203], v[88:91]
ds_read_b64_tr_b16 a[252:253], v17 offset:4104
v_mfma_f32_16x16x32_bf16 v[88:91], a[236:239], a[216:219], v[88:91]
ds_read_b64_tr_b16 a[254:255], v17 offset:6152
v_mfma_f32_16x16x32_bf16 v[92:95], a[236:239], a[220:223], v[92:95]
s_add_u32 m0, s36, 49024
v_mfma_f32_16x16x32_bf16 v[92:95], a[232:235], a[204:207], v[92:95]
s_waitcnt lgkmcnt(4)
buffer_load_dwordx4 v12, s[12:15], s40 offen offset:128 lds
v_mfma_f32_16x16x32_bf16 v[96:99], a[240:243], a[192:195], v[96:99]
ds_read_b64_tr_b16 a[224:225], v16 offset:8192
v_mfma_f32_16x16x32_bf16 v[96:99], a[244:247], a[208:211], v[96:99]
ds_read_b64_tr_b16 a[226:227], v16 offset:10240
v_mfma_f32_16x16x32_bf16 v[100:103], a[244:247], a[212:215], v[100:103]
s_add_u32 m0, s36, 57088
v_mfma_f32_16x16x32_bf16 v[100:103], a[240:243], a[196:199], v[100:103]
buffer_load_dwordx4 v12, s[12:15], s40 offen offset:256 lds
v_mfma_f32_16x16x32_bf16 v[104:107], a[240:243], a[200:203], v[104:107]
ds_read_b64_tr_b16 a[228:229], v16 offset:12288
v_mfma_f32_16x16x32_bf16 v[104:107], a[244:247], a[216:219], v[104:107]
s_mov_b32 s40, 3342336
ds_read_b64_tr_b16 a[230:231], v16 offset:14336
v_mfma_f32_16x16x32_bf16 v[108:111], a[244:247], a[220:223], v[108:111]
s_add_u32 m0, s36, 41984
v_mfma_f32_16x16x32_bf16 v[108:111], a[240:243], a[204:207], v[108:111]
s_waitcnt lgkmcnt(4)
buffer_load_dwordx4 v12, s[12:15], s40 offen offset:0 lds
v_mfma_f32_16x16x32_bf16 v[112:115], a[248:251], a[192:195], v[112:115]
ds_read_b64_tr_b16 a[232:233], v16 offset:8200
v_mfma_f32_16x16x32_bf16 v[112:115], a[252:255], a[208:211], v[112:115]
ds_read_b64_tr_b16 a[234:235], v16 offset:10248
v_mfma_f32_16x16x32_bf16 v[116:119], a[252:255], a[212:215], v[116:119]
s_add_u32 m0, s36, 50048
v_mfma_f32_16x16x32_bf16 v[116:119], a[248:251], a[196:199], v[116:119]
buffer_load_dwordx4 v12, s[12:15], s40 offen offset:128 lds
v_mfma_f32_16x16x32_bf16 v[120:123], a[248:251], a[200:203], v[120:123]
ds_read_b64_tr_b16 a[236:237], v16 offset:12296
v_mfma_f32_16x16x32_bf16 v[120:123], a[252:255], a[216:219], v[120:123]
ds_read_b64_tr_b16 a[238:239], v16 offset:14344
v_mfma_f32_16x16x32_bf16 v[124:127], a[252:255], a[220:223], v[124:127]
s_add_u32 m0, s36, 58112
v_mfma_f32_16x16x32_bf16 v[124:127], a[248:251], a[204:207], v[124:127]
s_waitcnt lgkmcnt(4)
buffer_load_dwordx4 v12, s[12:15], s40 offen offset:256 lds
v_mfma_f32_16x16x32_bf16 v[128:131], a[224:227], a[192:195], v[128:131]
ds_read_b64_tr_b16 a[240:241], v17 offset:8192
v_mfma_f32_16x16x32_bf16 v[128:131], a[228:231], a[208:211], v[128:131]
s_mov_b32 s40, 786432
ds_read_b64_tr_b16 a[242:243], v17 offset:10240
v_mfma_f32_16x16x32_bf16 v[132:135], a[228:231], a[212:215], v[132:135]
s_add_u32 m0, s37, 65536
v_mfma_f32_16x16x32_bf16 v[132:135], a[224:227], a[196:199], v[132:135]
buffer_load_dwordx4 v13, s[16:19], s40 offen lds
v_mfma_f32_16x16x32_bf16 v[136:139], a[224:227], a[200:203], v[136:139]
ds_read_b64_tr_b16 a[244:245], v17 offset:12288
v_mfma_f32_16x16x32_bf16 v[136:139], a[228:231], a[216:219], v[136:139]
s_mov_b32 s40, 835584
ds_read_b64_tr_b16 a[246:247], v17 offset:14336
v_mfma_f32_16x16x32_bf16 v[140:143], a[228:231], a[220:223], v[140:143]
s_add_u32 m0, s37, 66560
v_mfma_f32_16x16x32_bf16 v[140:143], a[224:227], a[204:207], v[140:143]
s_waitcnt lgkmcnt(4)
buffer_load_dwordx4 v13, s[16:19], s40 offen lds
v_mfma_f32_16x16x32_bf16 v[144:147], a[232:235], a[192:195], v[144:147]
ds_read_b64_tr_b16 a[248:249], v17 offset:8200
v_mfma_f32_16x16x32_bf16 v[144:147], a[236:239], a[208:211], v[144:147]
s_mov_b32 s40, 798720
ds_read_b64_tr_b16 a[250:251], v17 offset:10248
v_mfma_f32_16x16x32_bf16 v[148:151], a[236:239], a[212:215], v[148:151]
s_add_u32 m0, s37, 67584
v_mfma_f32_16x16x32_bf16 v[148:151], a[232:235], a[196:199], v[148:151]
buffer_load_dwordx4 v13, s[16:19], s40 offen lds
v_mfma_f32_16x16x32_bf16 v[152:155], a[232:235], a[200:203], v[152:155]
ds_read_b64_tr_b16 a[252:253], v17 offset:12296
v_mfma_f32_16x16x32_bf16 v[152:155], a[236:239], a[216:219], v[152:155]
s_mov_b32 s40, 847872
ds_read_b64_tr_b16 a[254:255], v17 offset:14344
v_mfma_f32_16x16x32_bf16 v[156:159], a[236:239], a[220:223], v[156:159]
s_add_u32 m0, s37, 68608
v_mfma_f32_16x16x32_bf16 v[156:159], a[232:235], a[204:207], v[156:159]
s_waitcnt lgkmcnt(4)
buffer_load_dwordx4 v13, s[16:19], s40 offen lds
v_mfma_f32_16x16x32_bf16 v[160:163], a[240:243], a[192:195], v[160:163]
ds_read_b64_tr_b16 a[224:225], v16 offset:16384
v_mfma_f32_16x16x32_bf16 v[160:163], a[244:247], a[208:211], v[160:163]
ds_read_b64_tr_b16 a[226:227], v16 offset:18432
v_mfma_f32_16x16x32_bf16 v[164:167], a[244:247], a[212:215], v[164:167]
s_xor_b32 s41, s3, 32768
v_mfma_f32_16x16x32_bf16 v[164:167], a[240:243], a[196:199], v[164:167]
buffer_load_dwordx4 a[160:163], v3, s[20:23], s41 offen sc1
v_mfma_f32_16x16x32_bf16 v[168:171], a[240:243], a[200:203], v[168:171]
ds_read_b64_tr_b16 a[228:229], v16 offset:20480
v_mfma_f32_16x16x32_bf16 v[168:171], a[244:247], a[216:219], v[168:171]
ds_read_b64_tr_b16 a[230:231], v16 offset:22528
v_mfma_f32_16x16x32_bf16 v[172:175], a[244:247], a[220:223], v[172:175]
s_xor_b32 s41, s3, 33792
v_mfma_f32_16x16x32_bf16 v[172:175], a[240:243], a[204:207], v[172:175]
s_waitcnt lgkmcnt(4)
buffer_load_dwordx4 a[164:167], v3, s[20:23], s41 offen sc1
v_mfma_f32_16x16x32_bf16 v[176:179], a[248:251], a[192:195], v[176:179]
ds_read_b64_tr_b16 a[232:233], v16 offset:16392
v_mfma_f32_16x16x32_bf16 v[176:179], a[252:255], a[208:211], v[176:179]
ds_read_b64_tr_b16 a[234:235], v16 offset:18440
v_mfma_f32_16x16x32_bf16 v[180:183], a[252:255], a[212:215], v[180:183]
s_xor_b32 s41, s3, 34816
v_mfma_f32_16x16x32_bf16 v[180:183], a[248:251], a[196:199], v[180:183]
buffer_load_dwordx4 a[168:171], v3, s[20:23], s41 offen sc1
v_mfma_f32_16x16x32_bf16 v[184:187], a[248:251], a[200:203], v[184:187]
ds_read_b64_tr_b16 a[236:237], v16 offset:20488
v_mfma_f32_16x16x32_bf16 v[184:187], a[252:255], a[216:219], v[184:187]
ds_read_b64_tr_b16 a[238:239], v16 offset:22536
v_mfma_f32_16x16x32_bf16 v[188:191], a[252:255], a[220:223], v[188:191]
s_xor_b32 s41, s3, 35840
v_mfma_f32_16x16x32_bf16 v[188:191], a[248:251], a[204:207], v[188:191]
s_waitcnt lgkmcnt(4)
buffer_load_dwordx4 a[172:175], v3, s[20:23], s41 offen sc1
v_mfma_f32_16x16x32_bf16 v[192:195], a[224:227], a[192:195], v[192:195]
ds_read_b64_tr_b16 a[240:241], v17 offset:16384
v_mfma_f32_16x16x32_bf16 v[192:195], a[228:231], a[208:211], v[192:195]
ds_read_b64_tr_b16 a[242:243], v17 offset:18432
v_mfma_f32_16x16x32_bf16 v[196:199], a[228:231], a[212:215], v[196:199]
s_xor_b32 s41, s3, 36864
v_mfma_f32_16x16x32_bf16 v[196:199], a[224:227], a[196:199], v[196:199]
buffer_load_dwordx4 a[176:179], v3, s[20:23], s41 offen sc1
v_mfma_f32_16x16x32_bf16 v[200:203], a[224:227], a[200:203], v[200:203]
ds_read_b64_tr_b16 a[244:245], v17 offset:20480
v_mfma_f32_16x16x32_bf16 v[200:203], a[228:231], a[216:219], v[200:203]
ds_read_b64_tr_b16 a[246:247], v17 offset:22528
v_mfma_f32_16x16x32_bf16 v[204:207], a[228:231], a[220:223], v[204:207]
s_xor_b32 s41, s3, 37888
v_mfma_f32_16x16x32_bf16 v[204:207], a[224:227], a[204:207], v[204:207]
s_waitcnt lgkmcnt(4)
buffer_load_dwordx4 a[180:183], v3, s[20:23], s41 offen sc1
v_mfma_f32_16x16x32_bf16 v[208:211], a[232:235], a[192:195], v[208:211]
ds_read_b64_tr_b16 a[248:249], v17 offset:16392
v_mfma_f32_16x16x32_bf16 v[208:211], a[236:239], a[208:211], v[208:211]
ds_read_b64_tr_b16 a[250:251], v17 offset:18440
v_mfma_f32_16x16x32_bf16 v[212:215], a[236:239], a[212:215], v[212:215]
s_xor_b32 s41, s3, 38912
v_mfma_f32_16x16x32_bf16 v[212:215], a[232:235], a[196:199], v[212:215]
buffer_load_dwordx4 a[184:187], v3, s[20:23], s41 offen sc1
v_mfma_f32_16x16x32_bf16 v[216:219], a[232:235], a[200:203], v[216:219]
ds_read_b64_tr_b16 a[252:253], v17 offset:20488
v_mfma_f32_16x16x32_bf16 v[216:219], a[236:239], a[216:219], v[216:219]
ds_read_b64_tr_b16 a[254:255], v17 offset:22536
v_mfma_f32_16x16x32_bf16 v[220:223], a[236:239], a[220:223], v[220:223]
s_xor_b32 s41, s3, 39936
v_mfma_f32_16x16x32_bf16 v[220:223], a[232:235], a[204:207], v[220:223]
s_waitcnt lgkmcnt(4)
buffer_load_dwordx4 a[188:191], v3, s[20:23], s41 offen sc1
v_mfma_f32_16x16x32_bf16 v[224:227], a[240:243], a[192:195], v[224:227]
ds_read_b64_tr_b16 a[224:225], v50 offset:0
v_mfma_f32_16x16x32_bf16 v[224:227], a[244:247], a[208:211], v[224:227]
ds_read_b64_tr_b16 a[226:227], v50 offset:2048
v_mfma_f32_16x16x32_bf16 v[228:231], a[244:247], a[212:215], v[228:231]
s_add_u32 m0, s71, 4480
v_mfma_f32_16x16x32_bf16 v[228:231], a[240:243], a[196:199], v[228:231]
buffer_load_dwordx4 v54, s[60:63], s70 offen offset:640 lds
v_mfma_f32_16x16x32_bf16 v[232:235], a[240:243], a[200:203], v[232:235]
ds_read_b64_tr_b16 a[228:229], v50 offset:4096
v_mfma_f32_16x16x32_bf16 v[232:235], a[244:247], a[216:219], v[232:235]
ds_read_b64_tr_b16 a[230:231], v50 offset:6144
v_mfma_f32_16x16x32_bf16 v[236:239], a[244:247], a[220:223], v[236:239]
ds_read_b64_tr_b16 a[232:233], v51 offset:0
v_mfma_f32_16x16x32_bf16 v[236:239], a[240:243], a[204:207], v[236:239]
s_waitcnt lgkmcnt(5)
ds_read_b64_tr_b16 a[234:235], v51 offset:2048
v_mfma_f32_16x16x32_bf16 v[240:243], a[248:251], a[192:195], v[240:243]
s_add_u32 m0, s71, 5376
v_mfma_f32_16x16x32_bf16 v[240:243], a[252:255], a[208:211], v[240:243]
buffer_load_dwordx4 v54, s[60:63], s70 offen offset:768 lds
v_mfma_f32_16x16x32_bf16 v[244:247], a[252:255], a[212:215], v[244:247]
ds_read_b64_tr_b16 a[236:237], v51 offset:4096
v_mfma_f32_16x16x32_bf16 v[244:247], a[248:251], a[196:199], v[244:247]
ds_read_b64_tr_b16 a[238:239], v51 offset:6144
v_mfma_f32_16x16x32_bf16 v[248:251], a[248:251], a[200:203], v[248:251]
s_add_u32 m0, s71, 6272
v_mfma_f32_16x16x32_bf16 v[248:251], a[252:255], a[216:219], v[248:251]
buffer_load_dwordx4 v54, s[60:63], s70 offen offset:896 lds
v_mfma_f32_16x16x32_bf16 v[252:255], a[252:255], a[220:223], v[252:255]
ds_read_b64_tr_b16 a[240:241], v50 offset:8192
v_mfma_f32_16x16x32_bf16 v[252:255], a[248:251], a[204:207], v[252:255]
s_waitcnt lgkmcnt(5)
ds_read_b64_tr_b16 a[242:243], v50 offset:10240
v_mfma_f32_16x16x32_bf16 a[0:3], a[224:227], a[192:195], a[0:3]
s_add_u32 m0, s71, 7168
v_mfma_f32_16x16x32_bf16 a[0:3], a[228:231], a[208:211], a[0:3]
buffer_load_dwordx4 v54, s[60:63], s70 offen offset:1024 lds
v_mfma_f32_16x16x32_bf16 a[4:7], a[228:231], a[212:215], a[4:7]
ds_read_b64_tr_b16 a[244:245], v50 offset:12288
v_mfma_f32_16x16x32_bf16 a[4:7], a[224:227], a[196:199], a[4:7]
ds_read_b64_tr_b16 a[246:247], v50 offset:14336
v_mfma_f32_16x16x32_bf16 a[8:11], a[224:227], a[200:203], a[8:11]
s_add_u32 m0, s71, 8064
v_mfma_f32_16x16x32_bf16 a[8:11], a[228:231], a[216:219], a[8:11]
buffer_load_dwordx4 v54, s[60:63], s70 offen offset:1152 lds
v_mfma_f32_16x16x32_bf16 a[12:15], a[228:231], a[220:223], a[12:15]
ds_read_b64_tr_b16 a[248:249], v51 offset:8192
v_mfma_f32_16x16x32_bf16 a[12:15], a[224:227], a[204:207], a[12:15]
s_waitcnt lgkmcnt(5)
ds_read_b64_tr_b16 a[250:251], v51 offset:10240
v_mfma_f32_16x16x32_bf16 a[16:19], a[232:235], a[192:195], a[16:19]
v_mfma_f32_16x16x32_bf16 a[16:19], a[236:239], a[208:211], a[16:19]
v_mfma_f32_16x16x32_bf16 a[20:23], a[236:239], a[212:215], a[20:23]
ds_read_b64_tr_b16 a[252:253], v51 offset:12288
v_mfma_f32_16x16x32_bf16 a[20:23], a[232:235], a[196:199], a[20:23]
ds_read_b64_tr_b16 a[254:255], v51 offset:14336
v_mfma_f32_16x16x32_bf16 a[24:27], a[232:235], a[200:203], a[24:27]
v_mfma_f32_16x16x32_bf16 a[24:27], a[236:239], a[216:219], a[24:27]
v_mfma_f32_16x16x32_bf16 a[28:31], a[236:239], a[220:223], a[28:31]
v_mfma_f32_16x16x32_bf16 a[28:31], a[232:235], a[204:207], a[28:31]
s_waitcnt vmcnt(30) lgkmcnt(0)
v_mfma_f32_16x16x32_bf16 a[32:35], a[240:243], a[192:195], a[32:35]
s_barrier
v_mfma_f32_16x16x32_bf16 a[32:35], a[244:247], a[208:211], a[32:35]
ds_read_b64_tr_b16 a[224:225], v14 offset:0
v_mfma_f32_16x16x32_bf16 a[36:39], a[244:247], a[212:215], a[36:39]
ds_read_b64_tr_b16 a[226:227], v14 offset:2048
v_mfma_f32_16x16x32_bf16 a[36:39], a[240:243], a[196:199], a[36:39]
ds_read_b64_tr_b16 a[228:229], v14 offset:4096
v_mfma_f32_16x16x32_bf16 a[40:43], a[240:243], a[200:203], a[40:43]
ds_read_b64_tr_b16 a[230:231], v14 offset:6144
v_mfma_f32_16x16x32_bf16 a[40:43], a[244:247], a[216:219], a[40:43]
ds_read_b64_tr_b16 a[232:233], v14 offset:8
v_mfma_f32_16x16x32_bf16 a[44:47], a[244:247], a[220:223], a[44:47]
ds_read_b64_tr_b16 a[234:235], v14 offset:2056
v_mfma_f32_16x16x32_bf16 a[44:47], a[240:243], a[204:207], a[44:47]
ds_read_b64_tr_b16 a[236:237], v14 offset:4104
v_mfma_f32_16x16x32_bf16 a[48:51], a[248:251], a[192:195], a[48:51]
ds_read_b64_tr_b16 a[238:239], v14 offset:6152
v_mfma_f32_16x16x32_bf16 a[48:51], a[252:255], a[208:211], a[48:51]
v_mfma_f32_16x16x32_bf16 a[52:55], a[252:255], a[212:215], a[52:55]
v_mfma_f32_16x16x32_bf16 a[52:55], a[248:251], a[196:199], a[52:55]
v_mfma_f32_16x16x32_bf16 a[56:59], a[248:251], a[200:203], a[56:59]
v_mfma_f32_16x16x32_bf16 a[56:59], a[252:255], a[216:219], a[56:59]
v_mfma_f32_16x16x32_bf16 a[60:63], a[252:255], a[220:223], a[60:63]
v_mfma_f32_16x16x32_bf16 a[60:63], a[248:251], a[204:207], a[60:63]
s_waitcnt lgkmcnt(4)
v_mfma_f32_16x16x32_bf16 v[64:67], a[224:227], a[128:131], v[64:67]
ds_read_b64_tr_b16 a[240:241], v15 offset:0
v_mfma_f32_16x16x32_bf16 v[64:67], a[228:231], a[144:147], v[64:67]
ds_read_b64_tr_b16 a[242:243], v15 offset:2048
v_mfma_f32_16x16x32_bf16 v[68:71], a[228:231], a[148:151], v[68:71]
s_mov_b32 s40, 5505024
v_mfma_f32_16x16x32_bf16 v[68:71], a[224:227], a[132:135], v[68:71]
buffer_load_dword v48, v44, s[12:15], s40 offen
v_mfma_f32_16x16x32_bf16 v[72:75], a[224:227], a[136:139], v[72:75]
ds_read_b64_tr_b16 a[244:245], v15 offset:4096
v_mfma_f32_16x16x32_bf16 v[72:75], a[228:231], a[152:155], v[72:75]
ds_read_b64_tr_b16 a[246:247], v15 offset:6144
v_mfma_f32_16x16x32_bf16 v[76:79], a[228:231], a[156:159], v[76:79]
s_mov_b32 s40, 1376256
v_mfma_f32_16x16x32_bf16 v[76:79], a[224:227], a[140:143], v[76:79]
s_waitcnt lgkmcnt(4)
buffer_load_dword v49, v45, s[16:19], s40 offen
v_mfma_f32_16x16x32_bf16 v[80:83], a[232:235], a[128:131], v[80:83]
ds_read_b64_tr_b16 a[248:249], v15 offset:8
v_mfma_f32_16x16x32_bf16 v[80:83], a[236:239], a[144:147], v[80:83]
s_mov_b32 s40, 3932160
ds_read_b64_tr_b16 a[250:251], v15 offset:2056
v_mfma_f32_16x16x32_bf16 v[84:87], a[236:239], a[148:151], v[84:87]
s_add_u32 m0, s36, 81920
v_mfma_f32_16x16x32_bf16 v[84:87], a[232:235], a[132:135], v[84:87]
buffer_load_dwordx4 v12, s[12:15], s40 offen offset:0 lds
v_mfma_f32_16x16x32_bf16 v[88:91], a[232:235], a[136:139], v[88:91]
ds_read_b64_tr_b16 a[252:253], v15 offset:4104
v_mfma_f32_16x16x32_bf16 v[88:91], a[236:239], a[152:155], v[88:91]
ds_read_b64_tr_b16 a[254:255], v15 offset:6152
v_mfma_f32_16x16x32_bf16 v[92:95], a[236:239], a[156:159], v[92:95]
s_add_u32 m0, s36, 89984
v_mfma_f32_16x16x32_bf16 v[92:95], a[232:235], a[140:143], v[92:95]
s_waitcnt lgkmcnt(4)
buffer_load_dwordx4 v12, s[12:15], s40 offen offset:128 lds
v_mfma_f32_16x16x32_bf16 v[96:99], a[240:243], a[128:131], v[96:99]
ds_read_b64_tr_b16 a[224:225], v14 offset:8192
v_mfma_f32_16x16x32_bf16 v[96:99], a[244:247], a[144:147], v[96:99]
ds_read_b64_tr_b16 a[226:227], v14 offset:10240
v_mfma_f32_16x16x32_bf16 v[100:103], a[244:247], a[148:151], v[100:103]
s_add_u32 m0, s36, 98048
v_mfma_f32_16x16x32_bf16 v[100:103], a[240:243], a[132:135], v[100:103]
buffer_load_dwordx4 v12, s[12:15], s40 offen offset:256 lds
v_mfma_f32_16x16x32_bf16 v[104:107], a[240:243], a[136:139], v[104:107]
ds_read_b64_tr_b16 a[228:229], v14 offset:12288
v_mfma_f32_16x16x32_bf16 v[104:107], a[244:247], a[152:155], v[104:107]
s_mov_b32 s40, 4128768
ds_read_b64_tr_b16 a[230:231], v14 offset:14336
v_mfma_f32_16x16x32_bf16 v[108:111], a[244:247], a[156:159], v[108:111]
s_add_u32 m0, s36, 82944
v_mfma_f32_16x16x32_bf16 v[108:111], a[240:243], a[140:143], v[108:111]
s_waitcnt lgkmcnt(4)
buffer_load_dwordx4 v12, s[12:15], s40 offen offset:0 lds
v_mfma_f32_16x16x32_bf16 v[112:115], a[248:251], a[128:131], v[112:115]
ds_read_b64_tr_b16 a[232:233], v14 offset:8200
v_mfma_f32_16x16x32_bf16 v[112:115], a[252:255], a[144:147], v[112:115]
ds_read_b64_tr_b16 a[234:235], v14 offset:10248
v_mfma_f32_16x16x32_bf16 v[116:119], a[252:255], a[148:151], v[116:119]
s_add_u32 m0, s36, 91008
v_mfma_f32_16x16x32_bf16 v[116:119], a[248:251], a[132:135], v[116:119]
buffer_load_dwordx4 v12, s[12:15], s40 offen offset:128 lds
v_mfma_f32_16x16x32_bf16 v[120:123], a[248:251], a[136:139], v[120:123]
ds_read_b64_tr_b16 a[236:237], v14 offset:12296
v_mfma_f32_16x16x32_bf16 v[120:123], a[252:255], a[152:155], v[120:123]
ds_read_b64_tr_b16 a[238:239], v14 offset:14344
v_mfma_f32_16x16x32_bf16 v[124:127], a[252:255], a[156:159], v[124:127]
s_add_u32 m0, s36, 99072
v_mfma_f32_16x16x32_bf16 v[124:127], a[248:251], a[140:143], v[124:127]
s_waitcnt lgkmcnt(4)
buffer_load_dwordx4 v12, s[12:15], s40 offen offset:256 lds
v_mfma_f32_16x16x32_bf16 v[128:131], a[224:227], a[128:131], v[128:131]
ds_read_b64_tr_b16 a[240:241], v15 offset:8192
v_mfma_f32_16x16x32_bf16 v[128:131], a[228:231], a[144:147], v[128:131]
s_mov_b32 s40, 983040
ds_read_b64_tr_b16 a[242:243], v15 offset:10240
v_mfma_f32_16x16x32_bf16 v[132:135], a[228:231], a[148:151], v[132:135]
s_add_u32 m0, s37, 106496
v_mfma_f32_16x16x32_bf16 v[132:135], a[224:227], a[132:135], v[132:135]
buffer_load_dwordx4 v13, s[16:19], s40 offen lds
v_mfma_f32_16x16x32_bf16 v[136:139], a[224:227], a[136:139], v[136:139]
ds_read_b64_tr_b16 a[244:245], v15 offset:12288
v_mfma_f32_16x16x32_bf16 v[136:139], a[228:231], a[152:155], v[136:139]
s_mov_b32 s40, 1032192
ds_read_b64_tr_b16 a[246:247], v15 offset:14336
v_mfma_f32_16x16x32_bf16 v[140:143], a[228:231], a[156:159], v[140:143]
s_add_u32 m0, s37, 107520
v_mfma_f32_16x16x32_bf16 v[140:143], a[224:227], a[140:143], v[140:143]
s_waitcnt lgkmcnt(4)
buffer_load_dwordx4 v13, s[16:19], s40 offen lds
v_mfma_f32_16x16x32_bf16 v[144:147], a[232:235], a[128:131], v[144:147]
ds_read_b64_tr_b16 a[248:249], v15 offset:8200
v_mfma_f32_16x16x32_bf16 v[144:147], a[236:239], a[144:147], v[144:147]
s_mov_b32 s40, 995328
ds_read_b64_tr_b16 a[250:251], v15 offset:10248
v_mfma_f32_16x16x32_bf16 v[148:151], a[236:239], a[148:151], v[148:151]
s_add_u32 m0, s37, 108544
v_mfma_f32_16x16x32_bf16 v[148:151], a[232:235], a[132:135], v[148:151]
buffer_load_dwordx4 v13, s[16:19], s40 offen lds
v_mfma_f32_16x16x32_bf16 v[152:155], a[232:235], a[136:139], v[152:155]
ds_read_b64_tr_b16 a[252:253], v15 offset:12296
v_mfma_f32_16x16x32_bf16 v[152:155], a[236:239], a[152:155], v[152:155]
s_mov_b32 s40, 1044480
ds_read_b64_tr_b16 a[254:255], v15 offset:14344
v_mfma_f32_16x16x32_bf16 v[156:159], a[236:239], a[156:159], v[156:159]
s_add_u32 m0, s37, 109568
v_mfma_f32_16x16x32_bf16 v[156:159], a[232:235], a[140:143], v[156:159]
s_waitcnt lgkmcnt(4)
buffer_load_dwordx4 v13, s[16:19], s40 offen lds
v_mfma_f32_16x16x32_bf16 v[160:163], a[240:243], a[128:131], v[160:163]
ds_read_b64_tr_b16 a[224:225], v14 offset:16384
v_mfma_f32_16x16x32_bf16 v[160:163], a[244:247], a[144:147], v[160:163]
ds_read_b64_tr_b16 a[226:227], v14 offset:18432
v_mfma_f32_16x16x32_bf16 v[164:167], a[244:247], a[148:151], v[164:167]
s_xor_b32 s41, s3, 40960
v_mfma_f32_16x16x32_bf16 v[164:167], a[240:243], a[132:135], v[164:167]
buffer_load_dwordx4 a[192:195], v3, s[20:23], s41 offen sc1
v_mfma_f32_16x16x32_bf16 v[168:171], a[240:243], a[136:139], v[168:171]
ds_read_b64_tr_b16 a[228:229], v14 offset:20480
v_mfma_f32_16x16x32_bf16 v[168:171], a[244:247], a[152:155], v[168:171]
ds_read_b64_tr_b16 a[230:231], v14 offset:22528
v_mfma_f32_16x16x32_bf16 v[172:175], a[244:247], a[156:159], v[172:175]
s_xor_b32 s41, s3, 41984
v_mfma_f32_16x16x32_bf16 v[172:175], a[240:243], a[140:143], v[172:175]
s_waitcnt lgkmcnt(4)
buffer_load_dwordx4 a[196:199], v3, s[20:23], s41 offen sc1
v_mfma_f32_16x16x32_bf16 v[176:179], a[248:251], a[128:131], v[176:179]
ds_read_b64_tr_b16 a[232:233], v14 offset:16392
v_mfma_f32_16x16x32_bf16 v[176:179], a[252:255], a[144:147], v[176:179]
ds_read_b64_tr_b16 a[234:235], v14 offset:18440
v_mfma_f32_16x16x32_bf16 v[180:183], a[252:255], a[148:151], v[180:183]
s_xor_b32 s41, s3, 43008
v_mfma_f32_16x16x32_bf16 v[180:183], a[248:251], a[132:135], v[180:183]
buffer_load_dwordx4 a[200:203], v3, s[20:23], s41 offen sc1
v_mfma_f32_16x16x32_bf16 v[184:187], a[248:251], a[136:139], v[184:187]
ds_read_b64_tr_b16 a[236:237], v14 offset:20488
v_mfma_f32_16x16x32_bf16 v[184:187], a[252:255], a[152:155], v[184:187]
ds_read_b64_tr_b16 a[238:239], v14 offset:22536
v_mfma_f32_16x16x32_bf16 v[188:191], a[252:255], a[156:159], v[188:191]
s_xor_b32 s41, s3, 44032
v_mfma_f32_16x16x32_bf16 v[188:191], a[248:251], a[140:143], v[188:191]
s_waitcnt lgkmcnt(4)
buffer_load_dwordx4 a[204:207], v3, s[20:23], s41 offen sc1
v_mfma_f32_16x16x32_bf16 v[192:195], a[224:227], a[128:131], v[192:195]
ds_read_b64_tr_b16 a[240:241], v15 offset:16384
v_mfma_f32_16x16x32_bf16 v[192:195], a[228:231], a[144:147], v[192:195]
ds_read_b64_tr_b16 a[242:243], v15 offset:18432
v_mfma_f32_16x16x32_bf16 v[196:199], a[228:231], a[148:151], v[196:199]
s_xor_b32 s41, s3, 45056
v_mfma_f32_16x16x32_bf16 v[196:199], a[224:227], a[132:135], v[196:199]
buffer_load_dwordx4 a[208:211], v3, s[20:23], s41 offen sc1
v_mfma_f32_16x16x32_bf16 v[200:203], a[224:227], a[136:139], v[200:203]
ds_read_b64_tr_b16 a[244:245], v15 offset:20480
v_mfma_f32_16x16x32_bf16 v[200:203], a[228:231], a[152:155], v[200:203]
ds_read_b64_tr_b16 a[246:247], v15 offset:22528
v_mfma_f32_16x16x32_bf16 v[204:207], a[228:231], a[156:159], v[204:207]
s_xor_b32 s41, s3, 46080
v_mfma_f32_16x16x32_bf16 v[204:207], a[224:227], a[140:143], v[204:207]
s_waitcnt lgkmcnt(4)
buffer_load_dwordx4 a[212:215], v3, s[20:23], s41 offen sc1
v_mfma_f32_16x16x32_bf16 v[208:211], a[232:235], a[128:131], v[208:211]
ds_read_b64_tr_b16 a[248:249], v15 offset:16392
v_mfma_f32_16x16x32_bf16 v[208:211], a[236:239], a[144:147], v[208:211]
ds_read_b64_tr_b16 a[250:251], v15 offset:18440
v_mfma_f32_16x16x32_bf16 v[212:215], a[236:239], a[148:151], v[212:215]
s_xor_b32 s41, s3, 47104
v_mfma_f32_16x16x32_bf16 v[212:215], a[232:235], a[132:135], v[212:215]
buffer_load_dwordx4 a[216:219], v3, s[20:23], s41 offen sc1
v_mfma_f32_16x16x32_bf16 v[216:219], a[232:235], a[136:139], v[216:219]
ds_read_b64_tr_b16 a[252:253], v15 offset:20488
v_mfma_f32_16x16x32_bf16 v[216:219], a[236:239], a[152:155], v[216:219]
ds_read_b64_tr_b16 a[254:255], v15 offset:22536
v_mfma_f32_16x16x32_bf16 v[220:223], a[236:239], a[156:159], v[220:223]
s_xor_b32 s41, s3, 48128
v_mfma_f32_16x16x32_bf16 v[220:223], a[232:235], a[140:143], v[220:223]
s_waitcnt lgkmcnt(4)
buffer_load_dwordx4 a[220:223], v3, s[20:23], s41 offen sc1
v_mfma_f32_16x16x32_bf16 v[224:227], a[240:243], a[128:131], v[224:227]
ds_read_b64_tr_b16 a[224:225], v18 offset:0
v_mfma_f32_16x16x32_bf16 v[224:227], a[244:247], a[144:147], v[224:227]
ds_read_b64_tr_b16 a[226:227], v18 offset:2048
v_mfma_f32_16x16x32_bf16 v[228:231], a[244:247], a[148:151], v[228:231]
v_mfma_f32_16x16x32_bf16 v[228:231], a[240:243], a[132:135], v[228:231]
v_mfma_f32_16x16x32_bf16 v[232:235], a[240:243], a[136:139], v[232:235]
ds_read_b64_tr_b16 a[228:229], v18 offset:4096
v_mfma_f32_16x16x32_bf16 v[232:235], a[244:247], a[152:155], v[232:235]
ds_read_b64_tr_b16 a[230:231], v18 offset:6144
v_mfma_f32_16x16x32_bf16 v[236:239], a[244:247], a[156:159], v[236:239]
ds_read_b64_tr_b16 a[232:233], v19 offset:0
v_mfma_f32_16x16x32_bf16 v[236:239], a[240:243], a[140:143], v[236:239]
s_waitcnt lgkmcnt(5)
ds_read_b64_tr_b16 a[234:235], v19 offset:2048
v_mfma_f32_16x16x32_bf16 v[240:243], a[248:251], a[128:131], v[240:243]
v_mfma_f32_16x16x32_bf16 v[240:243], a[252:255], a[144:147], v[240:243]
v_mfma_f32_16x16x32_bf16 v[244:247], a[252:255], a[148:151], v[244:247]
ds_read_b64_tr_b16 a[236:237], v19 offset:4096
v_mfma_f32_16x16x32_bf16 v[244:247], a[248:251], a[132:135], v[244:247]
ds_read_b64_tr_b16 a[238:239], v19 offset:6144
v_mfma_f32_16x16x32_bf16 v[248:251], a[248:251], a[136:139], v[248:251]
v_mfma_f32_16x16x32_bf16 v[248:251], a[252:255], a[152:155], v[248:251]
v_mfma_f32_16x16x32_bf16 v[252:255], a[252:255], a[156:159], v[252:255]
ds_read_b64_tr_b16 a[240:241], v18 offset:8192
v_mfma_f32_16x16x32_bf16 v[252:255], a[248:251], a[140:143], v[252:255]
s_waitcnt lgkmcnt(5)
ds_read_b64_tr_b16 a[242:243], v18 offset:10240
v_mfma_f32_16x16x32_bf16 a[0:3], a[224:227], a[128:131], a[0:3]
v_mfma_f32_16x16x32_bf16 a[0:3], a[228:231], a[144:147], a[0:3]
v_mfma_f32_16x16x32_bf16 a[4:7], a[228:231], a[148:151], a[4:7]
ds_read_b64_tr_b16 a[244:245], v18 offset:12288
v_mfma_f32_16x16x32_bf16 a[4:7], a[224:227], a[132:135], a[4:7]
ds_read_b64_tr_b16 a[246:247], v18 offset:14336
v_mfma_f32_16x16x32_bf16 a[8:11], a[224:227], a[136:139], a[8:11]
v_mfma_f32_16x16x32_bf16 a[8:11], a[228:231], a[152:155], a[8:11]
v_mfma_f32_16x16x32_bf16 a[12:15], a[228:231], a[156:159], a[12:15]
ds_read_b64_tr_b16 a[248:249], v19 offset:8192
v_mfma_f32_16x16x32_bf16 a[12:15], a[224:227], a[140:143], a[12:15]
s_waitcnt lgkmcnt(5)
ds_read_b64_tr_b16 a[250:251], v19 offset:10240
v_mfma_f32_16x16x32_bf16 a[16:19], a[232:235], a[128:131], a[16:19]
v_mfma_f32_16x16x32_bf16 a[16:19], a[236:239], a[144:147], a[16:19]
v_mfma_f32_16x16x32_bf16 a[20:23], a[236:239], a[148:151], a[20:23]
ds_read_b64_tr_b16 a[252:253], v19 offset:12288
v_mfma_f32_16x16x32_bf16 a[20:23], a[232:235], a[132:135], a[20:23]
ds_read_b64_tr_b16 a[254:255], v19 offset:14336
v_mfma_f32_16x16x32_bf16 a[24:27], a[232:235], a[136:139], a[24:27]
v_mfma_f32_16x16x32_bf16 a[24:27], a[236:239], a[152:155], a[24:27]
v_mfma_f32_16x16x32_bf16 a[28:31], a[236:239], a[156:159], a[28:31]
v_mfma_f32_16x16x32_bf16 a[28:31], a[232:235], a[140:143], a[28:31]
s_waitcnt vmcnt(25) lgkmcnt(0)
v_mfma_f32_16x16x32_bf16 a[32:35], a[240:243], a[128:131], a[32:35]
s_barrier
v_mfma_f32_16x16x32_bf16 a[32:35], a[244:247], a[144:147], a[32:35]
ds_read_b64_tr_b16 a[224:225], v14 offset:40960
v_mfma_f32_16x16x32_bf16 a[36:39], a[244:247], a[148:151], a[36:39]
ds_read_b64_tr_b16 a[226:227], v14 offset:43008
v_mfma_f32_16x16x32_bf16 a[36:39], a[240:243], a[132:135], a[36:39]
ds_read_b64_tr_b16 a[228:229], v14 offset:45056
v_mfma_f32_16x16x32_bf16 a[40:43], a[240:243], a[136:139], a[40:43]
ds_read_b64_tr_b16 a[230:231], v14 offset:47104
v_mfma_f32_16x16x32_bf16 a[40:43], a[244:247], a[152:155], a[40:43]
ds_read_b64_tr_b16 a[232:233], v14 offset:40968
v_mfma_f32_16x16x32_bf16 a[44:47], a[244:247], a[156:159], a[44:47]
ds_read_b64_tr_b16 a[234:235], v14 offset:43016
v_mfma_f32_16x16x32_bf16 a[44:47], a[240:243], a[140:143], a[44:47]
ds_read_b64_tr_b16 a[236:237], v14 offset:45064
v_mfma_f32_16x16x32_bf16 a[48:51], a[248:251], a[128:131], a[48:51]
ds_read_b64_tr_b16 a[238:239], v14 offset:47112
v_mfma_f32_16x16x32_bf16 a[48:51], a[252:255], a[144:147], a[48:51]
v_mfma_f32_16x16x32_bf16 a[52:55], a[252:255], a[148:151], a[52:55]
v_mfma_f32_16x16x32_bf16 a[52:55], a[248:251], a[132:135], a[52:55]
v_mfma_f32_16x16x32_bf16 a[56:59], a[248:251], a[136:139], a[56:59]
v_mfma_f32_16x16x32_bf16 a[56:59], a[252:255], a[152:155], a[56:59]
v_mfma_f32_16x16x32_bf16 a[60:63], a[252:255], a[156:159], a[60:63]
v_mfma_f32_16x16x32_bf16 a[60:63], a[248:251], a[140:143], a[60:63]
s_waitcnt lgkmcnt(4)
v_mfma_f32_16x16x32_bf16 v[64:67], a[224:227], a[160:163], v[64:67]
ds_read_b64_tr_b16 a[240:241], v15 offset:40960
v_mfma_f32_16x16x32_bf16 v[64:67], a[228:231], a[176:179], v[64:67]
ds_read_b64_tr_b16 a[242:243], v15 offset:43008
v_mfma_f32_16x16x32_bf16 v[68:71], a[228:231], a[180:183], v[68:71]
s_mov_b32 s40, 6291456
v_mfma_f32_16x16x32_bf16 v[68:71], a[224:227], a[164:167], v[68:71]
buffer_load_dword v46, v44, s[12:15], s40 offen
v_mfma_f32_16x16x32_bf16 v[72:75], a[224:227], a[168:171], v[72:75]
ds_read_b64_tr_b16 a[244:245], v15 offset:45056
v_mfma_f32_16x16x32_bf16 v[72:75], a[228:231], a[184:187], v[72:75]
ds_read_b64_tr_b16 a[246:247], v15 offset:47104
v_mfma_f32_16x16x32_bf16 v[76:79], a[228:231], a[188:191], v[76:79]
s_mov_b32 s40, 1572864
v_mfma_f32_16x16x32_bf16 v[76:79], a[224:227], a[172:175], v[76:79]
s_waitcnt lgkmcnt(4)
buffer_load_dword v47, v45, s[16:19], s40 offen
v_mfma_f32_16x16x32_bf16 v[80:83], a[232:235], a[160:163], v[80:83]
ds_read_b64_tr_b16 a[248:249], v15 offset:40968
v_mfma_f32_16x16x32_bf16 v[80:83], a[236:239], a[176:179], v[80:83]
s_mov_b32 s40, 4718592
ds_read_b64_tr_b16 a[250:251], v15 offset:43016
v_mfma_f32_16x16x32_bf16 v[84:87], a[236:239], a[180:183], v[84:87]
s_add_u32 m0, s36, 0
v_mfma_f32_16x16x32_bf16 v[84:87], a[232:235], a[164:167], v[84:87]
buffer_load_dwordx4 v12, s[12:15], s40 offen offset:0 lds
v_mfma_f32_16x16x32_bf16 v[88:91], a[232:235], a[168:171], v[88:91]
ds_read_b64_tr_b16 a[252:253], v15 offset:45064
v_mfma_f32_16x16x32_bf16 v[88:91], a[236:239], a[184:187], v[88:91]
ds_read_b64_tr_b16 a[254:255], v15 offset:47112
v_mfma_f32_16x16x32_bf16 v[92:95], a[236:239], a[188:191], v[92:95]
s_add_u32 m0, s36, 8064
v_mfma_f32_16x16x32_bf16 v[92:95], a[232:235], a[172:175], v[92:95]
s_waitcnt lgkmcnt(4)
buffer_load_dwordx4 v12, s[12:15], s40 offen offset:128 lds
v_mfma_f32_16x16x32_bf16 v[96:99], a[240:243], a[160:163], v[96:99]
ds_read_b64_tr_b16 a[224:225], v14 offset:49152
v_mfma_f32_16x16x32_bf16 v[96:99], a[244:247], a[176:179], v[96:99]
ds_read_b64_tr_b16 a[226:227], v14 offset:51200
v_mfma_f32_16x16x32_bf16 v[100:103], a[244:247], a[180:183], v[100:103]
s_add_u32 m0, s36, 16128
v_mfma_f32_16x16x32_bf16 v[100:103], a[240:243], a[164:167], v[100:103]
buffer_load_dwordx4 v12, s[12:15], s40 offen offset:256 lds
v_mfma_f32_16x16x32_bf16 v[104:107], a[240:243], a[168:171], v[104:107]
ds_read_b64_tr_b16 a[228:229], v14 offset:53248
v_mfma_f32_16x16x32_bf16 v[104:107], a[244:247], a[184:187], v[104:107]
s_mov_b32 s40, 4915200
ds_read_b64_tr_b16 a[230:231], v14 offset:55296
v_mfma_f32_16x16x32_bf16 v[108:111], a[244:247], a[188:191], v[108:111]
s_add_u32 m0, s36, 1024
v_mfma_f32_16x16x32_bf16 v[108:111], a[240:243], a[172:175], v[108:111]
s_waitcnt lgkmcnt(4)
buffer_load_dwordx4 v12, s[12:15], s40 offen offset:0 lds
v_mfma_f32_16x16x32_bf16 v[112:115], a[248:251], a[160:163], v[112:115]
ds_read_b64_tr_b16 a[232:233], v14 offset:49160
v_mfma_f32_16x16x32_bf16 v[112:115], a[252:255], a[176:179], v[112:115]
ds_read_b64_tr_b16 a[234:235], v14 offset:51208
v_mfma_f32_16x16x32_bf16 v[116:119], a[252:255], a[180:183], v[116:119]
s_add_u32 m0, s36, 9088
v_mfma_f32_16x16x32_bf16 v[116:119], a[248:251], a[164:167], v[116:119]
buffer_load_dwordx4 v12, s[12:15], s40 offen offset:128 lds
v_mfma_f32_16x16x32_bf16 v[120:123], a[248:251], a[168:171], v[120:123]
ds_read_b64_tr_b16 a[236:237], v14 offset:53256
v_mfma_f32_16x16x32_bf16 v[120:123], a[252:255], a[184:187], v[120:123]
ds_read_b64_tr_b16 a[238:239], v14 offset:55304
v_mfma_f32_16x16x32_bf16 v[124:127], a[252:255], a[188:191], v[124:127]
s_add_u32 m0, s36, 17152
v_mfma_f32_16x16x32_bf16 v[124:127], a[248:251], a[172:175], v[124:127]
s_waitcnt lgkmcnt(4)
buffer_load_dwordx4 v12, s[12:15], s40 offen offset:256 lds
v_mfma_f32_16x16x32_bf16 v[128:131], a[224:227], a[160:163], v[128:131]
ds_read_b64_tr_b16 a[240:241], v15 offset:49152
v_mfma_f32_16x16x32_bf16 v[128:131], a[228:231], a[176:179], v[128:131]
s_mov_b32 s40, 1179648
ds_read_b64_tr_b16 a[242:243], v15 offset:51200
v_mfma_f32_16x16x32_bf16 v[132:135], a[228:231], a[180:183], v[132:135]
s_add_u32 m0, s37, 24576
v_mfma_f32_16x16x32_bf16 v[132:135], a[224:227], a[164:167], v[132:135]
buffer_load_dwordx4 v13, s[16:19], s40 offen lds
v_mfma_f32_16x16x32_bf16 v[136:139], a[224:227], a[168:171], v[136:139]
ds_read_b64_tr_b16 a[244:245], v15 offset:53248
v_mfma_f32_16x16x32_bf16 v[136:139], a[228:231], a[184:187], v[136:139]
s_mov_b32 s40, 1228800
ds_read_b64_tr_b16 a[246:247], v15 offset:55296
v_mfma_f32_16x16x32_bf16 v[140:143], a[228:231], a[188:191], v[140:143]
s_add_u32 m0, s37, 25600
v_mfma_f32_16x16x32_bf16 v[140:143], a[224:227], a[172:175], v[140:143]
s_waitcnt lgkmcnt(4)
buffer_load_dwordx4 v13, s[16:19], s40 offen lds
v_mfma_f32_16x16x32_bf16 v[144:147], a[232:235], a[160:163], v[144:147]
ds_read_b64_tr_b16 a[248:249], v15 offset:49160
v_mfma_f32_16x16x32_bf16 v[144:147], a[236:239], a[176:179], v[144:147]
s_mov_b32 s40, 1191936
ds_read_b64_tr_b16 a[250:251], v15 offset:51208
v_mfma_f32_16x16x32_bf16 v[148:151], a[236:239], a[180:183], v[148:151]
s_add_u32 m0, s37, 26624
v_mfma_f32_16x16x32_bf16 v[148:151], a[232:235], a[164:167], v[148:151]
buffer_load_dwordx4 v13, s[16:19], s40 offen lds
v_mfma_f32_16x16x32_bf16 v[152:155], a[232:235], a[168:171], v[152:155]
ds_read_b64_tr_b16 a[252:253], v15 offset:53256
v_mfma_f32_16x16x32_bf16 v[152:155], a[236:239], a[184:187], v[152:155]
s_mov_b32 s40, 1241088
ds_read_b64_tr_b16 a[254:255], v15 offset:55304
v_mfma_f32_16x16x32_bf16 v[156:159], a[236:239], a[188:191], v[156:159]
s_add_u32 m0, s37, 27648
v_mfma_f32_16x16x32_bf16 v[156:159], a[232:235], a[172:175], v[156:159]
s_waitcnt lgkmcnt(4)
buffer_load_dwordx4 v13, s[16:19], s40 offen lds
v_mfma_f32_16x16x32_bf16 v[160:163], a[240:243], a[160:163], v[160:163]
ds_read_b64_tr_b16 a[224:225], v14 offset:57344
v_mfma_f32_16x16x32_bf16 v[160:163], a[244:247], a[176:179], v[160:163]
ds_read_b64_tr_b16 a[226:227], v14 offset:59392
v_mfma_f32_16x16x32_bf16 v[164:167], a[244:247], a[180:183], v[164:167]
s_xor_b32 s41, s3, 49152
v_mfma_f32_16x16x32_bf16 v[164:167], a[240:243], a[164:167], v[164:167]
buffer_load_dwordx4 a[128:131], v3, s[20:23], s41 offen sc1
v_mfma_f32_16x16x32_bf16 v[168:171], a[240:243], a[168:171], v[168:171]
ds_read_b64_tr_b16 a[228:229], v14 offset:61440
v_mfma_f32_16x16x32_bf16 v[168:171], a[244:247], a[184:187], v[168:171]
ds_read_b64_tr_b16 a[230:231], v14 offset:63488
v_mfma_f32_16x16x32_bf16 v[172:175], a[244:247], a[188:191], v[172:175]
s_xor_b32 s41, s3, 50176
v_mfma_f32_16x16x32_bf16 v[172:175], a[240:243], a[172:175], v[172:175]
s_waitcnt lgkmcnt(4)
buffer_load_dwordx4 a[132:135], v3, s[20:23], s41 offen sc1
v_mfma_f32_16x16x32_bf16 v[176:179], a[248:251], a[160:163], v[176:179]
ds_read_b64_tr_b16 a[232:233], v14 offset:57352
v_mfma_f32_16x16x32_bf16 v[176:179], a[252:255], a[176:179], v[176:179]
ds_read_b64_tr_b16 a[234:235], v14 offset:59400
v_mfma_f32_16x16x32_bf16 v[180:183], a[252:255], a[180:183], v[180:183]
s_xor_b32 s41, s3, 51200
v_mfma_f32_16x16x32_bf16 v[180:183], a[248:251], a[164:167], v[180:183]
buffer_load_dwordx4 a[136:139], v3, s[20:23], s41 offen sc1
v_mfma_f32_16x16x32_bf16 v[184:187], a[248:251], a[168:171], v[184:187]
ds_read_b64_tr_b16 a[236:237], v14 offset:61448
v_mfma_f32_16x16x32_bf16 v[184:187], a[252:255], a[184:187], v[184:187]
ds_read_b64_tr_b16 a[238:239], v14 offset:63496
v_mfma_f32_16x16x32_bf16 v[188:191], a[252:255], a[188:191], v[188:191]
s_xor_b32 s41, s3, 52224
v_mfma_f32_16x16x32_bf16 v[188:191], a[248:251], a[172:175], v[188:191]
s_waitcnt lgkmcnt(4)
buffer_load_dwordx4 a[140:143], v3, s[20:23], s41 offen sc1
v_mfma_f32_16x16x32_bf16 v[192:195], a[224:227], a[160:163], v[192:195]
ds_read_b64_tr_b16 a[240:241], v15 offset:57344
v_mfma_f32_16x16x32_bf16 v[192:195], a[228:231], a[176:179], v[192:195]
ds_read_b64_tr_b16 a[242:243], v15 offset:59392
v_mfma_f32_16x16x32_bf16 v[196:199], a[228:231], a[180:183], v[196:199]
s_xor_b32 s41, s3, 53248
v_mfma_f32_16x16x32_bf16 v[196:199], a[224:227], a[164:167], v[196:199]
buffer_load_dwordx4 a[144:147], v3, s[20:23], s41 offen sc1
v_mfma_f32_16x16x32_bf16 v[200:203], a[224:227], a[168:171], v[200:203]
ds_read_b64_tr_b16 a[244:245], v15 offset:61440
v_mfma_f32_16x16x32_bf16 v[200:203], a[228:231], a[184:187], v[200:203]
ds_read_b64_tr_b16 a[246:247], v15 offset:63488
v_mfma_f32_16x16x32_bf16 v[204:207], a[228:231], a[188:191], v[204:207]
s_xor_b32 s41, s3, 54272
v_mfma_f32_16x16x32_bf16 v[204:207], a[224:227], a[172:175], v[204:207]
s_waitcnt lgkmcnt(4)
buffer_load_dwordx4 a[148:151], v3, s[20:23], s41 offen sc1
v_mfma_f32_16x16x32_bf16 v[208:211], a[232:235], a[160:163], v[208:211]
ds_read_b64_tr_b16 a[248:249], v15 offset:57352
v_mfma_f32_16x16x32_bf16 v[208:211], a[236:239], a[176:179], v[208:211]
ds_read_b64_tr_b16 a[250:251], v15 offset:59400
v_mfma_f32_16x16x32_bf16 v[212:215], a[236:239], a[180:183], v[212:215]
s_xor_b32 s41, s3, 55296
v_mfma_f32_16x16x32_bf16 v[212:215], a[232:235], a[164:167], v[212:215]
buffer_load_dwordx4 a[152:155], v3, s[20:23], s41 offen sc1
v_mfma_f32_16x16x32_bf16 v[216:219], a[232:235], a[168:171], v[216:219]
ds_read_b64_tr_b16 a[252:253], v15 offset:61448
v_mfma_f32_16x16x32_bf16 v[216:219], a[236:239], a[184:187], v[216:219]
ds_read_b64_tr_b16 a[254:255], v15 offset:63496
v_mfma_f32_16x16x32_bf16 v[220:223], a[236:239], a[188:191], v[220:223]
s_xor_b32 s41, s3, 56320
v_mfma_f32_16x16x32_bf16 v[220:223], a[232:235], a[172:175], v[220:223]
s_waitcnt lgkmcnt(4)
buffer_load_dwordx4 a[156:159], v3, s[20:23], s41 offen sc1
v_mfma_f32_16x16x32_bf16 v[224:227], a[240:243], a[160:163], v[224:227]
ds_read_b64_tr_b16 a[224:225], v18 offset:40960
v_mfma_f32_16x16x32_bf16 v[224:227], a[244:247], a[176:179], v[224:227]
ds_read_b64_tr_b16 a[226:227], v18 offset:43008
v_mfma_f32_16x16x32_bf16 v[228:231], a[244:247], a[180:183], v[228:231]
v_mfma_f32_16x16x32_bf16 v[228:231], a[240:243], a[164:167], v[228:231]
v_mfma_f32_16x16x32_bf16 v[232:235], a[240:243], a[168:171], v[232:235]
ds_read_b64_tr_b16 a[228:229], v18 offset:45056
v_mfma_f32_16x16x32_bf16 v[232:235], a[244:247], a[184:187], v[232:235]
ds_read_b64_tr_b16 a[230:231], v18 offset:47104
v_mfma_f32_16x16x32_bf16 v[236:239], a[244:247], a[188:191], v[236:239]
ds_read_b64_tr_b16 a[232:233], v19 offset:40960
v_mfma_f32_16x16x32_bf16 v[236:239], a[240:243], a[172:175], v[236:239]
s_waitcnt lgkmcnt(5)
ds_read_b64_tr_b16 a[234:235], v19 offset:43008
v_mfma_f32_16x16x32_bf16 v[240:243], a[248:251], a[160:163], v[240:243]
v_mfma_f32_16x16x32_bf16 v[240:243], a[252:255], a[176:179], v[240:243]
v_mfma_f32_16x16x32_bf16 v[244:247], a[252:255], a[180:183], v[244:247]
ds_read_b64_tr_b16 a[236:237], v19 offset:45056
v_mfma_f32_16x16x32_bf16 v[244:247], a[248:251], a[164:167], v[244:247]
ds_read_b64_tr_b16 a[238:239], v19 offset:47104
v_mfma_f32_16x16x32_bf16 v[248:251], a[248:251], a[168:171], v[248:251]
v_mfma_f32_16x16x32_bf16 v[248:251], a[252:255], a[184:187], v[248:251]
v_mfma_f32_16x16x32_bf16 v[252:255], a[252:255], a[188:191], v[252:255]
ds_read_b64_tr_b16 a[240:241], v18 offset:49152
v_mfma_f32_16x16x32_bf16 v[252:255], a[248:251], a[172:175], v[252:255]
s_waitcnt lgkmcnt(5)
ds_read_b64_tr_b16 a[242:243], v18 offset:51200
v_mfma_f32_16x16x32_bf16 a[0:3], a[224:227], a[160:163], a[0:3]
v_mfma_f32_16x16x32_bf16 a[0:3], a[228:231], a[176:179], a[0:3]
v_mfma_f32_16x16x32_bf16 a[4:7], a[228:231], a[180:183], a[4:7]
ds_read_b64_tr_b16 a[244:245], v18 offset:53248
v_mfma_f32_16x16x32_bf16 a[4:7], a[224:227], a[164:167], a[4:7]
ds_read_b64_tr_b16 a[246:247], v18 offset:55296
v_mfma_f32_16x16x32_bf16 a[8:11], a[224:227], a[168:171], a[8:11]
v_mfma_f32_16x16x32_bf16 a[8:11], a[228:231], a[184:187], a[8:11]
v_mfma_f32_16x16x32_bf16 a[12:15], a[228:231], a[188:191], a[12:15]
ds_read_b64_tr_b16 a[248:249], v19 offset:49152
v_mfma_f32_16x16x32_bf16 a[12:15], a[224:227], a[172:175], a[12:15]
s_waitcnt lgkmcnt(5)
ds_read_b64_tr_b16 a[250:251], v19 offset:51200
v_mfma_f32_16x16x32_bf16 a[16:19], a[232:235], a[160:163], a[16:19]
v_mfma_f32_16x16x32_bf16 a[16:19], a[236:239], a[176:179], a[16:19]
v_mfma_f32_16x16x32_bf16 a[20:23], a[236:239], a[180:183], a[20:23]
ds_read_b64_tr_b16 a[252:253], v19 offset:53248
v_mfma_f32_16x16x32_bf16 a[20:23], a[232:235], a[164:167], a[20:23]
ds_read_b64_tr_b16 a[254:255], v19 offset:55296
v_mfma_f32_16x16x32_bf16 a[24:27], a[232:235], a[168:171], a[24:27]
v_mfma_f32_16x16x32_bf16 a[24:27], a[236:239], a[184:187], a[24:27]
v_mfma_f32_16x16x32_bf16 a[28:31], a[236:239], a[188:191], a[28:31]
v_mfma_f32_16x16x32_bf16 a[28:31], a[232:235], a[172:175], a[28:31]
s_waitcnt vmcnt(20) lgkmcnt(0)
v_mfma_f32_16x16x32_bf16 a[32:35], a[240:243], a[160:163], a[32:35]
s_barrier
v_mfma_f32_16x16x32_bf16 a[32:35], a[244:247], a[176:179], a[32:35]
s_add_u32 s60, s94, 4194304
ds_read_b64_tr_b16 a[224:225], v16 offset:0
v_mfma_f32_16x16x32_bf16 a[36:39], a[244:247], a[180:183], a[36:39]
s_addc_u32 s61, s95, 0
ds_read_b64_tr_b16 a[226:227], v16 offset:2048
v_mfma_f32_16x16x32_bf16 a[36:39], a[240:243], a[164:167], a[36:39]
s_mov_b32 s62, 9830400
ds_read_b64_tr_b16 a[228:229], v16 offset:4096
v_mfma_f32_16x16x32_bf16 a[40:43], a[240:243], a[168:171], a[40:43]
s_mov_b32 s63, 0x20000
ds_read_b64_tr_b16 a[230:231], v16 offset:6144
v_mfma_f32_16x16x32_bf16 a[40:43], a[244:247], a[184:187], a[40:43]
ds_read_b64_tr_b16 a[232:233], v16 offset:8
v_mfma_f32_16x16x32_bf16 a[44:47], a[244:247], a[188:191], a[44:47]
ds_read_b64_tr_b16 a[234:235], v16 offset:2056
v_mfma_f32_16x16x32_bf16 a[44:47], a[240:243], a[172:175], a[44:47]
ds_read_b64_tr_b16 a[236:237], v16 offset:4104
v_mfma_f32_16x16x32_bf16 a[48:51], a[248:251], a[160:163], a[48:51]
ds_read_b64_tr_b16 a[238:239], v16 offset:6152
v_mfma_f32_16x16x32_bf16 a[48:51], a[252:255], a[176:179], a[48:51]
v_mfma_f32_16x16x32_bf16 a[52:55], a[252:255], a[180:183], a[52:55]
v_mfma_f32_16x16x32_bf16 a[52:55], a[248:251], a[164:167], a[52:55]
v_mfma_f32_16x16x32_bf16 a[56:59], a[248:251], a[168:171], a[56:59]
v_mfma_f32_16x16x32_bf16 a[56:59], a[252:255], a[184:187], a[56:59]
v_mfma_f32_16x16x32_bf16 a[60:63], a[252:255], a[188:191], a[60:63]
v_mfma_f32_16x16x32_bf16 a[60:63], a[248:251], a[172:175], a[60:63]
s_waitcnt lgkmcnt(4)
v_mfma_f32_16x16x32_bf16 v[64:67], a[224:227], a[192:195], v[64:67]
ds_read_b64_tr_b16 a[240:241], v17 offset:0
v_mfma_f32_16x16x32_bf16 v[64:67], a[228:231], a[208:211], v[64:67]
ds_read_b64_tr_b16 a[242:243], v17 offset:2048
v_mfma_f32_16x16x32_bf16 v[68:71], a[228:231], a[212:215], v[68:71]
s_mov_b32 s40, 7077888
ds_read_b64_tr_b16 v[28:29], v55 offset:0
v_mfma_f32_16x16x32_bf16 v[68:71], a[224:227], a[196:199], v[68:71]
buffer_load_dword v48, v44, s[12:15], s40 offen
v_mfma_f32_16x16x32_bf16 v[72:75], a[224:227], a[200:203], v[72:75]
ds_read_b64_tr_b16 a[244:245], v17 offset:4096
v_mfma_f32_16x16x32_bf16 v[72:75], a[228:231], a[216:219], v[72:75]
ds_read_b64_tr_b16 a[246:247], v17 offset:6144
v_mfma_f32_16x16x32_bf16 v[76:79], a[228:231], a[220:223], v[76:79]
s_mov_b32 s40, 1769472
ds_read_b64_tr_b16 v[30:31], v55 offset:20480
v_mfma_f32_16x16x32_bf16 v[76:79], a[224:227], a[204:207], v[76:79]
s_waitcnt lgkmcnt(6)
buffer_load_dword v49, v45, s[16:19], s40 offen
v_mfma_f32_16x16x32_bf16 v[80:83], a[232:235], a[192:195], v[80:83]
ds_read_b64_tr_b16 a[248:249], v17 offset:8
v_mfma_f32_16x16x32_bf16 v[80:83], a[236:239], a[208:211], v[80:83]
s_mov_b32 s40, 5505024
ds_read_b64_tr_b16 a[250:251], v17 offset:2056
v_mfma_f32_16x16x32_bf16 v[84:87], a[236:239], a[212:215], v[84:87]
s_add_u32 m0, s36, 40960
ds_read_b64_tr_b16 v[32:33], v56 offset:0
v_mfma_f32_16x16x32_bf16 v[84:87], a[232:235], a[196:199], v[84:87]
buffer_load_dwordx4 v12, s[12:15], s40 offen offset:0 lds
v_mfma_f32_16x16x32_bf16 v[88:91], a[232:235], a[200:203], v[88:91]
ds_read_b64_tr_b16 a[252:253], v17 offset:4104
v_mfma_f32_16x16x32_bf16 v[88:91], a[236:239], a[216:219], v[88:91]
ds_read_b64_tr_b16 a[254:255], v17 offset:6152
v_mfma_f32_16x16x32_bf16 v[92:95], a[236:239], a[220:223], v[92:95]
s_add_u32 m0, s36, 49024
ds_read_b64_tr_b16 v[34:35], v56 offset:20480
v_mfma_f32_16x16x32_bf16 v[92:95], a[232:235], a[204:207], v[92:95]
s_waitcnt lgkmcnt(7)
buffer_load_dwordx4 v12, s[12:15], s40 offen offset:128 lds
v_mfma_f32_16x16x32_bf16 v[96:99], a[240:243], a[192:195], v[96:99]
ds_read_b64_tr_b16 a[224:225], v16 offset:8192
v_mfma_f32_16x16x32_bf16 v[96:99], a[244:247], a[208:211], v[96:99]
ds_read_b64_tr_b16 a[226:227], v16 offset:10240
v_mfma_f32_16x16x32_bf16 v[100:103], a[244:247], a[212:215], v[100:103]
s_add_u32 m0, s36, 57088
ds_read_b64_tr_b16 v[36:37], v57 offset:0
v_mfma_f32_16x16x32_bf16 v[100:103], a[240:243], a[196:199], v[100:103]
buffer_load_dwordx4 v12, s[12:15], s40 offen offset:256 lds
v_mfma_f32_16x16x32_bf16 v[104:107], a[240:243], a[200:203], v[104:107]
ds_read_b64_tr_b16 a[228:229], v16 offset:12288
v_mfma_f32_16x16x32_bf16 v[104:107], a[244:247], a[216:219], v[104:107]
s_mov_b32 s40, 5701632
ds_read_b64_tr_b16 a[230:231], v16 offset:14336
v_mfma_f32_16x16x32_bf16 v[108:111], a[244:247], a[220:223], v[108:111]
s_add_u32 m0, s36, 41984
ds_read_b64_tr_b16 v[38:39], v57 offset:20480
v_mfma_f32_16x16x32_bf16 v[108:111], a[240:243], a[204:207], v[108:111]
s_waitcnt lgkmcnt(7)
buffer_load_dwordx4 v12, s[12:15], s40 offen offset:0 lds
v_mfma_f32_16x16x32_bf16 v[112:115], a[248:251], a[192:195], v[112:115]
ds_read_b64_tr_b16 a[232:233], v16 offset:8200
v_mfma_f32_16x16x32_bf16 v[112:115], a[252:255], a[208:211], v[112:115]
ds_read_b64_tr_b16 a[234:235], v16 offset:10248
v_mfma_f32_16x16x32_bf16 v[116:119], a[252:255], a[212:215], v[116:119]
s_add_u32 m0, s36, 50048
ds_read_b64_tr_b16 v[40:41], v58 offset:0
v_mfma_f32_16x16x32_bf16 v[116:119], a[248:251], a[196:199], v[116:119]
buffer_load_dwordx4 v12, s[12:15], s40 offen offset:128 lds
v_mfma_f32_16x16x32_bf16 v[120:123], a[248:251], a[200:203], v[120:123]
ds_read_b64_tr_b16 a[236:237], v16 offset:12296
v_mfma_f32_16x16x32_bf16 v[120:123], a[252:255], a[216:219], v[120:123]
ds_read_b64_tr_b16 a[238:239], v16 offset:14344
v_mfma_f32_16x16x32_bf16 v[124:127], a[252:255], a[220:223], v[124:127]
s_add_u32 m0, s36, 58112
ds_read_b64_tr_b16 v[42:43], v58 offset:20480
v_mfma_f32_16x16x32_bf16 v[124:127], a[248:251], a[204:207], v[124:127]
s_waitcnt lgkmcnt(7)
buffer_load_dwordx4 v12, s[12:15], s40 offen offset:256 lds
v_mfma_f32_16x16x32_bf16 v[128:131], a[224:227], a[192:195], v[128:131]
ds_read_b64_tr_b16 a[240:241], v17 offset:8192
v_mfma_f32_16x16x32_bf16 v[128:131], a[228:231], a[208:211], v[128:131]
s_mov_b32 s40, 1376256
ds_read_b64_tr_b16 a[242:243], v17 offset:10240
v_mfma_f32_16x16x32_bf16 v[132:135], a[228:231], a[212:215], v[132:135]
s_add_u32 m0, s37, 65536
v_mfma_f32_16x16x32_bf16 v[132:135], a[224:227], a[196:199], v[132:135]
buffer_load_dwordx4 v13, s[16:19], s40 offen lds
v_mfma_f32_16x16x32_bf16 v[136:139], a[224:227], a[200:203], v[136:139]
ds_read_b64_tr_b16 a[244:245], v17 offset:12288
v_mfma_f32_16x16x32_bf16 v[136:139], a[228:231], a[216:219], v[136:139]
s_mov_b32 s40, 1425408
ds_read_b64_tr_b16 a[246:247], v17 offset:14336
v_mfma_f32_16x16x32_bf16 v[140:143], a[228:231], a[220:223], v[140:143]
s_add_u32 m0, s37, 66560
v_mfma_f32_16x16x32_bf16 v[140:143], a[224:227], a[204:207], v[140:143]
s_waitcnt lgkmcnt(5)
buffer_load_dwordx4 v13, s[16:19], s40 offen lds
v_mfma_f32_16x16x32_bf16 v[144:147], a[232:235], a[192:195], v[144:147]
ds_read_b64_tr_b16 a[248:249], v17 offset:8200
v_mfma_f32_16x16x32_bf16 v[144:147], a[236:239], a[208:211], v[144:147]
s_mov_b32 s40, 1388544
ds_read_b64_tr_b16 a[250:251], v17 offset:10248
v_mfma_f32_16x16x32_bf16 v[148:151], a[236:239], a[212:215], v[148:151]
s_add_u32 m0, s37, 67584
v_mfma_f32_16x16x32_bf16 v[148:151], a[232:235], a[196:199], v[148:151]
buffer_load_dwordx4 v13, s[16:19], s40 offen lds
v_mfma_f32_16x16x32_bf16 v[152:155], a[232:235], a[200:203], v[152:155]
ds_read_b64_tr_b16 a[252:253], v17 offset:12296
v_mfma_f32_16x16x32_bf16 v[152:155], a[236:239], a[216:219], v[152:155]
s_mov_b32 s40, 1437696
ds_read_b64_tr_b16 a[254:255], v17 offset:14344
v_mfma_f32_16x16x32_bf16 v[156:159], a[236:239], a[220:223], v[156:159]
s_add_u32 m0, s37, 68608
v_mfma_f32_16x16x32_bf16 v[156:159], a[232:235], a[204:207], v[156:159]
s_waitcnt lgkmcnt(4)
buffer_load_dwordx4 v13, s[16:19], s40 offen lds
v_mfma_f32_16x16x32_bf16 v[160:163], a[240:243], a[192:195], v[160:163]
ds_read_b64_tr_b16 a[224:225], v16 offset:16384
v_mfma_f32_16x16x32_bf16 v[160:163], a[244:247], a[208:211], v[160:163]
ds_read_b64_tr_b16 a[226:227], v16 offset:18432
v_mfma_f32_16x16x32_bf16 v[164:167], a[244:247], a[212:215], v[164:167]
s_xor_b32 s41, s3, 57344
v_mfma_f32_16x16x32_bf16 v[164:167], a[240:243], a[196:199], v[164:167]
buffer_load_dwordx4 a[160:163], v3, s[20:23], s41 offen sc1
v_mfma_f32_16x16x32_bf16 v[168:171], a[240:243], a[200:203], v[168:171]
ds_read_b64_tr_b16 a[228:229], v16 offset:20480
v_mfma_f32_16x16x32_bf16 v[168:171], a[244:247], a[216:219], v[168:171]
ds_read_b64_tr_b16 a[230:231], v16 offset:22528
v_mfma_f32_16x16x32_bf16 v[172:175], a[244:247], a[220:223], v[172:175]
s_xor_b32 s41, s3, 58368
v_mfma_f32_16x16x32_bf16 v[172:175], a[240:243], a[204:207], v[172:175]
s_waitcnt lgkmcnt(4)
buffer_load_dwordx4 a[164:167], v3, s[20:23], s41 offen sc1
v_mfma_f32_16x16x32_bf16 v[176:179], a[248:251], a[192:195], v[176:179]
ds_read_b64_tr_b16 a[232:233], v16 offset:16392
v_mfma_f32_16x16x32_bf16 v[176:179], a[252:255], a[208:211], v[176:179]
ds_read_b64_tr_b16 a[234:235], v16 offset:18440
v_mfma_f32_16x16x32_bf16 v[180:183], a[252:255], a[212:215], v[180:183]
s_xor_b32 s41, s3, 59392
v_mfma_f32_16x16x32_bf16 v[180:183], a[248:251], a[196:199], v[180:183]
buffer_load_dwordx4 a[168:171], v3, s[20:23], s41 offen sc1
v_mfma_f32_16x16x32_bf16 v[184:187], a[248:251], a[200:203], v[184:187]
ds_read_b64_tr_b16 a[236:237], v16 offset:20488
v_mfma_f32_16x16x32_bf16 v[184:187], a[252:255], a[216:219], v[184:187]
ds_read_b64_tr_b16 a[238:239], v16 offset:22536
v_mfma_f32_16x16x32_bf16 v[188:191], a[252:255], a[220:223], v[188:191]
s_xor_b32 s41, s3, 60416
v_mfma_f32_16x16x32_bf16 v[188:191], a[248:251], a[204:207], v[188:191]
s_waitcnt lgkmcnt(4)
buffer_load_dwordx4 a[172:175], v3, s[20:23], s41 offen sc1
v_mfma_f32_16x16x32_bf16 v[192:195], a[224:227], a[192:195], v[192:195]
ds_read_b64_tr_b16 a[240:241], v17 offset:16384
v_mfma_f32_16x16x32_bf16 v[192:195], a[228:231], a[208:211], v[192:195]
ds_read_b64_tr_b16 a[242:243], v17 offset:18432
v_mfma_f32_16x16x32_bf16 v[196:199], a[228:231], a[212:215], v[196:199]
s_xor_b32 s41, s3, 61440
v_mfma_f32_16x16x32_bf16 v[196:199], a[224:227], a[196:199], v[196:199]
buffer_load_dwordx4 a[176:179], v3, s[20:23], s41 offen sc1
v_mfma_f32_16x16x32_bf16 v[200:203], a[224:227], a[200:203], v[200:203]
ds_read_b64_tr_b16 a[244:245], v17 offset:20480
v_mfma_f32_16x16x32_bf16 v[200:203], a[228:231], a[216:219], v[200:203]
ds_read_b64_tr_b16 a[246:247], v17 offset:22528
v_mfma_f32_16x16x32_bf16 v[204:207], a[228:231], a[220:223], v[204:207]
s_xor_b32 s41, s3, 62464
v_mfma_f32_16x16x32_bf16 v[204:207], a[224:227], a[204:207], v[204:207]
s_waitcnt lgkmcnt(4)
buffer_load_dwordx4 a[180:183], v3, s[20:23], s41 offen sc1
v_mfma_f32_16x16x32_bf16 v[208:211], a[232:235], a[192:195], v[208:211]
ds_read_b64_tr_b16 a[248:249], v17 offset:16392
v_mfma_f32_16x16x32_bf16 v[208:211], a[236:239], a[208:211], v[208:211]
ds_read_b64_tr_b16 a[250:251], v17 offset:18440
v_mfma_f32_16x16x32_bf16 v[212:215], a[236:239], a[212:215], v[212:215]
s_xor_b32 s41, s3, 63488
v_mfma_f32_16x16x32_bf16 v[212:215], a[232:235], a[196:199], v[212:215]
buffer_load_dwordx4 a[184:187], v3, s[20:23], s41 offen sc1
v_mfma_f32_16x16x32_bf16 v[216:219], a[232:235], a[200:203], v[216:219]
ds_read_b64_tr_b16 a[252:253], v17 offset:20488
v_mfma_f32_16x16x32_bf16 v[216:219], a[236:239], a[216:219], v[216:219]
ds_read_b64_tr_b16 a[254:255], v17 offset:22536
v_mfma_f32_16x16x32_bf16 v[220:223], a[236:239], a[220:223], v[220:223]
s_xor_b32 s41, s3, 64512
buffer_store_dwordx4 v[28:31], v3, s[60:63], s69 offen offset:0 sc1
v_mfma_f32_16x16x32_bf16 v[220:223], a[232:235], a[204:207], v[220:223]
s_waitcnt lgkmcnt(4)
buffer_load_dwordx4 a[188:191], v3, s[20:23], s41 offen sc1
v_mfma_f32_16x16x32_bf16 v[224:227], a[240:243], a[192:195], v[224:227]
ds_read_b64_tr_b16 a[224:225], v50 offset:0
v_mfma_f32_16x16x32_bf16 v[224:227], a[244:247], a[208:211], v[224:227]
ds_read_b64_tr_b16 a[226:227], v50 offset:2048
v_mfma_f32_16x16x32_bf16 v[228:231], a[244:247], a[212:215], v[228:231]
v_mfma_f32_16x16x32_bf16 v[228:231], a[240:243], a[196:199], v[228:231]
v_mfma_f32_16x16x32_bf16 v[232:235], a[240:243], a[200:203], v[232:235]
ds_read_b64_tr_b16 a[228:229], v50 offset:4096
v_mfma_f32_16x16x32_bf16 v[232:235], a[244:247], a[216:219], v[232:235]
ds_read_b64_tr_b16 a[230:231], v50 offset:6144
v_mfma_f32_16x16x32_bf16 v[236:239], a[244:247], a[220:223], v[236:239]
ds_read_b64_tr_b16 a[232:233], v51 offset:0
v_mfma_f32_16x16x32_bf16 v[236:239], a[240:243], a[204:207], v[236:239]
s_waitcnt lgkmcnt(5)
ds_read_b64_tr_b16 a[234:235], v51 offset:2048
v_mfma_f32_16x16x32_bf16 v[240:243], a[248:251], a[192:195], v[240:243]
buffer_store_dwordx4 v[32:35], v3, s[60:63], s69 offen offset:1024 sc1
v_mfma_f32_16x16x32_bf16 v[240:243], a[252:255], a[208:211], v[240:243]
v_mfma_f32_16x16x32_bf16 v[244:247], a[252:255], a[212:215], v[244:247]
ds_read_b64_tr_b16 a[236:237], v51 offset:4096
v_mfma_f32_16x16x32_bf16 v[244:247], a[248:251], a[196:199], v[244:247]
ds_read_b64_tr_b16 a[238:239], v51 offset:6144
v_mfma_f32_16x16x32_bf16 v[248:251], a[248:251], a[200:203], v[248:251]
v_mfma_f32_16x16x32_bf16 v[248:251], a[252:255], a[216:219], v[248:251]
v_mfma_f32_16x16x32_bf16 v[252:255], a[252:255], a[220:223], v[252:255]
ds_read_b64_tr_b16 a[240:241], v50 offset:8192
v_mfma_f32_16x16x32_bf16 v[252:255], a[248:251], a[204:207], v[252:255]
s_waitcnt lgkmcnt(5)
ds_read_b64_tr_b16 a[242:243], v50 offset:10240
v_mfma_f32_16x16x32_bf16 a[0:3], a[224:227], a[192:195], a[0:3]
buffer_store_dwordx4 v[36:39], v3, s[60:63], s69 offen offset:2048 sc1
v_mfma_f32_16x16x32_bf16 a[0:3], a[228:231], a[208:211], a[0:3]
v_mfma_f32_16x16x32_bf16 a[4:7], a[228:231], a[212:215], a[4:7]
ds_read_b64_tr_b16 a[244:245], v50 offset:12288
v_mfma_f32_16x16x32_bf16 a[4:7], a[224:227], a[196:199], a[4:7]
ds_read_b64_tr_b16 a[246:247], v50 offset:14336
v_mfma_f32_16x16x32_bf16 a[8:11], a[224:227], a[200:203], a[8:11]
v_mfma_f32_16x16x32_bf16 a[8:11], a[228:231], a[216:219], a[8:11]
v_mfma_f32_16x16x32_bf16 a[12:15], a[228:231], a[220:223], a[12:15]
ds_read_b64_tr_b16 a[248:249], v51 offset:8192
v_mfma_f32_16x16x32_bf16 a[12:15], a[224:227], a[204:207], a[12:15]
s_waitcnt lgkmcnt(5)
ds_read_b64_tr_b16 a[250:251], v51 offset:10240
v_mfma_f32_16x16x32_bf16 a[16:19], a[232:235], a[192:195], a[16:19]
buffer_store_dwordx4 v[40:43], v3, s[60:63], s69 offen offset:3072 sc1
v_mfma_f32_16x16x32_bf16 a[16:19], a[236:239], a[208:211], a[16:19]
v_mfma_f32_16x16x32_bf16 a[20:23], a[236:239], a[212:215], a[20:23]
ds_read_b64_tr_b16 a[252:253], v51 offset:12288
v_mfma_f32_16x16x32_bf16 a[20:23], a[232:235], a[196:199], a[20:23]
ds_read_b64_tr_b16 a[254:255], v51 offset:14336
v_mfma_f32_16x16x32_bf16 a[24:27], a[232:235], a[200:203], a[24:27]
v_mfma_f32_16x16x32_bf16 a[24:27], a[236:239], a[216:219], a[24:27]
v_mfma_f32_16x16x32_bf16 a[28:31], a[236:239], a[220:223], a[28:31]
v_mfma_f32_16x16x32_bf16 a[28:31], a[232:235], a[204:207], a[28:31]
s_waitcnt vmcnt(24) lgkmcnt(0)
v_mfma_f32_16x16x32_bf16 a[32:35], a[240:243], a[192:195], a[32:35]
s_barrier
v_mfma_f32_16x16x32_bf16 a[32:35], a[244:247], a[208:211], a[32:35]
ds_read_b64_tr_b16 a[224:225], v14 offset:0
v_mfma_f32_16x16x32_bf16 a[36:39], a[244:247], a[212:215], a[36:39]
ds_read_b64_tr_b16 a[226:227], v14 offset:2048
v_mfma_f32_16x16x32_bf16 a[36:39], a[240:243], a[196:199], a[36:39]
ds_read_b64_tr_b16 a[228:229], v14 offset:4096
v_mfma_f32_16x16x32_bf16 a[40:43], a[240:243], a[200:203], a[40:43]
ds_read_b64_tr_b16 a[230:231], v14 offset:6144
v_mfma_f32_16x16x32_bf16 a[40:43], a[244:247], a[216:219], a[40:43]
ds_read_b64_tr_b16 a[232:233], v14 offset:8
v_mfma_f32_16x16x32_bf16 a[44:47], a[244:247], a[220:223], a[44:47]
ds_read_b64_tr_b16 a[234:235], v14 offset:2056
v_mfma_f32_16x16x32_bf16 a[44:47], a[240:243], a[204:207], a[44:47]
ds_read_b64_tr_b16 a[236:237], v14 offset:4104
v_mfma_f32_16x16x32_bf16 a[48:51], a[248:251], a[192:195], a[48:51]
ds_read_b64_tr_b16 a[238:239], v14 offset:6152
v_mfma_f32_16x16x32_bf16 a[48:51], a[252:255], a[208:211], a[48:51]
v_mfma_f32_16x16x32_bf16 a[52:55], a[252:255], a[212:215], a[52:55]
v_mfma_f32_16x16x32_bf16 a[52:55], a[248:251], a[196:199], a[52:55]
v_mfma_f32_16x16x32_bf16 a[56:59], a[248:251], a[200:203], a[56:59]
v_mfma_f32_16x16x32_bf16 a[56:59], a[252:255], a[216:219], a[56:59]
v_mfma_f32_16x16x32_bf16 a[60:63], a[252:255], a[220:223], a[60:63]
v_mfma_f32_16x16x32_bf16 a[60:63], a[248:251], a[204:207], a[60:63]
s_waitcnt lgkmcnt(4)
v_mfma_f32_16x16x32_bf16 v[64:67], a[224:227], a[128:131], v[64:67]
ds_read_b64_tr_b16 a[240:241], v15 offset:0
v_mfma_f32_16x16x32_bf16 v[64:67], a[228:231], a[144:147], v[64:67]
s_mov_b32 s40, 6291456
ds_read_b64_tr_b16 a[242:243], v15 offset:2048
v_mfma_f32_16x16x32_bf16 v[68:71], a[228:231], a[148:151], v[68:71]
s_add_u32 m0, s36, 81920
ds_read_b64_tr_b16 v[28:29], v55 offset:1024
v_mfma_f32_16x16x32_bf16 v[68:71], a[224:227], a[132:135], v[68:71]
buffer_load_dwordx4 v12, s[12:15], s40 offen offset:0 lds
v_mfma_f32_16x16x32_bf16 v[72:75], a[224:227], a[136:139], v[72:75]
ds_read_b64_tr_b16 a[244:245], v15 offset:4096
v_mfma_f32_16x16x32_bf16 v[72:75], a[228:231], a[152:155], v[72:75]
ds_read_b64_tr_b16 a[246:247], v15 offset:6144
v_mfma_f32_16x16x32_bf16 v[76:79], a[228:231], a[156:159], v[76:79]
s_add_u32 m0, s36, 89984
ds_read_b64_tr_b16 v[30:31], v55 offset:21504
v_mfma_f32_16x16x32_bf16 v[76:79], a[224:227], a[140:143], v[76:79]
s_waitcnt lgkmcnt(6)
buffer_load_dwordx4 v12, s[12:15], s40 offen offset:128 lds
v_mfma_f32_16x16x32_bf16 v[80:83], a[232:235], a[128:131], v[80:83]
ds_read_b64_tr_b16 a[248:249], v15 offset:8
v_mfma_f32_16x16x32_bf16 v[80:83], a[236:239], a[144:147], v[80:83]
ds_read_b64_tr_b16 a[250:251], v15 offset:2056
v_mfma_f32_16x16x32_bf16 v[84:87], a[236:239], a[148:151], v[84:87]
s_add_u32 m0, s36, 98048
ds_read_b64_tr_b16 v[32:33], v56 offset:1024
v_mfma_f32_16x16x32_bf16 v[84:87], a[232:235], a[132:135], v[84:87]
buffer_load_dwordx4 v12, s[12:15], s40 offen offset:256 lds
v_mfma_f32_16x16x32_bf16 v[88:91], a[232:235], a[136:139], v[88:91]
ds_read_b64_tr_b16 a[252:253], v15 offset:4104
v_mfma_f32_16x16x32_bf16 v[88:91], a[236:239], a[152:155], v[88:91]
s_mov_b32 s40, 6488064
ds_read_b64_tr_b16 a[254:255], v15 offset:6152
v_mfma_f32_16x16x32_bf16 v[92:95], a[236:239], a[156:159], v[92:95]
s_add_u32 m0, s36, 82944
ds_read_b64_tr_b16 v[34:35], v56 offset:21504
v_mfma_f32_16x16x32_bf16 v[92:95], a[232:235], a[140:143], v[92:95]
s_waitcnt lgkmcnt(7)
buffer_load_dwordx4 v12, s[12:15], s40 offen offset:0 lds
v_mfma_f32_16x16x32_bf16 v[96:99], a[240:243], a[128:131], v[96:99]
ds_read_b64_tr_b16 a[224:225], v14 offset:8192
v_mfma_f32_16x16x32_bf16 v[96:99], a[244:247], a[144:147], v[96:99]
ds_read_b64_tr_b16 a[226:227], v14 offset:10240
v_mfma_f32_16x16x32_bf16 v[100:103], a[244:247], a[148:151], v[100:103]
s_add_u32 m0, s36, 91008
ds_read_b64_tr_b16 v[36:37], v57 offset:1024
v_mfma_f32_16x16x32_bf16 v[100:103], a[240:243], a[132:135], v[100:103]
buffer_load_dwordx4 v12, s[12:15], s40 offen offset:128 lds
v_mfma_f32_16x16x32_bf16 v[104:107], a[240:243], a[136:139], v[104:107]
ds_read_b64_tr_b16 a[228:229], v14 offset:12288
v_mfma_f32_16x16x32_bf16 v[104:107], a[244:247], a[152:155], v[104:107]
ds_read_b64_tr_b16 a[230:231], v14 offset:14336
v_mfma_f32_16x16x32_bf16 v[108:111], a[244:247], a[156:159], v[108:111]
s_add_u32 m0, s36, 99072
ds_read_b64_tr_b16 v[38:39], v57 offset:21504
v_mfma_f32_16x16x32_bf16 v[108:111], a[240:243], a[140:143], v[108:111]
s_waitcnt lgkmcnt(7)
buffer_load_dwordx4 v12, s[12:15], s40 offen offset:256 lds
v_mfma_f32_16x16x32_bf16 v[112:115], a[248:251], a[128:131], v[112:115]
ds_read_b64_tr_b16 a[232:233], v14 offset:8200
v_mfma_f32_16x16x32_bf16 v[112:115], a[252:255], a[144:147], v[112:115]
s_mov_b32 s40, 1572864
ds_read_b64_tr_b16 a[234:235], v14 offset:10248
v_mfma_f32_16x16x32_bf16 v[116:119], a[252:255], a[148:151], v[116:119]
s_add_u32 m0, s37, 106496
v_mfma_f32_16x16x32_bf16 v[116:119], a[248:251], a[132:135], v[116:119]
buffer_load_dwordx4 v13, s[16:19], s40 offen lds
v_mfma_f32_16x16x32_bf16 v[120:123], a[248:251], a[136:139], v[120:123]
ds_read_b64_tr_b16 a[236:237], v14 offset:12296
v_mfma_f32_16x16x32_bf16 v[120:123], a[252:255], a[152:155], v[120:123]
s_mov_b32 s40, 1622016
ds_read_b64_tr_b16 a[238:239], v14 offset:14344
v_mfma_f32_16x16x32_bf16 v[124:127], a[252:255], a[156:159], v[124:127]
s_add_u32 m0, s37, 107520
v_mfma_f32_16x16x32_bf16 v[124:127], a[248:251], a[140:143], v[124:127]
s_waitcnt lgkmcnt(5)
buffer_load_dwordx4 v13, s[16:19], s40 offen lds
v_mfma_f32_16x16x32_bf16 v[128:131], a[224:227], a[128:131], v[128:131]
ds_read_b64_tr_b16 a[240:241], v15 offset:8192
v_mfma_f32_16x16x32_bf16 v[128:131], a[228:231], a[144:147], v[128:131]
s_mov_b32 s40, 1585152
ds_read_b64_tr_b16 a[242:243], v15 offset:10240
v_mfma_f32_16x16x32_bf16 v[132:135], a[228:231], a[148:151], v[132:135]
s_add_u32 m0, s37, 108544
v_mfma_f32_16x16x32_bf16 v[132:135], a[224:227], a[132:135], v[132:135]
buffer_load_dwordx4 v13, s[16:19], s40 offen lds
v_mfma_f32_16x16x32_bf16 v[136:139], a[224:227], a[136:139], v[136:139]
ds_read_b64_tr_b16 a[244:245], v15 offset:12288
v_mfma_f32_16x16x32_bf16 v[136:139], a[228:231], a[152:155], v[136:139]
s_mov_b32 s40, 1634304
ds_read_b64_tr_b16 a[246:247], v15 offset:14336
v_mfma_f32_16x16x32_bf16 v[140:143], a[228:231], a[156:159], v[140:143]
s_add_u32 m0, s37, 109568
v_mfma_f32_16x16x32_bf16 v[140:143], a[224:227], a[140:143], v[140:143]
s_waitcnt lgkmcnt(4)
buffer_load_dwordx4 v13, s[16:19], s40 offen lds
v_mfma_f32_16x16x32_bf16 v[144:147], a[232:235], a[128:131], v[144:147]
ds_read_b64_tr_b16 a[248:249], v15 offset:8200
v_mfma_f32_16x16x32_bf16 v[144:147], a[236:239], a[144:147], v[144:147]
ds_read_b64_tr_b16 a[250:251], v15 offset:10248
v_mfma_f32_16x16x32_bf16 v[148:151], a[236:239], a[148:151], v[148:151]
s_xor_b32 s41, s3, 65536
v_mfma_f32_16x16x32_bf16 v[148:151], a[232:235], a[132:135], v[148:151]
buffer_load_dwordx4 a[192:195], v3, s[20:23], s41 offen sc1
v_mfma_f32_16x16x32_bf16 v[152:155], a[232:235], a[136:139], v[152:155]
ds_read_b64_tr_b16 a[252:253], v15 offset:12296
v_mfma_f32_16x16x32_bf16 v[152:155], a[236:239], a[152:155], v[152:155]
ds_read_b64_tr_b16 a[254:255], v15 offset:14344
v_mfma_f32_16x16x32_bf16 v[156:159], a[236:239], a[156:159], v[156:159]
s_xor_b32 s41, s3, 66560
v_mfma_f32_16x16x32_bf16 v[156:159], a[232:235], a[140:143], v[156:159]
s_waitcnt lgkmcnt(4)
buffer_load_dwordx4 a[196:199], v3, s[20:23], s41 offen sc1
v_mfma_f32_16x16x32_bf16 v[160:163], a[240:243], a[128:131], v[160:163]
ds_read_b64_tr_b16 a[224:225], v14 offset:16384
v_mfma_f32_16x16x32_bf16 v[160:163], a[244:247], a[144:147], v[160:163]
ds_read_b64_tr_b16 a[226:227], v14 offset:18432
v_mfma_f32_16x16x32_bf16 v[164:167], a[244:247], a[148:151], v[164:167]
s_xor_b32 s41, s3, 67584
v_mfma_f32_16x16x32_bf16 v[164:167], a[240:243], a[132:135], v[164:167]
buffer_load_dwordx4 a[200:203], v3, s[20:23], s41 offen sc1
v_mfma_f32_16x16x32_bf16 v[168:171], a[240:243], a[136:139], v[168:171]
ds_read_b64_tr_b16 a[228:229], v14 offset:20480
v_mfma_f32_16x16x32_bf16 v[168:171], a[244:247], a[152:155], v[168:171]
ds_read_b64_tr_b16 a[230:231], v14 offset:22528
v_mfma_f32_16x16x32_bf16 v[172:175], a[244:247], a[156:159], v[172:175]
s_xor_b32 s41, s3, 68608
v_mfma_f32_16x16x32_bf16 v[172:175], a[240:243], a[140:143], v[172:175]
s_waitcnt lgkmcnt(4)
buffer_load_dwordx4 a[204:207], v3, s[20:23], s41 offen sc1
v_mfma_f32_16x16x32_bf16 v[176:179], a[248:251], a[128:131], v[176:179]
ds_read_b64_tr_b16 a[232:233], v14 offset:16392
v_mfma_f32_16x16x32_bf16 v[176:179], a[252:255], a[144:147], v[176:179]
ds_read_b64_tr_b16 a[234:235], v14 offset:18440
v_mfma_f32_16x16x32_bf16 v[180:183], a[252:255], a[148:151], v[180:183]
s_xor_b32 s41, s3, 69632
v_mfma_f32_16x16x32_bf16 v[180:183], a[248:251], a[132:135], v[180:183]
buffer_load_dwordx4 a[208:211], v3, s[20:23], s41 offen sc1
v_mfma_f32_16x16x32_bf16 v[184:187], a[248:251], a[136:139], v[184:187]
ds_read_b64_tr_b16 a[236:237], v14 offset:20488
v_mfma_f32_16x16x32_bf16 v[184:187], a[252:255], a[152:155], v[184:187]
ds_read_b64_tr_b16 a[238:239], v14 offset:22536
v_mfma_f32_16x16x32_bf16 v[188:191], a[252:255], a[156:159], v[188:191]
s_xor_b32 s41, s3, 70656
v_mfma_f32_16x16x32_bf16 v[188:191], a[248:251], a[140:143], v[188:191]
s_waitcnt lgkmcnt(4)
buffer_load_dwordx4 a[212:215], v3, s[20:23], s41 offen sc1
v_mfma_f32_16x16x32_bf16 v[192:195], a[224:227], a[128:131], v[192:195]
ds_read_b64_tr_b16 a[240:241], v15 offset:16384
v_mfma_f32_16x16x32_bf16 v[192:195], a[228:231], a[144:147], v[192:195]
ds_read_b64_tr_b16 a[242:243], v15 offset:18432
v_mfma_f32_16x16x32_bf16 v[196:199], a[228:231], a[148:151], v[196:199]
s_xor_b32 s41, s3, 71680
v_mfma_f32_16x16x32_bf16 v[196:199], a[224:227], a[132:135], v[196:199]
buffer_load_dwordx4 a[216:219], v3, s[20:23], s41 offen sc1
v_mfma_f32_16x16x32_bf16 v[200:203], a[224:227], a[136:139], v[200:203]
ds_read_b64_tr_b16 a[244:245], v15 offset:20480
v_mfma_f32_16x16x32_bf16 v[200:203], a[228:231], a[152:155], v[200:203]
ds_read_b64_tr_b16 a[246:247], v15 offset:22528
v_mfma_f32_16x16x32_bf16 v[204:207], a[228:231], a[156:159], v[204:207]
s_xor_b32 s41, s3, 72704
v_mfma_f32_16x16x32_bf16 v[204:207], a[224:227], a[140:143], v[204:207]
s_waitcnt lgkmcnt(4)
buffer_load_dwordx4 a[220:223], v3, s[20:23], s41 offen sc1
v_mfma_f32_16x16x32_bf16 v[208:211], a[232:235], a[128:131], v[208:211]
ds_read_b64_tr_b16 a[248:249], v15 offset:16392
v_mfma_f32_16x16x32_bf16 v[208:211], a[236:239], a[144:147], v[208:211]
ds_read_b64_tr_b16 a[250:251], v15 offset:18440
v_mfma_f32_16x16x32_bf16 v[212:215], a[236:239], a[148:151], v[212:215]
v_mfma_f32_16x16x32_bf16 v[212:215], a[232:235], a[132:135], v[212:215]
v_mfma_f32_16x16x32_bf16 v[216:219], a[232:235], a[136:139], v[216:219]
ds_read_b64_tr_b16 a[252:253], v15 offset:20488
v_mfma_f32_16x16x32_bf16 v[216:219], a[236:239], a[152:155], v[216:219]
ds_read_b64_tr_b16 a[254:255], v15 offset:22536
v_mfma_f32_16x16x32_bf16 v[220:223], a[236:239], a[156:159], v[220:223]
buffer_store_dwordx4 v[28:31], v1, s[60:63], s69 offen offset:3072 sc1
v_mfma_f32_16x16x32_bf16 v[220:223], a[232:235], a[140:143], v[220:223]
s_waitcnt lgkmcnt(4)
v_mfma_f32_16x16x32_bf16 v[224:227], a[240:243], a[128:131], v[224:227]
ds_read_b64_tr_b16 a[224:225], v18 offset:0
v_mfma_f32_16x16x32_bf16 v[224:227], a[244:247], a[144:147], v[224:227]
ds_read_b64_tr_b16 a[226:227], v18 offset:2048
v_mfma_f32_16x16x32_bf16 v[228:231], a[244:247], a[148:151], v[228:231]
v_mfma_f32_16x16x32_bf16 v[228:231], a[240:243], a[132:135], v[228:231]
v_mfma_f32_16x16x32_bf16 v[232:235], a[240:243], a[136:139], v[232:235]
ds_read_b64_tr_b16 a[228:229], v18 offset:4096
v_mfma_f32_16x16x32_bf16 v[232:235], a[244:247], a[152:155], v[232:235]
ds_read_b64_tr_b16 a[230:231], v18 offset:6144
v_mfma_f32_16x16x32_bf16 v[236:239], a[244:247], a[156:159], v[236:239]
ds_read_b64_tr_b16 a[232:233], v19 offset:0
v_mfma_f32_16x16x32_bf16 v[236:239], a[240:243], a[140:143], v[236:239]
s_waitcnt lgkmcnt(5)
ds_read_b64_tr_b16 a[234:235], v19 offset:2048
v_mfma_f32_16x16x32_bf16 v[240:243], a[248:251], a[128:131], v[240:243]
s_add_u32 s69, s69, 1024
v_mfma_f32_16x16x32_bf16 v[240:243], a[252:255], a[144:147], v[240:243]
buffer_store_dwordx4 v[32:35], v59, s[60:63], s69 offen offset:0 sc1
v_mfma_f32_16x16x32_bf16 v[244:247], a[252:255], a[148:151], v[244:247]
ds_read_b64_tr_b16 a[236:237], v19 offset:4096
v_mfma_f32_16x16x32_bf16 v[244:247], a[248:251], a[132:135], v[244:247]
ds_read_b64_tr_b16 a[238:239], v19 offset:6144
v_mfma_f32_16x16x32_bf16 v[248:251], a[248:251], a[136:139], v[248:251]
v_mfma_f32_16x16x32_bf16 v[248:251], a[252:255], a[152:155], v[248:251]
v_mfma_f32_16x16x32_bf16 v[252:255], a[252:255], a[156:159], v[252:255]
ds_read_b64_tr_b16 a[240:241], v18 offset:8192
v_mfma_f32_16x16x32_bf16 v[252:255], a[248:251], a[140:143], v[252:255]
s_waitcnt lgkmcnt(5)
ds_read_b64_tr_b16 a[242:243], v18 offset:10240
v_mfma_f32_16x16x32_bf16 a[0:3], a[224:227], a[128:131], a[0:3]
buffer_store_dwordx4 v[36:39], v59, s[60:63], s69 offen offset:1024 sc1
v_mfma_f32_16x16x32_bf16 a[0:3], a[228:231], a[144:147], a[0:3]
v_mfma_f32_16x16x32_bf16 a[4:7], a[228:231], a[148:151], a[4:7]
ds_read_b64_tr_b16 a[244:245], v18 offset:12288
v_mfma_f32_16x16x32_bf16 a[4:7], a[224:227], a[132:135], a[4:7]
ds_read_b64_tr_b16 a[246:247], v18 offset:14336
v_mfma_f32_16x16x32_bf16 a[8:11], a[224:227], a[136:139], a[8:11]
v_mfma_f32_16x16x32_bf16 a[8:11], a[228:231], a[152:155], a[8:11]
v_mfma_f32_16x16x32_bf16 a[12:15], a[228:231], a[156:159], a[12:15]
ds_read_b64_tr_b16 a[248:249], v19 offset:8192
v_mfma_f32_16x16x32_bf16 a[12:15], a[224:227], a[140:143], a[12:15]
s_waitcnt lgkmcnt(5)
ds_read_b64_tr_b16 a[250:251], v19 offset:10240
v_mfma_f32_16x16x32_bf16 a[16:19], a[232:235], a[128:131], a[16:19]
v_mfma_f32_16x16x32_bf16 a[16:19], a[236:239], a[144:147], a[16:19]
v_mfma_f32_16x16x32_bf16 a[20:23], a[236:239], a[148:151], a[20:23]
ds_read_b64_tr_b16 a[252:253], v19 offset:12288
v_mfma_f32_16x16x32_bf16 a[20:23], a[232:235], a[132:135], a[20:23]
ds_read_b64_tr_b16 a[254:255], v19 offset:14336
v_mfma_f32_16x16x32_bf16 a[24:27], a[232:235], a[136:139], a[24:27]
v_mfma_f32_16x16x32_bf16 a[24:27], a[236:239], a[152:155], a[24:27]
v_mfma_f32_16x16x32_bf16 a[28:31], a[236:239], a[156:159], a[28:31]
v_mfma_f32_16x16x32_bf16 a[28:31], a[232:235], a[140:143], a[28:31]
s_waitcnt vmcnt(24) lgkmcnt(0)
v_mfma_f32_16x16x32_bf16 a[32:35], a[240:243], a[128:131], a[32:35]
s_barrier
v_mfma_f32_16x16x32_bf16 a[32:35], a[244:247], a[144:147], a[32:35]
ds_read_b64_tr_b16 a[224:225], v14 offset:40960
v_mfma_f32_16x16x32_bf16 a[36:39], a[244:247], a[148:151], a[36:39]
ds_read_b64_tr_b16 a[226:227], v14 offset:43008
v_mfma_f32_16x16x32_bf16 a[36:39], a[240:243], a[132:135], a[36:39]
ds_read_b64_tr_b16 a[228:229], v14 offset:45056
v_mfma_f32_16x16x32_bf16 a[40:43], a[240:243], a[136:139], a[40:43]
ds_read_b64_tr_b16 a[230:231], v14 offset:47104
v_mfma_f32_16x16x32_bf16 a[40:43], a[244:247], a[152:155], a[40:43]
ds_read_b64_tr_b16 a[232:233], v14 offset:40968
v_mfma_f32_16x16x32_bf16 a[44:47], a[244:247], a[156:159], a[44:47]
ds_read_b64_tr_b16 a[234:235], v14 offset:43016
v_mfma_f32_16x16x32_bf16 a[44:47], a[240:243], a[140:143], a[44:47]
ds_read_b64_tr_b16 a[236:237], v14 offset:45064
v_mfma_f32_16x16x32_bf16 a[48:51], a[248:251], a[128:131], a[48:51]
ds_read_b64_tr_b16 a[238:239], v14 offset:47112
v_mfma_f32_16x16x32_bf16 a[48:51], a[252:255], a[144:147], a[48:51]
v_mfma_f32_16x16x32_bf16 a[52:55], a[252:255], a[148:151], a[52:55]
v_mfma_f32_16x16x32_bf16 a[52:55], a[248:251], a[132:135], a[52:55]
v_mfma_f32_16x16x32_bf16 a[56:59], a[248:251], a[136:139], a[56:59]
v_mfma_f32_16x16x32_bf16 a[56:59], a[252:255], a[152:155], a[56:59]
v_mfma_f32_16x16x32_bf16 a[60:63], a[252:255], a[156:159], a[60:63]
v_mfma_f32_16x16x32_bf16 a[60:63], a[248:251], a[140:143], a[60:63]
s_waitcnt lgkmcnt(4)
v_mfma_f32_16x16x32_bf16 v[64:67], a[224:227], a[160:163], v[64:67]
ds_read_b64_tr_b16 a[240:241], v15 offset:40960
v_mfma_f32_16x16x32_bf16 v[64:67], a[228:231], a[176:179], v[64:67]
s_mov_b32 s40, 7077888
ds_read_b64_tr_b16 a[242:243], v15 offset:43008
v_mfma_f32_16x16x32_bf16 v[68:71], a[228:231], a[180:183], v[68:71]
s_add_u32 m0, s36, 0
ds_read_b64_tr_b16 v[40:41], v58 offset:1024
v_mfma_f32_16x16x32_bf16 v[68:71], a[224:227], a[164:167], v[68:71]
buffer_load_dwordx4 v12, s[12:15], s40 offen offset:0 lds
v_mfma_f32_16x16x32_bf16 v[72:75], a[224:227], a[168:171], v[72:75]
ds_read_b64_tr_b16 a[244:245], v15 offset:45056
v_mfma_f32_16x16x32_bf16 v[72:75], a[228:231], a[184:187], v[72:75]
ds_read_b64_tr_b16 a[246:247], v15 offset:47104
v_mfma_f32_16x16x32_bf16 v[76:79], a[228:231], a[188:191], v[76:79]
s_add_u32 m0, s36, 8064
ds_read_b64_tr_b16 v[42:43], v58 offset:21504
v_mfma_f32_16x16x32_bf16 v[76:79], a[224:227], a[172:175], v[76:79]
s_waitcnt lgkmcnt(6)
buffer_load_dwordx4 v12, s[12:15], s40 offen offset:128 lds
v_mfma_f32_16x16x32_bf16 v[80:83], a[232:235], a[160:163], v[80:83]
ds_read_b64_tr_b16 a[248:249], v15 offset:40968
v_mfma_f32_16x16x32_bf16 v[80:83], a[236:239], a[176:179], v[80:83]
ds_read_b64_tr_b16 a[250:251], v15 offset:43016
v_mfma_f32_16x16x32_bf16 v[84:87], a[236:239], a[180:183], v[84:87]
s_add_u32 m0, s36, 16128
ds_read_b64_tr_b16 v[28:29], v55 offset:2048
v_mfma_f32_16x16x32_bf16 v[84:87], a[232:235], a[164:167], v[84:87]
buffer_load_dwordx4 v12, s[12:15], s40 offen offset:256 lds
v_mfma_f32_16x16x32_bf16 v[88:91], a[232:235], a[168:171], v[88:91]
ds_read_b64_tr_b16 a[252:253], v15 offset:45064
v_mfma_f32_16x16x32_bf16 v[88:91], a[236:239], a[184:187], v[88:91]
s_mov_b32 s40, 7274496
ds_read_b64_tr_b16 a[254:255], v15 offset:47112
v_mfma_f32_16x16x32_bf16 v[92:95], a[236:239], a[188:191], v[92:95]
s_add_u32 m0, s36, 1024
ds_read_b64_tr_b16 v[30:31], v55 offset:22528
v_mfma_f32_16x16x32_bf16 v[92:95], a[232:235], a[172:175], v[92:95]
s_waitcnt lgkmcnt(7)
buffer_load_dwordx4 v12, s[12:15], s40 offen offset:0 lds
v_mfma_f32_16x16x32_bf16 v[96:99], a[240:243], a[160:163], v[96:99]
ds_read_b64_tr_b16 a[224:225], v14 offset:49152
v_mfma_f32_16x16x32_bf16 v[96:99], a[244:247], a[176:179], v[96:99]
ds_read_b64_tr_b16 a[226:227], v14 offset:51200
v_mfma_f32_16x16x32_bf16 v[100:103], a[244:247], a[180:183], v[100:103]
s_add_u32 m0, s36, 9088
ds_read_b64_tr_b16 v[32:33], v56 offset:2048
v_mfma_f32_16x16x32_bf16 v[100:103], a[240:243], a[164:167], v[100:103]
buffer_load_dwordx4 v12, s[12:15], s40 offen offset:128 lds
v_mfma_f32_16x16x32_bf16 v[104:107], a[240:243], a[168:171], v[104:107]
ds_read_b64_tr_b16 a[228:229], v14 offset:53248
v_mfma_f32_16x16x32_bf16 v[104:107], a[244:247], a[184:187], v[104:107]
ds_read_b64_tr_b16 a[230:231], v14 offset:55296
v_mfma_f32_16x16x32_bf16 v[108:111], a[244:247], a[188:191], v[108:111]
s_add_u32 m0, s36, 17152
ds_read_b64_tr_b16 v[34:35], v56 offset:22528
v_mfma_f32_16x16x32_bf16 v[108:111], a[240:243], a[172:175], v[108:111]
s_waitcnt lgkmcnt(7)
buffer_load_dwordx4 v12, s[12:15], s40 offen offset:256 lds
v_mfma_f32_16x16x32_bf16 v[112:115], a[248:251], a[160:163], v[112:115]
ds_read_b64_tr_b16 a[232:233], v14 offset:49160
v_mfma_f32_16x16x32_bf16 v[112:115], a[252:255], a[176:179], v[112:115]
s_mov_b32 s40, 1769472
ds_read_b64_tr_b16 a[234:235], v14 offset:51208
v_mfma_f32_16x16x32_bf16 v[116:119], a[252:255], a[180:183], v[116:119]
s_add_u32 m0, s37, 24576
v_mfma_f32_16x16x32_bf16 v[116:119], a[248:251], a[164:167], v[116:119]
buffer_load_dwordx4 v13, s[16:19], s40 offen lds
v_mfma_f32_16x16x32_bf16 v[120:123], a[248:251], a[168:171], v[120:123]
ds_read_b64_tr_b16 a[236:237], v14 offset:53256
v_mfma_f32_16x16x32_bf16 v[120:123], a[252:255], a[184:187], v[120:123]
s_mov_b32 s40, 1818624
ds_read_b64_tr_b16 a[238:239], v14 offset:55304
v_mfma_f32_16x16x32_bf16 v[124:127], a[252:255], a[188:191], v[124:127]
s_add_u32 m0, s37, 25600
v_mfma_f32_16x16x32_bf16 v[124:127], a[248:251], a[172:175], v[124:127]
s_waitcnt lgkmcnt(5)
buffer_load_dwordx4 v13, s[16:19], s40 offen lds
v_mfma_f32_16x16x32_bf16 v[128:131], a[224:227], a[160:163], v[128:131]
ds_read_b64_tr_b16 a[240:241], v15 offset:49152
v_mfma_f32_16x16x32_bf16 v[128:131], a[228:231], a[176:179], v[128:131]
s_mov_b32 s40, 1781760
ds_read_b64_tr_b16 a[242:243], v15 offset:51200
v_mfma_f32_16x16x32_bf16 v[132:135], a[228:231], a[180:183], v[132:135]
s_add_u32 m0, s37, 26624
v_mfma_f32_16x16x32_bf16 v[132:135], a[224:227], a[164:167], v[132:135]
buffer_load_dwordx4 v13, s[16:19], s40 offen lds
v_mfma_f32_16x16x32_bf16 v[136:139], a[224:227], a[168:171], v[136:139]
ds_read_b64_tr_b16 a[244:245], v15 offset:53248
v_mfma_f32_16x16x32_bf16 v[136:139], a[228:231], a[184:187], v[136:139]
s_mov_b32 s40, 1830912
ds_read_b64_tr_b16 a[246:247], v15 offset:55296
v_mfma_f32_16x16x32_bf16 v[140:143], a[228:231], a[188:191], v[140:143]
s_add_u32 m0, s37, 27648
v_mfma_f32_16x16x32_bf16 v[140:143], a[224:227], a[172:175], v[140:143]
s_waitcnt lgkmcnt(4)
buffer_load_dwordx4 v13, s[16:19], s40 offen lds
v_mfma_f32_16x16x32_bf16 v[144:147], a[232:235], a[160:163], v[144:147]
ds_read_b64_tr_b16 a[248:249], v15 offset:49160
v_mfma_f32_16x16x32_bf16 v[144:147], a[236:239], a[176:179], v[144:147]
ds_read_b64_tr_b16 a[250:251], v15 offset:51208
v_mfma_f32_16x16x32_bf16 v[148:151], a[236:239], a[180:183], v[148:151]
s_xor_b32 s41, s3, 73728
v_mfma_f32_16x16x32_bf16 v[148:151], a[232:235], a[164:167], v[148:151]
buffer_load_dwordx4 a[128:131], v3, s[20:23], s41 offen sc1
v_mfma_f32_16x16x32_bf16 v[152:155], a[232:235], a[168:171], v[152:155]
ds_read_b64_tr_b16 a[252:253], v15 offset:53256
v_mfma_f32_16x16x32_bf16 v[152:155], a[236:239], a[184:187], v[152:155]
ds_read_b64_tr_b16 a[254:255], v15 offset:55304
v_mfma_f32_16x16x32_bf16 v[156:159], a[236:239], a[188:191], v[156:159]
s_xor_b32 s41, s3, 74752
v_mfma_f32_16x16x32_bf16 v[156:159], a[232:235], a[172:175], v[156:159]
s_waitcnt lgkmcnt(4)
buffer_load_dwordx4 a[132:135], v3, s[20:23], s41 offen sc1
v_mfma_f32_16x16x32_bf16 v[160:163], a[240:243], a[160:163], v[160:163]
ds_read_b64_tr_b16 a[224:225], v14 offset:57344
v_mfma_f32_16x16x32_bf16 v[160:163], a[244:247], a[176:179], v[160:163]
ds_read_b64_tr_b16 a[226:227], v14 offset:59392
v_mfma_f32_16x16x32_bf16 v[164:167], a[244:247], a[180:183], v[164:167]
s_xor_b32 s41, s3, 75776
v_mfma_f32_16x16x32_bf16 v[164:167], a[240:243], a[164:167], v[164:167]
buffer_load_dwordx4 a[136:139], v3, s[20:23], s41 offen sc1
v_mfma_f32_16x16x32_bf16 v[168:171], a[240:243], a[168:171], v[168:171]
ds_read_b64_tr_b16 a[228:229], v14 offset:61440
v_mfma_f32_16x16x32_bf16 v[168:171], a[244:247], a[184:187], v[168:171]
ds_read_b64_tr_b16 a[230:231], v14 offset:63488
v_mfma_f32_16x16x32_bf16 v[172:175], a[244:247], a[188:191], v[172:175]
s_xor_b32 s41, s3, 76800
v_mfma_f32_16x16x32_bf16 v[172:175], a[240:243], a[172:175], v[172:175]
s_waitcnt lgkmcnt(4)
buffer_load_dwordx4 a[140:143], v3, s[20:23], s41 offen sc1
v_mfma_f32_16x16x32_bf16 v[176:179], a[248:251], a[160:163], v[176:179]
ds_read_b64_tr_b16 a[232:233], v14 offset:57352
v_mfma_f32_16x16x32_bf16 v[176:179], a[252:255], a[176:179], v[176:179]
ds_read_b64_tr_b16 a[234:235], v14 offset:59400
v_mfma_f32_16x16x32_bf16 v[180:183], a[252:255], a[180:183], v[180:183]
s_xor_b32 s41, s3, 77824
v_mfma_f32_16x16x32_bf16 v[180:183], a[248:251], a[164:167], v[180:183]
buffer_load_dwordx4 a[144:147], v3, s[20:23], s41 offen sc1
v_mfma_f32_16x16x32_bf16 v[184:187], a[248:251], a[168:171], v[184:187]
ds_read_b64_tr_b16 a[236:237], v14 offset:61448
v_mfma_f32_16x16x32_bf16 v[184:187], a[252:255], a[184:187], v[184:187]
ds_read_b64_tr_b16 a[238:239], v14 offset:63496
v_mfma_f32_16x16x32_bf16 v[188:191], a[252:255], a[188:191], v[188:191]
s_xor_b32 s41, s3, 78848
v_mfma_f32_16x16x32_bf16 v[188:191], a[248:251], a[172:175], v[188:191]
s_waitcnt lgkmcnt(4)
buffer_load_dwordx4 a[148:151], v3, s[20:23], s41 offen sc1
v_mfma_f32_16x16x32_bf16 v[192:195], a[224:227], a[160:163], v[192:195]
ds_read_b64_tr_b16 a[240:241], v15 offset:57344
v_mfma_f32_16x16x32_bf16 v[192:195], a[228:231], a[176:179], v[192:195]
ds_read_b64_tr_b16 a[242:243], v15 offset:59392
v_mfma_f32_16x16x32_bf16 v[196:199], a[228:231], a[180:183], v[196:199]
s_xor_b32 s41, s3, 79872
v_mfma_f32_16x16x32_bf16 v[196:199], a[224:227], a[164:167], v[196:199]
buffer_load_dwordx4 a[152:155], v3, s[20:23], s41 offen sc1
v_mfma_f32_16x16x32_bf16 v[200:203], a[224:227], a[168:171], v[200:203]
ds_read_b64_tr_b16 a[244:245], v15 offset:61440
v_mfma_f32_16x16x32_bf16 v[200:203], a[228:231], a[184:187], v[200:203]
ds_read_b64_tr_b16 a[246:247], v15 offset:63488
v_mfma_f32_16x16x32_bf16 v[204:207], a[228:231], a[188:191], v[204:207]
s_xor_b32 s41, s3, 80896
v_mfma_f32_16x16x32_bf16 v[204:207], a[224:227], a[172:175], v[204:207]
s_waitcnt lgkmcnt(4)
buffer_load_dwordx4 a[156:159], v3, s[20:23], s41 offen sc1
v_mfma_f32_16x16x32_bf16 v[208:211], a[232:235], a[160:163], v[208:211]
ds_read_b64_tr_b16 a[248:249], v15 offset:57352
v_mfma_f32_16x16x32_bf16 v[208:211], a[236:239], a[176:179], v[208:211]
ds_read_b64_tr_b16 a[250:251], v15 offset:59400
v_mfma_f32_16x16x32_bf16 v[212:215], a[236:239], a[180:183], v[212:215]
v_mfma_f32_16x16x32_bf16 v[212:215], a[232:235], a[164:167], v[212:215]
v_mfma_f32_16x16x32_bf16 v[216:219], a[232:235], a[168:171], v[216:219]
ds_read_b64_tr_b16 a[252:253], v15 offset:61448
v_mfma_f32_16x16x32_bf16 v[216:219], a[236:239], a[184:187], v[216:219]
ds_read_b64_tr_b16 a[254:255], v15 offset:63496
v_mfma_f32_16x16x32_bf16 v[220:223], a[236:239], a[188:191], v[220:223]
buffer_store_dwordx4 v[40:43], v59, s[60:63], s69 offen offset:2048 sc1
v_mfma_f32_16x16x32_bf16 v[220:223], a[232:235], a[172:175], v[220:223]
s_waitcnt lgkmcnt(4)
v_mfma_f32_16x16x32_bf16 v[224:227], a[240:243], a[160:163], v[224:227]
ds_read_b64_tr_b16 a[224:225], v18 offset:40960
v_mfma_f32_16x16x32_bf16 v[224:227], a[244:247], a[176:179], v[224:227]
ds_read_b64_tr_b16 a[226:227], v18 offset:43008
v_mfma_f32_16x16x32_bf16 v[228:231], a[244:247], a[180:183], v[228:231]
v_mfma_f32_16x16x32_bf16 v[228:231], a[240:243], a[164:167], v[228:231]
v_mfma_f32_16x16x32_bf16 v[232:235], a[240:243], a[168:171], v[232:235]
ds_read_b64_tr_b16 a[228:229], v18 offset:45056
v_mfma_f32_16x16x32_bf16 v[232:235], a[244:247], a[184:187], v[232:235]
ds_read_b64_tr_b16 a[230:231], v18 offset:47104
v_mfma_f32_16x16x32_bf16 v[236:239], a[244:247], a[188:191], v[236:239]
ds_read_b64_tr_b16 a[232:233], v19 offset:40960
v_mfma_f32_16x16x32_bf16 v[236:239], a[240:243], a[172:175], v[236:239]
s_waitcnt lgkmcnt(5)
ds_read_b64_tr_b16 a[234:235], v19 offset:43008
v_mfma_f32_16x16x32_bf16 v[240:243], a[248:251], a[160:163], v[240:243]
buffer_store_dwordx4 v[28:31], v59, s[60:63], s69 offen offset:3072 sc1
v_mfma_f32_16x16x32_bf16 v[240:243], a[252:255], a[176:179], v[240:243]
v_mfma_f32_16x16x32_bf16 v[244:247], a[252:255], a[180:183], v[244:247]
ds_read_b64_tr_b16 a[236:237], v19 offset:45056
v_mfma_f32_16x16x32_bf16 v[244:247], a[248:251], a[164:167], v[244:247]
ds_read_b64_tr_b16 a[238:239], v19 offset:47104
v_mfma_f32_16x16x32_bf16 v[248:251], a[248:251], a[168:171], v[248:251]
v_mfma_f32_16x16x32_bf16 v[248:251], a[252:255], a[184:187], v[248:251]
v_mfma_f32_16x16x32_bf16 v[252:255], a[252:255], a[188:191], v[252:255]
ds_read_b64_tr_b16 a[240:241], v18 offset:49152
v_mfma_f32_16x16x32_bf16 v[252:255], a[248:251], a[172:175], v[252:255]
s_waitcnt lgkmcnt(5)
ds_read_b64_tr_b16 a[242:243], v18 offset:51200
v_mfma_f32_16x16x32_bf16 a[0:3], a[224:227], a[160:163], a[0:3]
s_add_u32 s69, s69, 1024
v_mfma_f32_16x16x32_bf16 a[0:3], a[228:231], a[176:179], a[0:3]
buffer_store_dwordx4 v[32:35], v59, s[60:63], s69 offen offset:3072 sc1
v_mfma_f32_16x16x32_bf16 a[4:7], a[228:231], a[180:183], a[4:7]
ds_read_b64_tr_b16 a[244:245], v18 offset:53248
v_mfma_f32_16x16x32_bf16 a[4:7], a[224:227], a[164:167], a[4:7]
ds_read_b64_tr_b16 a[246:247], v18 offset:55296
v_mfma_f32_16x16x32_bf16 a[8:11], a[224:227], a[168:171], a[8:11]
v_mfma_f32_16x16x32_bf16 a[8:11], a[228:231], a[184:187], a[8:11]
v_mfma_f32_16x16x32_bf16 a[12:15], a[228:231], a[188:191], a[12:15]
ds_read_b64_tr_b16 a[248:249], v19 offset:49152
v_mfma_f32_16x16x32_bf16 a[12:15], a[224:227], a[172:175], a[12:15]
s_waitcnt lgkmcnt(5)
ds_read_b64_tr_b16 a[250:251], v19 offset:51200
v_mfma_f32_16x16x32_bf16 a[16:19], a[232:235], a[160:163], a[16:19]
v_mfma_f32_16x16x32_bf16 a[16:19], a[236:239], a[176:179], a[16:19]
v_mfma_f32_16x16x32_bf16 a[20:23], a[236:239], a[180:183], a[20:23]
ds_read_b64_tr_b16 a[252:253], v19 offset:53248
v_mfma_f32_16x16x32_bf16 a[20:23], a[232:235], a[164:167], a[20:23]
ds_read_b64_tr_b16 a[254:255], v19 offset:55296
v_mfma_f32_16x16x32_bf16 a[24:27], a[232:235], a[168:171], a[24:27]
v_mfma_f32_16x16x32_bf16 a[24:27], a[236:239], a[184:187], a[24:27]
v_mfma_f32_16x16x32_bf16 a[28:31], a[236:239], a[188:191], a[28:31]
v_mfma_f32_16x16x32_bf16 a[28:31], a[232:235], a[172:175], a[28:31]
s_waitcnt vmcnt(24) lgkmcnt(0)
v_mfma_f32_16x16x32_bf16 a[32:35], a[240:243], a[160:163], a[32:35]
s_barrier
v_mfma_f32_16x16x32_bf16 a[32:35], a[244:247], a[176:179], a[32:35]
ds_read_b64_tr_b16 a[224:225], v50 offset:0
v_mfma_f32_16x16x32_bf16 a[36:39], a[244:247], a[180:183], a[36:39]
ds_read_b64_tr_b16 a[226:227], v50 offset:2048
v_mfma_f32_16x16x32_bf16 a[36:39], a[240:243], a[164:167], a[36:39]
ds_read_b64_tr_b16 a[228:229], v50 offset:4096
v_mfma_f32_16x16x32_bf16 a[40:43], a[240:243], a[168:171], a[40:43]
ds_read_b64_tr_b16 a[230:231], v50 offset:6144
v_mfma_f32_16x16x32_bf16 a[40:43], a[244:247], a[184:187], a[40:43]
ds_read_b64_tr_b16 a[232:233], v51 offset:0
v_mfma_f32_16x16x32_bf16 a[44:47], a[244:247], a[188:191], a[44:47]
ds_read_b64_tr_b16 a[234:235], v51 offset:2048
v_mfma_f32_16x16x32_bf16 a[44:47], a[240:243], a[172:175], a[44:47]
ds_read_b64_tr_b16 a[236:237], v51 offset:4096
v_mfma_f32_16x16x32_bf16 a[48:51], a[248:251], a[160:163], a[48:51]
ds_read_b64_tr_b16 a[238:239], v51 offset:6144
v_mfma_f32_16x16x32_bf16 a[48:51], a[252:255], a[176:179], a[48:51]
v_mfma_f32_16x16x32_bf16 a[52:55], a[252:255], a[180:183], a[52:55]
v_mfma_f32_16x16x32_bf16 a[52:55], a[248:251], a[164:167], a[52:55]
v_mfma_f32_16x16x32_bf16 a[56:59], a[248:251], a[168:171], a[56:59]
v_mfma_f32_16x16x32_bf16 a[56:59], a[252:255], a[184:187], a[56:59]
v_mfma_f32_16x16x32_bf16 a[60:63], a[252:255], a[188:191], a[60:63]
v_mfma_f32_16x16x32_bf16 a[60:63], a[248:251], a[172:175], a[60:63]
s_waitcnt lgkmcnt(4)
v_mfma_f32_16x16x32_bf16 a[0:3], a[224:227], a[192:195], a[0:3]
ds_read_b64_tr_b16 a[240:241], v50 offset:8192
v_mfma_f32_16x16x32_bf16 a[0:3], a[228:231], a[208:211], a[0:3]
s_mov_b32 s44, 0xbfb8aa3b
ds_read_b64_tr_b16 a[242:243], v50 offset:10240
v_mfma_f32_16x16x32_bf16 a[4:7], a[228:231], a[212:215], a[4:7]
ds_read_b64_tr_b16 a[244:245], v50 offset:12288
v_mfma_f32_16x16x32_bf16 a[4:7], a[224:227], a[196:199], a[4:7]
ds_read_b64_tr_b16 a[246:247], v50 offset:14336
v_mfma_f32_16x16x32_bf16 a[8:11], a[224:227], a[200:203], a[8:11]
ds_read_b64_tr_b16 a[248:249], v51 offset:8192
v_mfma_f32_16x16x32_bf16 a[8:11], a[228:231], a[216:219], a[8:11]
ds_read_b64_tr_b16 a[250:251], v51 offset:10240
v_mfma_f32_16x16x32_bf16 a[12:15], a[228:231], a[220:223], a[12:15]
ds_read_b64_tr_b16 a[252:253], v51 offset:12288
v_mfma_f32_16x16x32_bf16 a[12:15], a[224:227], a[204:207], a[12:15]
s_waitcnt lgkmcnt(7)
ds_read_b64_tr_b16 a[254:255], v51 offset:14336
v_mfma_f32_16x16x32_bf16 a[16:19], a[232:235], a[192:195], a[16:19]
v_mfma_f32_16x16x32_bf16 a[16:19], a[236:239], a[208:211], a[16:19]
v_mfma_f32_16x16x32_bf16 a[20:23], a[236:239], a[212:215], a[20:23]
v_mfma_f32_16x16x32_bf16 a[20:23], a[232:235], a[196:199], a[20:23]
v_mfma_f32_16x16x32_bf16 a[24:27], a[232:235], a[200:203], a[24:27]
v_mfma_f32_16x16x32_bf16 a[24:27], a[236:239], a[216:219], a[24:27]
v_mfma_f32_16x16x32_bf16 a[28:31], a[236:239], a[220:223], a[28:31]
v_mfma_f32_16x16x32_bf16 a[28:31], a[232:235], a[204:207], a[28:31]
s_waitcnt vmcnt(3) lgkmcnt(0)
v_mfma_f32_16x16x32_bf16 a[32:35], a[240:243], a[192:195], a[32:35]
s_barrier
v_mfma_f32_16x16x32_bf16 a[32:35], a[244:247], a[208:211], a[32:35]
ds_read_b64_tr_b16 a[160:161], v18 offset:0
v_mfma_f32_16x16x32_bf16 a[36:39], a[244:247], a[212:215], a[36:39]
ds_read_b64_tr_b16 a[162:163], v18 offset:2048
v_mfma_f32_16x16x32_bf16 a[36:39], a[240:243], a[196:199], a[36:39]
ds_read_b64_tr_b16 a[164:165], v18 offset:4096
v_mfma_f32_16x16x32_bf16 a[40:43], a[240:243], a[200:203], a[40:43]
ds_read_b64_tr_b16 a[166:167], v18 offset:6144
v_mfma_f32_16x16x32_bf16 a[40:43], a[244:247], a[216:219], a[40:43]
ds_read_b64_tr_b16 a[168:169], v19 offset:0
v_mfma_f32_16x16x32_bf16 a[44:47], a[244:247], a[220:223], a[44:47]
ds_read_b64_tr_b16 a[170:171], v19 offset:2048
v_mfma_f32_16x16x32_bf16 a[44:47], a[240:243], a[204:207], a[44:47]
ds_read_b64_tr_b16 a[172:173], v19 offset:4096
v_mfma_f32_16x16x32_bf16 a[48:51], a[248:251], a[192:195], a[48:51]
ds_read_b64_tr_b16 a[174:175], v19 offset:6144
v_mfma_f32_16x16x32_bf16 a[48:51], a[252:255], a[208:211], a[48:51]
ds_read_b64_tr_b16 a[176:177], v18 offset:8192
v_mfma_f32_16x16x32_bf16 a[52:55], a[252:255], a[212:215], a[52:55]
ds_read_b64_tr_b16 a[178:179], v18 offset:10240
v_mfma_f32_16x16x32_bf16 a[52:55], a[248:251], a[196:199], a[52:55]
ds_read_b64_tr_b16 a[180:181], v18 offset:12288
v_mfma_f32_16x16x32_bf16 a[56:59], a[248:251], a[200:203], a[56:59]
ds_read_b64_tr_b16 a[182:183], v18 offset:14336
v_mfma_f32_16x16x32_bf16 a[56:59], a[252:255], a[216:219], a[56:59]
s_mov_b32 s32, 0
ds_read_b64_tr_b16 a[184:185], v19 offset:8192
v_mfma_f32_16x16x32_bf16 a[60:63], a[252:255], a[220:223], a[60:63]
s_add_u32 m0, s30, 0
ds_read_b64_tr_b16 a[186:187], v19 offset:10240
v_mfma_f32_16x16x32_bf16 a[60:63], a[248:251], a[204:207], a[60:63]
s_waitcnt lgkmcnt(9)
buffer_load_dwordx4 v10, s[4:7], s32 offen offset:0 lds
v_mfma_f32_16x16x32_bf16 a[0:3], a[160:163], a[128:131], a[0:3]
ds_read_b64_tr_b16 a[188:189], v19 offset:12288
v_mfma_f32_16x16x32_bf16 a[0:3], a[164:167], a[144:147], a[0:3]
ds_read_b64_tr_b16 a[190:191], v19 offset:14336
v_mfma_f32_16x16x32_bf16 a[4:7], a[164:167], a[148:151], a[4:7]
v_mfma_f32_16x16x32_bf16 a[4:7], a[160:163], a[132:135], a[4:7]
v_mfma_f32_16x16x32_bf16 a[8:11], a[160:163], a[136:139], a[8:11]
ds_read_b64_tr_b16 a[224:225], v16 offset:0
v_mfma_f32_16x16x32_bf16 a[8:11], a[164:167], a[152:155], a[8:11]
v_mfma_f32_16x16x32_bf16 a[12:15], a[164:167], a[156:159], a[12:15]
s_add_u32 m0, s30, 3968
ds_read_b64_tr_b16 a[226:227], v16 offset:2048
v_mfma_f32_16x16x32_bf16 a[12:15], a[160:163], a[140:143], a[12:15]
s_waitcnt lgkmcnt(9)
buffer_load_dwordx4 v10, s[4:7], s32 offen offset:128 lds
v_mfma_f32_16x16x32_bf16 a[16:19], a[168:171], a[128:131], a[16:19]
ds_read_b64_tr_b16 a[228:229], v16 offset:4096
v_mfma_f32_16x16x32_bf16 a[16:19], a[172:175], a[144:147], a[16:19]
v_mfma_f32_16x16x32_bf16 a[20:23], a[172:175], a[148:151], a[20:23]
ds_read_b64_tr_b16 a[230:231], v16 offset:6144
v_mfma_f32_16x16x32_bf16 a[20:23], a[168:171], a[132:135], a[20:23]
v_mfma_f32_16x16x32_bf16 a[24:27], a[168:171], a[136:139], a[24:27]
ds_read_b64_tr_b16 a[232:233], v14 offset:0
v_mfma_f32_16x16x32_bf16 a[24:27], a[172:175], a[152:155], a[24:27]
v_mfma_f32_16x16x32_bf16 a[28:31], a[172:175], a[156:159], a[28:31]
s_add_u32 m0, s30, 7936
ds_read_b64_tr_b16 a[234:235], v14 offset:2048
v_mfma_f32_16x16x32_bf16 a[28:31], a[168:171], a[140:143], a[28:31]
s_waitcnt lgkmcnt(9)
buffer_load_dwordx4 v10, s[4:7], s32 offen offset:256 lds
v_mfma_f32_16x16x32_bf16 a[32:35], a[176:179], a[128:131], a[32:35]
ds_read_b64_tr_b16 a[236:237], v14 offset:4096
v_mfma_f32_16x16x32_bf16 a[32:35], a[180:183], a[144:147], a[32:35]
v_mfma_f32_16x16x32_bf16 a[36:39], a[180:183], a[148:151], a[36:39]
ds_read_b64_tr_b16 a[238:239], v14 offset:6144
v_mfma_f32_16x16x32_bf16 a[36:39], a[176:179], a[132:135], a[36:39]
v_mfma_f32_16x16x32_bf16 a[40:43], a[176:179], a[136:139], a[40:43]
ds_read_b64_tr_b16 a[240:241], v16 offset:8
v_mfma_f32_16x16x32_bf16 a[40:43], a[180:183], a[152:155], a[40:43]
s_mov_b32 s32, 12288
v_mfma_f32_16x16x32_bf16 a[44:47], a[180:183], a[156:159], a[44:47]
s_add_u32 m0, s30, 12288
ds_read_b64_tr_b16 a[242:243], v16 offset:2056
v_mfma_f32_16x16x32_bf16 a[44:47], a[176:179], a[140:143], a[44:47]
s_waitcnt lgkmcnt(9)
buffer_load_dwordx4 v10, s[4:7], s32 offen offset:0 lds
v_mfma_f32_16x16x32_bf16 a[48:51], a[184:187], a[128:131], a[48:51]
ds_read_b64_tr_b16 a[244:245], v16 offset:4104
v_mfma_f32_16x16x32_bf16 a[48:51], a[188:191], a[144:147], a[48:51]
v_mfma_f32_16x16x32_bf16 a[52:55], a[188:191], a[148:151], a[52:55]
ds_read_b64_tr_b16 a[246:247], v16 offset:6152
v_mfma_f32_16x16x32_bf16 a[52:55], a[184:187], a[132:135], a[52:55]
v_mfma_f32_16x16x32_bf16 a[56:59], a[184:187], a[136:139], a[56:59]
ds_read_b64_tr_b16 a[248:249], v14 offset:8
v_mfma_f32_16x16x32_bf16 a[56:59], a[188:191], a[152:155], a[56:59]
v_mfma_f32_16x16x32_bf16 a[60:63], a[188:191], a[156:159], a[60:63]
s_add_u32 m0, s30, 16256
ds_read_b64_tr_b16 a[250:251], v14 offset:2056
v_mfma_f32_16x16x32_bf16 a[60:63], a[184:187], a[140:143], a[60:63]
s_waitcnt lgkmcnt(6)
buffer_load_dwordx4 v10, s[4:7], s32 offen offset:128 lds
v_mfma_f32_16x16x32_bf16 v[64:67], a[224:227], a[192:195], v[64:67]
ds_read_b64_tr_b16 a[252:253], v14 offset:4104
v_mfma_f32_16x16x32_bf16 v[64:67], a[228:231], a[208:211], v[64:67]
v_mfma_f32_16x16x32_bf16 v[64:67], a[232:235], a[128:131], v[64:67]
ds_read_b64_tr_b16 a[254:255], v14 offset:6152
v_mfma_f32_16x16x32_bf16 v[64:67], a[236:239], a[144:147], v[64:67]
v_mfma_f32_16x16x32_bf16 v[68:71], a[236:239], a[148:151], v[68:71]
ds_read_b64_tr_b16 a[160:161], v17 offset:0
v_mfma_f32_16x16x32_bf16 v[68:71], a[232:235], a[132:135], v[68:71]
v_mfma_f32_16x16x32_bf16 v[68:71], a[228:231], a[212:215], v[68:71]
s_add_u32 m0, s30, 20224
ds_read_b64_tr_b16 a[162:163], v17 offset:2048
v_accvgpr_read_b32 v28, a0
v_mfma_f32_16x16x32_bf16 v[68:71], a[224:227], a[196:199], v[68:71]
buffer_load_dwordx4 v10, s[4:7], s32 offen offset:256 lds
v_accvgpr_read_b32 v29, a1
v_mfma_f32_16x16x32_bf16 v[72:75], a[224:227], a[200:203], v[72:75]
ds_read_b64_tr_b16 a[164:165], v17 offset:4096
v_accvgpr_read_b32 v30, a2
v_mfma_f32_16x16x32_bf16 v[72:75], a[228:231], a[216:219], v[72:75]
v_accvgpr_read_b32 v31, a3
v_mul_f32 v36, s44, v28
v_mfma_f32_16x16x32_bf16 v[72:75], a[232:235], a[136:139], v[72:75]
ds_read_b64_tr_b16 a[166:167], v17 offset:6144
v_mul_f32 v37, s44, v29
v_mfma_f32_16x16x32_bf16 v[72:75], a[236:239], a[152:155], v[72:75]
v_mul_f32 v38, s44, v30
v_mul_f32 v39, s44, v31
v_mfma_f32_16x16x32_bf16 v[76:79], a[236:239], a[156:159], v[76:79]
ds_read_b64_tr_b16 a[168:169], v15 offset:0
v_accvgpr_read_b32 v44, a16
v_mfma_f32_16x16x32_bf16 v[76:79], a[232:235], a[140:143], v[76:79]
s_mov_b32 s32, 24576
v_exp_f32 v36, v36
v_mfma_f32_16x16x32_bf16 v[76:79], a[228:231], a[220:223], v[76:79]
s_add_u32 m0, s30, 24576
ds_read_b64_tr_b16 a[170:171], v15 offset:2048
v_accvgpr_read_b32 v45, a17
v_mfma_f32_16x16x32_bf16 v[76:79], a[224:227], a[204:207], v[76:79]
s_waitcnt lgkmcnt(6)
buffer_load_dwordx4 v10, s[4:7], s32 offen offset:0 lds
v_accvgpr_read_b32 v46, a18
v_mfma_f32_16x16x32_bf16 v[80:83], a[240:243], a[192:195], v[80:83]
ds_read_b64_tr_b16 a[172:173], v15 offset:4096
v_accvgpr_read_b32 v47, a19
v_mfma_f32_16x16x32_bf16 v[80:83], a[244:247], a[208:211], v[80:83]
v_exp_f32 v37, v37
v_mfma_f32_16x16x32_bf16 v[80:83], a[248:251], a[128:131], v[80:83]
ds_read_b64_tr_b16 a[174:175], v15 offset:6144
v_mul_f32 v52, s44, v44
v_mfma_f32_16x16x32_bf16 v[80:83], a[252:255], a[144:147], v[80:83]
v_exp_f32 v38, v38
v_mfma_f32_16x16x32_bf16 v[84:87], a[252:255], a[148:151], v[84:87]
ds_read_b64_tr_b16 a[176:177], v17 offset:8
v_mul_f32 v53, s44, v45
v_mfma_f32_16x16x32_bf16 v[84:87], a[248:251], a[132:135], v[84:87]
v_exp_f32 v39, v39
v_mfma_f32_16x16x32_bf16 v[84:87], a[244:247], a[212:215], v[84:87]
s_add_u32 m0, s30, 28544
ds_read_b64_tr_b16 a[178:179], v17 offset:2056
v_accvgpr_read_b32 v32, a32
v_mfma_f32_16x16x32_bf16 v[84:87], a[240:243], a[196:199], v[84:87]
buffer_load_dwordx4 v10, s[4:7], s32 offen offset:128 lds
v_accvgpr_read_b32 v33, a33
v_mfma_f32_16x16x32_bf16 v[88:91], a[240:243], a[200:203], v[88:91]
ds_read_b64_tr_b16 a[180:181], v17 offset:4104
v_accvgpr_read_b32 v34, a34
v_mfma_f32_16x16x32_bf16 v[88:91], a[244:247], a[216:219], v[88:91]
v_mul_f32 v54, s44, v46
v_accvgpr_read_b32 v35, a35
v_mfma_f32_16x16x32_bf16 v[88:91], a[248:251], a[136:139], v[88:91]
ds_read_b64_tr_b16 a[182:183], v17 offset:6152
v_mul_f32 v55, s44, v47
v_mfma_f32_16x16x32_bf16 v[88:91], a[252:255], a[152:155], v[88:91]
v_exp_f32 v52, v52
v_mfma_f32_16x16x32_bf16 v[92:95], a[252:255], a[156:159], v[92:95]
ds_read_b64_tr_b16 a[184:185], v15 offset:8
v_add_f32 v36, 1.0, v36
v_mfma_f32_16x16x32_bf16 v[92:95], a[248:251], a[140:143], v[92:95]
v_exp_f32 v53, v53
v_mfma_f32_16x16x32_bf16 v[92:95], a[244:247], a[220:223], v[92:95]
s_add_u32 m0, s30, 32512
ds_read_b64_tr_b16 a[186:187], v15 offset:2056
v_add_f32 v37, 1.0, v37
v_mfma_f32_16x16x32_bf16 v[92:95], a[240:243], a[204:207], v[92:95]
s_waitcnt lgkmcnt(6)
buffer_load_dwordx4 v10, s[4:7], s32 offen offset:256 lds
v_add_f32 v38, 1.0, v38
v_mfma_f32_16x16x32_bf16 v[96:99], a[160:163], a[192:195], v[96:99]
ds_read_b64_tr_b16 a[188:189], v15 offset:4104
v_add_f32 v39, 1.0, v39
v_mfma_f32_16x16x32_bf16 v[96:99], a[164:167], a[208:211], v[96:99]
v_exp_f32 v54, v54
v_mfma_f32_16x16x32_bf16 v[96:99], a[168:171], a[128:131], v[96:99]
ds_read_b64_tr_b16 a[190:191], v15 offset:6152
v_mfma_f32_16x16x32_bf16 v[96:99], a[172:175], a[144:147], v[96:99]
v_exp_f32 v55, v55
v_mfma_f32_16x16x32_bf16 v[100:103], a[172:175], a[148:151], v[100:103]
ds_read_b64_tr_b16 a[224:225], v16 offset:8192
v_accvgpr_read_b32 v48, a48
v_mfma_f32_16x16x32_bf16 v[100:103], a[168:171], a[132:135], v[100:103]
s_mov_b32 s32, 36864
v_rcp_f32 v36, v36
v_mfma_f32_16x16x32_bf16 v[100:103], a[164:167], a[212:215], v[100:103]
s_add_u32 m0, s30, 36864
ds_read_b64_tr_b16 a[226:227], v16 offset:10240
v_accvgpr_read_b32 v49, a49
v_mfma_f32_16x16x32_bf16 v[100:103], a[160:163], a[196:199], v[100:103]
buffer_load_dwordx4 v10, s[4:7], s32 offen offset:0 lds
v_accvgpr_read_b32 v50, a50
v_mfma_f32_16x16x32_bf16 v[104:107], a[160:163], a[200:203], v[104:107]
ds_read_b64_tr_b16 a[228:229], v16 offset:12288
v_accvgpr_read_b32 v51, a51
v_mfma_f32_16x16x32_bf16 v[104:107], a[164:167], a[216:219], v[104:107]
v_rcp_f32 v37, v37
v_mfma_f32_16x16x32_bf16 v[104:107], a[168:171], a[136:139], v[104:107]
ds_read_b64_tr_b16 a[230:231], v16 offset:14336
v_add_f32 v52, 1.0, v52
v_mfma_f32_16x16x32_bf16 v[104:107], a[172:175], a[152:155], v[104:107]
v_rcp_f32 v38, v38
v_mfma_f32_16x16x32_bf16 v[108:111], a[172:175], a[156:159], v[108:111]
ds_read_b64_tr_b16 a[232:233], v14 offset:8192
v_add_f32 v53, 1.0, v53
v_mfma_f32_16x16x32_bf16 v[108:111], a[168:171], a[140:143], v[108:111]
v_rcp_f32 v39, v39
v_mfma_f32_16x16x32_bf16 v[108:111], a[164:167], a[220:223], v[108:111]
s_add_u32 m0, s30, 40832
ds_read_b64_tr_b16 a[234:235], v14 offset:10240
v_mul_f32 v28, v28, v32
v_mfma_f32_16x16x32_bf16 v[108:111], a[160:163], a[204:207], v[108:111]
s_waitcnt lgkmcnt(6)
buffer_load_dwordx4 v10, s[4:7], s32 offen offset:128 lds
v_mul_f32 v29, v29, v33
v_mfma_f32_16x16x32_bf16 v[112:115], a[176:179], a[192:195], v[112:115]
ds_read_b64_tr_b16 a[236:237], v14 offset:12288
v_mul_f32 v30, v30, v34
v_mfma_f32_16x16x32_bf16 v[112:115], a[180:183], a[208:211], v[112:115]
v_add_f32 v54, 1.0, v54
v_mul_f32 v31, v31, v35
v_mfma_f32_16x16x32_bf16 v[112:115], a[184:187], a[128:131], v[112:115]
ds_read_b64_tr_b16 a[238:239], v14 offset:14336
v_add_f32 v55, 1.0, v55
v_mfma_f32_16x16x32_bf16 v[112:115], a[188:191], a[144:147], v[112:115]
v_rcp_f32 v52, v52
v_mfma_f32_16x16x32_bf16 v[116:119], a[188:191], a[148:151], v[116:119]
ds_read_b64_tr_b16 a[240:241], v16 offset:8200
v_mul_f32 v28, v28, v36
v_mfma_f32_16x16x32_bf16 v[116:119], a[184:187], a[132:135], v[116:119]
v_rcp_f32 v53, v53
v_mfma_f32_16x16x32_bf16 v[116:119], a[180:183], a[212:215], v[116:119]
s_add_u32 m0, s30, 44800
ds_read_b64_tr_b16 a[242:243], v16 offset:10248
v_mul_f32 v29, v29, v37
v_mfma_f32_16x16x32_bf16 v[116:119], a[176:179], a[196:199], v[116:119]
buffer_load_dwordx4 v10, s[4:7], s32 offen offset:256 lds
v_mul_f32 v30, v30, v38
v_mfma_f32_16x16x32_bf16 v[120:123], a[176:179], a[200:203], v[120:123]
ds_read_b64_tr_b16 a[244:245], v16 offset:12296
v_mul_f32 v31, v31, v39
v_mfma_f32_16x16x32_bf16 v[120:123], a[180:183], a[216:219], v[120:123]
v_rcp_f32 v54, v54
v_mfma_f32_16x16x32_bf16 v[120:123], a[184:187], a[136:139], v[120:123]
ds_read_b64_tr_b16 a[246:247], v16 offset:14344
v_cvt_pk_bf16_f32 v56, v28, v29
v_mfma_f32_16x16x32_bf16 v[120:123], a[188:191], a[152:155], v[120:123]
v_rcp_f32 v55, v55
v_mfma_f32_16x16x32_bf16 v[124:127], a[188:191], a[156:159], v[124:127]
ds_read_b64_tr_b16 a[248:249], v14 offset:8200
v_mul_f32 v44, v44, v48
v_mfma_f32_16x16x32_bf16 v[124:127], a[184:187], a[140:143], v[124:127]
s_mov_b32 s33, 0
v_cvt_pk_bf16_f32 v57, v30, v31
v_mul_f32 v45, v45, v49
v_mfma_f32_16x16x32_bf16 v[124:127], a[180:183], a[220:223], v[124:127]
s_add_u32 m0, s31, 0
ds_read_b64_tr_b16 a[250:251], v14 offset:10248
v_mul_f32 v46, v46, v50
v_mfma_f32_16x16x32_bf16 v[124:127], a[176:179], a[204:207], v[124:127]
s_waitcnt lgkmcnt(6)
buffer_load_dwordx4 v11, s[8:11], s33 offen offset:0 lds
v_mul_f32 v47, v47, v51
v_mfma_f32_16x16x32_bf16 v[128:131], a[224:227], a[192:195], v[128:131]
ds_read_b64_tr_b16 a[252:253], v14 offset:12296
v_mul_f32 v44, v44, v52
v_mfma_f32_16x16x32_bf16 v[128:131], a[228:231], a[208:211], v[128:131]
v_mul_f32 v45, v45, v53
v_mul_f32 v46, v46, v54
v_mfma_f32_16x16x32_bf16 v[128:131], a[232:235], a[128:131], v[128:131]
ds_read_b64_tr_b16 a[254:255], v14 offset:14344
v_mul_f32 v47, v47, v55
v_mfma_f32_16x16x32_bf16 v[128:131], a[236:239], a[144:147], v[128:131]
v_cvt_pk_bf16_f32 v58, v44, v45
v_cvt_pk_bf16_f32 v59, v46, v47
v_mfma_f32_16x16x32_bf16 v[132:135], a[236:239], a[148:151], v[132:135]
ds_read_b64_tr_b16 a[160:161], v17 offset:8192
v_accvgpr_read_b32 v28, a4
v_mfma_f32_16x16x32_bf16 v[132:135], a[232:235], a[132:135], v[132:135]
s_xor_b32 s42, s64, 0
buffer_store_dwordx4 v[56:59], v3, s[24:27], s42 offen sc1
v_accvgpr_read_b32 v29, a5
v_mfma_f32_16x16x32_bf16 v[132:135], a[228:231], a[212:215], v[132:135]
s_add_u32 m0, s31, 4096
ds_read_b64_tr_b16 a[162:163], v17 offset:10240
v_accvgpr_read_b32 v30, a6
v_mfma_f32_16x16x32_bf16 v[132:135], a[224:227], a[196:199], v[132:135]
buffer_load_dwordx4 v23, s[8:11], s33 offen offset:0 lds
v_accvgpr_read_b32 v31, a7
v_mfma_f32_16x16x32_bf16 v[136:139], a[224:227], a[200:203], v[136:139]
ds_read_b64_tr_b16 a[164:165], v17 offset:12288
v_mul_f32 v36, s44, v28
v_mfma_f32_16x16x32_bf16 v[136:139], a[228:231], a[216:219], v[136:139]
v_mul_f32 v37, s44, v29
v_mul_f32 v38, s44, v30
v_mfma_f32_16x16x32_bf16 v[136:139], a[232:235], a[136:139], v[136:139]
ds_read_b64_tr_b16 a[166:167], v17 offset:14336
v_mul_f32 v39, s44, v31
v_mfma_f32_16x16x32_bf16 v[136:139], a[236:239], a[152:155], v[136:139]
v_exp_f32 v36, v36
v_mfma_f32_16x16x32_bf16 v[140:143], a[236:239], a[156:159], v[140:143]
ds_read_b64_tr_b16 a[168:169], v15 offset:8192
v_accvgpr_read_b32 v44, a20
v_mfma_f32_16x16x32_bf16 v[140:143], a[232:235], a[140:143], v[140:143]
v_exp_f32 v37, v37
v_mfma_f32_16x16x32_bf16 v[140:143], a[228:231], a[220:223], v[140:143]
s_add_u32 m0, s31, 8064
ds_read_b64_tr_b16 a[170:171], v15 offset:10240
v_accvgpr_read_b32 v45, a21
v_mfma_f32_16x16x32_bf16 v[140:143], a[224:227], a[204:207], v[140:143]
s_waitcnt lgkmcnt(6)
buffer_load_dwordx4 v11, s[8:11], s33 offen offset:128 lds
v_accvgpr_read_b32 v46, a22
v_mfma_f32_16x16x32_bf16 v[144:147], a[240:243], a[192:195], v[144:147]
ds_read_b64_tr_b16 a[172:173], v15 offset:12288
v_accvgpr_read_b32 v47, a23
v_mfma_f32_16x16x32_bf16 v[144:147], a[244:247], a[208:211], v[144:147]
v_exp_f32 v38, v38
v_mfma_f32_16x16x32_bf16 v[144:147], a[248:251], a[128:131], v[144:147]
ds_read_b64_tr_b16 a[174:175], v15 offset:14336
v_mul_f32 v52, s44, v44
v_mfma_f32_16x16x32_bf16 v[144:147], a[252:255], a[144:147], v[144:147]
v_exp_f32 v39, v39
v_mfma_f32_16x16x32_bf16 v[148:151], a[252:255], a[148:151], v[148:151]
ds_read_b64_tr_b16 a[176:177], v17 offset:8200
v_accvgpr_read_b32 v32, a36
v_mfma_f32_16x16x32_bf16 v[148:151], a[248:251], a[132:135], v[148:151]
v_accvgpr_read_b32 v33, a37
v_mul_f32 v53, s44, v45
v_mfma_f32_16x16x32_bf16 v[148:151], a[244:247], a[212:215], v[148:151]
s_add_u32 m0, s31, 12160
ds_read_b64_tr_b16 a[178:179], v17 offset:10248
v_accvgpr_read_b32 v34, a38
v_mfma_f32_16x16x32_bf16 v[148:151], a[240:243], a[196:199], v[148:151]
buffer_load_dwordx4 v23, s[8:11], s33 offen offset:128 lds
v_mul_f32 v54, s44, v46
v_mfma_f32_16x16x32_bf16 v[152:155], a[240:243], a[200:203], v[152:155]
ds_read_b64_tr_b16 a[180:181], v17 offset:12296
v_accvgpr_read_b32 v35, a39
v_mfma_f32_16x16x32_bf16 v[152:155], a[244:247], a[216:219], v[152:155]
v_mul_f32 v55, s44, v47
v_add_f32 v36, 1.0, v36
v_mfma_f32_16x16x32_bf16 v[152:155], a[248:251], a[136:139], v[152:155]
ds_read_b64_tr_b16 a[182:183], v17 offset:14344
v_add_f32 v37, 1.0, v37
v_mfma_f32_16x16x32_bf16 v[152:155], a[252:255], a[152:155], v[152:155]
v_exp_f32 v52, v52
v_mfma_f32_16x16x32_bf16 v[156:159], a[252:255], a[156:159], v[156:159]
ds_read_b64_tr_b16 a[184:185], v15 offset:8200
v_add_f32 v38, 1.0, v38
v_mfma_f32_16x16x32_bf16 v[156:159], a[248:251], a[140:143], v[156:159]
v_exp_f32 v53, v53
v_mfma_f32_16x16x32_bf16 v[156:159], a[244:247], a[220:223], v[156:159]
ds_read_b64_tr_b16 a[186:187], v15 offset:10248
v_add_f32 v39, 1.0, v39
v_mfma_f32_16x16x32_bf16 v[156:159], a[240:243], a[204:207], v[156:159]
s_waitcnt lgkmcnt(6)
v_exp_f32 v54, v54
v_mfma_f32_16x16x32_bf16 v[160:163], a[160:163], a[192:195], v[160:163]
ds_read_b64_tr_b16 a[188:189], v15 offset:12296
v_mfma_f32_16x16x32_bf16 v[160:163], a[164:167], a[208:211], v[160:163]
v_exp_f32 v55, v55
v_mfma_f32_16x16x32_bf16 v[160:163], a[168:171], a[128:131], v[160:163]
ds_read_b64_tr_b16 a[190:191], v15 offset:14344
v_accvgpr_read_b32 v48, a52
v_mfma_f32_16x16x32_bf16 v[160:163], a[172:175], a[144:147], v[160:163]
v_rcp_f32 v36, v36
v_mfma_f32_16x16x32_bf16 v[164:167], a[172:175], a[148:151], v[164:167]
ds_read_b64_tr_b16 a[224:225], v16 offset:16384
v_accvgpr_read_b32 v49, a53
v_mfma_f32_16x16x32_bf16 v[164:167], a[168:171], a[132:135], v[164:167]
v_rcp_f32 v37, v37
v_mfma_f32_16x16x32_bf16 v[164:167], a[164:167], a[212:215], v[164:167]
ds_read_b64_tr_b16 a[226:227], v16 offset:18432
v_accvgpr_read_b32 v50, a54
v_mfma_f32_16x16x32_bf16 v[164:167], a[160:163], a[196:199], v[164:167]
v_rcp_f32 v38, v38
v_mfma_f32_16x16x32_bf16 v[168:171], a[160:163], a[200:203], v[168:171]
ds_read_b64_tr_b16 a[228:229], v16 offset:20480
v_accvgpr_read_b32 v51, a55
v_mfma_f32_16x16x32_bf16 v[168:171], a[164:167], a[216:219], v[168:171]
v_rcp_f32 v39, v39
v_mfma_f32_16x16x32_bf16 v[168:171], a[168:171], a[136:139], v[168:171]
ds_read_b64_tr_b16 a[230:231], v16 offset:22528
v_mul_f32 v28, v28, v32
v_mfma_f32_16x16x32_bf16 v[168:171], a[172:175], a[152:155], v[168:171]
v_add_f32 v52, 1.0, v52
v_mul_f32 v29, v29, v33
v_mfma_f32_16x16x32_bf16 v[172:175], a[172:175], a[156:159], v[172:175]
ds_read_b64_tr_b16 a[232:233], v14 offset:16384
v_add_f32 v53, 1.0, v53
v_mfma_f32_16x16x32_bf16 v[172:175], a[168:171], a[140:143], v[172:175]
v_mul_f32 v30, v30, v34
v_add_f32 v54, 1.0, v54
v_mfma_f32_16x16x32_bf16 v[172:175], a[164:167], a[220:223], v[172:175]
ds_read_b64_tr_b16 a[234:235], v14 offset:18432
v_mul_f32 v31, v31, v35
v_mfma_f32_16x16x32_bf16 v[172:175], a[160:163], a[204:207], v[172:175]
s_waitcnt lgkmcnt(6)
v_add_f32 v55, 1.0, v55
v_mul_f32 v28, v28, v36
v_mfma_f32_16x16x32_bf16 v[176:179], a[176:179], a[192:195], v[176:179]
ds_read_b64_tr_b16 a[236:237], v14 offset:20480
v_mul_f32 v29, v29, v37
v_mfma_f32_16x16x32_bf16 v[176:179], a[180:183], a[208:211], v[176:179]
v_rcp_f32 v52, v52
v_mfma_f32_16x16x32_bf16 v[176:179], a[184:187], a[128:131], v[176:179]
ds_read_b64_tr_b16 a[238:239], v14 offset:22528
v_mul_f32 v30, v30, v38
v_mfma_f32_16x16x32_bf16 v[176:179], a[188:191], a[144:147], v[176:179]
v_rcp_f32 v53, v53
v_mfma_f32_16x16x32_bf16 v[180:183], a[188:191], a[148:151], v[180:183]
ds_read_b64_tr_b16 a[240:241], v16 offset:16392
v_mul_f32 v31, v31, v39
v_mfma_f32_16x16x32_bf16 v[180:183], a[184:187], a[132:135], v[180:183]
v_rcp_f32 v54, v54
v_mfma_f32_16x16x32_bf16 v[180:183], a[180:183], a[212:215], v[180:183]
ds_read_b64_tr_b16 a[242:243], v16 offset:18440
v_cvt_pk_bf16_f32 v40, v28, v29
v_mfma_f32_16x16x32_bf16 v[180:183], a[176:179], a[196:199], v[180:183]
v_rcp_f32 v55, v55
v_mfma_f32_16x16x32_bf16 v[184:187], a[176:179], a[200:203], v[184:187]
ds_read_b64_tr_b16 a[244:245], v16 offset:20488
v_mul_f32 v44, v44, v48
v_mfma_f32_16x16x32_bf16 v[184:187], a[180:183], a[216:219], v[184:187]
v_cvt_pk_bf16_f32 v41, v30, v31
v_mul_f32 v45, v45, v49
v_mfma_f32_16x16x32_bf16 v[184:187], a[184:187], a[136:139], v[184:187]
ds_read_b64_tr_b16 a[246:247], v16 offset:22536
v_mul_f32 v46, v46, v50
v_mfma_f32_16x16x32_bf16 v[184:187], a[188:191], a[152:155], v[184:187]
v_mul_f32 v47, v47, v51
v_mul_f32 v44, v44, v52
v_mfma_f32_16x16x32_bf16 v[188:191], a[188:191], a[156:159], v[188:191]
ds_read_b64_tr_b16 a[248:249], v14 offset:16392
v_mul_f32 v45, v45, v53
v_mfma_f32_16x16x32_bf16 v[188:191], a[184:187], a[140:143], v[188:191]
v_mul_f32 v46, v46, v54
v_mul_f32 v47, v47, v55
v_mfma_f32_16x16x32_bf16 v[188:191], a[180:183], a[220:223], v[188:191]
ds_read_b64_tr_b16 a[250:251], v14 offset:18440
v_cvt_pk_bf16_f32 v42, v44, v45
v_mfma_f32_16x16x32_bf16 v[188:191], a[176:179], a[204:207], v[188:191]
s_waitcnt lgkmcnt(6)
v_cvt_pk_bf16_f32 v43, v46, v47
v_accvgpr_read_b32 v28, a8
v_mfma_f32_16x16x32_bf16 v[192:195], a[224:227], a[192:195], v[192:195]
ds_read_b64_tr_b16 a[252:253], v14 offset:20488
v_accvgpr_read_b32 v29, a9
v_mfma_f32_16x16x32_bf16 v[192:195], a[228:231], a[208:211], v[192:195]
s_xor_b32 s42, s64, 1024
buffer_store_dwordx4 v[40:43], v3, s[24:27], s42 offen sc1
v_accvgpr_read_b32 v30, a10
v_mfma_f32_16x16x32_bf16 v[192:195], a[232:235], a[128:131], v[192:195]
ds_read_b64_tr_b16 a[254:255], v14 offset:22536
v_accvgpr_read_b32 v31, a11
v_mfma_f32_16x16x32_bf16 v[192:195], a[236:239], a[144:147], v[192:195]
v_mul_f32 v36, s44, v28
v_mul_f32 v37, s44, v29
v_mfma_f32_16x16x32_bf16 v[196:199], a[236:239], a[148:151], v[196:199]
ds_read_b64_tr_b16 a[160:161], v17 offset:16384
v_mul_f32 v38, s44, v30
v_mfma_f32_16x16x32_bf16 v[196:199], a[232:235], a[132:135], v[196:199]
v_mul_f32 v39, s44, v31
v_accvgpr_read_b32 v44, a24
v_mfma_f32_16x16x32_bf16 v[196:199], a[228:231], a[212:215], v[196:199]
ds_read_b64_tr_b16 a[162:163], v17 offset:18432
v_accvgpr_read_b32 v45, a25
v_mfma_f32_16x16x32_bf16 v[196:199], a[224:227], a[196:199], v[196:199]
v_exp_f32 v36, v36
v_mfma_f32_16x16x32_bf16 v[200:203], a[224:227], a[200:203], v[200:203]
ds_read_b64_tr_b16 a[164:165], v17 offset:20480
v_accvgpr_read_b32 v46, a26
v_mfma_f32_16x16x32_bf16 v[200:203], a[228:231], a[216:219], v[200:203]
v_exp_f32 v37, v37
v_mfma_f32_16x16x32_bf16 v[200:203], a[232:235], a[136:139], v[200:203]
ds_read_b64_tr_b16 a[166:167], v17 offset:22528
v_accvgpr_read_b32 v47, a27
v_mfma_f32_16x16x32_bf16 v[200:203], a[236:239], a[152:155], v[200:203]
v_exp_f32 v38, v38
v_mfma_f32_16x16x32_bf16 v[204:207], a[236:239], a[156:159], v[204:207]
ds_read_b64_tr_b16 a[168:169], v15 offset:16384
v_mul_f32 v52, s44, v44
v_mfma_f32_16x16x32_bf16 v[204:207], a[232:235], a[140:143], v[204:207]
v_exp_f32 v39, v39
v_mfma_f32_16x16x32_bf16 v[204:207], a[228:231], a[220:223], v[204:207]
ds_read_b64_tr_b16 a[170:171], v15 offset:18432
v_accvgpr_read_b32 v32, a40
v_mfma_f32_16x16x32_bf16 v[204:207], a[224:227], a[204:207], v[204:207]
s_waitcnt lgkmcnt(6)
v_accvgpr_read_b32 v33, a41
v_mul_f32 v53, s44, v45
v_mfma_f32_16x16x32_bf16 v[208:211], a[240:243], a[192:195], v[208:211]
ds_read_b64_tr_b16 a[172:173], v15 offset:20480
v_accvgpr_read_b32 v34, a42
v_mfma_f32_16x16x32_bf16 v[208:211], a[244:247], a[208:211], v[208:211]
v_mul_f32 v54, s44, v46
v_accvgpr_read_b32 v35, a43
v_mfma_f32_16x16x32_bf16 v[208:211], a[248:251], a[128:131], v[208:211]
ds_read_b64_tr_b16 a[174:175], v15 offset:22528
v_mul_f32 v55, s44, v47
v_mfma_f32_16x16x32_bf16 v[208:211], a[252:255], a[144:147], v[208:211]
v_exp_f32 v52, v52
v_mfma_f32_16x16x32_bf16 v[212:215], a[252:255], a[148:151], v[212:215]
ds_read_b64_tr_b16 a[176:177], v17 offset:16392
v_add_f32 v36, 1.0, v36
v_mfma_f32_16x16x32_bf16 v[212:215], a[248:251], a[132:135], v[212:215]
v_exp_f32 v53, v53
v_mfma_f32_16x16x32_bf16 v[212:215], a[244:247], a[212:215], v[212:215]
ds_read_b64_tr_b16 a[178:179], v17 offset:18440
v_add_f32 v37, 1.0, v37
v_mfma_f32_16x16x32_bf16 v[212:215], a[240:243], a[196:199], v[212:215]
v_exp_f32 v54, v54
v_mfma_f32_16x16x32_bf16 v[216:219], a[240:243], a[200:203], v[216:219]
ds_read_b64_tr_b16 a[180:181], v17 offset:20488
v_add_f32 v38, 1.0, v38
v_mfma_f32_16x16x32_bf16 v[216:219], a[244:247], a[216:219], v[216:219]
v_exp_f32 v55, v55
v_mfma_f32_16x16x32_bf16 v[216:219], a[248:251], a[136:139], v[216:219]
ds_read_b64_tr_b16 a[182:183], v17 offset:22536
v_add_f32 v39, 1.0, v39
v_mfma_f32_16x16x32_bf16 v[216:219], a[252:255], a[152:155], v[216:219]
v_rcp_f32 v36, v36
v_mfma_f32_16x16x32_bf16 v[220:223], a[252:255], a[156:159], v[220:223]
ds_read_b64_tr_b16 a[184:185], v15 offset:16392
v_accvgpr_read_b32 v48, a56
v_mfma_f32_16x16x32_bf16 v[220:223], a[248:251], a[140:143], v[220:223]
v_rcp_f32 v37, v37
v_mfma_f32_16x16x32_bf16 v[220:223], a[244:247], a[220:223], v[220:223]
ds_read_b64_tr_b16 a[186:187], v15 offset:18440
v_accvgpr_read_b32 v49, a57
v_mfma_f32_16x16x32_bf16 v[220:223], a[240:243], a[204:207], v[220:223]
s_waitcnt lgkmcnt(6)
v_rcp_f32 v38, v38
v_mfma_f32_16x16x32_bf16 v[224:227], a[160:163], a[192:195], v[224:227]
ds_read_b64_tr_b16 a[188:189], v15 offset:20488
v_accvgpr_read_b32 v50, a58
v_mfma_f32_16x16x32_bf16 v[224:227], a[164:167], a[208:211], v[224:227]
v_rcp_f32 v39, v39
v_mfma_f32_16x16x32_bf16 v[224:227], a[168:171], a[128:131], v[224:227]
ds_read_b64_tr_b16 a[190:191], v15 offset:22536
v_accvgpr_read_b32 v51, a59
v_mfma_f32_16x16x32_bf16 v[224:227], a[172:175], a[144:147], v[224:227]
v_mul_f32 v28, v28, v32
v_add_f32 v52, 1.0, v52
v_mfma_f32_16x16x32_bf16 v[228:231], a[172:175], a[148:151], v[228:231]
v_mul_f32 v29, v29, v33
v_add_f32 v53, 1.0, v53
v_mfma_f32_16x16x32_bf16 v[228:231], a[168:171], a[132:135], v[228:231]
v_mul_f32 v30, v30, v34
v_add_f32 v54, 1.0, v54
v_mfma_f32_16x16x32_bf16 v[228:231], a[164:167], a[212:215], v[228:231]
v_mul_f32 v31, v31, v35
v_add_f32 v55, 1.0, v55
v_mfma_f32_16x16x32_bf16 v[228:231], a[160:163], a[196:199], v[228:231]
v_rcp_f32 v52, v52
v_mfma_f32_16x16x32_bf16 v[232:235], a[160:163], a[200:203], v[232:235]
v_rcp_f32 v53, v53
v_mfma_f32_16x16x32_bf16 v[232:235], a[164:167], a[216:219], v[232:235]
v_rcp_f32 v54, v54
v_mfma_f32_16x16x32_bf16 v[232:235], a[168:171], a[136:139], v[232:235]
v_rcp_f32 v55, v55
v_mfma_f32_16x16x32_bf16 v[232:235], a[172:175], a[152:155], v[232:235]
v_mul_f32 v28, v28, v36
v_mul_f32 v29, v29, v37
v_mfma_f32_16x16x32_bf16 v[236:239], a[172:175], a[156:159], v[236:239]
v_mul_f32 v30, v30, v38
v_mul_f32 v31, v31, v39
v_mfma_f32_16x16x32_bf16 v[236:239], a[168:171], a[140:143], v[236:239]
v_cvt_pk_bf16_f32 v56, v28, v29
v_mul_f32 v44, v44, v48
v_mfma_f32_16x16x32_bf16 v[236:239], a[164:167], a[220:223], v[236:239]
v_cvt_pk_bf16_f32 v57, v30, v31
v_mul_f32 v45, v45, v49
v_mfma_f32_16x16x32_bf16 v[236:239], a[160:163], a[204:207], v[236:239]
s_waitcnt lgkmcnt(0)
v_mul_f32 v46, v46, v50
v_mul_f32 v47, v47, v51
v_mfma_f32_16x16x32_bf16 v[240:243], a[176:179], a[192:195], v[240:243]
v_mul_f32 v44, v44, v52
v_mul_f32 v45, v45, v53
v_mfma_f32_16x16x32_bf16 v[240:243], a[180:183], a[208:211], v[240:243]
v_mul_f32 v46, v46, v54
v_mul_f32 v47, v47, v55
v_mfma_f32_16x16x32_bf16 v[240:243], a[184:187], a[128:131], v[240:243]
v_cvt_pk_bf16_f32 v58, v44, v45
v_cvt_pk_bf16_f32 v59, v46, v47
v_mfma_f32_16x16x32_bf16 v[240:243], a[188:191], a[144:147], v[240:243]
s_xor_b32 s42, s64, 2048
buffer_store_dwordx4 v[56:59], v3, s[24:27], s42 offen sc1
v_mfma_f32_16x16x32_bf16 v[244:247], a[188:191], a[148:151], v[244:247]
v_mfma_f32_16x16x32_bf16 v[244:247], a[184:187], a[132:135], v[244:247]
v_mfma_f32_16x16x32_bf16 v[244:247], a[180:183], a[212:215], v[244:247]
v_mfma_f32_16x16x32_bf16 v[244:247], a[176:179], a[196:199], v[244:247]
v_mfma_f32_16x16x32_bf16 v[248:251], a[176:179], a[200:203], v[248:251]
v_mfma_f32_16x16x32_bf16 v[248:251], a[180:183], a[216:219], v[248:251]
v_mfma_f32_16x16x32_bf16 v[248:251], a[184:187], a[136:139], v[248:251]
v_mfma_f32_16x16x32_bf16 v[248:251], a[188:191], a[152:155], v[248:251]
v_mfma_f32_16x16x32_bf16 v[252:255], a[188:191], a[156:159], v[252:255]
v_mfma_f32_16x16x32_bf16 v[252:255], a[184:187], a[140:143], v[252:255]
v_mfma_f32_16x16x32_bf16 v[252:255], a[180:183], a[220:223], v[252:255]
v_mfma_f32_16x16x32_bf16 v[252:255], a[176:179], a[204:207], v[252:255]
v_accvgpr_read_b32 v28, a12
v_accvgpr_read_b32 v29, a13
v_accvgpr_read_b32 v30, a14
v_accvgpr_read_b32 v31, a15
v_mul_f32 v36, s44, v28
v_mul_f32 v37, s44, v29
v_mul_f32 v38, s44, v30
v_mul_f32 v39, s44, v31
v_exp_f32 v36, v36
v_exp_f32 v37, v37
v_exp_f32 v38, v38
v_exp_f32 v39, v39
v_accvgpr_read_b32 v32, a44
v_accvgpr_read_b32 v33, a45
v_accvgpr_read_b32 v34, a46
v_accvgpr_read_b32 v35, a47
v_add_f32 v36, 1.0, v36
v_add_f32 v37, 1.0, v37
v_add_f32 v38, 1.0, v38
v_add_f32 v39, 1.0, v39
v_rcp_f32 v36, v36
v_rcp_f32 v37, v37
v_rcp_f32 v38, v38
v_rcp_f32 v39, v39
v_pk_mul_f32 v[28:29], v[28:29], v[32:33]
v_pk_mul_f32 v[30:31], v[30:31], v[34:35]
v_pk_mul_f32 v[28:29], v[28:29], v[36:37]
v_pk_mul_f32 v[30:31], v[30:31], v[38:39]
v_cvt_pk_bf16_f32 v40, v28, v29
v_cvt_pk_bf16_f32 v41, v30, v31
v_accvgpr_read_b32 v28, a28
v_accvgpr_read_b32 v29, a29
v_accvgpr_read_b32 v30, a30
v_accvgpr_read_b32 v31, a31
v_mul_f32 v36, s44, v28
v_mul_f32 v37, s44, v29
v_mul_f32 v38, s44, v30
v_mul_f32 v39, s44, v31
v_exp_f32 v36, v36
v_exp_f32 v37, v37
v_exp_f32 v38, v38
v_exp_f32 v39, v39
v_accvgpr_read_b32 v32, a60
v_accvgpr_read_b32 v33, a61
v_accvgpr_read_b32 v34, a62
v_accvgpr_read_b32 v35, a63
v_add_f32 v36, 1.0, v36
v_add_f32 v37, 1.0, v37
v_add_f32 v38, 1.0, v38
v_add_f32 v39, 1.0, v39
v_rcp_f32 v36, v36
v_rcp_f32 v37, v37
v_rcp_f32 v38, v38
v_rcp_f32 v39, v39
v_pk_mul_f32 v[28:29], v[28:29], v[32:33]
v_pk_mul_f32 v[30:31], v[30:31], v[34:35]
v_pk_mul_f32 v[28:29], v[28:29], v[36:37]
v_pk_mul_f32 v[30:31], v[30:31], v[38:39]
v_cvt_pk_bf16_f32 v42, v28, v29
v_cvt_pk_bf16_f32 v43, v30, v31
s_xor_b32 s42, s64, 3072
buffer_store_dwordx4 v[40:43], v3, s[24:27], s42 offen sc1
A_done:
v_mov_b32 v12, v3
v_add_u32 v13, 61440, v3
v_add_u32 v14, 122880, v3
v_add_u32 v15, s3, v3
v_xor_b32 v16, 1024, v15
v_add_u32 v17, 4096, v15
v_add_u32 v18, 4096, v16
v_lshlrev_b32 v22, 3, v2
s_add_u32 s12, s94, s101
s_addc_u32 s13, s95, 0
s_mov_b32 s14, 1228800
s_mov_b32 s15, 0x20000
s_add_u32 s20, s94, 50331648
s_addc_u32 s21, s95, 0
s_mov_b32 s22, 15728640
s_mov_b32 s23, 0x20000
s_mov_b32 s35, 0
s_mov_b32 s44, 0x3dd53b95
s_mov_b32 s45, s44
v_pk_mul_f32 v[64:65], v[64:65], s[44:45]
v_pk_mul_f32 v[66:67], v[66:67], s[44:45]
v_cvt_pk_bf16_f32 v64, v64, v65
v_cvt_pk_bf16_f32 v65, v66, v67
v_pk_mul_f32 v[80:81], v[80:81], s[44:45]
v_pk_mul_f32 v[82:83], v[82:83], s[44:45]
v_cvt_pk_bf16_f32 v66, v80, v81
v_cvt_pk_bf16_f32 v67, v82, v83
v_pk_mul_f32 v[68:69], v[68:69], s[44:45]
v_pk_mul_f32 v[70:71], v[70:71], s[44:45]
v_cvt_pk_bf16_f32 v68, v68, v69
v_cvt_pk_bf16_f32 v69, v70, v71
v_pk_mul_f32 v[84:85], v[84:85], s[44:45]
v_pk_mul_f32 v[86:87], v[86:87], s[44:45]
v_cvt_pk_bf16_f32 v70, v84, v85
v_cvt_pk_bf16_f32 v71, v86, v87
v_pk_mul_f32 v[72:73], v[72:73], s[44:45]
v_pk_mul_f32 v[74:75], v[74:75], s[44:45]
v_cvt_pk_bf16_f32 v72, v72, v73
v_cvt_pk_bf16_f32 v73, v74, v75
v_pk_mul_f32 v[88:89], v[88:89], s[44:45]
v_pk_mul_f32 v[90:91], v[90:91], s[44:45]
v_cvt_pk_bf16_f32 v74, v88, v89
v_cvt_pk_bf16_f32 v75, v90, v91
v_pk_mul_f32 v[76:77], v[76:77], s[44:45]
v_pk_mul_f32 v[78:79], v[78:79], s[44:45]
v_cvt_pk_bf16_f32 v76, v76, v77
v_cvt_pk_bf16_f32 v77, v78, v79
v_pk_mul_f32 v[92:93], v[92:93], s[44:45]
v_pk_mul_f32 v[94:95], v[94:95], s[44:45]
v_cvt_pk_bf16_f32 v78, v92, v93
v_cvt_pk_bf16_f32 v79, v94, v95
v_pk_mul_f32 v[96:97], v[96:97], s[44:45]
v_pk_mul_f32 v[98:99], v[98:99], s[44:45]
v_cvt_pk_bf16_f32 v80, v96, v97
v_cvt_pk_bf16_f32 v81, v98, v99
v_pk_mul_f32 v[112:113], v[112:113], s[44:45]
v_pk_mul_f32 v[114:115], v[114:115], s[44:45]
v_cvt_pk_bf16_f32 v82, v112, v113
v_cvt_pk_bf16_f32 v83, v114, v115
v_pk_mul_f32 v[100:101], v[100:101], s[44:45]
v_pk_mul_f32 v[102:103], v[102:103], s[44:45]
v_cvt_pk_bf16_f32 v84, v100, v101
v_cvt_pk_bf16_f32 v85, v102, v103
v_pk_mul_f32 v[116:117], v[116:117], s[44:45]
v_pk_mul_f32 v[118:119], v[118:119], s[44:45]
v_cvt_pk_bf16_f32 v86, v116, v117
v_cvt_pk_bf16_f32 v87, v118, v119
v_pk_mul_f32 v[104:105], v[104:105], s[44:45]
v_pk_mul_f32 v[106:107], v[106:107], s[44:45]
v_cvt_pk_bf16_f32 v88, v104, v105
v_cvt_pk_bf16_f32 v89, v106, v107
v_pk_mul_f32 v[120:121], v[120:121], s[44:45]
v_pk_mul_f32 v[122:123], v[122:123], s[44:45]
v_cvt_pk_bf16_f32 v90, v120, v121
v_cvt_pk_bf16_f32 v91, v122, v123
v_pk_mul_f32 v[108:109], v[108:109], s[44:45]
v_pk_mul_f32 v[110:111], v[110:111], s[44:45]
v_cvt_pk_bf16_f32 v92, v108, v109
v_cvt_pk_bf16_f32 v93, v110, v111
v_pk_mul_f32 v[124:125], v[124:125], s[44:45]
v_pk_mul_f32 v[126:127], v[126:127], s[44:45]
v_cvt_pk_bf16_f32 v94, v124, v125
v_cvt_pk_bf16_f32 v95, v126, v127
v_pk_mul_f32 v[128:129], v[128:129], s[44:45]
v_pk_mul_f32 v[130:131], v[130:131], s[44:45]
v_cvt_pk_bf16_f32 v96, v128, v129
v_cvt_pk_bf16_f32 v97, v130, v131
v_pk_mul_f32 v[144:145], v[144:145], s[44:45]
v_pk_mul_f32 v[146:147], v[146:147], s[44:45]
v_cvt_pk_bf16_f32 v98, v144, v145
v_cvt_pk_bf16_f32 v99, v146, v147
v_pk_mul_f32 v[132:133], v[132:133], s[44:45]
v_pk_mul_f32 v[134:135], v[134:135], s[44:45]
v_cvt_pk_bf16_f32 v100, v132, v133
v_cvt_pk_bf16_f32 v101, v134, v135
v_pk_mul_f32 v[148:149], v[148:149], s[44:45]
v_pk_mul_f32 v[150:151], v[150:151], s[44:45]
v_cvt_pk_bf16_f32 v102, v148, v149
v_cvt_pk_bf16_f32 v103, v150, v151
v_pk_mul_f32 v[136:137], v[136:137], s[44:45]
v_pk_mul_f32 v[138:139], v[138:139], s[44:45]
v_cvt_pk_bf16_f32 v104, v136, v137
v_cvt_pk_bf16_f32 v105, v138, v139
v_pk_mul_f32 v[152:153], v[152:153], s[44:45]
v_pk_mul_f32 v[154:155], v[154:155], s[44:45]
v_cvt_pk_bf16_f32 v106, v152, v153
v_cvt_pk_bf16_f32 v107, v154, v155
v_pk_mul_f32 v[140:141], v[140:141], s[44:45]
v_pk_mul_f32 v[142:143], v[142:143], s[44:45]
v_cvt_pk_bf16_f32 v108, v140, v141
v_cvt_pk_bf16_f32 v109, v142, v143
v_pk_mul_f32 v[156:157], v[156:157], s[44:45]
v_pk_mul_f32 v[158:159], v[158:159], s[44:45]
v_cvt_pk_bf16_f32 v110, v156, v157
v_cvt_pk_bf16_f32 v111, v158, v159
v_pk_mul_f32 v[160:161], v[160:161], s[44:45]
v_pk_mul_f32 v[162:163], v[162:163], s[44:45]
v_cvt_pk_bf16_f32 v112, v160, v161
v_cvt_pk_bf16_f32 v113, v162, v163
v_pk_mul_f32 v[176:177], v[176:177], s[44:45]
v_pk_mul_f32 v[178:179], v[178:179], s[44:45]
v_cvt_pk_bf16_f32 v114, v176, v177
v_cvt_pk_bf16_f32 v115, v178, v179
v_pk_mul_f32 v[164:165], v[164:165], s[44:45]
v_pk_mul_f32 v[166:167], v[166:167], s[44:45]
v_cvt_pk_bf16_f32 v116, v164, v165
v_cvt_pk_bf16_f32 v117, v166, v167
v_pk_mul_f32 v[180:181], v[180:181], s[44:45]
v_pk_mul_f32 v[182:183], v[182:183], s[44:45]
v_cvt_pk_bf16_f32 v118, v180, v181
v_cvt_pk_bf16_f32 v119, v182, v183
v_pk_mul_f32 v[168:169], v[168:169], s[44:45]
v_pk_mul_f32 v[170:171], v[170:171], s[44:45]
v_cvt_pk_bf16_f32 v120, v168, v169
v_cvt_pk_bf16_f32 v121, v170, v171
v_pk_mul_f32 v[184:185], v[184:185], s[44:45]
v_pk_mul_f32 v[186:187], v[186:187], s[44:45]
v_cvt_pk_bf16_f32 v122, v184, v185
v_cvt_pk_bf16_f32 v123, v186, v187
v_pk_mul_f32 v[172:173], v[172:173], s[44:45]
v_pk_mul_f32 v[174:175], v[174:175], s[44:45]
v_cvt_pk_bf16_f32 v124, v172, v173
v_cvt_pk_bf16_f32 v125, v174, v175
v_pk_mul_f32 v[188:189], v[188:189], s[44:45]
v_pk_mul_f32 v[190:191], v[190:191], s[44:45]
v_cvt_pk_bf16_f32 v126, v188, v189
v_cvt_pk_bf16_f32 v127, v190, v191
v_pk_mul_f32 v[192:193], v[192:193], s[44:45]
v_pk_mul_f32 v[194:195], v[194:195], s[44:45]
v_cvt_pk_bf16_f32 v128, v192, v193
v_cvt_pk_bf16_f32 v129, v194, v195
v_pk_mul_f32 v[208:209], v[208:209], s[44:45]
v_pk_mul_f32 v[210:211], v[210:211], s[44:45]
v_cvt_pk_bf16_f32 v130, v208, v209
v_cvt_pk_bf16_f32 v131, v210, v211
v_pk_mul_f32 v[196:197], v[196:197], s[44:45]
v_pk_mul_f32 v[198:199], v[198:199], s[44:45]
v_cvt_pk_bf16_f32 v132, v196, v197
v_cvt_pk_bf16_f32 v133, v198, v199
v_pk_mul_f32 v[212:213], v[212:213], s[44:45]
v_pk_mul_f32 v[214:215], v[214:215], s[44:45]
v_cvt_pk_bf16_f32 v134, v212, v213
v_cvt_pk_bf16_f32 v135, v214, v215
v_pk_mul_f32 v[200:201], v[200:201], s[44:45]
v_pk_mul_f32 v[202:203], v[202:203], s[44:45]
v_cvt_pk_bf16_f32 v136, v200, v201
v_cvt_pk_bf16_f32 v137, v202, v203
v_pk_mul_f32 v[216:217], v[216:217], s[44:45]
v_pk_mul_f32 v[218:219], v[218:219], s[44:45]
v_cvt_pk_bf16_f32 v138, v216, v217
v_cvt_pk_bf16_f32 v139, v218, v219
v_pk_mul_f32 v[204:205], v[204:205], s[44:45]
v_pk_mul_f32 v[206:207], v[206:207], s[44:45]
v_cvt_pk_bf16_f32 v140, v204, v205
v_cvt_pk_bf16_f32 v141, v206, v207
v_pk_mul_f32 v[220:221], v[220:221], s[44:45]
v_pk_mul_f32 v[222:223], v[222:223], s[44:45]
v_cvt_pk_bf16_f32 v142, v220, v221
v_cvt_pk_bf16_f32 v143, v222, v223
v_pk_mul_f32 v[224:225], v[224:225], s[44:45]
v_pk_mul_f32 v[226:227], v[226:227], s[44:45]
v_cvt_pk_bf16_f32 v144, v224, v225
v_cvt_pk_bf16_f32 v145, v226, v227
v_pk_mul_f32 v[240:241], v[240:241], s[44:45]
v_pk_mul_f32 v[242:243], v[242:243], s[44:45]
v_cvt_pk_bf16_f32 v146, v240, v241
v_cvt_pk_bf16_f32 v147, v242, v243
v_pk_mul_f32 v[228:229], v[228:229], s[44:45]
v_pk_mul_f32 v[230:231], v[230:231], s[44:45]
v_cvt_pk_bf16_f32 v148, v228, v229
v_cvt_pk_bf16_f32 v149, v230, v231
v_pk_mul_f32 v[244:245], v[244:245], s[44:45]
v_pk_mul_f32 v[246:247], v[246:247], s[44:45]
v_cvt_pk_bf16_f32 v150, v244, v245
v_cvt_pk_bf16_f32 v151, v246, v247
v_pk_mul_f32 v[232:233], v[232:233], s[44:45]
v_pk_mul_f32 v[234:235], v[234:235], s[44:45]
v_cvt_pk_bf16_f32 v152, v232, v233
v_cvt_pk_bf16_f32 v153, v234, v235
v_pk_mul_f32 v[248:249], v[248:249], s[44:45]
v_pk_mul_f32 v[250:251], v[250:251], s[44:45]
v_cvt_pk_bf16_f32 v154, v248, v249
v_cvt_pk_bf16_f32 v155, v250, v251
v_pk_mul_f32 v[236:237], v[236:237], s[44:45]
v_pk_mul_f32 v[238:239], v[238:239], s[44:45]
v_cvt_pk_bf16_f32 v156, v236, v237
v_cvt_pk_bf16_f32 v157, v238, v239
v_pk_mul_f32 v[252:253], v[252:253], s[44:45]
v_pk_mul_f32 v[254:255], v[254:255], s[44:45]
v_cvt_pk_bf16_f32 v158, v252, v253
v_cvt_pk_bf16_f32 v159, v254, v255
v_mov_b32 v244, 0xff800000
v_mov_b32 v245, 0xff800000
v_mov_b32 v246, 0xff800000
v_mov_b32 v247, 0xff800000
K_attn:
s_mov_b32 s32, 49152
s_mov_b32 s33, 0
s_waitcnt vmcnt(14)
s_barrier
ds_read_b128 a[208:211], v4 offset:0
ds_read_b128 a[212:215], v5 offset:0
ds_read_b128 a[216:219], v4 offset:4096
ds_read_b128 a[220:223], v5 offset:4096
ds_read_b128 a[224:227], v4 offset:8192
ds_read_b128 a[228:231], v5 offset:8192
s_waitcnt lgkmcnt(3)
v_mfma_f32_16x16x32_bf16 v[160:163], a[208:211], v[64:67], 0
v_mfma_f32_16x16x32_bf16 v[160:163], a[212:215], v[80:83], v[160:163]
s_waitcnt lgkmcnt(0)
v_mfma_f32_16x16x32_bf16 v[160:163], a[216:219], v[96:99], v[160:163]
ds_read_b128 a[232:235], v4 offset:2048
v_mfma_f32_16x16x32_bf16 v[160:163], a[220:223], v[112:115], v[160:163]
v_mfma_f32_16x16x32_bf16 v[160:163], a[224:227], v[128:131], v[160:163]
ds_read_b128 a[236:239], v5 offset:2048
v_mfma_f32_16x16x32_bf16 v[160:163], a[228:231], v[144:147], v[160:163]
v_mfma_f32_16x16x32_bf16 v[164:167], a[228:231], v[148:151], 0
ds_read_b128 a[240:243], v4 offset:6144
v_mfma_f32_16x16x32_bf16 v[164:167], a[224:227], v[132:135], v[164:167]
v_mfma_f32_16x16x32_bf16 v[164:167], a[220:223], v[116:119], v[164:167]
ds_read_b128 a[244:247], v5 offset:6144
v_mfma_f32_16x16x32_bf16 v[164:167], a[216:219], v[100:103], v[164:167]
v_mfma_f32_16x16x32_bf16 v[164:167], a[212:215], v[84:87], v[164:167]
ds_read_b128 a[248:251], v4 offset:10240
v_mfma_f32_16x16x32_bf16 v[164:167], a[208:211], v[68:71], v[164:167]
v_mfma_f32_16x16x32_bf16 v[168:171], a[208:211], v[72:75], 0
ds_read_b128 a[252:255], v5 offset:10240
v_mfma_f32_16x16x32_bf16 v[168:171], a[212:215], v[88:91], v[168:171]
v_mfma_f32_16x16x32_bf16 v[168:171], a[216:219], v[104:107], v[168:171]
v_mfma_f32_16x16x32_bf16 v[168:171], a[220:223], v[120:123], v[168:171]
v_mfma_f32_16x16x32_bf16 v[168:171], a[224:227], v[136:139], v[168:171]
s_add_u32 m0, s31, 16128
v_mfma_f32_16x16x32_bf16 v[168:171], a[228:231], v[152:155], v[168:171]
buffer_load_dwordx4 v11, s[8:11], s33 offen offset:256 lds
v_mfma_f32_16x16x32_bf16 v[172:175], a[228:231], v[156:159], 0
v_mfma_f32_16x16x32_bf16 v[172:175], a[224:227], v[140:143], v[172:175]
v_mfma_f32_16x16x32_bf16 v[172:175], a[220:223], v[124:127], v[172:175]
v_mfma_f32_16x16x32_bf16 v[172:175], a[216:219], v[108:111], v[172:175]
v_mfma_f32_16x16x32_bf16 v[172:175], a[212:215], v[92:95], v[172:175]
v_mfma_f32_16x16x32_bf16 v[172:175], a[208:211], v[76:79], v[172:175]
s_waitcnt lgkmcnt(0)
v_mfma_f32_16x16x32_bf16 v[176:179], a[232:235], v[64:67], 0
s_add_u32 m0, s31, 20224
v_mfma_f32_16x16x32_bf16 v[176:179], a[236:239], v[80:83], v[176:179]
buffer_load_dwordx4 v23, s[8:11], s33 offen offset:256 lds
v_mfma_f32_16x16x32_bf16 v[176:179], a[240:243], v[96:99], v[176:179]
v_mfma_f32_16x16x32_bf16 v[176:179], a[244:247], v[112:115], v[176:179]
v_mfma_f32_16x16x32_bf16 v[176:179], a[248:251], v[128:131], v[176:179]
v_mfma_f32_16x16x32_bf16 v[176:179], a[252:255], v[144:147], v[176:179]
v_mfma_f32_16x16x32_bf16 v[180:183], a[252:255], v[148:151], 0
s_mov_b32 s33, 24576
v_mfma_f32_16x16x32_bf16 v[180:183], a[248:251], v[132:135], v[180:183]
v_mfma_f32_16x16x32_bf16 v[180:183], a[244:247], v[116:119], v[180:183]
v_mfma_f32_16x16x32_bf16 v[180:183], a[240:243], v[100:103], v[180:183]
v_mfma_f32_16x16x32_bf16 v[180:183], a[236:239], v[84:87], v[180:183]
v_mfma_f32_16x16x32_bf16 v[180:183], a[232:235], v[68:71], v[180:183]
v_mfma_f32_16x16x32_bf16 v[184:187], a[232:235], v[72:75], 0
v_mfma_f32_16x16x32_bf16 v[184:187], a[236:239], v[88:91], v[184:187]
v_mfma_f32_16x16x32_bf16 v[184:187], a[240:243], v[104:107], v[184:187]
v_mfma_f32_16x16x32_bf16 v[184:187], a[244:247], v[120:123], v[184:187]
v_mfma_f32_16x16x32_bf16 v[184:187], a[248:251], v[136:139], v[184:187]
v_mfma_f32_16x16x32_bf16 v[184:187], a[252:255], v[152:155], v[184:187]
v_mfma_f32_16x16x32_bf16 v[188:191], a[252:255], v[156:159], 0
v_mfma_f32_16x16x32_bf16 v[188:191], a[248:251], v[140:143], v[188:191]
v_mfma_f32_16x16x32_bf16 v[188:191], a[244:247], v[124:127], v[188:191]
v_mfma_f32_16x16x32_bf16 v[188:191], a[240:243], v[108:111], v[188:191]
v_mfma_f32_16x16x32_bf16 v[188:191], a[236:239], v[92:95], v[188:191]
v_mfma_f32_16x16x32_bf16 v[188:191], a[232:235], v[76:79], v[188:191]
s_barrier
s_add_u32 m0, s30, 0
s_nop 0
buffer_load_dwordx4 v10, s[4:7], s32 offen offset:0 lds
ds_read_b128 a[192:195], v4 offset:12288
ds_read_b128 a[196:199], v5 offset:12288
s_add_u32 m0, s30, 3968
s_nop 0
buffer_load_dwordx4 v10, s[4:7], s32 offen offset:128 lds
ds_read_b128 a[200:203], v4 offset:16384
ds_read_b128 a[204:207], v5 offset:16384
ds_read_b128 a[208:211], v4 offset:20480
ds_read_b128 a[212:215], v5 offset:20480
s_add_u32 m0, s30, 7936
s_nop 0
buffer_load_dwordx4 v10, s[4:7], s32 offen offset:256 lds
s_add_u32 s32, s32, 12288
s_add_u32 m0, s31, 24576
s_nop 0
buffer_load_dwordx4 v11, s[8:11], s33 offen offset:0 lds
v_max3_f32 v248, v160, v161, v244
v_max3_f32 v248, v162, v163, v248
v_max3_f32 v248, v176, v177, v248
v_max3_f32 v248, v178, v179, v248
v_max3_f32 v249, v164, v165, v245
v_max3_f32 v249, v166, v167, v249
v_max3_f32 v249, v180, v181, v249
v_max3_f32 v249, v182, v183, v249
v_max3_f32 v250, v168, v169, v246
v_max3_f32 v250, v170, v171, v250
v_max3_f32 v250, v184, v185, v250
v_max3_f32 v250, v186, v187, v250
v_max3_f32 v251, v172, v173, v247
v_max3_f32 v251, v174, v175, v251
v_max3_f32 v251, v188, v189, v251
v_max3_f32 v251, v190, v191, v251
v_mov_b32 v252, v248
v_mov_b32 v253, v249
v_mov_b32 v254, v250
v_mov_b32 v255, v251
s_nop 0
v_permlane32_swap_b32 v248, v252
v_permlane32_swap_b32 v249, v253
v_permlane32_swap_b32 v250, v254
v_permlane32_swap_b32 v251, v255
v_max_f32 v248, v248, v252
v_max_f32 v249, v249, v253
v_max_f32 v250, v250, v254
v_max_f32 v251, v251, v255
v_mov_b32 v252, v248
v_mov_b32 v253, v249
v_mov_b32 v254, v250
v_mov_b32 v255, v251
s_nop 0
v_permlane16_swap_b32 v248, v252
v_permlane16_swap_b32 v249, v253
v_permlane16_swap_b32 v250, v254
v_permlane16_swap_b32 v251, v255
v_max_f32 v248, v248, v252
v_max_f32 v249, v249, v253
v_max_f32 v250, v250, v254
v_max_f32 v251, v251, v255
v_sub_f32 v224, 0, v248
v_sub_f32 v225, 0, v248
v_sub_f32 v226, 0, v248
v_sub_f32 v227, 0, v248
v_mov_b32 v240, 0
v_pk_add_f32 v[160:161], v[160:161], v[224:225]
v_pk_add_f32 v[162:163], v[162:163], v[224:225]
v_pk_add_f32 v[176:177], v[176:177], v[224:225]
v_pk_add_f32 v[178:179], v[178:179], v[224:225]
v_sub_f32 v228, 0, v249
v_sub_f32 v229, 0, v249
v_sub_f32 v230, 0, v249
v_sub_f32 v231, 0, v249
v_mov_b32 v241, 0
v_pk_add_f32 v[164:165], v[164:165], v[228:229]
v_pk_add_f32 v[166:167], v[166:167], v[228:229]
v_pk_add_f32 v[180:181], v[180:181], v[228:229]
v_pk_add_f32 v[182:183], v[182:183], v[228:229]
v_sub_f32 v232, 0, v250
v_sub_f32 v233, 0, v250
v_sub_f32 v234, 0, v250
v_sub_f32 v235, 0, v250
v_mov_b32 v242, 0
v_pk_add_f32 v[168:169], v[168:169], v[232:233]
v_pk_add_f32 v[170:171], v[170:171], v[232:233]
v_pk_add_f32 v[184:185], v[184:185], v[232:233]
v_pk_add_f32 v[186:187], v[186:187], v[232:233]
v_sub_f32 v236, 0, v251
v_sub_f32 v237, 0, v251
v_sub_f32 v238, 0, v251
v_sub_f32 v239, 0, v251
v_mov_b32 v243, 0
v_pk_add_f32 v[172:173], v[172:173], v[236:237]
v_pk_add_f32 v[174:175], v[174:175], v[236:237]
v_pk_add_f32 v[188:189], v[188:189], v[236:237]
v_pk_add_f32 v[190:191], v[190:191], v[236:237]
v_exp_f32 v160, v160
v_exp_f32 v161, v161
v_exp_f32 v162, v162
v_add_f32 v240, v240, v160
v_add_f32 v240, v240, v161
v_exp_f32 v163, v163
v_cvt_pk_bf16_f32 v192, v160, v161
v_add_f32 v240, v240, v162
v_exp_f32 v164, v164
v_exp_f32 v165, v165
v_add_f32 v240, v240, v163
v_cvt_pk_bf16_f32 v193, v162, v163
v_exp_f32 v166, v166
v_add_f32 v241, v241, v164
v_add_f32 v241, v241, v165
v_cvt_pk_bf16_f32 v196, v164, v165
v_exp_f32 v167, v167
v_exp_f32 v168, v168
v_add_f32 v241, v241, v166
v_exp_f32 v169, v169
v_add_f32 v241, v241, v167
v_cvt_pk_bf16_f32 v197, v166, v167
v_exp_f32 v170, v170
v_add_f32 v242, v242, v168
v_add_f32 v242, v242, v169
v_cvt_pk_bf16_f32 v200, v168, v169
v_exp_f32 v171, v171
v_exp_f32 v172, v172
v_add_f32 v242, v242, v170
v_exp_f32 v173, v173
v_add_f32 v242, v242, v171
v_cvt_pk_bf16_f32 v201, v170, v171
v_exp_f32 v174, v174
v_add_f32 v243, v243, v172
v_exp_f32 v175, v175
v_add_f32 v243, v243, v173
v_cvt_pk_bf16_f32 v204, v172, v173
v_exp_f32 v176, v176
v_add_f32 v243, v243, v174
v_exp_f32 v177, v177
v_add_f32 v243, v243, v175
v_cvt_pk_bf16_f32 v205, v174, v175
v_exp_f32 v178, v178
v_add_f32 v240, v240, v176
v_exp_f32 v179, v179
v_add_f32 v240, v240, v177
v_cvt_pk_bf16_f32 v194, v176, v177
v_exp_f32 v180, v180
v_add_f32 v240, v240, v178
v_exp_f32 v181, v181
v_add_f32 v240, v240, v179
v_cvt_pk_bf16_f32 v195, v178, v179
v_add_f32 v241, v241, v180
v_exp_f32 v182, v182
v_exp_f32 v183, v183
v_add_f32 v241, v241, v181
v_cvt_pk_bf16_f32 v198, v180, v181
v_add_f32 v241, v241, v182
v_exp_f32 v184, v184
v_exp_f32 v185, v185
s_waitcnt lgkmcnt(3)
s_nop 1
v_mfma_f32_16x16x32_bf16 v[160:163], a[192:195], v[64:67], v[224:227]
v_add_f32 v241, v241, v183
v_mfma_f32_16x16x32_bf16 v[160:163], a[196:199], v[80:83], v[160:163]
v_cvt_pk_bf16_f32 v199, v182, v183
v_add_f32 v242, v242, v184
v_mfma_f32_16x16x32_bf16 v[160:163], a[200:203], v[96:99], v[160:163]
s_waitcnt lgkmcnt(0)
v_exp_f32 v186, v186
v_mfma_f32_16x16x32_bf16 v[160:163], a[204:207], v[112:115], v[160:163]
v_mfma_f32_16x16x32_bf16 v[160:163], a[208:211], v[128:131], v[160:163]
s_add_u32 m0, s31, 28672
ds_read_b128 a[216:219], v4 offset:14336
v_add_f32 v242, v242, v185
v_mfma_f32_16x16x32_bf16 v[160:163], a[212:215], v[144:147], v[160:163]
buffer_load_dwordx4 v23, s[8:11], s33 offen offset:0 lds
v_mfma_f32_16x16x32_bf16 v[164:167], a[212:215], v[148:151], v[228:231]
ds_read_b128 a[220:223], v5 offset:14336
v_cvt_pk_bf16_f32 v202, v184, v185
v_mfma_f32_16x16x32_bf16 v[164:167], a[208:211], v[132:135], v[164:167]
v_exp_f32 v187, v187
v_mfma_f32_16x16x32_bf16 v[164:167], a[204:207], v[116:119], v[164:167]
ds_read_b128 a[224:227], v4 offset:18432
v_add_f32 v242, v242, v186
v_mfma_f32_16x16x32_bf16 v[164:167], a[200:203], v[100:103], v[164:167]
v_exp_f32 v188, v188
v_mfma_f32_16x16x32_bf16 v[164:167], a[196:199], v[84:87], v[164:167]
ds_read_b128 a[228:231], v5 offset:18432
v_add_f32 v242, v242, v187
v_mfma_f32_16x16x32_bf16 v[164:167], a[192:195], v[68:71], v[164:167]
v_exp_f32 v189, v189
v_mfma_f32_16x16x32_bf16 v[168:171], a[192:195], v[72:75], v[232:235]
s_add_u32 m0, s31, 32640
ds_read_b128 a[232:235], v4 offset:22528
v_cvt_pk_bf16_f32 v203, v186, v187
v_mfma_f32_16x16x32_bf16 v[168:171], a[196:199], v[88:91], v[168:171]
buffer_load_dwordx4 v11, s[8:11], s33 offen offset:128 lds
v_mfma_f32_16x16x32_bf16 v[168:171], a[200:203], v[104:107], v[168:171]
ds_read_b128 a[236:239], v5 offset:22528
v_add_f32 v243, v243, v188
v_mfma_f32_16x16x32_bf16 v[168:171], a[204:207], v[120:123], v[168:171]
v_exp_f32 v190, v190
v_mfma_f32_16x16x32_bf16 v[168:171], a[208:211], v[136:139], v[168:171]
v_exp_f32 v191, v191
v_mfma_f32_16x16x32_bf16 v[168:171], a[212:215], v[152:155], v[168:171]
v_add_f32 v243, v243, v189
v_mfma_f32_16x16x32_bf16 v[172:175], a[212:215], v[156:159], v[236:239]
v_cvt_pk_bf16_f32 v206, v188, v189
v_mfma_f32_16x16x32_bf16 v[172:175], a[208:211], v[140:143], v[172:175]
s_add_u32 m0, s31, 36736
v_add_f32 v243, v243, v190
v_mfma_f32_16x16x32_bf16 v[172:175], a[204:207], v[124:127], v[172:175]
buffer_load_dwordx4 v23, s[8:11], s33 offen offset:128 lds
v_mfma_f32_16x16x32_bf16 v[172:175], a[200:203], v[108:111], v[172:175]
v_add_f32 v243, v243, v191
v_mfma_f32_16x16x32_bf16 v[172:175], a[196:199], v[92:95], v[172:175]
v_cvt_pk_bf16_f32 v207, v190, v191
v_mfma_f32_16x16x32_bf16 v[172:175], a[192:195], v[76:79], v[172:175]
s_waitcnt lgkmcnt(3)
v_mfma_f32_16x16x32_bf16 v[176:179], a[216:219], v[64:67], v[224:227]
v_exp_f32 v160, v160
v_mfma_f32_16x16x32_bf16 v[176:179], a[220:223], v[80:83], v[176:179]
v_mfma_f32_16x16x32_bf16 v[176:179], a[224:227], v[96:99], v[176:179]
s_waitcnt lgkmcnt(0)
v_mfma_f32_16x16x32_bf16 v[176:179], a[228:231], v[112:115], v[176:179]
v_exp_f32 v161, v161
v_mfma_f32_16x16x32_bf16 v[176:179], a[232:235], v[128:131], v[176:179]
v_exp_f32 v162, v162
v_mfma_f32_16x16x32_bf16 v[176:179], a[236:239], v[144:147], v[176:179]
v_add_f32 v240, v240, v160
v_mfma_f32_16x16x32_bf16 v[180:183], a[236:239], v[148:151], v[228:231]
v_add_f32 v240, v240, v161
v_mfma_f32_16x16x32_bf16 v[180:183], a[232:235], v[132:135], v[180:183]
v_exp_f32 v163, v163
v_mfma_f32_16x16x32_bf16 v[180:183], a[228:231], v[116:119], v[180:183]
v_cvt_pk_bf16_f32 v208, v160, v161
v_mfma_f32_16x16x32_bf16 v[180:183], a[224:227], v[100:103], v[180:183]
v_add_f32 v240, v240, v162
v_mfma_f32_16x16x32_bf16 v[180:183], a[220:223], v[84:87], v[180:183]
v_mfma_f32_16x16x32_bf16 v[180:183], a[216:219], v[68:71], v[180:183]
v_exp_f32 v164, v164
v_mfma_f32_16x16x32_bf16 v[184:187], a[216:219], v[72:75], v[232:235]
v_exp_f32 v165, v165
v_mfma_f32_16x16x32_bf16 v[184:187], a[220:223], v[88:91], v[184:187]
v_add_f32 v240, v240, v163
v_mfma_f32_16x16x32_bf16 v[184:187], a[224:227], v[104:107], v[184:187]
v_cvt_pk_bf16_f32 v209, v162, v163
v_mfma_f32_16x16x32_bf16 v[184:187], a[228:231], v[120:123], v[184:187]
v_exp_f32 v166, v166
v_mfma_f32_16x16x32_bf16 v[184:187], a[232:235], v[136:139], v[184:187]
v_add_f32 v241, v241, v164
v_mfma_f32_16x16x32_bf16 v[184:187], a[236:239], v[152:155], v[184:187]
v_add_f32 v241, v241, v165
v_mfma_f32_16x16x32_bf16 v[188:191], a[236:239], v[156:159], v[236:239]
v_cvt_pk_bf16_f32 v212, v164, v165
v_mfma_f32_16x16x32_bf16 v[188:191], a[232:235], v[140:143], v[188:191]
v_exp_f32 v167, v167
v_mfma_f32_16x16x32_bf16 v[188:191], a[228:231], v[124:127], v[188:191]
v_exp_f32 v168, v168
v_mfma_f32_16x16x32_bf16 v[188:191], a[224:227], v[108:111], v[188:191]
v_mfma_f32_16x16x32_bf16 v[188:191], a[220:223], v[92:95], v[188:191]
v_add_f32 v241, v241, v166
v_mfma_f32_16x16x32_bf16 v[188:191], a[216:219], v[76:79], v[188:191]
v_exp_f32 v169, v169
v_add_f32 v241, v241, v167
v_cvt_pk_bf16_f32 v213, v166, v167
v_add_f32 v242, v242, v168
v_exp_f32 v170, v170
v_exp_f32 v171, v171
s_waitcnt vmcnt(12) lgkmcnt(0)
v_add_f32 v242, v242, v169
v_cvt_pk_bf16_f32 v216, v168, v169
s_barrier
v_exp_f32 v172, v172
s_add_u32 m0, s30, 12288
v_add_f32 v242, v242, v170
buffer_load_dwordx4 v10, s[4:7], s32 offen offset:0 lds
ds_read_b128 a[208:211], v4 offset:24576
v_add_f32 v242, v242, v171
v_exp_f32 v173, v173
ds_read_b128 a[212:215], v5 offset:24576
v_cvt_pk_bf16_f32 v217, v170, v171
v_exp_f32 v174, v174
ds_read_b128 a[216:219], v4 offset:28672
v_add_f32 v243, v243, v172
v_exp_f32 v175, v175
s_add_u32 m0, s30, 16256
ds_read_b128 a[220:223], v5 offset:28672
v_add_f32 v243, v243, v173
buffer_load_dwordx4 v10, s[4:7], s32 offen offset:128 lds
ds_read_b128 a[224:227], v4 offset:32768
v_cvt_pk_bf16_f32 v220, v172, v173
v_exp_f32 v176, v176
ds_read_b128 a[228:231], v5 offset:32768
v_add_f32 v243, v243, v174
v_exp_f32 v177, v177
v_add_f32 v243, v243, v175
s_add_u32 m0, s30, 20224
v_cvt_pk_bf16_f32 v221, v174, v175
buffer_load_dwordx4 v10, s[4:7], s32 offen offset:256 lds
s_add_u32 s32, s32, 12288
v_exp_f32 v178, v178
v_add_f32 v240, v240, v176
v_add_f32 v240, v240, v177
v_exp_f32 v179, v179
s_waitcnt lgkmcnt(3)
v_cvt_pk_bf16_f32 v210, v176, v177
v_mfma_f32_16x16x32_bf16 v[160:163], a[208:211], v[64:67], v[224:227]
s_add_u32 m0, s31, 40704
v_exp_f32 v180, v180
v_mfma_f32_16x16x32_bf16 v[160:163], a[212:215], v[80:83], v[160:163]
buffer_load_dwordx4 v11, s[8:11], s33 offen offset:256 lds
v_mfma_f32_16x16x32_bf16 v[160:163], a[216:219], v[96:99], v[160:163]
s_waitcnt lgkmcnt(0)
v_add_f32 v240, v240, v178
v_add_f32 v240, v240, v179
v_mfma_f32_16x16x32_bf16 v[160:163], a[220:223], v[112:115], v[160:163]
v_exp_f32 v181, v181
v_mfma_f32_16x16x32_bf16 v[160:163], a[224:227], v[128:131], v[160:163]
ds_read_b128 a[232:235], v4 offset:26624
v_mfma_f32_16x16x32_bf16 v[160:163], a[228:231], v[144:147], v[160:163]
v_cvt_pk_bf16_f32 v211, v178, v179
v_mfma_f32_16x16x32_bf16 v[164:167], a[228:231], v[148:151], v[228:231]
ds_read_b128 a[236:239], v5 offset:26624
v_add_f32 v241, v241, v180
v_mfma_f32_16x16x32_bf16 v[164:167], a[224:227], v[132:135], v[164:167]
v_exp_f32 v182, v182
v_mfma_f32_16x16x32_bf16 v[164:167], a[220:223], v[116:119], v[164:167]
s_add_u32 m0, s31, 44800
ds_read_b128 a[240:243], v4 offset:30720
v_add_f32 v241, v241, v181
v_mfma_f32_16x16x32_bf16 v[164:167], a[216:219], v[100:103], v[164:167]
buffer_load_dwordx4 v23, s[8:11], s33 offen offset:256 lds
v_mfma_f32_16x16x32_bf16 v[164:167], a[212:215], v[84:87], v[164:167]
s_add_u32 s33, s33, 24576
ds_read_b128 a[244:247], v5 offset:30720
v_cvt_pk_bf16_f32 v214, v180, v181
v_mfma_f32_16x16x32_bf16 v[164:167], a[208:211], v[68:71], v[164:167]
v_exp_f32 v183, v183
v_mfma_f32_16x16x32_bf16 v[168:171], a[208:211], v[72:75], v[232:235]
ds_read_b128 a[248:251], v4 offset:34816
v_add_f32 v241, v241, v182
v_mfma_f32_16x16x32_bf16 v[168:171], a[212:215], v[88:91], v[168:171]
v_exp_f32 v184, v184
v_mfma_f32_16x16x32_bf16 v[168:171], a[216:219], v[104:107], v[168:171]
ds_read_b128 a[252:255], v5 offset:34816
v_add_f32 v241, v241, v183
v_mfma_f32_16x16x32_bf16 v[168:171], a[220:223], v[120:123], v[168:171]
v_exp_f32 v185, v185
v_mfma_f32_16x16x32_bf16 v[168:171], a[224:227], v[136:139], v[168:171]
ds_read_b64_tr_b16 a[192:193], v6 offset:0
v_mfma_f32_16x16x32_bf16 v[168:171], a[228:231], v[152:155], v[168:171]
ds_read_b64_tr_b16 a[194:195], v6 offset:2048
v_cvt_pk_bf16_f32 v215, v182, v183
v_mfma_f32_16x16x32_bf16 v[172:175], a[228:231], v[156:159], v[236:239]
ds_read_b64_tr_b16 a[196:197], v6 offset:4096
v_add_f32 v242, v242, v184
v_mfma_f32_16x16x32_bf16 v[172:175], a[224:227], v[140:143], v[172:175]
ds_read_b64_tr_b16 a[198:199], v6 offset:6144
v_mfma_f32_16x16x32_bf16 v[172:175], a[220:223], v[124:127], v[172:175]
v_exp_f32 v186, v186
v_mfma_f32_16x16x32_bf16 v[172:175], a[216:219], v[108:111], v[172:175]
ds_read_b64_tr_b16 a[200:201], v7 offset:0
v_add_f32 v242, v242, v185
v_mfma_f32_16x16x32_bf16 v[172:175], a[212:215], v[92:95], v[172:175]
ds_read_b64_tr_b16 a[202:203], v7 offset:2048
v_cvt_pk_bf16_f32 v218, v184, v185
v_mfma_f32_16x16x32_bf16 v[172:175], a[208:211], v[76:79], v[172:175]
s_waitcnt lgkmcnt(9)
v_exp_f32 v187, v187
v_mfma_f32_16x16x32_bf16 v[176:179], a[232:235], v[64:67], v[224:227]
v_exp_f32 v188, v188
v_mfma_f32_16x16x32_bf16 v[176:179], a[236:239], v[80:83], v[176:179]
ds_read_b64_tr_b16 a[204:205], v7 offset:4096
v_add_f32 v242, v242, v186
v_mfma_f32_16x16x32_bf16 v[176:179], a[240:243], v[96:99], v[176:179]
s_waitcnt lgkmcnt(7)
ds_read_b64_tr_b16 a[206:207], v7 offset:6144
v_add_f32 v242, v242, v187
v_mfma_f32_16x16x32_bf16 v[176:179], a[244:247], v[112:115], v[176:179]
v_exp_f32 v189, v189
v_mfma_f32_16x16x32_bf16 v[176:179], a[248:251], v[128:131], v[176:179]
v_cvt_pk_bf16_f32 v219, v186, v187
v_mfma_f32_16x16x32_bf16 v[176:179], a[252:255], v[144:147], v[176:179]
ds_read_b64_tr_b16 a[208:209], v8 offset:0
v_add_f32 v243, v243, v188
v_mfma_f32_16x16x32_bf16 v[180:183], a[252:255], v[148:151], v[228:231]
ds_read_b64_tr_b16 a[210:211], v8 offset:2048
v_mfma_f32_16x16x32_bf16 v[180:183], a[248:251], v[132:135], v[180:183]
v_exp_f32 v190, v190
v_mfma_f32_16x16x32_bf16 v[180:183], a[244:247], v[116:119], v[180:183]
v_exp_f32 v191, v191
v_mfma_f32_16x16x32_bf16 v[180:183], a[240:243], v[100:103], v[180:183]
ds_read_b64_tr_b16 a[212:213], v8 offset:4096
v_add_f32 v243, v243, v189
v_mfma_f32_16x16x32_bf16 v[180:183], a[236:239], v[84:87], v[180:183]
ds_read_b64_tr_b16 a[214:215], v8 offset:6144
v_cvt_pk_bf16_f32 v222, v188, v189
v_mfma_f32_16x16x32_bf16 v[180:183], a[232:235], v[68:71], v[180:183]
v_add_f32 v243, v243, v190
v_mfma_f32_16x16x32_bf16 v[184:187], a[232:235], v[72:75], v[232:235]
v_add_f32 v243, v243, v191
v_mfma_f32_16x16x32_bf16 v[184:187], a[236:239], v[88:91], v[184:187]
ds_read_b64_tr_b16 a[216:217], v9 offset:0
v_cvt_pk_bf16_f32 v223, v190, v191
v_mfma_f32_16x16x32_bf16 v[184:187], a[240:243], v[104:107], v[184:187]
ds_read_b64_tr_b16 a[218:219], v9 offset:2048
v_mfma_f32_16x16x32_bf16 v[184:187], a[244:247], v[120:123], v[184:187]
v_mfma_f32_16x16x32_bf16 v[184:187], a[248:251], v[136:139], v[184:187]
v_exp_f32 v160, v160
v_mfma_f32_16x16x32_bf16 v[184:187], a[252:255], v[152:155], v[184:187]
ds_read_b64_tr_b16 a[220:221], v9 offset:4096
v_mfma_f32_16x16x32_bf16 v[188:191], a[252:255], v[156:159], v[236:239]
ds_read_b64_tr_b16 a[222:223], v9 offset:6144
v_mfma_f32_16x16x32_bf16 v[188:191], a[248:251], v[140:143], v[188:191]
v_exp_f32 v161, v161
v_mfma_f32_16x16x32_bf16 v[188:191], a[244:247], v[124:127], v[188:191]
v_exp_f32 v162, v162
v_mfma_f32_16x16x32_bf16 v[188:191], a[240:243], v[108:111], v[188:191]
ds_read_b64_tr_b16 a[224:225], v6 offset:8192
v_add_f32 v240, v240, v160
v_mfma_f32_16x16x32_bf16 v[188:191], a[236:239], v[92:95], v[188:191]
ds_read_b64_tr_b16 a[226:227], v6 offset:10240
v_add_f32 v240, v240, v161
v_mfma_f32_16x16x32_bf16 v[188:191], a[232:235], v[76:79], v[188:191]
s_waitcnt lgkmcnt(9)
v_exp_f32 v163, v163
v_mfma_f32_16x16x32_bf16 a[0:3], a[192:195], v[192:195], 0
v_cvt_pk_bf16_f32 v28, v160, v161
v_mfma_f32_16x16x32_bf16 a[0:3], a[196:199], v[208:211], a[0:3]
ds_read_b64_tr_b16 a[228:229], v6 offset:12288
v_add_f32 v240, v240, v162
v_mfma_f32_16x16x32_bf16 a[4:7], a[196:199], v[212:215], 0
ds_read_b64_tr_b16 a[230:231], v6 offset:14336
v_mfma_f32_16x16x32_bf16 a[4:7], a[192:195], v[196:199], a[4:7]
v_exp_f32 v164, v164
v_mfma_f32_16x16x32_bf16 a[8:11], a[192:195], v[200:203], 0
v_exp_f32 v165, v165
v_mfma_f32_16x16x32_bf16 a[8:11], a[196:199], v[216:219], a[8:11]
ds_read_b64_tr_b16 a[232:233], v7 offset:8192
v_add_f32 v240, v240, v163
v_mfma_f32_16x16x32_bf16 a[12:15], a[196:199], v[220:223], 0
ds_read_b64_tr_b16 a[234:235], v7 offset:10240
v_cvt_pk_bf16_f32 v29, v162, v163
v_mfma_f32_16x16x32_bf16 a[12:15], a[192:195], v[204:207], a[12:15]
s_waitcnt lgkmcnt(9)
v_exp_f32 v166, v166
v_mfma_f32_16x16x32_bf16 a[16:19], a[200:203], v[192:195], 0
v_add_f32 v241, v241, v164
v_mfma_f32_16x16x32_bf16 a[16:19], a[204:207], v[208:211], a[16:19]
ds_read_b64_tr_b16 a[236:237], v7 offset:12288
v_add_f32 v241, v241, v165
v_mfma_f32_16x16x32_bf16 a[20:23], a[204:207], v[212:215], 0
ds_read_b64_tr_b16 a[238:239], v7 offset:14336
v_cvt_pk_bf16_f32 v32, v164, v165
v_mfma_f32_16x16x32_bf16 a[20:23], a[200:203], v[196:199], a[20:23]
v_exp_f32 v167, v167
v_mfma_f32_16x16x32_bf16 a[24:27], a[200:203], v[200:203], 0
v_exp_f32 v168, v168
v_mfma_f32_16x16x32_bf16 a[24:27], a[204:207], v[216:219], a[24:27]
ds_read_b64_tr_b16 a[240:241], v8 offset:8192
v_mfma_f32_16x16x32_bf16 a[28:31], a[204:207], v[220:223], 0
ds_read_b64_tr_b16 a[242:243], v8 offset:10240
v_add_f32 v241, v241, v166
v_mfma_f32_16x16x32_bf16 a[28:31], a[200:203], v[204:207], a[28:31]
s_waitcnt lgkmcnt(9)
v_exp_f32 v169, v169
v_mfma_f32_16x16x32_bf16 a[32:35], a[208:211], v[192:195], 0
v_mfma_f32_16x16x32_bf16 a[32:35], a[212:215], v[208:211], a[32:35]
ds_read_b64_tr_b16 a[244:245], v8 offset:12288
v_add_f32 v241, v241, v167
v_mfma_f32_16x16x32_bf16 a[36:39], a[212:215], v[212:215], 0
ds_read_b64_tr_b16 a[246:247], v8 offset:14336
v_cvt_pk_bf16_f32 v33, v166, v167
v_mfma_f32_16x16x32_bf16 a[36:39], a[208:211], v[196:199], a[36:39]
v_exp_f32 v170, v170
v_mfma_f32_16x16x32_bf16 a[40:43], a[208:211], v[200:203], 0
v_add_f32 v242, v242, v168
v_mfma_f32_16x16x32_bf16 a[40:43], a[212:215], v[216:219], a[40:43]
ds_read_b64_tr_b16 a[248:249], v9 offset:8192
v_add_f32 v242, v242, v169
v_mfma_f32_16x16x32_bf16 a[44:47], a[212:215], v[220:223], 0
ds_read_b64_tr_b16 a[250:251], v9 offset:10240
v_cvt_pk_bf16_f32 v36, v168, v169
v_mfma_f32_16x16x32_bf16 a[44:47], a[208:211], v[204:207], a[44:47]
s_waitcnt lgkmcnt(9)
v_exp_f32 v171, v171
v_mfma_f32_16x16x32_bf16 a[48:51], a[216:219], v[192:195], 0
v_exp_f32 v172, v172
v_mfma_f32_16x16x32_bf16 a[48:51], a[220:223], v[208:211], a[48:51]
ds_read_b64_tr_b16 a[252:253], v9 offset:12288
v_mfma_f32_16x16x32_bf16 a[52:55], a[220:223], v[212:215], 0
ds_read_b64_tr_b16 a[254:255], v9 offset:14336
v_add_f32 v242, v242, v170
v_mfma_f32_16x16x32_bf16 a[52:55], a[216:219], v[196:199], a[52:55]
v_exp_f32 v173, v173
v_mfma_f32_16x16x32_bf16 a[56:59], a[216:219], v[200:203], 0
v_add_f32 v242, v242, v171
v_mfma_f32_16x16x32_bf16 a[56:59], a[220:223], v[216:219], a[56:59]
v_cvt_pk_bf16_f32 v37, v170, v171
v_mfma_f32_16x16x32_bf16 a[60:63], a[220:223], v[220:223], 0
v_exp_f32 v174, v174
v_mfma_f32_16x16x32_bf16 a[60:63], a[216:219], v[204:207], a[60:63]
s_waitcnt lgkmcnt(9)
v_mfma_f32_16x16x32_bf16 a[64:67], a[224:227], v[192:195], 0
v_add_f32 v243, v243, v172
v_mfma_f32_16x16x32_bf16 a[64:67], a[228:231], v[208:211], a[64:67]
v_exp_f32 v175, v175
v_mfma_f32_16x16x32_bf16 a[68:71], a[228:231], v[212:215], 0
v_add_f32 v243, v243, v173
v_mfma_f32_16x16x32_bf16 a[68:71], a[224:227], v[196:199], a[68:71]
s_waitcnt vmcnt(12) lgkmcnt(0)
v_cvt_pk_bf16_f32 v40, v172, v173
v_mfma_f32_16x16x32_bf16 a[72:75], a[224:227], v[200:203], 0
s_barrier
v_exp_f32 v176, v176
v_mfma_f32_16x16x32_bf16 a[72:75], a[228:231], v[216:219], a[72:75]
v_mfma_f32_16x16x32_bf16 a[76:79], a[228:231], v[220:223], 0
s_add_u32 m0, s30, 24576
v_add_f32 v243, v243, v174
v_mfma_f32_16x16x32_bf16 a[76:79], a[224:227], v[204:207], a[76:79]
buffer_load_dwordx4 v10, s[4:7], s32 offen offset:0 lds
v_mfma_f32_16x16x32_bf16 a[80:83], a[232:235], v[192:195], 0
v_exp_f32 v177, v177
v_mfma_f32_16x16x32_bf16 a[80:83], a[236:239], v[208:211], a[80:83]
v_add_f32 v243, v243, v175
v_cvt_pk_bf16_f32 v41, v174, v175
v_mfma_f32_16x16x32_bf16 a[84:87], a[236:239], v[212:215], 0
v_exp_f32 v178, v178
v_mfma_f32_16x16x32_bf16 a[84:87], a[232:235], v[196:199], a[84:87]
v_mfma_f32_16x16x32_bf16 a[88:91], a[232:235], v[200:203], 0
ds_read_b128 a[192:195], v4 offset:36864
v_add_f32 v240, v240, v176
v_mfma_f32_16x16x32_bf16 a[88:91], a[236:239], v[216:219], a[88:91]
v_exp_f32 v179, v179
v_mfma_f32_16x16x32_bf16 a[92:95], a[236:239], v[220:223], 0
s_add_u32 m0, s30, 28544
ds_read_b128 a[196:199], v5 offset:36864
v_add_f32 v240, v240, v177
v_mfma_f32_16x16x32_bf16 a[92:95], a[232:235], v[204:207], a[92:95]
buffer_load_dwordx4 v10, s[4:7], s32 offen offset:128 lds
v_mfma_f32_16x16x32_bf16 a[96:99], a[240:243], v[192:195], 0
ds_read_b128 a[200:203], v4 offset:40960
v_cvt_pk_bf16_f32 v30, v176, v177
v_mfma_f32_16x16x32_bf16 a[96:99], a[244:247], v[208:211], a[96:99]
v_exp_f32 v180, v180
v_mfma_f32_16x16x32_bf16 a[100:103], a[244:247], v[212:215], 0
ds_read_b128 a[204:207], v5 offset:40960
v_add_f32 v240, v240, v178
v_mfma_f32_16x16x32_bf16 a[100:103], a[240:243], v[196:199], a[100:103]
v_exp_f32 v181, v181
v_mfma_f32_16x16x32_bf16 a[104:107], a[240:243], v[200:203], 0
ds_read_b128 a[208:211], v4 offset:45056
v_add_f32 v240, v240, v179
v_mfma_f32_16x16x32_bf16 a[104:107], a[244:247], v[216:219], a[104:107]
v_cvt_pk_bf16_f32 v31, v178, v179
v_mfma_f32_16x16x32_bf16 a[108:111], a[244:247], v[220:223], 0
s_add_u32 m0, s30, 32512
ds_read_b128 a[212:215], v5 offset:45056
v_add_f32 v241, v241, v180
v_mfma_f32_16x16x32_bf16 a[108:111], a[240:243], v[204:207], a[108:111]
buffer_load_dwordx4 v10, s[4:7], s32 offen offset:256 lds
v_mfma_f32_16x16x32_bf16 a[112:115], a[248:251], v[192:195], 0
s_add_u32 s32, s32, 12288
v_exp_f32 v182, v182
v_mfma_f32_16x16x32_bf16 a[112:115], a[252:255], v[208:211], a[112:115]
v_exp_f32 v183, v183
v_mfma_f32_16x16x32_bf16 a[116:119], a[252:255], v[212:215], 0
v_add_f32 v241, v241, v181
v_mfma_f32_16x16x32_bf16 a[116:119], a[248:251], v[196:199], a[116:119]
v_cvt_pk_bf16_f32 v34, v180, v181
v_add_f32 v241, v241, v182
v_mfma_f32_16x16x32_bf16 a[120:123], a[248:251], v[200:203], 0
v_exp_f32 v184, v184
v_mfma_f32_16x16x32_bf16 a[120:123], a[252:255], v[216:219], a[120:123]
s_add_u32 m0, s31, 0
v_mfma_f32_16x16x32_bf16 a[124:127], a[252:255], v[220:223], 0
buffer_load_dwordx4 v11, s[8:11], s33 offen offset:0 lds
v_mfma_f32_16x16x32_bf16 a[124:127], a[248:251], v[204:207], a[124:127]
s_waitcnt lgkmcnt(3)
v_exp_f32 v185, v185
v_mfma_f32_16x16x32_bf16 v[160:163], a[192:195], v[64:67], v[224:227]
v_add_f32 v241, v241, v183
v_mfma_f32_16x16x32_bf16 v[160:163], a[196:199], v[80:83], v[160:163]
v_cvt_pk_bf16_f32 v35, v182, v183
v_add_f32 v242, v242, v184
v_mfma_f32_16x16x32_bf16 v[160:163], a[200:203], v[96:99], v[160:163]
s_waitcnt lgkmcnt(0)
v_exp_f32 v186, v186
v_mfma_f32_16x16x32_bf16 v[160:163], a[204:207], v[112:115], v[160:163]
v_mfma_f32_16x16x32_bf16 v[160:163], a[208:211], v[128:131], v[160:163]
s_add_u32 m0, s31, 4096
ds_read_b128 a[216:219], v4 offset:38912
v_add_f32 v242, v242, v185
v_mfma_f32_16x16x32_bf16 v[160:163], a[212:215], v[144:147], v[160:163]
buffer_load_dwordx4 v23, s[8:11], s33 offen offset:0 lds
v_mfma_f32_16x16x32_bf16 v[164:167], a[212:215], v[148:151], v[228:231]
ds_read_b128 a[220:223], v5 offset:38912
v_cvt_pk_bf16_f32 v38, v184, v185
v_mfma_f32_16x16x32_bf16 v[164:167], a[208:211], v[132:135], v[164:167]
v_exp_f32 v187, v187
v_mfma_f32_16x16x32_bf16 v[164:167], a[204:207], v[116:119], v[164:167]
ds_read_b128 a[224:227], v4 offset:43008
v_add_f32 v242, v242, v186
v_mfma_f32_16x16x32_bf16 v[164:167], a[200:203], v[100:103], v[164:167]
v_exp_f32 v188, v188
v_mfma_f32_16x16x32_bf16 v[164:167], a[196:199], v[84:87], v[164:167]
ds_read_b128 a[228:231], v5 offset:43008
v_add_f32 v242, v242, v187
v_mfma_f32_16x16x32_bf16 v[164:167], a[192:195], v[68:71], v[164:167]
v_exp_f32 v189, v189
v_mfma_f32_16x16x32_bf16 v[168:171], a[192:195], v[72:75], v[232:235]
s_add_u32 m0, s31, 8064
ds_read_b128 a[232:235], v4 offset:47104
v_cvt_pk_bf16_f32 v39, v186, v187
v_mfma_f32_16x16x32_bf16 v[168:171], a[196:199], v[88:91], v[168:171]
buffer_load_dwordx4 v11, s[8:11], s33 offen offset:128 lds
v_mfma_f32_16x16x32_bf16 v[168:171], a[200:203], v[104:107], v[168:171]
ds_read_b128 a[236:239], v5 offset:47104
v_add_f32 v243, v243, v188
v_mfma_f32_16x16x32_bf16 v[168:171], a[204:207], v[120:123], v[168:171]
v_exp_f32 v190, v190
v_mfma_f32_16x16x32_bf16 v[168:171], a[208:211], v[136:139], v[168:171]
v_exp_f32 v191, v191
v_mfma_f32_16x16x32_bf16 v[168:171], a[212:215], v[152:155], v[168:171]
ds_read_b64_tr_b16 a[240:241], v6 offset:16384
v_add_f32 v243, v243, v189
v_mfma_f32_16x16x32_bf16 v[172:175], a[212:215], v[156:159], v[236:239]
ds_read_b64_tr_b16 a[242:243], v6 offset:18432
v_cvt_pk_bf16_f32 v42, v188, v189
v_mfma_f32_16x16x32_bf16 v[172:175], a[208:211], v[140:143], v[172:175]
s_add_u32 m0, s31, 12160
v_add_f32 v243, v243, v190
v_mfma_f32_16x16x32_bf16 v[172:175], a[204:207], v[124:127], v[172:175]
buffer_load_dwordx4 v23, s[8:11], s33 offen offset:128 lds
v_mfma_f32_16x16x32_bf16 v[172:175], a[200:203], v[108:111], v[172:175]
ds_read_b64_tr_b16 a[244:245], v6 offset:20480
v_add_f32 v243, v243, v191
v_mfma_f32_16x16x32_bf16 v[172:175], a[196:199], v[92:95], v[172:175]
ds_read_b64_tr_b16 a[246:247], v6 offset:22528
v_cvt_pk_bf16_f32 v43, v190, v191
v_mfma_f32_16x16x32_bf16 v[172:175], a[192:195], v[76:79], v[172:175]
s_waitcnt lgkmcnt(7)
v_mfma_f32_16x16x32_bf16 v[176:179], a[216:219], v[64:67], v[224:227]
v_exp_f32 v160, v160
v_mfma_f32_16x16x32_bf16 v[176:179], a[220:223], v[80:83], v[176:179]
ds_read_b64_tr_b16 a[248:249], v7 offset:16384
v_mfma_f32_16x16x32_bf16 v[176:179], a[224:227], v[96:99], v[176:179]
s_waitcnt lgkmcnt(5)
ds_read_b64_tr_b16 a[250:251], v7 offset:18432
v_mfma_f32_16x16x32_bf16 v[176:179], a[228:231], v[112:115], v[176:179]
v_exp_f32 v161, v161
v_mfma_f32_16x16x32_bf16 v[176:179], a[232:235], v[128:131], v[176:179]
v_exp_f32 v162, v162
v_mfma_f32_16x16x32_bf16 v[176:179], a[236:239], v[144:147], v[176:179]
ds_read_b64_tr_b16 a[252:253], v7 offset:20480
v_add_f32 v240, v240, v160
v_mfma_f32_16x16x32_bf16 v[180:183], a[236:239], v[148:151], v[228:231]
ds_read_b64_tr_b16 a[254:255], v7 offset:22528
v_add_f32 v240, v240, v161
v_mfma_f32_16x16x32_bf16 v[180:183], a[232:235], v[132:135], v[180:183]
v_exp_f32 v163, v163
v_mfma_f32_16x16x32_bf16 v[180:183], a[228:231], v[116:119], v[180:183]
v_cvt_pk_bf16_f32 v44, v160, v161
v_mfma_f32_16x16x32_bf16 v[180:183], a[224:227], v[100:103], v[180:183]
ds_read_b64_tr_b16 a[192:193], v8 offset:16384
v_add_f32 v240, v240, v162
v_mfma_f32_16x16x32_bf16 v[180:183], a[220:223], v[84:87], v[180:183]
ds_read_b64_tr_b16 a[194:195], v8 offset:18432
v_mfma_f32_16x16x32_bf16 v[180:183], a[216:219], v[68:71], v[180:183]
v_exp_f32 v164, v164
v_mfma_f32_16x16x32_bf16 v[184:187], a[216:219], v[72:75], v[232:235]
v_exp_f32 v165, v165
v_mfma_f32_16x16x32_bf16 v[184:187], a[220:223], v[88:91], v[184:187]
ds_read_b64_tr_b16 a[196:197], v8 offset:20480
v_add_f32 v240, v240, v163
v_mfma_f32_16x16x32_bf16 v[184:187], a[224:227], v[104:107], v[184:187]
ds_read_b64_tr_b16 a[198:199], v8 offset:22528
v_cvt_pk_bf16_f32 v45, v162, v163
v_mfma_f32_16x16x32_bf16 v[184:187], a[228:231], v[120:123], v[184:187]
v_exp_f32 v166, v166
v_mfma_f32_16x16x32_bf16 v[184:187], a[232:235], v[136:139], v[184:187]
v_add_f32 v241, v241, v164
v_mfma_f32_16x16x32_bf16 v[184:187], a[236:239], v[152:155], v[184:187]
ds_read_b64_tr_b16 a[200:201], v9 offset:16384
v_add_f32 v241, v241, v165
v_mfma_f32_16x16x32_bf16 v[188:191], a[236:239], v[156:159], v[236:239]
ds_read_b64_tr_b16 a[202:203], v9 offset:18432
v_cvt_pk_bf16_f32 v48, v164, v165
v_mfma_f32_16x16x32_bf16 v[188:191], a[232:235], v[140:143], v[188:191]
v_exp_f32 v167, v167
v_mfma_f32_16x16x32_bf16 v[188:191], a[228:231], v[124:127], v[188:191]
v_exp_f32 v168, v168
v_mfma_f32_16x16x32_bf16 v[188:191], a[224:227], v[108:111], v[188:191]
ds_read_b64_tr_b16 a[204:205], v9 offset:20480
v_mfma_f32_16x16x32_bf16 v[188:191], a[220:223], v[92:95], v[188:191]
ds_read_b64_tr_b16 a[206:207], v9 offset:22528
v_add_f32 v241, v241, v166
v_mfma_f32_16x16x32_bf16 v[188:191], a[216:219], v[76:79], v[188:191]
s_waitcnt lgkmcnt(9)
v_exp_f32 v169, v169
v_mfma_f32_16x16x32_bf16 a[128:131], a[240:243], v[192:195], 0
v_mfma_f32_16x16x32_bf16 a[128:131], a[244:247], v[208:211], a[128:131]
v_add_f32 v241, v241, v167
v_mfma_f32_16x16x32_bf16 a[132:135], a[244:247], v[212:215], 0
v_cvt_pk_bf16_f32 v49, v166, v167
v_add_f32 v242, v242, v168
v_mfma_f32_16x16x32_bf16 a[132:135], a[240:243], v[196:199], a[132:135]
v_exp_f32 v170, v170
v_mfma_f32_16x16x32_bf16 a[136:139], a[240:243], v[200:203], 0
v_mfma_f32_16x16x32_bf16 a[136:139], a[244:247], v[216:219], a[136:139]
v_exp_f32 v171, v171
v_mfma_f32_16x16x32_bf16 a[140:143], a[244:247], v[220:223], 0
v_mfma_f32_16x16x32_bf16 a[140:143], a[240:243], v[204:207], a[140:143]
s_waitcnt vmcnt(12) lgkmcnt(0)
v_add_f32 v242, v242, v169
v_cvt_pk_bf16_f32 v52, v168, v169
v_mfma_f32_16x16x32_bf16 a[144:147], a[248:251], v[192:195], 0
s_barrier
v_exp_f32 v172, v172
v_mfma_f32_16x16x32_bf16 a[144:147], a[252:255], v[208:211], a[144:147]
v_mfma_f32_16x16x32_bf16 a[148:151], a[252:255], v[212:215], 0
s_add_u32 m0, s30, 36864
buffer_store_dwordx2 v[26:27], v25, s[56:59], s47 offen sc1
v_add_f32 v242, v242, v170
v_mfma_f32_16x16x32_bf16 a[148:151], a[248:251], v[196:199], a[148:151]
buffer_load_dwordx4 v10, s[4:7], s32 offen offset:0 lds
v_mfma_f32_16x16x32_bf16 a[152:155], a[248:251], v[200:203], 0
ds_read_b128 a[208:211], v4 offset:0
v_add_f32 v242, v242, v171
v_mfma_f32_16x16x32_bf16 a[152:155], a[252:255], v[216:219], a[152:155]
v_exp_f32 v173, v173
v_mfma_f32_16x16x32_bf16 a[156:159], a[252:255], v[220:223], 0
ds_read_b128 a[212:215], v5 offset:0
v_cvt_pk_bf16_f32 v53, v170, v171
v_mfma_f32_16x16x32_bf16 a[156:159], a[248:251], v[204:207], a[156:159]
v_exp_f32 v174, v174
v_mfma_f32_16x16x32_bf16 a[160:163], a[192:195], v[192:195], 0
ds_read_b128 a[216:219], v4 offset:4096
v_add_f32 v243, v243, v172
v_mfma_f32_16x16x32_bf16 a[160:163], a[196:199], v[208:211], a[160:163]
v_exp_f32 v175, v175
v_mfma_f32_16x16x32_bf16 a[164:167], a[196:199], v[212:215], 0
s_add_u32 m0, s30, 40832
ds_read_b128 a[220:223], v5 offset:4096
v_add_f32 v243, v243, v173
v_mfma_f32_16x16x32_bf16 a[164:167], a[192:195], v[196:199], a[164:167]
buffer_load_dwordx4 v10, s[4:7], s32 offen offset:128 lds
v_mfma_f32_16x16x32_bf16 a[168:171], a[192:195], v[200:203], 0
ds_read_b128 a[224:227], v4 offset:8192
v_cvt_pk_bf16_f32 v56, v172, v173
v_mfma_f32_16x16x32_bf16 a[168:171], a[196:199], v[216:219], a[168:171]
v_exp_f32 v176, v176
v_mfma_f32_16x16x32_bf16 a[172:175], a[196:199], v[220:223], 0
ds_read_b128 a[228:231], v5 offset:8192
v_add_f32 v243, v243, v174
v_mfma_f32_16x16x32_bf16 a[172:175], a[192:195], v[204:207], a[172:175]
v_exp_f32 v177, v177
v_mfma_f32_16x16x32_bf16 a[176:179], a[200:203], v[192:195], 0
v_add_f32 v243, v243, v175
v_mfma_f32_16x16x32_bf16 a[176:179], a[204:207], v[208:211], a[176:179]
s_add_u32 m0, s30, 44800
v_cvt_pk_bf16_f32 v57, v174, v175
v_mfma_f32_16x16x32_bf16 a[180:183], a[204:207], v[212:215], 0
buffer_load_dwordx4 v10, s[4:7], s32 offen offset:256 lds
v_mfma_f32_16x16x32_bf16 a[180:183], a[200:203], v[196:199], a[180:183]
s_add_u32 s32, s32, 12288
v_exp_f32 v178, v178
v_mfma_f32_16x16x32_bf16 a[184:187], a[200:203], v[200:203], 0
v_add_f32 v240, v240, v176
v_add_f32 v240, v240, v177
v_mfma_f32_16x16x32_bf16 a[184:187], a[204:207], v[216:219], a[184:187]
v_exp_f32 v179, v179
v_mfma_f32_16x16x32_bf16 a[188:191], a[204:207], v[220:223], 0
v_mfma_f32_16x16x32_bf16 a[188:191], a[200:203], v[204:207], a[188:191]
s_waitcnt lgkmcnt(3)
v_cvt_pk_bf16_f32 v46, v176, v177
v_mfma_f32_16x16x32_bf16 v[160:163], a[208:211], v[64:67], v[224:227]
s_add_u32 m0, s31, 16128
v_exp_f32 v180, v180
v_mfma_f32_16x16x32_bf16 v[160:163], a[212:215], v[80:83], v[160:163]
buffer_load_dwordx4 v11, s[8:11], s33 offen offset:256 lds
v_mfma_f32_16x16x32_bf16 v[160:163], a[216:219], v[96:99], v[160:163]
s_waitcnt lgkmcnt(0)
v_add_f32 v240, v240, v178
v_add_f32 v240, v240, v179
v_mfma_f32_16x16x32_bf16 v[160:163], a[220:223], v[112:115], v[160:163]
v_exp_f32 v181, v181
v_mfma_f32_16x16x32_bf16 v[160:163], a[224:227], v[128:131], v[160:163]
ds_read_b128 a[232:235], v4 offset:2048
v_mfma_f32_16x16x32_bf16 v[160:163], a[228:231], v[144:147], v[160:163]
v_cvt_pk_bf16_f32 v47, v178, v179
v_mfma_f32_16x16x32_bf16 v[164:167], a[228:231], v[148:151], v[228:231]
ds_read_b128 a[236:239], v5 offset:2048
v_add_f32 v241, v241, v180
v_mfma_f32_16x16x32_bf16 v[164:167], a[224:227], v[132:135], v[164:167]
v_exp_f32 v182, v182
v_mfma_f32_16x16x32_bf16 v[164:167], a[220:223], v[116:119], v[164:167]
s_add_u32 m0, s31, 20224
ds_read_b128 a[240:243], v4 offset:6144
v_add_f32 v241, v241, v181
v_mfma_f32_16x16x32_bf16 v[164:167], a[216:219], v[100:103], v[164:167]
buffer_load_dwordx4 v23, s[8:11], s33 offen offset:256 lds
v_mfma_f32_16x16x32_bf16 v[164:167], a[212:215], v[84:87], v[164:167]
s_add_u32 s33, s33, 24576
ds_read_b128 a[244:247], v5 offset:6144
v_cvt_pk_bf16_f32 v50, v180, v181
v_mfma_f32_16x16x32_bf16 v[164:167], a[208:211], v[68:71], v[164:167]
v_exp_f32 v183, v183
v_mfma_f32_16x16x32_bf16 v[168:171], a[208:211], v[72:75], v[232:235]
ds_read_b128 a[248:251], v4 offset:10240
v_add_f32 v241, v241, v182
v_mfma_f32_16x16x32_bf16 v[168:171], a[212:215], v[88:91], v[168:171]
v_exp_f32 v184, v184
v_mfma_f32_16x16x32_bf16 v[168:171], a[216:219], v[104:107], v[168:171]
ds_read_b128 a[252:255], v5 offset:10240
v_add_f32 v241, v241, v183
v_mfma_f32_16x16x32_bf16 v[168:171], a[220:223], v[120:123], v[168:171]
v_exp_f32 v185, v185
v_mfma_f32_16x16x32_bf16 v[168:171], a[224:227], v[136:139], v[168:171]
ds_read_b64_tr_b16 a[192:193], v6 offset:24576
v_mfma_f32_16x16x32_bf16 v[168:171], a[228:231], v[152:155], v[168:171]
ds_read_b64_tr_b16 a[194:195], v6 offset:26624
v_cvt_pk_bf16_f32 v51, v182, v183
v_mfma_f32_16x16x32_bf16 v[172:175], a[228:231], v[156:159], v[236:239]
ds_read_b64_tr_b16 a[196:197], v6 offset:28672
v_add_f32 v242, v242, v184
v_mfma_f32_16x16x32_bf16 v[172:175], a[224:227], v[140:143], v[172:175]
ds_read_b64_tr_b16 a[198:199], v6 offset:30720
v_mfma_f32_16x16x32_bf16 v[172:175], a[220:223], v[124:127], v[172:175]
v_exp_f32 v186, v186
v_mfma_f32_16x16x32_bf16 v[172:175], a[216:219], v[108:111], v[172:175]
ds_read_b64_tr_b16 a[200:201], v7 offset:24576
v_add_f32 v242, v242, v185
v_mfma_f32_16x16x32_bf16 v[172:175], a[212:215], v[92:95], v[172:175]
ds_read_b64_tr_b16 a[202:203], v7 offset:26624
v_cvt_pk_bf16_f32 v54, v184, v185
v_mfma_f32_16x16x32_bf16 v[172:175], a[208:211], v[76:79], v[172:175]
s_waitcnt lgkmcnt(9)
v_exp_f32 v187, v187
v_mfma_f32_16x16x32_bf16 v[176:179], a[232:235], v[64:67], v[224:227]
v_exp_f32 v188, v188
v_mfma_f32_16x16x32_bf16 v[176:179], a[236:239], v[80:83], v[176:179]
ds_read_b64_tr_b16 a[204:205], v7 offset:28672
v_add_f32 v242, v242, v186
v_mfma_f32_16x16x32_bf16 v[176:179], a[240:243], v[96:99], v[176:179]
s_waitcnt lgkmcnt(7)
ds_read_b64_tr_b16 a[206:207], v7 offset:30720
v_add_f32 v242, v242, v187
v_mfma_f32_16x16x32_bf16 v[176:179], a[244:247], v[112:115], v[176:179]
v_exp_f32 v189, v189
v_mfma_f32_16x16x32_bf16 v[176:179], a[248:251], v[128:131], v[176:179]
v_cvt_pk_bf16_f32 v55, v186, v187
v_mfma_f32_16x16x32_bf16 v[176:179], a[252:255], v[144:147], v[176:179]
ds_read_b64_tr_b16 a[208:209], v8 offset:24576
v_add_f32 v243, v243, v188
v_mfma_f32_16x16x32_bf16 v[180:183], a[252:255], v[148:151], v[228:231]
ds_read_b64_tr_b16 a[210:211], v8 offset:26624
v_mfma_f32_16x16x32_bf16 v[180:183], a[248:251], v[132:135], v[180:183]
v_exp_f32 v190, v190
v_mfma_f32_16x16x32_bf16 v[180:183], a[244:247], v[116:119], v[180:183]
v_exp_f32 v191, v191
v_mfma_f32_16x16x32_bf16 v[180:183], a[240:243], v[100:103], v[180:183]
ds_read_b64_tr_b16 a[212:213], v8 offset:28672
v_add_f32 v243, v243, v189
v_mfma_f32_16x16x32_bf16 v[180:183], a[236:239], v[84:87], v[180:183]
ds_read_b64_tr_b16 a[214:215], v8 offset:30720
v_cvt_pk_bf16_f32 v58, v188, v189
v_mfma_f32_16x16x32_bf16 v[180:183], a[232:235], v[68:71], v[180:183]
v_add_f32 v243, v243, v190
v_mfma_f32_16x16x32_bf16 v[184:187], a[232:235], v[72:75], v[232:235]
v_add_f32 v243, v243, v191
v_mfma_f32_16x16x32_bf16 v[184:187], a[236:239], v[88:91], v[184:187]
ds_read_b64_tr_b16 a[216:217], v9 offset:24576
v_cvt_pk_bf16_f32 v59, v190, v191
v_mfma_f32_16x16x32_bf16 v[184:187], a[240:243], v[104:107], v[184:187]
ds_read_b64_tr_b16 a[218:219], v9 offset:26624
v_mfma_f32_16x16x32_bf16 v[184:187], a[244:247], v[120:123], v[184:187]
v_mfma_f32_16x16x32_bf16 v[184:187], a[248:251], v[136:139], v[184:187]
v_exp_f32 v160, v160
v_mfma_f32_16x16x32_bf16 v[184:187], a[252:255], v[152:155], v[184:187]
ds_read_b64_tr_b16 a[220:221], v9 offset:28672
v_mfma_f32_16x16x32_bf16 v[188:191], a[252:255], v[156:159], v[236:239]
ds_read_b64_tr_b16 a[222:223], v9 offset:30720
v_mfma_f32_16x16x32_bf16 v[188:191], a[248:251], v[140:143], v[188:191]
v_exp_f32 v161, v161
v_mfma_f32_16x16x32_bf16 v[188:191], a[244:247], v[124:127], v[188:191]
v_exp_f32 v162, v162
v_mfma_f32_16x16x32_bf16 v[188:191], a[240:243], v[108:111], v[188:191]
ds_read_b64_tr_b16 a[224:225], v6 offset:32768
v_add_f32 v240, v240, v160
v_mfma_f32_16x16x32_bf16 v[188:191], a[236:239], v[92:95], v[188:191]
ds_read_b64_tr_b16 a[226:227], v6 offset:34816
v_add_f32 v240, v240, v161
v_mfma_f32_16x16x32_bf16 v[188:191], a[232:235], v[76:79], v[188:191]
s_waitcnt lgkmcnt(9)
v_exp_f32 v163, v163
v_mfma_f32_16x16x32_bf16 a[0:3], a[192:195], v[28:31], a[0:3]
v_cvt_pk_bf16_f32 v192, v160, v161
v_mfma_f32_16x16x32_bf16 a[0:3], a[196:199], v[44:47], a[0:3]
ds_read_b64_tr_b16 a[228:229], v6 offset:36864
v_add_f32 v240, v240, v162
v_mfma_f32_16x16x32_bf16 a[4:7], a[196:199], v[48:51], a[4:7]
ds_read_b64_tr_b16 a[230:231], v6 offset:38912
v_mfma_f32_16x16x32_bf16 a[4:7], a[192:195], v[32:35], a[4:7]
v_exp_f32 v164, v164
v_mfma_f32_16x16x32_bf16 a[8:11], a[192:195], v[36:39], a[8:11]
v_exp_f32 v165, v165
v_mfma_f32_16x16x32_bf16 a[8:11], a[196:199], v[52:55], a[8:11]
ds_read_b64_tr_b16 a[232:233], v7 offset:32768
v_add_f32 v240, v240, v163
v_mfma_f32_16x16x32_bf16 a[12:15], a[196:199], v[56:59], a[12:15]
ds_read_b64_tr_b16 a[234:235], v7 offset:34816
v_cvt_pk_bf16_f32 v193, v162, v163
v_mfma_f32_16x16x32_bf16 a[12:15], a[192:195], v[40:43], a[12:15]
s_waitcnt lgkmcnt(9)
v_exp_f32 v166, v166
v_mfma_f32_16x16x32_bf16 a[16:19], a[200:203], v[28:31], a[16:19]
v_add_f32 v241, v241, v164
v_mfma_f32_16x16x32_bf16 a[16:19], a[204:207], v[44:47], a[16:19]
ds_read_b64_tr_b16 a[236:237], v7 offset:36864
v_add_f32 v241, v241, v165
v_mfma_f32_16x16x32_bf16 a[20:23], a[204:207], v[48:51], a[20:23]
ds_read_b64_tr_b16 a[238:239], v7 offset:38912
v_cvt_pk_bf16_f32 v196, v164, v165
v_mfma_f32_16x16x32_bf16 a[20:23], a[200:203], v[32:35], a[20:23]
v_exp_f32 v167, v167
v_mfma_f32_16x16x32_bf16 a[24:27], a[200:203], v[36:39], a[24:27]
v_exp_f32 v168, v168
v_mfma_f32_16x16x32_bf16 a[24:27], a[204:207], v[52:55], a[24:27]
ds_read_b64_tr_b16 a[240:241], v8 offset:32768
v_mfma_f32_16x16x32_bf16 a[28:31], a[204:207], v[56:59], a[28:31]
ds_read_b64_tr_b16 a[242:243], v8 offset:34816
v_add_f32 v241, v241, v166
v_mfma_f32_16x16x32_bf16 a[28:31], a[200:203], v[40:43], a[28:31]
s_waitcnt lgkmcnt(9)
v_exp_f32 v169, v169
v_mfma_f32_16x16x32_bf16 a[32:35], a[208:211], v[28:31], a[32:35]
v_mfma_f32_16x16x32_bf16 a[32:35], a[212:215], v[44:47], a[32:35]
ds_read_b64_tr_b16 a[244:245], v8 offset:36864
v_add_f32 v241, v241, v167
v_mfma_f32_16x16x32_bf16 a[36:39], a[212:215], v[48:51], a[36:39]
ds_read_b64_tr_b16 a[246:247], v8 offset:38912
v_cvt_pk_bf16_f32 v197, v166, v167
v_mfma_f32_16x16x32_bf16 a[36:39], a[208:211], v[32:35], a[36:39]
v_exp_f32 v170, v170
v_mfma_f32_16x16x32_bf16 a[40:43], a[208:211], v[36:39], a[40:43]
v_add_f32 v242, v242, v168
v_mfma_f32_16x16x32_bf16 a[40:43], a[212:215], v[52:55], a[40:43]
ds_read_b64_tr_b16 a[248:249], v9 offset:32768
v_add_f32 v242, v242, v169
v_mfma_f32_16x16x32_bf16 a[44:47], a[212:215], v[56:59], a[44:47]
ds_read_b64_tr_b16 a[250:251], v9 offset:34816
v_cvt_pk_bf16_f32 v200, v168, v169
v_mfma_f32_16x16x32_bf16 a[44:47], a[208:211], v[40:43], a[44:47]
s_waitcnt lgkmcnt(9)
v_exp_f32 v171, v171
v_mfma_f32_16x16x32_bf16 a[48:51], a[216:219], v[28:31], a[48:51]
v_exp_f32 v172, v172
v_mfma_f32_16x16x32_bf16 a[48:51], a[220:223], v[44:47], a[48:51]
ds_read_b64_tr_b16 a[252:253], v9 offset:36864
v_mfma_f32_16x16x32_bf16 a[52:55], a[220:223], v[48:51], a[52:55]
ds_read_b64_tr_b16 a[254:255], v9 offset:38912
v_add_f32 v242, v242, v170
v_mfma_f32_16x16x32_bf16 a[52:55], a[216:219], v[32:35], a[52:55]
v_exp_f32 v173, v173
v_mfma_f32_16x16x32_bf16 a[56:59], a[216:219], v[36:39], a[56:59]
v_add_f32 v242, v242, v171
v_mfma_f32_16x16x32_bf16 a[56:59], a[220:223], v[52:55], a[56:59]
v_cvt_pk_bf16_f32 v201, v170, v171
v_mfma_f32_16x16x32_bf16 a[60:63], a[220:223], v[56:59], a[60:63]
v_exp_f32 v174, v174
v_mfma_f32_16x16x32_bf16 a[60:63], a[216:219], v[40:43], a[60:63]
s_waitcnt lgkmcnt(9)
v_mfma_f32_16x16x32_bf16 a[64:67], a[224:227], v[28:31], a[64:67]
v_add_f32 v243, v243, v172
v_mfma_f32_16x16x32_bf16 a[64:67], a[228:231], v[44:47], a[64:67]
v_exp_f32 v175, v175
v_mfma_f32_16x16x32_bf16 a[68:71], a[228:231], v[48:51], a[68:71]
v_add_f32 v243, v243, v173
v_mfma_f32_16x16x32_bf16 a[68:71], a[224:227], v[32:35], a[68:71]
s_waitcnt vmcnt(13) lgkmcnt(0)
v_cvt_pk_bf16_f32 v204, v172, v173
v_mfma_f32_16x16x32_bf16 a[72:75], a[224:227], v[36:39], a[72:75]
s_barrier
v_exp_f32 v176, v176
v_mfma_f32_16x16x32_bf16 a[72:75], a[228:231], v[52:55], a[72:75]
v_mfma_f32_16x16x32_bf16 a[76:79], a[228:231], v[56:59], a[76:79]
s_add_u32 m0, s30, 0
v_add_f32 v243, v243, v174
v_mfma_f32_16x16x32_bf16 a[76:79], a[224:227], v[40:43], a[76:79]
buffer_load_dwordx4 v10, s[4:7], s32 offen offset:0 lds
v_mfma_f32_16x16x32_bf16 a[80:83], a[232:235], v[28:31], a[80:83]
v_exp_f32 v177, v177
v_mfma_f32_16x16x32_bf16 a[80:83], a[236:239], v[44:47], a[80:83]
v_add_f32 v243, v243, v175
v_cvt_pk_bf16_f32 v205, v174, v175
v_mfma_f32_16x16x32_bf16 a[84:87], a[236:239], v[48:51], a[84:87]
v_exp_f32 v178, v178
v_mfma_f32_16x16x32_bf16 a[84:87], a[232:235], v[32:35], a[84:87]
v_mfma_f32_16x16x32_bf16 a[88:91], a[232:235], v[36:39], a[88:91]
ds_read_b128 a[192:195], v4 offset:12288
v_add_f32 v240, v240, v176
v_mfma_f32_16x16x32_bf16 a[88:91], a[236:239], v[52:55], a[88:91]
v_exp_f32 v179, v179
v_mfma_f32_16x16x32_bf16 a[92:95], a[236:239], v[56:59], a[92:95]
s_add_u32 m0, s30, 3968
ds_read_b128 a[196:199], v5 offset:12288
v_add_f32 v240, v240, v177
v_mfma_f32_16x16x32_bf16 a[92:95], a[232:235], v[40:43], a[92:95]
buffer_load_dwordx4 v10, s[4:7], s32 offen offset:128 lds
v_mfma_f32_16x16x32_bf16 a[96:99], a[240:243], v[28:31], a[96:99]
ds_read_b128 a[200:203], v4 offset:16384
v_cvt_pk_bf16_f32 v194, v176, v177
v_mfma_f32_16x16x32_bf16 a[96:99], a[244:247], v[44:47], a[96:99]
v_exp_f32 v180, v180
v_mfma_f32_16x16x32_bf16 a[100:103], a[244:247], v[48:51], a[100:103]
ds_read_b128 a[204:207], v5 offset:16384
v_add_f32 v240, v240, v178
v_mfma_f32_16x16x32_bf16 a[100:103], a[240:243], v[32:35], a[100:103]
v_exp_f32 v181, v181
v_mfma_f32_16x16x32_bf16 a[104:107], a[240:243], v[36:39], a[104:107]
ds_read_b128 a[208:211], v4 offset:20480
v_add_f32 v240, v240, v179
v_mfma_f32_16x16x32_bf16 a[104:107], a[244:247], v[52:55], a[104:107]
v_cvt_pk_bf16_f32 v195, v178, v179
v_mfma_f32_16x16x32_bf16 a[108:111], a[244:247], v[56:59], a[108:111]
s_add_u32 m0, s30, 7936
ds_read_b128 a[212:215], v5 offset:20480
v_add_f32 v241, v241, v180
v_mfma_f32_16x16x32_bf16 a[108:111], a[240:243], v[40:43], a[108:111]
buffer_load_dwordx4 v10, s[4:7], s32 offen offset:256 lds
v_mfma_f32_16x16x32_bf16 a[112:115], a[248:251], v[28:31], a[112:115]
s_add_u32 s32, s32, 12288
v_exp_f32 v182, v182
v_mfma_f32_16x16x32_bf16 a[112:115], a[252:255], v[44:47], a[112:115]
v_exp_f32 v183, v183
v_mfma_f32_16x16x32_bf16 a[116:119], a[252:255], v[48:51], a[116:119]
v_add_f32 v241, v241, v181
v_mfma_f32_16x16x32_bf16 a[116:119], a[248:251], v[32:35], a[116:119]
v_cvt_pk_bf16_f32 v198, v180, v181
v_add_f32 v241, v241, v182
v_mfma_f32_16x16x32_bf16 a[120:123], a[248:251], v[36:39], a[120:123]
v_exp_f32 v184, v184
v_mfma_f32_16x16x32_bf16 a[120:123], a[252:255], v[52:55], a[120:123]
s_add_u32 m0, s31, 24576
v_mfma_f32_16x16x32_bf16 a[124:127], a[252:255], v[56:59], a[124:127]
buffer_load_dwordx4 v11, s[8:11], s33 offen offset:0 lds
v_mfma_f32_16x16x32_bf16 a[124:127], a[248:251], v[40:43], a[124:127]
s_waitcnt lgkmcnt(3)
v_exp_f32 v185, v185
s_mov_b32 s34, 13
.p2align 6
K_loop:
v_mfma_f32_16x16x32_bf16 v[160:163], a[192:195], v[64:67], v[224:227]
v_add_f32 v241, v241, v183
v_mfma_f32_16x16x32_bf16 v[160:163], a[196:199], v[80:83], v[160:163]
v_cvt_pk_bf16_f32 v199, v182, v183
v_add_f32 v242, v242, v184
v_mfma_f32_16x16x32_bf16 v[160:163], a[200:203], v[96:99], v[160:163]
s_waitcnt lgkmcnt(0)
v_exp_f32 v186, v186
v_mfma_f32_16x16x32_bf16 v[160:163], a[204:207], v[112:115], v[160:163]
v_mfma_f32_16x16x32_bf16 v[160:163], a[208:211], v[128:131], v[160:163]
s_add_u32 m0, s31, 28672
ds_read_b128 a[216:219], v4 offset:14336
v_add_f32 v242, v242, v185
v_mfma_f32_16x16x32_bf16 v[160:163], a[212:215], v[144:147], v[160:163]
buffer_load_dwordx4 v23, s[8:11], s33 offen offset:0 lds
v_mfma_f32_16x16x32_bf16 v[164:167], a[212:215], v[148:151], v[228:231]
ds_read_b128 a[220:223], v5 offset:14336
v_cvt_pk_bf16_f32 v202, v184, v185
v_mfma_f32_16x16x32_bf16 v[164:167], a[208:211], v[132:135], v[164:167]
v_exp_f32 v187, v187
v_mfma_f32_16x16x32_bf16 v[164:167], a[204:207], v[116:119], v[164:167]
ds_read_b128 a[224:227], v4 offset:18432
v_add_f32 v242, v242, v186
v_mfma_f32_16x16x32_bf16 v[164:167], a[200:203], v[100:103], v[164:167]
v_exp_f32 v188, v188
v_mfma_f32_16x16x32_bf16 v[164:167], a[196:199], v[84:87], v[164:167]
ds_read_b128 a[228:231], v5 offset:18432
v_add_f32 v242, v242, v187
v_mfma_f32_16x16x32_bf16 v[164:167], a[192:195], v[68:71], v[164:167]
v_exp_f32 v189, v189
v_mfma_f32_16x16x32_bf16 v[168:171], a[192:195], v[72:75], v[232:235]
s_add_u32 m0, s31, 32640
ds_read_b128 a[232:235], v4 offset:22528
v_cvt_pk_bf16_f32 v203, v186, v187
v_mfma_f32_16x16x32_bf16 v[168:171], a[196:199], v[88:91], v[168:171]
buffer_load_dwordx4 v11, s[8:11], s33 offen offset:128 lds
v_mfma_f32_16x16x32_bf16 v[168:171], a[200:203], v[104:107], v[168:171]
ds_read_b128 a[236:239], v5 offset:22528
v_add_f32 v243, v243, v188
v_mfma_f32_16x16x32_bf16 v[168:171], a[204:207], v[120:123], v[168:171]
v_exp_f32 v190, v190
v_mfma_f32_16x16x32_bf16 v[168:171], a[208:211], v[136:139], v[168:171]
v_exp_f32 v191, v191
v_mfma_f32_16x16x32_bf16 v[168:171], a[212:215], v[152:155], v[168:171]
ds_read_b64_tr_b16 a[240:241], v6 offset:40960
v_add_f32 v243, v243, v189
v_mfma_f32_16x16x32_bf16 v[172:175], a[212:215], v[156:159], v[236:239]
ds_read_b64_tr_b16 a[242:243], v6 offset:43008
v_cvt_pk_bf16_f32 v206, v188, v189
v_mfma_f32_16x16x32_bf16 v[172:175], a[208:211], v[140:143], v[172:175]
s_add_u32 m0, s31, 36736
v_add_f32 v243, v243, v190
v_mfma_f32_16x16x32_bf16 v[172:175], a[204:207], v[124:127], v[172:175]
buffer_load_dwordx4 v23, s[8:11], s33 offen offset:128 lds
v_mfma_f32_16x16x32_bf16 v[172:175], a[200:203], v[108:111], v[172:175]
ds_read_b64_tr_b16 a[244:245], v6 offset:45056
v_add_f32 v243, v243, v191
v_mfma_f32_16x16x32_bf16 v[172:175], a[196:199], v[92:95], v[172:175]
ds_read_b64_tr_b16 a[246:247], v6 offset:47104
v_cvt_pk_bf16_f32 v207, v190, v191
v_mfma_f32_16x16x32_bf16 v[172:175], a[192:195], v[76:79], v[172:175]
s_waitcnt lgkmcnt(7)
v_mfma_f32_16x16x32_bf16 v[176:179], a[216:219], v[64:67], v[224:227]
v_exp_f32 v160, v160
v_mfma_f32_16x16x32_bf16 v[176:179], a[220:223], v[80:83], v[176:179]
ds_read_b64_tr_b16 a[248:249], v7 offset:40960
v_mfma_f32_16x16x32_bf16 v[176:179], a[224:227], v[96:99], v[176:179]
s_waitcnt lgkmcnt(5)
ds_read_b64_tr_b16 a[250:251], v7 offset:43008
v_mfma_f32_16x16x32_bf16 v[176:179], a[228:231], v[112:115], v[176:179]
v_exp_f32 v161, v161
v_mfma_f32_16x16x32_bf16 v[176:179], a[232:235], v[128:131], v[176:179]
v_exp_f32 v162, v162
v_mfma_f32_16x16x32_bf16 v[176:179], a[236:239], v[144:147], v[176:179]
ds_read_b64_tr_b16 a[252:253], v7 offset:45056
v_add_f32 v240, v240, v160
v_mfma_f32_16x16x32_bf16 v[180:183], a[236:239], v[148:151], v[228:231]
ds_read_b64_tr_b16 a[254:255], v7 offset:47104
v_add_f32 v240, v240, v161
v_mfma_f32_16x16x32_bf16 v[180:183], a[232:235], v[132:135], v[180:183]
v_exp_f32 v163, v163
v_mfma_f32_16x16x32_bf16 v[180:183], a[228:231], v[116:119], v[180:183]
v_cvt_pk_bf16_f32 v208, v160, v161
v_mfma_f32_16x16x32_bf16 v[180:183], a[224:227], v[100:103], v[180:183]
ds_read_b64_tr_b16 a[192:193], v8 offset:40960
v_add_f32 v240, v240, v162
v_mfma_f32_16x16x32_bf16 v[180:183], a[220:223], v[84:87], v[180:183]
ds_read_b64_tr_b16 a[194:195], v8 offset:43008
v_mfma_f32_16x16x32_bf16 v[180:183], a[216:219], v[68:71], v[180:183]
v_exp_f32 v164, v164
v_mfma_f32_16x16x32_bf16 v[184:187], a[216:219], v[72:75], v[232:235]
v_exp_f32 v165, v165
v_mfma_f32_16x16x32_bf16 v[184:187], a[220:223], v[88:91], v[184:187]
ds_read_b64_tr_b16 a[196:197], v8 offset:45056
v_add_f32 v240, v240, v163
v_mfma_f32_16x16x32_bf16 v[184:187], a[224:227], v[104:107], v[184:187]
ds_read_b64_tr_b16 a[198:199], v8 offset:47104
v_cvt_pk_bf16_f32 v209, v162, v163
v_mfma_f32_16x16x32_bf16 v[184:187], a[228:231], v[120:123], v[184:187]
v_exp_f32 v166, v166
v_mfma_f32_16x16x32_bf16 v[184:187], a[232:235], v[136:139], v[184:187]
v_add_f32 v241, v241, v164
v_mfma_f32_16x16x32_bf16 v[184:187], a[236:239], v[152:155], v[184:187]
ds_read_b64_tr_b16 a[200:201], v9 offset:40960
v_add_f32 v241, v241, v165
v_mfma_f32_16x16x32_bf16 v[188:191], a[236:239], v[156:159], v[236:239]
ds_read_b64_tr_b16 a[202:203], v9 offset:43008
v_cvt_pk_bf16_f32 v212, v164, v165
v_mfma_f32_16x16x32_bf16 v[188:191], a[232:235], v[140:143], v[188:191]
v_exp_f32 v167, v167
v_mfma_f32_16x16x32_bf16 v[188:191], a[228:231], v[124:127], v[188:191]
v_exp_f32 v168, v168
v_mfma_f32_16x16x32_bf16 v[188:191], a[224:227], v[108:111], v[188:191]
ds_read_b64_tr_b16 a[204:205], v9 offset:45056
v_mfma_f32_16x16x32_bf16 v[188:191], a[220:223], v[92:95], v[188:191]
ds_read_b64_tr_b16 a[206:207], v9 offset:47104
v_add_f32 v241, v241, v166
v_mfma_f32_16x16x32_bf16 v[188:191], a[216:219], v[76:79], v[188:191]
s_waitcnt lgkmcnt(9)
v_exp_f32 v169, v169
v_mfma_f32_16x16x32_bf16 a[128:131], a[240:243], v[28:31], a[128:131]
v_mfma_f32_16x16x32_bf16 a[128:131], a[244:247], v[44:47], a[128:131]
v_add_f32 v241, v241, v167
v_mfma_f32_16x16x32_bf16 a[132:135], a[244:247], v[48:51], a[132:135]
v_cvt_pk_bf16_f32 v213, v166, v167
v_add_f32 v242, v242, v168
v_mfma_f32_16x16x32_bf16 a[132:135], a[240:243], v[32:35], a[132:135]
v_exp_f32 v170, v170
v_mfma_f32_16x16x32_bf16 a[136:139], a[240:243], v[36:39], a[136:139]
v_mfma_f32_16x16x32_bf16 a[136:139], a[244:247], v[52:55], a[136:139]
v_exp_f32 v171, v171
v_mfma_f32_16x16x32_bf16 a[140:143], a[244:247], v[56:59], a[140:143]
v_mfma_f32_16x16x32_bf16 a[140:143], a[240:243], v[40:43], a[140:143]
s_waitcnt vmcnt(12) lgkmcnt(0)
v_add_f32 v242, v242, v169
v_cvt_pk_bf16_f32 v216, v168, v169
v_mfma_f32_16x16x32_bf16 a[144:147], a[248:251], v[28:31], a[144:147]
s_barrier
v_exp_f32 v172, v172
v_mfma_f32_16x16x32_bf16 a[144:147], a[252:255], v[44:47], a[144:147]
v_mfma_f32_16x16x32_bf16 a[148:151], a[252:255], v[48:51], a[148:151]
s_add_u32 m0, s30, 12288
v_add_f32 v242, v242, v170
v_mfma_f32_16x16x32_bf16 a[148:151], a[248:251], v[32:35], a[148:151]
buffer_load_dwordx4 v10, s[4:7], s32 offen offset:0 lds
v_mfma_f32_16x16x32_bf16 a[152:155], a[248:251], v[36:39], a[152:155]
ds_read_b128 a[208:211], v4 offset:24576
v_add_f32 v242, v242, v171
v_mfma_f32_16x16x32_bf16 a[152:155], a[252:255], v[52:55], a[152:155]
v_exp_f32 v173, v173
v_mfma_f32_16x16x32_bf16 a[156:159], a[252:255], v[56:59], a[156:159]
ds_read_b128 a[212:215], v5 offset:24576
v_cvt_pk_bf16_f32 v217, v170, v171
v_mfma_f32_16x16x32_bf16 a[156:159], a[248:251], v[40:43], a[156:159]
v_exp_f32 v174, v174
v_mfma_f32_16x16x32_bf16 a[160:163], a[192:195], v[28:31], a[160:163]
ds_read_b128 a[216:219], v4 offset:28672
v_add_f32 v243, v243, v172
v_mfma_f32_16x16x32_bf16 a[160:163], a[196:199], v[44:47], a[160:163]
v_exp_f32 v175, v175
v_mfma_f32_16x16x32_bf16 a[164:167], a[196:199], v[48:51], a[164:167]
s_add_u32 m0, s30, 16256
ds_read_b128 a[220:223], v5 offset:28672
v_add_f32 v243, v243, v173
v_mfma_f32_16x16x32_bf16 a[164:167], a[192:195], v[32:35], a[164:167]
buffer_load_dwordx4 v10, s[4:7], s32 offen offset:128 lds
v_mfma_f32_16x16x32_bf16 a[168:171], a[192:195], v[36:39], a[168:171]
ds_read_b128 a[224:227], v4 offset:32768
v_cvt_pk_bf16_f32 v220, v172, v173
v_mfma_f32_16x16x32_bf16 a[168:171], a[196:199], v[52:55], a[168:171]
v_exp_f32 v176, v176
v_mfma_f32_16x16x32_bf16 a[172:175], a[196:199], v[56:59], a[172:175]
ds_read_b128 a[228:231], v5 offset:32768
v_add_f32 v243, v243, v174
v_mfma_f32_16x16x32_bf16 a[172:175], a[192:195], v[40:43], a[172:175]
v_exp_f32 v177, v177
v_mfma_f32_16x16x32_bf16 a[176:179], a[200:203], v[28:31], a[176:179]
v_add_f32 v243, v243, v175
v_mfma_f32_16x16x32_bf16 a[176:179], a[204:207], v[44:47], a[176:179]
s_add_u32 m0, s30, 20224
v_cvt_pk_bf16_f32 v221, v174, v175
v_mfma_f32_16x16x32_bf16 a[180:183], a[204:207], v[48:51], a[180:183]
buffer_load_dwordx4 v10, s[4:7], s32 offen offset:256 lds
v_mfma_f32_16x16x32_bf16 a[180:183], a[200:203], v[32:35], a[180:183]
s_add_u32 s32, s32, 12288
v_exp_f32 v178, v178
v_mfma_f32_16x16x32_bf16 a[184:187], a[200:203], v[36:39], a[184:187]
v_add_f32 v240, v240, v176
v_add_f32 v240, v240, v177
v_mfma_f32_16x16x32_bf16 a[184:187], a[204:207], v[52:55], a[184:187]
v_exp_f32 v179, v179
v_mfma_f32_16x16x32_bf16 a[188:191], a[204:207], v[56:59], a[188:191]
v_mfma_f32_16x16x32_bf16 a[188:191], a[200:203], v[40:43], a[188:191]
s_waitcnt lgkmcnt(3)
v_cvt_pk_bf16_f32 v210, v176, v177
v_mfma_f32_16x16x32_bf16 v[160:163], a[208:211], v[64:67], v[224:227]
s_add_u32 m0, s31, 40704
v_exp_f32 v180, v180
v_mfma_f32_16x16x32_bf16 v[160:163], a[212:215], v[80:83], v[160:163]
buffer_load_dwordx4 v11, s[8:11], s33 offen offset:256 lds
v_mfma_f32_16x16x32_bf16 v[160:163], a[216:219], v[96:99], v[160:163]
s_waitcnt lgkmcnt(0)
v_add_f32 v240, v240, v178
v_add_f32 v240, v240, v179
v_mfma_f32_16x16x32_bf16 v[160:163], a[220:223], v[112:115], v[160:163]
v_exp_f32 v181, v181
v_mfma_f32_16x16x32_bf16 v[160:163], a[224:227], v[128:131], v[160:163]
ds_read_b128 a[232:235], v4 offset:26624
v_mfma_f32_16x16x32_bf16 v[160:163], a[228:231], v[144:147], v[160:163]
v_cvt_pk_bf16_f32 v211, v178, v179
v_mfma_f32_16x16x32_bf16 v[164:167], a[228:231], v[148:151], v[228:231]
ds_read_b128 a[236:239], v5 offset:26624
v_add_f32 v241, v241, v180
v_mfma_f32_16x16x32_bf16 v[164:167], a[224:227], v[132:135], v[164:167]
v_exp_f32 v182, v182
v_mfma_f32_16x16x32_bf16 v[164:167], a[220:223], v[116:119], v[164:167]
s_add_u32 m0, s31, 44800
ds_read_b128 a[240:243], v4 offset:30720
v_add_f32 v241, v241, v181
v_mfma_f32_16x16x32_bf16 v[164:167], a[216:219], v[100:103], v[164:167]
buffer_load_dwordx4 v23, s[8:11], s33 offen offset:256 lds
v_mfma_f32_16x16x32_bf16 v[164:167], a[212:215], v[84:87], v[164:167]
s_add_u32 s33, s33, 24576
ds_read_b128 a[244:247], v5 offset:30720
v_cvt_pk_bf16_f32 v214, v180, v181
v_mfma_f32_16x16x32_bf16 v[164:167], a[208:211], v[68:71], v[164:167]
v_exp_f32 v183, v183
v_mfma_f32_16x16x32_bf16 v[168:171], a[208:211], v[72:75], v[232:235]
ds_read_b128 a[248:251], v4 offset:34816
v_add_f32 v241, v241, v182
v_mfma_f32_16x16x32_bf16 v[168:171], a[212:215], v[88:91], v[168:171]
v_exp_f32 v184, v184
v_mfma_f32_16x16x32_bf16 v[168:171], a[216:219], v[104:107], v[168:171]
ds_read_b128 a[252:255], v5 offset:34816
v_add_f32 v241, v241, v183
v_mfma_f32_16x16x32_bf16 v[168:171], a[220:223], v[120:123], v[168:171]
v_exp_f32 v185, v185
v_mfma_f32_16x16x32_bf16 v[168:171], a[224:227], v[136:139], v[168:171]
ds_read_b64_tr_b16 a[192:193], v6 offset:0
v_mfma_f32_16x16x32_bf16 v[168:171], a[228:231], v[152:155], v[168:171]
ds_read_b64_tr_b16 a[194:195], v6 offset:2048
v_cvt_pk_bf16_f32 v215, v182, v183
v_mfma_f32_16x16x32_bf16 v[172:175], a[228:231], v[156:159], v[236:239]
ds_read_b64_tr_b16 a[196:197], v6 offset:4096
v_add_f32 v242, v242, v184
v_mfma_f32_16x16x32_bf16 v[172:175], a[224:227], v[140:143], v[172:175]
ds_read_b64_tr_b16 a[198:199], v6 offset:6144
v_mfma_f32_16x16x32_bf16 v[172:175], a[220:223], v[124:127], v[172:175]
v_exp_f32 v186, v186
v_mfma_f32_16x16x32_bf16 v[172:175], a[216:219], v[108:111], v[172:175]
ds_read_b64_tr_b16 a[200:201], v7 offset:0
v_add_f32 v242, v242, v185
v_mfma_f32_16x16x32_bf16 v[172:175], a[212:215], v[92:95], v[172:175]
ds_read_b64_tr_b16 a[202:203], v7 offset:2048
v_cvt_pk_bf16_f32 v218, v184, v185
v_mfma_f32_16x16x32_bf16 v[172:175], a[208:211], v[76:79], v[172:175]
s_waitcnt lgkmcnt(9)
v_exp_f32 v187, v187
v_mfma_f32_16x16x32_bf16 v[176:179], a[232:235], v[64:67], v[224:227]
v_exp_f32 v188, v188
v_mfma_f32_16x16x32_bf16 v[176:179], a[236:239], v[80:83], v[176:179]
ds_read_b64_tr_b16 a[204:205], v7 offset:4096
v_add_f32 v242, v242, v186
v_mfma_f32_16x16x32_bf16 v[176:179], a[240:243], v[96:99], v[176:179]
s_waitcnt lgkmcnt(7)
ds_read_b64_tr_b16 a[206:207], v7 offset:6144
v_add_f32 v242, v242, v187
v_mfma_f32_16x16x32_bf16 v[176:179], a[244:247], v[112:115], v[176:179]
v_exp_f32 v189, v189
v_mfma_f32_16x16x32_bf16 v[176:179], a[248:251], v[128:131], v[176:179]
v_cvt_pk_bf16_f32 v219, v186, v187
v_mfma_f32_16x16x32_bf16 v[176:179], a[252:255], v[144:147], v[176:179]
ds_read_b64_tr_b16 a[208:209], v8 offset:0
v_add_f32 v243, v243, v188
v_mfma_f32_16x16x32_bf16 v[180:183], a[252:255], v[148:151], v[228:231]
ds_read_b64_tr_b16 a[210:211], v8 offset:2048
v_mfma_f32_16x16x32_bf16 v[180:183], a[248:251], v[132:135], v[180:183]
v_exp_f32 v190, v190
v_mfma_f32_16x16x32_bf16 v[180:183], a[244:247], v[116:119], v[180:183]
v_exp_f32 v191, v191
v_mfma_f32_16x16x32_bf16 v[180:183], a[240:243], v[100:103], v[180:183]
ds_read_b64_tr_b16 a[212:213], v8 offset:4096
v_add_f32 v243, v243, v189
v_mfma_f32_16x16x32_bf16 v[180:183], a[236:239], v[84:87], v[180:183]
ds_read_b64_tr_b16 a[214:215], v8 offset:6144
v_cvt_pk_bf16_f32 v222, v188, v189
v_mfma_f32_16x16x32_bf16 v[180:183], a[232:235], v[68:71], v[180:183]
v_add_f32 v243, v243, v190
v_mfma_f32_16x16x32_bf16 v[184:187], a[232:235], v[72:75], v[232:235]
v_add_f32 v243, v243, v191
v_mfma_f32_16x16x32_bf16 v[184:187], a[236:239], v[88:91], v[184:187]
ds_read_b64_tr_b16 a[216:217], v9 offset:0
v_cvt_pk_bf16_f32 v223, v190, v191
v_mfma_f32_16x16x32_bf16 v[184:187], a[240:243], v[104:107], v[184:187]
ds_read_b64_tr_b16 a[218:219], v9 offset:2048
v_mfma_f32_16x16x32_bf16 v[184:187], a[244:247], v[120:123], v[184:187]
v_mfma_f32_16x16x32_bf16 v[184:187], a[248:251], v[136:139], v[184:187]
v_exp_f32 v160, v160
v_mfma_f32_16x16x32_bf16 v[184:187], a[252:255], v[152:155], v[184:187]
ds_read_b64_tr_b16 a[220:221], v9 offset:4096
v_mfma_f32_16x16x32_bf16 v[188:191], a[252:255], v[156:159], v[236:239]
ds_read_b64_tr_b16 a[222:223], v9 offset:6144
v_mfma_f32_16x16x32_bf16 v[188:191], a[248:251], v[140:143], v[188:191]
v_exp_f32 v161, v161
v_mfma_f32_16x16x32_bf16 v[188:191], a[244:247], v[124:127], v[188:191]
v_exp_f32 v162, v162
v_mfma_f32_16x16x32_bf16 v[188:191], a[240:243], v[108:111], v[188:191]
ds_read_b64_tr_b16 a[224:225], v6 offset:8192
v_add_f32 v240, v240, v160
v_mfma_f32_16x16x32_bf16 v[188:191], a[236:239], v[92:95], v[188:191]
ds_read_b64_tr_b16 a[226:227], v6 offset:10240
v_add_f32 v240, v240, v161
v_mfma_f32_16x16x32_bf16 v[188:191], a[232:235], v[76:79], v[188:191]
s_waitcnt lgkmcnt(9)
v_exp_f32 v163, v163
v_mfma_f32_16x16x32_bf16 a[0:3], a[192:195], v[192:195], a[0:3]
v_cvt_pk_bf16_f32 v28, v160, v161
v_mfma_f32_16x16x32_bf16 a[0:3], a[196:199], v[208:211], a[0:3]
ds_read_b64_tr_b16 a[228:229], v6 offset:12288
v_add_f32 v240, v240, v162
v_mfma_f32_16x16x32_bf16 a[4:7], a[196:199], v[212:215], a[4:7]
ds_read_b64_tr_b16 a[230:231], v6 offset:14336
v_mfma_f32_16x16x32_bf16 a[4:7], a[192:195], v[196:199], a[4:7]
v_exp_f32 v164, v164
v_mfma_f32_16x16x32_bf16 a[8:11], a[192:195], v[200:203], a[8:11]
v_exp_f32 v165, v165
v_mfma_f32_16x16x32_bf16 a[8:11], a[196:199], v[216:219], a[8:11]
ds_read_b64_tr_b16 a[232:233], v7 offset:8192
v_add_f32 v240, v240, v163
v_mfma_f32_16x16x32_bf16 a[12:15], a[196:199], v[220:223], a[12:15]
ds_read_b64_tr_b16 a[234:235], v7 offset:10240
v_cvt_pk_bf16_f32 v29, v162, v163
v_mfma_f32_16x16x32_bf16 a[12:15], a[192:195], v[204:207], a[12:15]
s_waitcnt lgkmcnt(9)
v_exp_f32 v166, v166
v_mfma_f32_16x16x32_bf16 a[16:19], a[200:203], v[192:195], a[16:19]
v_add_f32 v241, v241, v164
v_mfma_f32_16x16x32_bf16 a[16:19], a[204:207], v[208:211], a[16:19]
ds_read_b64_tr_b16 a[236:237], v7 offset:12288
v_add_f32 v241, v241, v165
v_mfma_f32_16x16x32_bf16 a[20:23], a[204:207], v[212:215], a[20:23]
ds_read_b64_tr_b16 a[238:239], v7 offset:14336
v_cvt_pk_bf16_f32 v32, v164, v165
v_mfma_f32_16x16x32_bf16 a[20:23], a[200:203], v[196:199], a[20:23]
v_exp_f32 v167, v167
v_mfma_f32_16x16x32_bf16 a[24:27], a[200:203], v[200:203], a[24:27]
v_exp_f32 v168, v168
v_mfma_f32_16x16x32_bf16 a[24:27], a[204:207], v[216:219], a[24:27]
ds_read_b64_tr_b16 a[240:241], v8 offset:8192
v_mfma_f32_16x16x32_bf16 a[28:31], a[204:207], v[220:223], a[28:31]
ds_read_b64_tr_b16 a[242:243], v8 offset:10240
v_add_f32 v241, v241, v166
v_mfma_f32_16x16x32_bf16 a[28:31], a[200:203], v[204:207], a[28:31]
s_waitcnt lgkmcnt(9)
v_exp_f32 v169, v169
v_mfma_f32_16x16x32_bf16 a[32:35], a[208:211], v[192:195], a[32:35]
v_mfma_f32_16x16x32_bf16 a[32:35], a[212:215], v[208:211], a[32:35]
ds_read_b64_tr_b16 a[244:245], v8 offset:12288
v_add_f32 v241, v241, v167
v_mfma_f32_16x16x32_bf16 a[36:39], a[212:215], v[212:215], a[36:39]
ds_read_b64_tr_b16 a[246:247], v8 offset:14336
v_cvt_pk_bf16_f32 v33, v166, v167
v_mfma_f32_16x16x32_bf16 a[36:39], a[208:211], v[196:199], a[36:39]
v_exp_f32 v170, v170
v_mfma_f32_16x16x32_bf16 a[40:43], a[208:211], v[200:203], a[40:43]
v_add_f32 v242, v242, v168
v_mfma_f32_16x16x32_bf16 a[40:43], a[212:215], v[216:219], a[40:43]
ds_read_b64_tr_b16 a[248:249], v9 offset:8192
v_add_f32 v242, v242, v169
v_mfma_f32_16x16x32_bf16 a[44:47], a[212:215], v[220:223], a[44:47]
ds_read_b64_tr_b16 a[250:251], v9 offset:10240
v_cvt_pk_bf16_f32 v36, v168, v169
v_mfma_f32_16x16x32_bf16 a[44:47], a[208:211], v[204:207], a[44:47]
s_waitcnt lgkmcnt(9)
v_exp_f32 v171, v171
v_mfma_f32_16x16x32_bf16 a[48:51], a[216:219], v[192:195], a[48:51]
v_exp_f32 v172, v172
v_mfma_f32_16x16x32_bf16 a[48:51], a[220:223], v[208:211], a[48:51]
ds_read_b64_tr_b16 a[252:253], v9 offset:12288
v_mfma_f32_16x16x32_bf16 a[52:55], a[220:223], v[212:215], a[52:55]
ds_read_b64_tr_b16 a[254:255], v9 offset:14336
v_add_f32 v242, v242, v170
v_mfma_f32_16x16x32_bf16 a[52:55], a[216:219], v[196:199], a[52:55]
v_exp_f32 v173, v173
v_mfma_f32_16x16x32_bf16 a[56:59], a[216:219], v[200:203], a[56:59]
v_add_f32 v242, v242, v171
v_mfma_f32_16x16x32_bf16 a[56:59], a[220:223], v[216:219], a[56:59]
v_cvt_pk_bf16_f32 v37, v170, v171
v_mfma_f32_16x16x32_bf16 a[60:63], a[220:223], v[220:223], a[60:63]
v_exp_f32 v174, v174
v_mfma_f32_16x16x32_bf16 a[60:63], a[216:219], v[204:207], a[60:63]
s_waitcnt lgkmcnt(9)
v_mfma_f32_16x16x32_bf16 a[64:67], a[224:227], v[192:195], a[64:67]
v_add_f32 v243, v243, v172
v_mfma_f32_16x16x32_bf16 a[64:67], a[228:231], v[208:211], a[64:67]
v_exp_f32 v175, v175
v_mfma_f32_16x16x32_bf16 a[68:71], a[228:231], v[212:215], a[68:71]
v_add_f32 v243, v243, v173
v_mfma_f32_16x16x32_bf16 a[68:71], a[224:227], v[196:199], a[68:71]
s_waitcnt vmcnt(12) lgkmcnt(0)
v_cvt_pk_bf16_f32 v40, v172, v173
v_mfma_f32_16x16x32_bf16 a[72:75], a[224:227], v[200:203], a[72:75]
s_barrier
v_exp_f32 v176, v176
v_mfma_f32_16x16x32_bf16 a[72:75], a[228:231], v[216:219], a[72:75]
v_mfma_f32_16x16x32_bf16 a[76:79], a[228:231], v[220:223], a[76:79]
s_add_u32 m0, s30, 24576
v_add_f32 v243, v243, v174
v_mfma_f32_16x16x32_bf16 a[76:79], a[224:227], v[204:207], a[76:79]
buffer_load_dwordx4 v10, s[4:7], s32 offen offset:0 lds
v_mfma_f32_16x16x32_bf16 a[80:83], a[232:235], v[192:195], a[80:83]
v_exp_f32 v177, v177
v_mfma_f32_16x16x32_bf16 a[80:83], a[236:239], v[208:211], a[80:83]
v_add_f32 v243, v243, v175
v_cvt_pk_bf16_f32 v41, v174, v175
v_mfma_f32_16x16x32_bf16 a[84:87], a[236:239], v[212:215], a[84:87]
v_exp_f32 v178, v178
v_mfma_f32_16x16x32_bf16 a[84:87], a[232:235], v[196:199], a[84:87]
v_mfma_f32_16x16x32_bf16 a[88:91], a[232:235], v[200:203], a[88:91]
ds_read_b128 a[192:195], v4 offset:36864
v_add_f32 v240, v240, v176
v_mfma_f32_16x16x32_bf16 a[88:91], a[236:239], v[216:219], a[88:91]
v_exp_f32 v179, v179
v_mfma_f32_16x16x32_bf16 a[92:95], a[236:239], v[220:223], a[92:95]
s_add_u32 m0, s30, 28544
ds_read_b128 a[196:199], v5 offset:36864
v_add_f32 v240, v240, v177
v_mfma_f32_16x16x32_bf16 a[92:95], a[232:235], v[204:207], a[92:95]
buffer_load_dwordx4 v10, s[4:7], s32 offen offset:128 lds
v_mfma_f32_16x16x32_bf16 a[96:99], a[240:243], v[192:195], a[96:99]
ds_read_b128 a[200:203], v4 offset:40960
v_cvt_pk_bf16_f32 v30, v176, v177
v_mfma_f32_16x16x32_bf16 a[96:99], a[244:247], v[208:211], a[96:99]
v_exp_f32 v180, v180
v_mfma_f32_16x16x32_bf16 a[100:103], a[244:247], v[212:215], a[100:103]
ds_read_b128 a[204:207], v5 offset:40960
v_add_f32 v240, v240, v178
v_mfma_f32_16x16x32_bf16 a[100:103], a[240:243], v[196:199], a[100:103]
v_exp_f32 v181, v181
v_mfma_f32_16x16x32_bf16 a[104:107], a[240:243], v[200:203], a[104:107]
ds_read_b128 a[208:211], v4 offset:45056
v_add_f32 v240, v240, v179
v_mfma_f32_16x16x32_bf16 a[104:107], a[244:247], v[216:219], a[104:107]
v_cvt_pk_bf16_f32 v31, v178, v179
v_mfma_f32_16x16x32_bf16 a[108:111], a[244:247], v[220:223], a[108:111]
s_add_u32 m0, s30, 32512
ds_read_b128 a[212:215], v5 offset:45056
v_add_f32 v241, v241, v180
v_mfma_f32_16x16x32_bf16 a[108:111], a[240:243], v[204:207], a[108:111]
buffer_load_dwordx4 v10, s[4:7], s32 offen offset:256 lds
v_mfma_f32_16x16x32_bf16 a[112:115], a[248:251], v[192:195], a[112:115]
s_add_u32 s32, s32, 12288
v_exp_f32 v182, v182
v_mfma_f32_16x16x32_bf16 a[112:115], a[252:255], v[208:211], a[112:115]
v_exp_f32 v183, v183
v_mfma_f32_16x16x32_bf16 a[116:119], a[252:255], v[212:215], a[116:119]
v_add_f32 v241, v241, v181
v_mfma_f32_16x16x32_bf16 a[116:119], a[248:251], v[196:199], a[116:119]
v_cvt_pk_bf16_f32 v34, v180, v181
v_add_f32 v241, v241, v182
v_mfma_f32_16x16x32_bf16 a[120:123], a[248:251], v[200:203], a[120:123]
v_exp_f32 v184, v184
v_mfma_f32_16x16x32_bf16 a[120:123], a[252:255], v[216:219], a[120:123]
s_add_u32 m0, s31, 0
v_mfma_f32_16x16x32_bf16 a[124:127], a[252:255], v[220:223], a[124:127]
buffer_load_dwordx4 v11, s[8:11], s33 offen offset:0 lds
v_mfma_f32_16x16x32_bf16 a[124:127], a[248:251], v[204:207], a[124:127]
s_waitcnt lgkmcnt(3)
v_exp_f32 v185, v185
v_mfma_f32_16x16x32_bf16 v[160:163], a[192:195], v[64:67], v[224:227]
v_add_f32 v241, v241, v183
v_mfma_f32_16x16x32_bf16 v[160:163], a[196:199], v[80:83], v[160:163]
v_cvt_pk_bf16_f32 v35, v182, v183
v_add_f32 v242, v242, v184
v_mfma_f32_16x16x32_bf16 v[160:163], a[200:203], v[96:99], v[160:163]
s_waitcnt lgkmcnt(0)
v_exp_f32 v186, v186
v_mfma_f32_16x16x32_bf16 v[160:163], a[204:207], v[112:115], v[160:163]
v_mfma_f32_16x16x32_bf16 v[160:163], a[208:211], v[128:131], v[160:163]
s_add_u32 m0, s31, 4096
ds_read_b128 a[216:219], v4 offset:38912
v_add_f32 v242, v242, v185
v_mfma_f32_16x16x32_bf16 v[160:163], a[212:215], v[144:147], v[160:163]
buffer_load_dwordx4 v23, s[8:11], s33 offen offset:0 lds
v_mfma_f32_16x16x32_bf16 v[164:167], a[212:215], v[148:151], v[228:231]
ds_read_b128 a[220:223], v5 offset:38912
v_cvt_pk_bf16_f32 v38, v184, v185
v_mfma_f32_16x16x32_bf16 v[164:167], a[208:211], v[132:135], v[164:167]
v_exp_f32 v187, v187
v_mfma_f32_16x16x32_bf16 v[164:167], a[204:207], v[116:119], v[164:167]
ds_read_b128 a[224:227], v4 offset:43008
v_add_f32 v242, v242, v186
v_mfma_f32_16x16x32_bf16 v[164:167], a[200:203], v[100:103], v[164:167]
v_exp_f32 v188, v188
v_mfma_f32_16x16x32_bf16 v[164:167], a[196:199], v[84:87], v[164:167]
ds_read_b128 a[228:231], v5 offset:43008
v_add_f32 v242, v242, v187
v_mfma_f32_16x16x32_bf16 v[164:167], a[192:195], v[68:71], v[164:167]
v_exp_f32 v189, v189
v_mfma_f32_16x16x32_bf16 v[168:171], a[192:195], v[72:75], v[232:235]
s_add_u32 m0, s31, 8064
ds_read_b128 a[232:235], v4 offset:47104
v_cvt_pk_bf16_f32 v39, v186, v187
v_mfma_f32_16x16x32_bf16 v[168:171], a[196:199], v[88:91], v[168:171]
buffer_load_dwordx4 v11, s[8:11], s33 offen offset:128 lds
v_mfma_f32_16x16x32_bf16 v[168:171], a[200:203], v[104:107], v[168:171]
ds_read_b128 a[236:239], v5 offset:47104
v_add_f32 v243, v243, v188
v_mfma_f32_16x16x32_bf16 v[168:171], a[204:207], v[120:123], v[168:171]
v_exp_f32 v190, v190
v_mfma_f32_16x16x32_bf16 v[168:171], a[208:211], v[136:139], v[168:171]
v_exp_f32 v191, v191
v_mfma_f32_16x16x32_bf16 v[168:171], a[212:215], v[152:155], v[168:171]
ds_read_b64_tr_b16 a[240:241], v6 offset:16384
v_add_f32 v243, v243, v189
v_mfma_f32_16x16x32_bf16 v[172:175], a[212:215], v[156:159], v[236:239]
ds_read_b64_tr_b16 a[242:243], v6 offset:18432
v_cvt_pk_bf16_f32 v42, v188, v189
v_mfma_f32_16x16x32_bf16 v[172:175], a[208:211], v[140:143], v[172:175]
s_add_u32 m0, s31, 12160
v_add_f32 v243, v243, v190
v_mfma_f32_16x16x32_bf16 v[172:175], a[204:207], v[124:127], v[172:175]
buffer_load_dwordx4 v23, s[8:11], s33 offen offset:128 lds
v_mfma_f32_16x16x32_bf16 v[172:175], a[200:203], v[108:111], v[172:175]
ds_read_b64_tr_b16 a[244:245], v6 offset:20480
v_add_f32 v243, v243, v191
v_mfma_f32_16x16x32_bf16 v[172:175], a[196:199], v[92:95], v[172:175]
ds_read_b64_tr_b16 a[246:247], v6 offset:22528
v_cvt_pk_bf16_f32 v43, v190, v191
v_mfma_f32_16x16x32_bf16 v[172:175], a[192:195], v[76:79], v[172:175]
s_waitcnt lgkmcnt(7)
v_mfma_f32_16x16x32_bf16 v[176:179], a[216:219], v[64:67], v[224:227]
v_exp_f32 v160, v160
v_mfma_f32_16x16x32_bf16 v[176:179], a[220:223], v[80:83], v[176:179]
ds_read_b64_tr_b16 a[248:249], v7 offset:16384
v_mfma_f32_16x16x32_bf16 v[176:179], a[224:227], v[96:99], v[176:179]
s_waitcnt lgkmcnt(5)
ds_read_b64_tr_b16 a[250:251], v7 offset:18432
v_mfma_f32_16x16x32_bf16 v[176:179], a[228:231], v[112:115], v[176:179]
v_exp_f32 v161, v161
v_mfma_f32_16x16x32_bf16 v[176:179], a[232:235], v[128:131], v[176:179]
v_exp_f32 v162, v162
v_mfma_f32_16x16x32_bf16 v[176:179], a[236:239], v[144:147], v[176:179]
ds_read_b64_tr_b16 a[252:253], v7 offset:20480
v_add_f32 v240, v240, v160
v_mfma_f32_16x16x32_bf16 v[180:183], a[236:239], v[148:151], v[228:231]
ds_read_b64_tr_b16 a[254:255], v7 offset:22528
v_add_f32 v240, v240, v161
v_mfma_f32_16x16x32_bf16 v[180:183], a[232:235], v[132:135], v[180:183]
v_exp_f32 v163, v163
v_mfma_f32_16x16x32_bf16 v[180:183], a[228:231], v[116:119], v[180:183]
v_cvt_pk_bf16_f32 v44, v160, v161
v_mfma_f32_16x16x32_bf16 v[180:183], a[224:227], v[100:103], v[180:183]
ds_read_b64_tr_b16 a[192:193], v8 offset:16384
v_add_f32 v240, v240, v162
v_mfma_f32_16x16x32_bf16 v[180:183], a[220:223], v[84:87], v[180:183]
ds_read_b64_tr_b16 a[194:195], v8 offset:18432
v_mfma_f32_16x16x32_bf16 v[180:183], a[216:219], v[68:71], v[180:183]
v_exp_f32 v164, v164
v_mfma_f32_16x16x32_bf16 v[184:187], a[216:219], v[72:75], v[232:235]
v_exp_f32 v165, v165
v_mfma_f32_16x16x32_bf16 v[184:187], a[220:223], v[88:91], v[184:187]
ds_read_b64_tr_b16 a[196:197], v8 offset:20480
v_add_f32 v240, v240, v163
v_mfma_f32_16x16x32_bf16 v[184:187], a[224:227], v[104:107], v[184:187]
ds_read_b64_tr_b16 a[198:199], v8 offset:22528
v_cvt_pk_bf16_f32 v45, v162, v163
v_mfma_f32_16x16x32_bf16 v[184:187], a[228:231], v[120:123], v[184:187]
v_exp_f32 v166, v166
v_mfma_f32_16x16x32_bf16 v[184:187], a[232:235], v[136:139], v[184:187]
v_add_f32 v241, v241, v164
v_mfma_f32_16x16x32_bf16 v[184:187], a[236:239], v[152:155], v[184:187]
ds_read_b64_tr_b16 a[200:201], v9 offset:16384
v_add_f32 v241, v241, v165
v_mfma_f32_16x16x32_bf16 v[188:191], a[236:239], v[156:159], v[236:239]
ds_read_b64_tr_b16 a[202:203], v9 offset:18432
v_cvt_pk_bf16_f32 v48, v164, v165
v_mfma_f32_16x16x32_bf16 v[188:191], a[232:235], v[140:143], v[188:191]
v_exp_f32 v167, v167
v_mfma_f32_16x16x32_bf16 v[188:191], a[228:231], v[124:127], v[188:191]
v_exp_f32 v168, v168
v_mfma_f32_16x16x32_bf16 v[188:191], a[224:227], v[108:111], v[188:191]
ds_read_b64_tr_b16 a[204:205], v9 offset:20480
v_mfma_f32_16x16x32_bf16 v[188:191], a[220:223], v[92:95], v[188:191]
ds_read_b64_tr_b16 a[206:207], v9 offset:22528
v_add_f32 v241, v241, v166
v_mfma_f32_16x16x32_bf16 v[188:191], a[216:219], v[76:79], v[188:191]
s_waitcnt lgkmcnt(9)
v_exp_f32 v169, v169
v_mfma_f32_16x16x32_bf16 a[128:131], a[240:243], v[192:195], a[128:131]
v_mfma_f32_16x16x32_bf16 a[128:131], a[244:247], v[208:211], a[128:131]
v_add_f32 v241, v241, v167
v_mfma_f32_16x16x32_bf16 a[132:135], a[244:247], v[212:215], a[132:135]
v_cvt_pk_bf16_f32 v49, v166, v167
v_add_f32 v242, v242, v168
v_mfma_f32_16x16x32_bf16 a[132:135], a[240:243], v[196:199], a[132:135]
v_exp_f32 v170, v170
v_mfma_f32_16x16x32_bf16 a[136:139], a[240:243], v[200:203], a[136:139]
v_mfma_f32_16x16x32_bf16 a[136:139], a[244:247], v[216:219], a[136:139]
v_exp_f32 v171, v171
v_mfma_f32_16x16x32_bf16 a[140:143], a[244:247], v[220:223], a[140:143]
v_mfma_f32_16x16x32_bf16 a[140:143], a[240:243], v[204:207], a[140:143]
s_waitcnt vmcnt(12) lgkmcnt(0)
v_add_f32 v242, v242, v169
v_cvt_pk_bf16_f32 v52, v168, v169
v_mfma_f32_16x16x32_bf16 a[144:147], a[248:251], v[192:195], a[144:147]
s_barrier
v_exp_f32 v172, v172
v_mfma_f32_16x16x32_bf16 a[144:147], a[252:255], v[208:211], a[144:147]
v_mfma_f32_16x16x32_bf16 a[148:151], a[252:255], v[212:215], a[148:151]
s_add_u32 m0, s30, 36864
v_add_f32 v242, v242, v170
v_mfma_f32_16x16x32_bf16 a[148:151], a[248:251], v[196:199], a[148:151]
buffer_load_dwordx4 v10, s[4:7], s32 offen offset:0 lds
v_mfma_f32_16x16x32_bf16 a[152:155], a[248:251], v[200:203], a[152:155]
ds_read_b128 a[208:211], v4 offset:0
v_add_f32 v242, v242, v171
v_mfma_f32_16x16x32_bf16 a[152:155], a[252:255], v[216:219], a[152:155]
v_exp_f32 v173, v173
v_mfma_f32_16x16x32_bf16 a[156:159], a[252:255], v[220:223], a[156:159]
ds_read_b128 a[212:215], v5 offset:0
v_cvt_pk_bf16_f32 v53, v170, v171
v_mfma_f32_16x16x32_bf16 a[156:159], a[248:251], v[204:207], a[156:159]
v_exp_f32 v174, v174
v_mfma_f32_16x16x32_bf16 a[160:163], a[192:195], v[192:195], a[160:163]
ds_read_b128 a[216:219], v4 offset:4096
v_add_f32 v243, v243, v172
v_mfma_f32_16x16x32_bf16 a[160:163], a[196:199], v[208:211], a[160:163]
v_exp_f32 v175, v175
v_mfma_f32_16x16x32_bf16 a[164:167], a[196:199], v[212:215], a[164:167]
s_add_u32 m0, s30, 40832
ds_read_b128 a[220:223], v5 offset:4096
v_add_f32 v243, v243, v173
v_mfma_f32_16x16x32_bf16 a[164:167], a[192:195], v[196:199], a[164:167]
buffer_load_dwordx4 v10, s[4:7], s32 offen offset:128 lds
v_mfma_f32_16x16x32_bf16 a[168:171], a[192:195], v[200:203], a[168:171]
ds_read_b128 a[224:227], v4 offset:8192
v_cvt_pk_bf16_f32 v56, v172, v173
v_mfma_f32_16x16x32_bf16 a[168:171], a[196:199], v[216:219], a[168:171]
v_exp_f32 v176, v176
v_mfma_f32_16x16x32_bf16 a[172:175], a[196:199], v[220:223], a[172:175]
ds_read_b128 a[228:231], v5 offset:8192
v_add_f32 v243, v243, v174
v_mfma_f32_16x16x32_bf16 a[172:175], a[192:195], v[204:207], a[172:175]
v_exp_f32 v177, v177
v_mfma_f32_16x16x32_bf16 a[176:179], a[200:203], v[192:195], a[176:179]
v_add_f32 v243, v243, v175
v_mfma_f32_16x16x32_bf16 a[176:179], a[204:207], v[208:211], a[176:179]
s_add_u32 m0, s30, 44800
v_cvt_pk_bf16_f32 v57, v174, v175
v_mfma_f32_16x16x32_bf16 a[180:183], a[204:207], v[212:215], a[180:183]
buffer_load_dwordx4 v10, s[4:7], s32 offen offset:256 lds
v_mfma_f32_16x16x32_bf16 a[180:183], a[200:203], v[196:199], a[180:183]
s_add_u32 s32, s32, 12288
v_exp_f32 v178, v178
v_mfma_f32_16x16x32_bf16 a[184:187], a[200:203], v[200:203], a[184:187]
v_add_f32 v240, v240, v176
v_add_f32 v240, v240, v177
v_mfma_f32_16x16x32_bf16 a[184:187], a[204:207], v[216:219], a[184:187]
v_exp_f32 v179, v179
v_mfma_f32_16x16x32_bf16 a[188:191], a[204:207], v[220:223], a[188:191]
v_mfma_f32_16x16x32_bf16 a[188:191], a[200:203], v[204:207], a[188:191]
s_waitcnt lgkmcnt(3)
v_cvt_pk_bf16_f32 v46, v176, v177
v_mfma_f32_16x16x32_bf16 v[160:163], a[208:211], v[64:67], v[224:227]
s_add_u32 m0, s31, 16128
v_exp_f32 v180, v180
v_mfma_f32_16x16x32_bf16 v[160:163], a[212:215], v[80:83], v[160:163]
buffer_load_dwordx4 v11, s[8:11], s33 offen offset:256 lds
v_mfma_f32_16x16x32_bf16 v[160:163], a[216:219], v[96:99], v[160:163]
s_waitcnt lgkmcnt(0)
v_add_f32 v240, v240, v178
v_add_f32 v240, v240, v179
v_mfma_f32_16x16x32_bf16 v[160:163], a[220:223], v[112:115], v[160:163]
v_exp_f32 v181, v181
v_mfma_f32_16x16x32_bf16 v[160:163], a[224:227], v[128:131], v[160:163]
ds_read_b128 a[232:235], v4 offset:2048
v_mfma_f32_16x16x32_bf16 v[160:163], a[228:231], v[144:147], v[160:163]
v_cvt_pk_bf16_f32 v47, v178, v179
v_mfma_f32_16x16x32_bf16 v[164:167], a[228:231], v[148:151], v[228:231]
ds_read_b128 a[236:239], v5 offset:2048
v_add_f32 v241, v241, v180
v_mfma_f32_16x16x32_bf16 v[164:167], a[224:227], v[132:135], v[164:167]
v_exp_f32 v182, v182
v_mfma_f32_16x16x32_bf16 v[164:167], a[220:223], v[116:119], v[164:167]
s_add_u32 m0, s31, 20224
ds_read_b128 a[240:243], v4 offset:6144
v_add_f32 v241, v241, v181
v_mfma_f32_16x16x32_bf16 v[164:167], a[216:219], v[100:103], v[164:167]
buffer_load_dwordx4 v23, s[8:11], s33 offen offset:256 lds
v_mfma_f32_16x16x32_bf16 v[164:167], a[212:215], v[84:87], v[164:167]
s_add_u32 s33, s33, 24576
ds_read_b128 a[244:247], v5 offset:6144
v_cvt_pk_bf16_f32 v50, v180, v181
v_mfma_f32_16x16x32_bf16 v[164:167], a[208:211], v[68:71], v[164:167]
v_exp_f32 v183, v183
v_mfma_f32_16x16x32_bf16 v[168:171], a[208:211], v[72:75], v[232:235]
ds_read_b128 a[248:251], v4 offset:10240
v_add_f32 v241, v241, v182
v_mfma_f32_16x16x32_bf16 v[168:171], a[212:215], v[88:91], v[168:171]
v_exp_f32 v184, v184
v_mfma_f32_16x16x32_bf16 v[168:171], a[216:219], v[104:107], v[168:171]
ds_read_b128 a[252:255], v5 offset:10240
v_add_f32 v241, v241, v183
v_mfma_f32_16x16x32_bf16 v[168:171], a[220:223], v[120:123], v[168:171]
v_exp_f32 v185, v185
v_mfma_f32_16x16x32_bf16 v[168:171], a[224:227], v[136:139], v[168:171]
ds_read_b64_tr_b16 a[192:193], v6 offset:24576
v_mfma_f32_16x16x32_bf16 v[168:171], a[228:231], v[152:155], v[168:171]
ds_read_b64_tr_b16 a[194:195], v6 offset:26624
v_cvt_pk_bf16_f32 v51, v182, v183
v_mfma_f32_16x16x32_bf16 v[172:175], a[228:231], v[156:159], v[236:239]
ds_read_b64_tr_b16 a[196:197], v6 offset:28672
v_add_f32 v242, v242, v184
v_mfma_f32_16x16x32_bf16 v[172:175], a[224:227], v[140:143], v[172:175]
ds_read_b64_tr_b16 a[198:199], v6 offset:30720
v_mfma_f32_16x16x32_bf16 v[172:175], a[220:223], v[124:127], v[172:175]
v_exp_f32 v186, v186
v_mfma_f32_16x16x32_bf16 v[172:175], a[216:219], v[108:111], v[172:175]
ds_read_b64_tr_b16 a[200:201], v7 offset:24576
v_add_f32 v242, v242, v185
v_mfma_f32_16x16x32_bf16 v[172:175], a[212:215], v[92:95], v[172:175]
ds_read_b64_tr_b16 a[202:203], v7 offset:26624
v_cvt_pk_bf16_f32 v54, v184, v185
v_mfma_f32_16x16x32_bf16 v[172:175], a[208:211], v[76:79], v[172:175]
s_waitcnt lgkmcnt(9)
v_exp_f32 v187, v187
v_mfma_f32_16x16x32_bf16 v[176:179], a[232:235], v[64:67], v[224:227]
v_exp_f32 v188, v188
v_mfma_f32_16x16x32_bf16 v[176:179], a[236:239], v[80:83], v[176:179]
ds_read_b64_tr_b16 a[204:205], v7 offset:28672
v_add_f32 v242, v242, v186
v_mfma_f32_16x16x32_bf16 v[176:179], a[240:243], v[96:99], v[176:179]
s_waitcnt lgkmcnt(7)
ds_read_b64_tr_b16 a[206:207], v7 offset:30720
v_add_f32 v242, v242, v187
v_mfma_f32_16x16x32_bf16 v[176:179], a[244:247], v[112:115], v[176:179]
v_exp_f32 v189, v189
v_mfma_f32_16x16x32_bf16 v[176:179], a[248:251], v[128:131], v[176:179]
v_cvt_pk_bf16_f32 v55, v186, v187
v_mfma_f32_16x16x32_bf16 v[176:179], a[252:255], v[144:147], v[176:179]
ds_read_b64_tr_b16 a[208:209], v8 offset:24576
v_add_f32 v243, v243, v188
v_mfma_f32_16x16x32_bf16 v[180:183], a[252:255], v[148:151], v[228:231]
s_sub_u32 s34, s34, 1
ds_read_b64_tr_b16 a[210:211], v8 offset:26624
v_mfma_f32_16x16x32_bf16 v[180:183], a[248:251], v[132:135], v[180:183]
v_exp_f32 v190, v190
v_mfma_f32_16x16x32_bf16 v[180:183], a[244:247], v[116:119], v[180:183]
v_exp_f32 v191, v191
v_mfma_f32_16x16x32_bf16 v[180:183], a[240:243], v[100:103], v[180:183]
ds_read_b64_tr_b16 a[212:213], v8 offset:28672
v_add_f32 v243, v243, v189
v_mfma_f32_16x16x32_bf16 v[180:183], a[236:239], v[84:87], v[180:183]
ds_read_b64_tr_b16 a[214:215], v8 offset:30720
v_cvt_pk_bf16_f32 v58, v188, v189
v_mfma_f32_16x16x32_bf16 v[180:183], a[232:235], v[68:71], v[180:183]
v_add_f32 v243, v243, v190
v_mfma_f32_16x16x32_bf16 v[184:187], a[232:235], v[72:75], v[232:235]
v_add_f32 v243, v243, v191
v_mfma_f32_16x16x32_bf16 v[184:187], a[236:239], v[88:91], v[184:187]
ds_read_b64_tr_b16 a[216:217], v9 offset:24576
v_cvt_pk_bf16_f32 v59, v190, v191
v_mfma_f32_16x16x32_bf16 v[184:187], a[240:243], v[104:107], v[184:187]
ds_read_b64_tr_b16 a[218:219], v9 offset:26624
v_mfma_f32_16x16x32_bf16 v[184:187], a[244:247], v[120:123], v[184:187]
v_mfma_f32_16x16x32_bf16 v[184:187], a[248:251], v[136:139], v[184:187]
v_exp_f32 v160, v160
v_mfma_f32_16x16x32_bf16 v[184:187], a[252:255], v[152:155], v[184:187]
ds_read_b64_tr_b16 a[220:221], v9 offset:28672
v_mfma_f32_16x16x32_bf16 v[188:191], a[252:255], v[156:159], v[236:239]
ds_read_b64_tr_b16 a[222:223], v9 offset:30720
v_mfma_f32_16x16x32_bf16 v[188:191], a[248:251], v[140:143], v[188:191]
v_exp_f32 v161, v161
v_mfma_f32_16x16x32_bf16 v[188:191], a[244:247], v[124:127], v[188:191]
v_exp_f32 v162, v162
v_mfma_f32_16x16x32_bf16 v[188:191], a[240:243], v[108:111], v[188:191]
ds_read_b64_tr_b16 a[224:225], v6 offset:32768
v_add_f32 v240, v240, v160
v_mfma_f32_16x16x32_bf16 v[188:191], a[236:239], v[92:95], v[188:191]
ds_read_b64_tr_b16 a[226:227], v6 offset:34816
v_add_f32 v240, v240, v161
v_mfma_f32_16x16x32_bf16 v[188:191], a[232:235], v[76:79], v[188:191]
s_waitcnt lgkmcnt(9)
v_exp_f32 v163, v163
v_mfma_f32_16x16x32_bf16 a[0:3], a[192:195], v[28:31], a[0:3]
v_cvt_pk_bf16_f32 v192, v160, v161
v_mfma_f32_16x16x32_bf16 a[0:3], a[196:199], v[44:47], a[0:3]
ds_read_b64_tr_b16 a[228:229], v6 offset:36864
v_add_f32 v240, v240, v162
v_mfma_f32_16x16x32_bf16 a[4:7], a[196:199], v[48:51], a[4:7]
ds_read_b64_tr_b16 a[230:231], v6 offset:38912
v_mfma_f32_16x16x32_bf16 a[4:7], a[192:195], v[32:35], a[4:7]
v_exp_f32 v164, v164
v_mfma_f32_16x16x32_bf16 a[8:11], a[192:195], v[36:39], a[8:11]
v_exp_f32 v165, v165
v_mfma_f32_16x16x32_bf16 a[8:11], a[196:199], v[52:55], a[8:11]
ds_read_b64_tr_b16 a[232:233], v7 offset:32768
v_add_f32 v240, v240, v163
v_mfma_f32_16x16x32_bf16 a[12:15], a[196:199], v[56:59], a[12:15]
ds_read_b64_tr_b16 a[234:235], v7 offset:34816
v_cvt_pk_bf16_f32 v193, v162, v163
v_mfma_f32_16x16x32_bf16 a[12:15], a[192:195], v[40:43], a[12:15]
s_waitcnt lgkmcnt(9)
v_exp_f32 v166, v166
v_mfma_f32_16x16x32_bf16 a[16:19], a[200:203], v[28:31], a[16:19]
v_add_f32 v241, v241, v164
v_mfma_f32_16x16x32_bf16 a[16:19], a[204:207], v[44:47], a[16:19]
ds_read_b64_tr_b16 a[236:237], v7 offset:36864
v_add_f32 v241, v241, v165
v_mfma_f32_16x16x32_bf16 a[20:23], a[204:207], v[48:51], a[20:23]
ds_read_b64_tr_b16 a[238:239], v7 offset:38912
v_cvt_pk_bf16_f32 v196, v164, v165
v_mfma_f32_16x16x32_bf16 a[20:23], a[200:203], v[32:35], a[20:23]
v_exp_f32 v167, v167
v_mfma_f32_16x16x32_bf16 a[24:27], a[200:203], v[36:39], a[24:27]
v_exp_f32 v168, v168
v_mfma_f32_16x16x32_bf16 a[24:27], a[204:207], v[52:55], a[24:27]
ds_read_b64_tr_b16 a[240:241], v8 offset:32768
v_mfma_f32_16x16x32_bf16 a[28:31], a[204:207], v[56:59], a[28:31]
ds_read_b64_tr_b16 a[242:243], v8 offset:34816
v_add_f32 v241, v241, v166
v_mfma_f32_16x16x32_bf16 a[28:31], a[200:203], v[40:43], a[28:31]
s_waitcnt lgkmcnt(9)
v_exp_f32 v169, v169
v_mfma_f32_16x16x32_bf16 a[32:35], a[208:211], v[28:31], a[32:35]
v_mfma_f32_16x16x32_bf16 a[32:35], a[212:215], v[44:47], a[32:35]
ds_read_b64_tr_b16 a[244:245], v8 offset:36864
v_add_f32 v241, v241, v167
v_mfma_f32_16x16x32_bf16 a[36:39], a[212:215], v[48:51], a[36:39]
ds_read_b64_tr_b16 a[246:247], v8 offset:38912
v_cvt_pk_bf16_f32 v197, v166, v167
v_mfma_f32_16x16x32_bf16 a[36:39], a[208:211], v[32:35], a[36:39]
v_exp_f32 v170, v170
v_mfma_f32_16x16x32_bf16 a[40:43], a[208:211], v[36:39], a[40:43]
v_add_f32 v242, v242, v168
v_mfma_f32_16x16x32_bf16 a[40:43], a[212:215], v[52:55], a[40:43]
ds_read_b64_tr_b16 a[248:249], v9 offset:32768
v_add_f32 v242, v242, v169
v_mfma_f32_16x16x32_bf16 a[44:47], a[212:215], v[56:59], a[44:47]
ds_read_b64_tr_b16 a[250:251], v9 offset:34816
v_cvt_pk_bf16_f32 v200, v168, v169
v_mfma_f32_16x16x32_bf16 a[44:47], a[208:211], v[40:43], a[44:47]
s_waitcnt lgkmcnt(9)
v_exp_f32 v171, v171
v_mfma_f32_16x16x32_bf16 a[48:51], a[216:219], v[28:31], a[48:51]
v_exp_f32 v172, v172
v_mfma_f32_16x16x32_bf16 a[48:51], a[220:223], v[44:47], a[48:51]
ds_read_b64_tr_b16 a[252:253], v9 offset:36864
v_mfma_f32_16x16x32_bf16 a[52:55], a[220:223], v[48:51], a[52:55]
ds_read_b64_tr_b16 a[254:255], v9 offset:38912
v_add_f32 v242, v242, v170
v_mfma_f32_16x16x32_bf16 a[52:55], a[216:219], v[32:35], a[52:55]
v_exp_f32 v173, v173
v_mfma_f32_16x16x32_bf16 a[56:59], a[216:219], v[36:39], a[56:59]
v_add_f32 v242, v242, v171
v_mfma_f32_16x16x32_bf16 a[56:59], a[220:223], v[52:55], a[56:59]
v_cvt_pk_bf16_f32 v201, v170, v171
v_mfma_f32_16x16x32_bf16 a[60:63], a[220:223], v[56:59], a[60:63]
v_exp_f32 v174, v174
v_mfma_f32_16x16x32_bf16 a[60:63], a[216:219], v[40:43], a[60:63]
s_waitcnt lgkmcnt(9)
v_mfma_f32_16x16x32_bf16 a[64:67], a[224:227], v[28:31], a[64:67]
v_add_f32 v243, v243, v172
v_mfma_f32_16x16x32_bf16 a[64:67], a[228:231], v[44:47], a[64:67]
v_exp_f32 v175, v175
v_mfma_f32_16x16x32_bf16 a[68:71], a[228:231], v[48:51], a[68:71]
v_add_f32 v243, v243, v173
v_mfma_f32_16x16x32_bf16 a[68:71], a[224:227], v[32:35], a[68:71]
s_waitcnt vmcnt(12) lgkmcnt(0)
v_cvt_pk_bf16_f32 v204, v172, v173
v_mfma_f32_16x16x32_bf16 a[72:75], a[224:227], v[36:39], a[72:75]
s_barrier
v_exp_f32 v176, v176
v_mfma_f32_16x16x32_bf16 a[72:75], a[228:231], v[52:55], a[72:75]
v_mfma_f32_16x16x32_bf16 a[76:79], a[228:231], v[56:59], a[76:79]
s_add_u32 m0, s30, 0
v_add_f32 v243, v243, v174
v_mfma_f32_16x16x32_bf16 a[76:79], a[224:227], v[40:43], a[76:79]
buffer_load_dwordx4 v10, s[4:7], s32 offen offset:0 lds
v_mfma_f32_16x16x32_bf16 a[80:83], a[232:235], v[28:31], a[80:83]
v_exp_f32 v177, v177
v_mfma_f32_16x16x32_bf16 a[80:83], a[236:239], v[44:47], a[80:83]
v_add_f32 v243, v243, v175
v_cvt_pk_bf16_f32 v205, v174, v175
v_mfma_f32_16x16x32_bf16 a[84:87], a[236:239], v[48:51], a[84:87]
v_exp_f32 v178, v178
v_mfma_f32_16x16x32_bf16 a[84:87], a[232:235], v[32:35], a[84:87]
v_mfma_f32_16x16x32_bf16 a[88:91], a[232:235], v[36:39], a[88:91]
ds_read_b128 a[192:195], v4 offset:12288
v_add_f32 v240, v240, v176
v_mfma_f32_16x16x32_bf16 a[88:91], a[236:239], v[52:55], a[88:91]
v_exp_f32 v179, v179
v_mfma_f32_16x16x32_bf16 a[92:95], a[236:239], v[56:59], a[92:95]
s_add_u32 m0, s30, 3968
ds_read_b128 a[196:199], v5 offset:12288
v_add_f32 v240, v240, v177
v_mfma_f32_16x16x32_bf16 a[92:95], a[232:235], v[40:43], a[92:95]
buffer_load_dwordx4 v10, s[4:7], s32 offen offset:128 lds
v_mfma_f32_16x16x32_bf16 a[96:99], a[240:243], v[28:31], a[96:99]
ds_read_b128 a[200:203], v4 offset:16384
v_cvt_pk_bf16_f32 v194, v176, v177
v_mfma_f32_16x16x32_bf16 a[96:99], a[244:247], v[44:47], a[96:99]
v_exp_f32 v180, v180
v_mfma_f32_16x16x32_bf16 a[100:103], a[244:247], v[48:51], a[100:103]
ds_read_b128 a[204:207], v5 offset:16384
v_add_f32 v240, v240, v178
v_mfma_f32_16x16x32_bf16 a[100:103], a[240:243], v[32:35], a[100:103]
v_exp_f32 v181, v181
v_mfma_f32_16x16x32_bf16 a[104:107], a[240:243], v[36:39], a[104:107]
ds_read_b128 a[208:211], v4 offset:20480
v_add_f32 v240, v240, v179
v_mfma_f32_16x16x32_bf16 a[104:107], a[244:247], v[52:55], a[104:107]
v_cvt_pk_bf16_f32 v195, v178, v179
v_mfma_f32_16x16x32_bf16 a[108:111], a[244:247], v[56:59], a[108:111]
s_add_u32 m0, s30, 7936
ds_read_b128 a[212:215], v5 offset:20480
v_add_f32 v241, v241, v180
v_mfma_f32_16x16x32_bf16 a[108:111], a[240:243], v[40:43], a[108:111]
buffer_load_dwordx4 v10, s[4:7], s32 offen offset:256 lds
v_mfma_f32_16x16x32_bf16 a[112:115], a[248:251], v[28:31], a[112:115]
s_add_u32 s32, s32, 12288
v_exp_f32 v182, v182
v_mfma_f32_16x16x32_bf16 a[112:115], a[252:255], v[44:47], a[112:115]
v_exp_f32 v183, v183
v_mfma_f32_16x16x32_bf16 a[116:119], a[252:255], v[48:51], a[116:119]
v_add_f32 v241, v241, v181
v_mfma_f32_16x16x32_bf16 a[116:119], a[248:251], v[32:35], a[116:119]
v_cvt_pk_bf16_f32 v198, v180, v181
v_add_f32 v241, v241, v182
v_mfma_f32_16x16x32_bf16 a[120:123], a[248:251], v[36:39], a[120:123]
v_exp_f32 v184, v184
v_mfma_f32_16x16x32_bf16 a[120:123], a[252:255], v[52:55], a[120:123]
s_add_u32 m0, s31, 24576
v_mfma_f32_16x16x32_bf16 a[124:127], a[252:255], v[56:59], a[124:127]
buffer_load_dwordx4 v11, s[8:11], s33 offen offset:0 lds
v_mfma_f32_16x16x32_bf16 a[124:127], a[248:251], v[40:43], a[124:127]
s_waitcnt lgkmcnt(3)
s_cmp_gt_i32 s34, 0
v_exp_f32 v185, v185
s_cbranch_scc1 K_loop
s_cmp_lt_i32 s34, 0
s_cbranch_scc1 K_lx
buffer_load_dwordx4 v[248:251], v3, s[56:59], 0 offen offset:2048 sc1
buffer_load_dwordx4 v[252:255], v3, s[56:59], 0 offen offset:3072 sc1
buffer_load_dword v0, v63, s[96:99], 0 offen
s_branch K_loop
K_lx:
s_waitcnt vmcnt(25)
s_mov_b32 s42, 0
s_branch C_ph_chk
C_ph:
buffer_load_dwordx4 v[248:251], v3, s[56:59], 0 offen offset:2048 sc1
buffer_load_dwordx4 v[252:255], v3, s[56:59], 0 offen offset:3072 sc1
s_waitcnt vmcnt(0)
C_ph_chk:
v_cmp_ne_u64 s[40:41], v[26:27], v[248:249]
v_cmp_ne_u64 vcc, v[26:27], v[250:251]
s_or_b64 s[40:41], s[40:41], vcc
v_cmp_ne_u64 vcc, v[26:27], v[252:253]
s_or_b64 s[40:41], s[40:41], vcc
v_cmp_ne_u64 vcc, v[26:27], v[254:255]
s_or_b64 s[40:41], s[40:41], vcc
s_cbranch_scc0 C_ph_ok
s_sleep 8
s_add_u32 s42, s42, 1
s_cmp_lt_u32 s42, 0x40000
s_cbranch_scc1 C_ph
C_ph_ok:
s_mul_i32 s50, s39, 12
s_add_u32 s50, s50, 192
s_lshl_b32 s51, s50, 12
s_mul_i32 s50, s50, 5120
s_add_u32 s50, s50, s68
v_mfma_f32_16x16x32_bf16 v[160:163], a[192:195], v[64:67], v[224:227]
v_add_f32 v241, v241, v183
v_mfma_f32_16x16x32_bf16 v[160:163], a[196:199], v[80:83], v[160:163]
v_cvt_pk_bf16_f32 v199, v182, v183
v_add_f32 v242, v242, v184
v_mfma_f32_16x16x32_bf16 v[160:163], a[200:203], v[96:99], v[160:163]
s_waitcnt lgkmcnt(0)
v_exp_f32 v186, v186
v_mfma_f32_16x16x32_bf16 v[160:163], a[204:207], v[112:115], v[160:163]
v_mfma_f32_16x16x32_bf16 v[160:163], a[208:211], v[128:131], v[160:163]
s_add_u32 m0, s31, 28672
ds_read_b128 a[216:219], v4 offset:14336
v_add_f32 v242, v242, v185
v_mfma_f32_16x16x32_bf16 v[160:163], a[212:215], v[144:147], v[160:163]
buffer_load_dwordx4 v23, s[8:11], s33 offen offset:0 lds
v_mfma_f32_16x16x32_bf16 v[164:167], a[212:215], v[148:151], v[228:231]
ds_read_b128 a[220:223], v5 offset:14336
v_cvt_pk_bf16_f32 v202, v184, v185
v_mfma_f32_16x16x32_bf16 v[164:167], a[208:211], v[132:135], v[164:167]
v_exp_f32 v187, v187
v_mfma_f32_16x16x32_bf16 v[164:167], a[204:207], v[116:119], v[164:167]
ds_read_b128 a[224:227], v4 offset:18432
v_add_f32 v242, v242, v186
v_mfma_f32_16x16x32_bf16 v[164:167], a[200:203], v[100:103], v[164:167]
v_exp_f32 v188, v188
v_mfma_f32_16x16x32_bf16 v[164:167], a[196:199], v[84:87], v[164:167]
ds_read_b128 a[228:231], v5 offset:18432
v_add_f32 v242, v242, v187
v_mfma_f32_16x16x32_bf16 v[164:167], a[192:195], v[68:71], v[164:167]
v_exp_f32 v189, v189
v_mfma_f32_16x16x32_bf16 v[168:171], a[192:195], v[72:75], v[232:235]
s_add_u32 m0, s31, 32640
ds_read_b128 a[232:235], v4 offset:22528
v_cvt_pk_bf16_f32 v203, v186, v187
v_mfma_f32_16x16x32_bf16 v[168:171], a[196:199], v[88:91], v[168:171]
buffer_load_dwordx4 v11, s[8:11], s33 offen offset:128 lds
v_mfma_f32_16x16x32_bf16 v[168:171], a[200:203], v[104:107], v[168:171]
ds_read_b128 a[236:239], v5 offset:22528
v_add_f32 v243, v243, v188
v_mfma_f32_16x16x32_bf16 v[168:171], a[204:207], v[120:123], v[168:171]
v_exp_f32 v190, v190
v_mfma_f32_16x16x32_bf16 v[168:171], a[208:211], v[136:139], v[168:171]
v_exp_f32 v191, v191
v_mfma_f32_16x16x32_bf16 v[168:171], a[212:215], v[152:155], v[168:171]
ds_read_b64_tr_b16 a[240:241], v6 offset:40960
v_add_f32 v243, v243, v189
v_mfma_f32_16x16x32_bf16 v[172:175], a[212:215], v[156:159], v[236:239]
ds_read_b64_tr_b16 a[242:243], v6 offset:43008
v_cvt_pk_bf16_f32 v206, v188, v189
v_mfma_f32_16x16x32_bf16 v[172:175], a[208:211], v[140:143], v[172:175]
s_add_u32 m0, s31, 36736
v_add_f32 v243, v243, v190
v_mfma_f32_16x16x32_bf16 v[172:175], a[204:207], v[124:127], v[172:175]
buffer_load_dwordx4 v23, s[8:11], s33 offen offset:128 lds
v_mfma_f32_16x16x32_bf16 v[172:175], a[200:203], v[108:111], v[172:175]
ds_read_b64_tr_b16 a[244:245], v6 offset:45056
v_add_f32 v243, v243, v191
v_mfma_f32_16x16x32_bf16 v[172:175], a[196:199], v[92:95], v[172:175]
ds_read_b64_tr_b16 a[246:247], v6 offset:47104
v_cvt_pk_bf16_f32 v207, v190, v191
v_mfma_f32_16x16x32_bf16 v[172:175], a[192:195], v[76:79], v[172:175]
s_waitcnt lgkmcnt(7)
v_mfma_f32_16x16x32_bf16 v[176:179], a[216:219], v[64:67], v[224:227]
v_exp_f32 v160, v160
v_mfma_f32_16x16x32_bf16 v[176:179], a[220:223], v[80:83], v[176:179]
ds_read_b64_tr_b16 a[248:249], v7 offset:40960
v_mfma_f32_16x16x32_bf16 v[176:179], a[224:227], v[96:99], v[176:179]
s_waitcnt lgkmcnt(5)
ds_read_b64_tr_b16 a[250:251], v7 offset:43008
v_mfma_f32_16x16x32_bf16 v[176:179], a[228:231], v[112:115], v[176:179]
v_exp_f32 v161, v161
v_mfma_f32_16x16x32_bf16 v[176:179], a[232:235], v[128:131], v[176:179]
v_exp_f32 v162, v162
v_mfma_f32_16x16x32_bf16 v[176:179], a[236:239], v[144:147], v[176:179]
ds_read_b64_tr_b16 a[252:253], v7 offset:45056
v_add_f32 v240, v240, v160
v_mfma_f32_16x16x32_bf16 v[180:183], a[236:239], v[148:151], v[228:231]
ds_read_b64_tr_b16 a[254:255], v7 offset:47104
v_add_f32 v240, v240, v161
v_mfma_f32_16x16x32_bf16 v[180:183], a[232:235], v[132:135], v[180:183]
v_exp_f32 v163, v163
v_mfma_f32_16x16x32_bf16 v[180:183], a[228:231], v[116:119], v[180:183]
v_cvt_pk_bf16_f32 v208, v160, v161
v_mfma_f32_16x16x32_bf16 v[180:183], a[224:227], v[100:103], v[180:183]
ds_read_b64_tr_b16 a[192:193], v8 offset:40960
v_add_f32 v240, v240, v162
v_mfma_f32_16x16x32_bf16 v[180:183], a[220:223], v[84:87], v[180:183]
ds_read_b64_tr_b16 a[194:195], v8 offset:43008
v_mfma_f32_16x16x32_bf16 v[180:183], a[216:219], v[68:71], v[180:183]
v_exp_f32 v164, v164
v_mfma_f32_16x16x32_bf16 v[184:187], a[216:219], v[72:75], v[232:235]
v_exp_f32 v165, v165
v_mfma_f32_16x16x32_bf16 v[184:187], a[220:223], v[88:91], v[184:187]
ds_read_b64_tr_b16 a[196:197], v8 offset:45056
v_add_f32 v240, v240, v163
v_mfma_f32_16x16x32_bf16 v[184:187], a[224:227], v[104:107], v[184:187]
ds_read_b64_tr_b16 a[198:199], v8 offset:47104
v_cvt_pk_bf16_f32 v209, v162, v163
v_mfma_f32_16x16x32_bf16 v[184:187], a[228:231], v[120:123], v[184:187]
v_exp_f32 v166, v166
v_mfma_f32_16x16x32_bf16 v[184:187], a[232:235], v[136:139], v[184:187]
v_add_f32 v241, v241, v164
v_mfma_f32_16x16x32_bf16 v[184:187], a[236:239], v[152:155], v[184:187]
ds_read_b64_tr_b16 a[200:201], v9 offset:40960
v_add_f32 v241, v241, v165
v_mfma_f32_16x16x32_bf16 v[188:191], a[236:239], v[156:159], v[236:239]
ds_read_b64_tr_b16 a[202:203], v9 offset:43008
v_cvt_pk_bf16_f32 v212, v164, v165
v_mfma_f32_16x16x32_bf16 v[188:191], a[232:235], v[140:143], v[188:191]
v_exp_f32 v167, v167
v_mfma_f32_16x16x32_bf16 v[188:191], a[228:231], v[124:127], v[188:191]
v_exp_f32 v168, v168
v_mfma_f32_16x16x32_bf16 v[188:191], a[224:227], v[108:111], v[188:191]
ds_read_b64_tr_b16 a[204:205], v9 offset:45056
v_mfma_f32_16x16x32_bf16 v[188:191], a[220:223], v[92:95], v[188:191]
ds_read_b64_tr_b16 a[206:207], v9 offset:47104
v_add_f32 v241, v241, v166
v_mfma_f32_16x16x32_bf16 v[188:191], a[216:219], v[76:79], v[188:191]
s_waitcnt lgkmcnt(9)
v_exp_f32 v169, v169
v_mfma_f32_16x16x32_bf16 a[128:131], a[240:243], v[28:31], a[128:131]
v_mfma_f32_16x16x32_bf16 a[128:131], a[244:247], v[44:47], a[128:131]
v_add_f32 v241, v241, v167
v_mfma_f32_16x16x32_bf16 a[132:135], a[244:247], v[48:51], a[132:135]
v_cvt_pk_bf16_f32 v213, v166, v167
v_add_f32 v242, v242, v168
v_mfma_f32_16x16x32_bf16 a[132:135], a[240:243], v[32:35], a[132:135]
v_exp_f32 v170, v170
v_mfma_f32_16x16x32_bf16 a[136:139], a[240:243], v[36:39], a[136:139]
v_mfma_f32_16x16x32_bf16 a[136:139], a[244:247], v[52:55], a[136:139]
v_exp_f32 v171, v171
v_mfma_f32_16x16x32_bf16 a[140:143], a[244:247], v[56:59], a[140:143]
v_mfma_f32_16x16x32_bf16 a[140:143], a[240:243], v[40:43], a[140:143]
s_waitcnt vmcnt(12) lgkmcnt(0)
v_add_f32 v242, v242, v169
v_cvt_pk_bf16_f32 v216, v168, v169
v_mfma_f32_16x16x32_bf16 a[144:147], a[248:251], v[28:31], a[144:147]
s_barrier
v_exp_f32 v172, v172
v_mfma_f32_16x16x32_bf16 a[144:147], a[252:255], v[44:47], a[144:147]
v_mfma_f32_16x16x32_bf16 a[148:151], a[252:255], v[48:51], a[148:151]
v_add_f32 v242, v242, v170
v_mfma_f32_16x16x32_bf16 a[148:151], a[248:251], v[32:35], a[148:151]
v_mfma_f32_16x16x32_bf16 a[152:155], a[248:251], v[36:39], a[152:155]
ds_read_b128 a[208:211], v4 offset:24576
v_add_f32 v242, v242, v171
v_mfma_f32_16x16x32_bf16 a[152:155], a[252:255], v[52:55], a[152:155]
v_exp_f32 v173, v173
v_mfma_f32_16x16x32_bf16 a[156:159], a[252:255], v[56:59], a[156:159]
ds_read_b128 a[212:215], v5 offset:24576
v_cvt_pk_bf16_f32 v217, v170, v171
v_mfma_f32_16x16x32_bf16 a[156:159], a[248:251], v[40:43], a[156:159]
v_exp_f32 v174, v174
v_mfma_f32_16x16x32_bf16 a[160:163], a[192:195], v[28:31], a[160:163]
ds_read_b128 a[216:219], v4 offset:28672
v_add_f32 v243, v243, v172
v_mfma_f32_16x16x32_bf16 a[160:163], a[196:199], v[44:47], a[160:163]
v_exp_f32 v175, v175
v_mfma_f32_16x16x32_bf16 a[164:167], a[196:199], v[48:51], a[164:167]
ds_read_b128 a[220:223], v5 offset:28672
v_add_f32 v243, v243, v173
v_mfma_f32_16x16x32_bf16 a[164:167], a[192:195], v[32:35], a[164:167]
v_mfma_f32_16x16x32_bf16 a[168:171], a[192:195], v[36:39], a[168:171]
ds_read_b128 a[224:227], v4 offset:32768
v_cvt_pk_bf16_f32 v220, v172, v173
v_mfma_f32_16x16x32_bf16 a[168:171], a[196:199], v[52:55], a[168:171]
v_exp_f32 v176, v176
v_mfma_f32_16x16x32_bf16 a[172:175], a[196:199], v[56:59], a[172:175]
ds_read_b128 a[228:231], v5 offset:32768
v_add_f32 v243, v243, v174
v_mfma_f32_16x16x32_bf16 a[172:175], a[192:195], v[40:43], a[172:175]
v_exp_f32 v177, v177
v_mfma_f32_16x16x32_bf16 a[176:179], a[200:203], v[28:31], a[176:179]
v_add_f32 v243, v243, v175
v_mfma_f32_16x16x32_bf16 a[176:179], a[204:207], v[44:47], a[176:179]
v_cvt_pk_bf16_f32 v221, v174, v175
v_mfma_f32_16x16x32_bf16 a[180:183], a[204:207], v[48:51], a[180:183]
v_mfma_f32_16x16x32_bf16 a[180:183], a[200:203], v[32:35], a[180:183]
v_exp_f32 v178, v178
v_mfma_f32_16x16x32_bf16 a[184:187], a[200:203], v[36:39], a[184:187]
v_add_f32 v240, v240, v176
v_add_f32 v240, v240, v177
v_mfma_f32_16x16x32_bf16 a[184:187], a[204:207], v[52:55], a[184:187]
v_exp_f32 v179, v179
v_mfma_f32_16x16x32_bf16 a[188:191], a[204:207], v[56:59], a[188:191]
v_mfma_f32_16x16x32_bf16 a[188:191], a[200:203], v[40:43], a[188:191]
s_waitcnt lgkmcnt(3)
v_cvt_pk_bf16_f32 v210, v176, v177
v_mfma_f32_16x16x32_bf16 v[160:163], a[208:211], v[64:67], v[224:227]
s_add_u32 m0, s31, 40704
v_exp_f32 v180, v180
v_mfma_f32_16x16x32_bf16 v[160:163], a[212:215], v[80:83], v[160:163]
buffer_load_dwordx4 v11, s[8:11], s33 offen offset:256 lds
v_mfma_f32_16x16x32_bf16 v[160:163], a[216:219], v[96:99], v[160:163]
s_waitcnt lgkmcnt(0)
v_add_f32 v240, v240, v178
v_add_f32 v240, v240, v179
v_mfma_f32_16x16x32_bf16 v[160:163], a[220:223], v[112:115], v[160:163]
v_exp_f32 v181, v181
v_mfma_f32_16x16x32_bf16 v[160:163], a[224:227], v[128:131], v[160:163]
ds_read_b128 a[232:235], v4 offset:26624
v_mfma_f32_16x16x32_bf16 v[160:163], a[228:231], v[144:147], v[160:163]
v_cvt_pk_bf16_f32 v211, v178, v179
v_mfma_f32_16x16x32_bf16 v[164:167], a[228:231], v[148:151], v[228:231]
ds_read_b128 a[236:239], v5 offset:26624
v_add_f32 v241, v241, v180
v_mfma_f32_16x16x32_bf16 v[164:167], a[224:227], v[132:135], v[164:167]
v_exp_f32 v182, v182
v_mfma_f32_16x16x32_bf16 v[164:167], a[220:223], v[116:119], v[164:167]
s_add_u32 m0, s31, 44800
ds_read_b128 a[240:243], v4 offset:30720
v_add_f32 v241, v241, v181
v_mfma_f32_16x16x32_bf16 v[164:167], a[216:219], v[100:103], v[164:167]
buffer_load_dwordx4 v23, s[8:11], s33 offen offset:256 lds
v_mfma_f32_16x16x32_bf16 v[164:167], a[212:215], v[84:87], v[164:167]
s_add_u32 s33, s33, 24576
ds_read_b128 a[244:247], v5 offset:30720
v_cvt_pk_bf16_f32 v214, v180, v181
v_mfma_f32_16x16x32_bf16 v[164:167], a[208:211], v[68:71], v[164:167]
v_exp_f32 v183, v183
v_mfma_f32_16x16x32_bf16 v[168:171], a[208:211], v[72:75], v[232:235]
ds_read_b128 a[248:251], v4 offset:34816
v_add_f32 v241, v241, v182
v_mfma_f32_16x16x32_bf16 v[168:171], a[212:215], v[88:91], v[168:171]
v_exp_f32 v184, v184
v_mfma_f32_16x16x32_bf16 v[168:171], a[216:219], v[104:107], v[168:171]
ds_read_b128 a[252:255], v5 offset:34816
v_add_f32 v241, v241, v183
v_mfma_f32_16x16x32_bf16 v[168:171], a[220:223], v[120:123], v[168:171]
s_add_u32 m0, s52, 0
v_exp_f32 v185, v185
v_mfma_f32_16x16x32_bf16 v[168:171], a[224:227], v[136:139], v[168:171]
ds_read_b64_tr_b16 a[192:193], v6 offset:0
buffer_load_dwordx4 v3, s[12:15], s50 offen offset:0 sc1 lds
v_mfma_f32_16x16x32_bf16 v[168:171], a[228:231], v[152:155], v[168:171]
ds_read_b64_tr_b16 a[194:195], v6 offset:2048
v_cvt_pk_bf16_f32 v215, v182, v183
v_mfma_f32_16x16x32_bf16 v[172:175], a[228:231], v[156:159], v[236:239]
ds_read_b64_tr_b16 a[196:197], v6 offset:4096
v_add_f32 v242, v242, v184
v_mfma_f32_16x16x32_bf16 v[172:175], a[224:227], v[140:143], v[172:175]
ds_read_b64_tr_b16 a[198:199], v6 offset:6144
v_mfma_f32_16x16x32_bf16 v[172:175], a[220:223], v[124:127], v[172:175]
v_exp_f32 v186, v186
v_mfma_f32_16x16x32_bf16 v[172:175], a[216:219], v[108:111], v[172:175]
ds_read_b64_tr_b16 a[200:201], v7 offset:0
v_add_f32 v242, v242, v185
v_mfma_f32_16x16x32_bf16 v[172:175], a[212:215], v[92:95], v[172:175]
ds_read_b64_tr_b16 a[202:203], v7 offset:2048
v_cvt_pk_bf16_f32 v218, v184, v185
v_mfma_f32_16x16x32_bf16 v[172:175], a[208:211], v[76:79], v[172:175]
s_waitcnt lgkmcnt(9)
v_exp_f32 v187, v187
v_mfma_f32_16x16x32_bf16 v[176:179], a[232:235], v[64:67], v[224:227]
v_exp_f32 v188, v188
v_mfma_f32_16x16x32_bf16 v[176:179], a[236:239], v[80:83], v[176:179]
ds_read_b64_tr_b16 a[204:205], v7 offset:4096
v_add_f32 v242, v242, v186
v_mfma_f32_16x16x32_bf16 v[176:179], a[240:243], v[96:99], v[176:179]
s_waitcnt lgkmcnt(7)
ds_read_b64_tr_b16 a[206:207], v7 offset:6144
v_add_f32 v242, v242, v187
v_mfma_f32_16x16x32_bf16 v[176:179], a[244:247], v[112:115], v[176:179]
v_exp_f32 v189, v189
v_mfma_f32_16x16x32_bf16 v[176:179], a[248:251], v[128:131], v[176:179]
buffer_load_dwordx4 v3, s[12:15], s50 offen offset:1024 sc1 lds
v_cvt_pk_bf16_f32 v219, v186, v187
v_mfma_f32_16x16x32_bf16 v[176:179], a[252:255], v[144:147], v[176:179]
ds_read_b64_tr_b16 a[208:209], v8 offset:0
v_add_f32 v243, v243, v188
v_mfma_f32_16x16x32_bf16 v[180:183], a[252:255], v[148:151], v[228:231]
ds_read_b64_tr_b16 a[210:211], v8 offset:2048
v_mfma_f32_16x16x32_bf16 v[180:183], a[248:251], v[132:135], v[180:183]
v_exp_f32 v190, v190
v_mfma_f32_16x16x32_bf16 v[180:183], a[244:247], v[116:119], v[180:183]
v_exp_f32 v191, v191
v_mfma_f32_16x16x32_bf16 v[180:183], a[240:243], v[100:103], v[180:183]
ds_read_b64_tr_b16 a[212:213], v8 offset:4096
v_add_f32 v243, v243, v189
v_mfma_f32_16x16x32_bf16 v[180:183], a[236:239], v[84:87], v[180:183]
ds_read_b64_tr_b16 a[214:215], v8 offset:6144
v_cvt_pk_bf16_f32 v222, v188, v189
v_mfma_f32_16x16x32_bf16 v[180:183], a[232:235], v[68:71], v[180:183]
buffer_load_dwordx4 v3, s[12:15], s50 offen offset:2048 sc1 lds
v_add_f32 v243, v243, v190
v_mfma_f32_16x16x32_bf16 v[184:187], a[232:235], v[72:75], v[232:235]
v_add_f32 v243, v243, v191
v_mfma_f32_16x16x32_bf16 v[184:187], a[236:239], v[88:91], v[184:187]
ds_read_b64_tr_b16 a[216:217], v9 offset:0
v_cvt_pk_bf16_f32 v223, v190, v191
v_mfma_f32_16x16x32_bf16 v[184:187], a[240:243], v[104:107], v[184:187]
ds_read_b64_tr_b16 a[218:219], v9 offset:2048
v_mfma_f32_16x16x32_bf16 v[184:187], a[244:247], v[120:123], v[184:187]
buffer_load_dwordx4 v3, s[12:15], s50 offen offset:3072 sc1 lds
v_mfma_f32_16x16x32_bf16 v[184:187], a[248:251], v[136:139], v[184:187]
v_exp_f32 v160, v160
v_mfma_f32_16x16x32_bf16 v[184:187], a[252:255], v[152:155], v[184:187]
ds_read_b64_tr_b16 a[220:221], v9 offset:4096
v_mfma_f32_16x16x32_bf16 v[188:191], a[252:255], v[156:159], v[236:239]
ds_read_b64_tr_b16 a[222:223], v9 offset:6144
v_mfma_f32_16x16x32_bf16 v[188:191], a[248:251], v[140:143], v[188:191]
v_exp_f32 v161, v161
v_mfma_f32_16x16x32_bf16 v[188:191], a[244:247], v[124:127], v[188:191]
v_exp_f32 v162, v162
v_mfma_f32_16x16x32_bf16 v[188:191], a[240:243], v[108:111], v[188:191]
ds_read_b64_tr_b16 a[224:225], v6 offset:8192
v_add_f32 v240, v240, v160
v_mfma_f32_16x16x32_bf16 v[188:191], a[236:239], v[92:95], v[188:191]
ds_read_b64_tr_b16 a[226:227], v6 offset:10240
v_add_f32 v240, v240, v161
v_mfma_f32_16x16x32_bf16 v[188:191], a[232:235], v[76:79], v[188:191]
s_waitcnt lgkmcnt(9)
s_add_u32 m0, s52, 1024
v_exp_f32 v163, v163
v_mfma_f32_16x16x32_bf16 a[0:3], a[192:195], v[192:195], a[0:3]
buffer_load_dwordx4 v1, s[12:15], s50 offen offset:3072 sc1 lds
v_cvt_pk_bf16_f32 v28, v160, v161
v_mfma_f32_16x16x32_bf16 a[0:3], a[196:199], v[208:211], a[0:3]
s_add_u32 s50, s50, 10240
ds_read_b64_tr_b16 a[228:229], v6 offset:12288
v_add_f32 v240, v240, v162
v_mfma_f32_16x16x32_bf16 a[4:7], a[196:199], v[212:215], a[4:7]
ds_read_b64_tr_b16 a[230:231], v6 offset:14336
v_mfma_f32_16x16x32_bf16 a[4:7], a[192:195], v[196:199], a[4:7]
v_exp_f32 v164, v164
v_mfma_f32_16x16x32_bf16 a[8:11], a[192:195], v[200:203], a[8:11]
v_exp_f32 v165, v165
v_mfma_f32_16x16x32_bf16 a[8:11], a[196:199], v[216:219], a[8:11]
ds_read_b64_tr_b16 a[232:233], v7 offset:8192
v_add_f32 v240, v240, v163
v_mfma_f32_16x16x32_bf16 a[12:15], a[196:199], v[220:223], a[12:15]
ds_read_b64_tr_b16 a[234:235], v7 offset:10240
v_cvt_pk_bf16_f32 v29, v162, v163
v_mfma_f32_16x16x32_bf16 a[12:15], a[192:195], v[204:207], a[12:15]
s_waitcnt lgkmcnt(9)
s_add_u32 m0, s52, 20480
v_exp_f32 v166, v166
v_mfma_f32_16x16x32_bf16 a[16:19], a[200:203], v[192:195], a[16:19]
buffer_load_dwordx4 v3, s[12:15], s50 offen offset:0 sc1 lds
v_add_f32 v241, v241, v164
v_mfma_f32_16x16x32_bf16 a[16:19], a[204:207], v[208:211], a[16:19]
ds_read_b64_tr_b16 a[236:237], v7 offset:12288
v_add_f32 v241, v241, v165
v_mfma_f32_16x16x32_bf16 a[20:23], a[204:207], v[212:215], a[20:23]
ds_read_b64_tr_b16 a[238:239], v7 offset:14336
v_cvt_pk_bf16_f32 v32, v164, v165
v_mfma_f32_16x16x32_bf16 a[20:23], a[200:203], v[196:199], a[20:23]
v_exp_f32 v167, v167
v_mfma_f32_16x16x32_bf16 a[24:27], a[200:203], v[200:203], a[24:27]
v_exp_f32 v168, v168
v_mfma_f32_16x16x32_bf16 a[24:27], a[204:207], v[216:219], a[24:27]
ds_read_b64_tr_b16 a[240:241], v8 offset:8192
buffer_load_dwordx4 v3, s[12:15], s50 offen offset:1024 sc1 lds
v_mfma_f32_16x16x32_bf16 a[28:31], a[204:207], v[220:223], a[28:31]
ds_read_b64_tr_b16 a[242:243], v8 offset:10240
v_add_f32 v241, v241, v166
v_mfma_f32_16x16x32_bf16 a[28:31], a[200:203], v[204:207], a[28:31]
s_waitcnt lgkmcnt(9)
v_exp_f32 v169, v169
v_mfma_f32_16x16x32_bf16 a[32:35], a[208:211], v[192:195], a[32:35]
v_mfma_f32_16x16x32_bf16 a[32:35], a[212:215], v[208:211], a[32:35]
ds_read_b64_tr_b16 a[244:245], v8 offset:12288
v_add_f32 v241, v241, v167
v_mfma_f32_16x16x32_bf16 a[36:39], a[212:215], v[212:215], a[36:39]
ds_read_b64_tr_b16 a[246:247], v8 offset:14336
v_cvt_pk_bf16_f32 v33, v166, v167
v_mfma_f32_16x16x32_bf16 a[36:39], a[208:211], v[196:199], a[36:39]
v_exp_f32 v170, v170
v_mfma_f32_16x16x32_bf16 a[40:43], a[208:211], v[200:203], a[40:43]
buffer_load_dwordx4 v3, s[12:15], s50 offen offset:2048 sc1 lds
v_add_f32 v242, v242, v168
v_mfma_f32_16x16x32_bf16 a[40:43], a[212:215], v[216:219], a[40:43]
ds_read_b64_tr_b16 a[248:249], v9 offset:8192
v_add_f32 v242, v242, v169
v_mfma_f32_16x16x32_bf16 a[44:47], a[212:215], v[220:223], a[44:47]
ds_read_b64_tr_b16 a[250:251], v9 offset:10240
v_cvt_pk_bf16_f32 v36, v168, v169
v_mfma_f32_16x16x32_bf16 a[44:47], a[208:211], v[204:207], a[44:47]
s_waitcnt lgkmcnt(9)
v_exp_f32 v171, v171
v_mfma_f32_16x16x32_bf16 a[48:51], a[216:219], v[192:195], a[48:51]
v_exp_f32 v172, v172
v_mfma_f32_16x16x32_bf16 a[48:51], a[220:223], v[208:211], a[48:51]
ds_read_b64_tr_b16 a[252:253], v9 offset:12288
buffer_load_dwordx4 v3, s[12:15], s50 offen offset:3072 sc1 lds
v_mfma_f32_16x16x32_bf16 a[52:55], a[220:223], v[212:215], a[52:55]
ds_read_b64_tr_b16 a[254:255], v9 offset:14336
v_add_f32 v242, v242, v170
v_mfma_f32_16x16x32_bf16 a[52:55], a[216:219], v[196:199], a[52:55]
v_exp_f32 v173, v173
v_mfma_f32_16x16x32_bf16 a[56:59], a[216:219], v[200:203], a[56:59]
s_add_u32 m0, s52, 21504
v_add_f32 v242, v242, v171
v_mfma_f32_16x16x32_bf16 a[56:59], a[220:223], v[216:219], a[56:59]
buffer_load_dwordx4 v1, s[12:15], s50 offen offset:3072 sc1 lds
v_cvt_pk_bf16_f32 v37, v170, v171
v_mfma_f32_16x16x32_bf16 a[60:63], a[220:223], v[220:223], a[60:63]
s_add_u32 s50, s50, 10240
v_exp_f32 v174, v174
v_mfma_f32_16x16x32_bf16 a[60:63], a[216:219], v[204:207], a[60:63]
s_waitcnt lgkmcnt(9)
v_mfma_f32_16x16x32_bf16 a[64:67], a[224:227], v[192:195], a[64:67]
v_add_f32 v243, v243, v172
v_mfma_f32_16x16x32_bf16 a[64:67], a[228:231], v[208:211], a[64:67]
v_exp_f32 v175, v175
v_mfma_f32_16x16x32_bf16 a[68:71], a[228:231], v[212:215], a[68:71]
v_add_f32 v243, v243, v173
v_mfma_f32_16x16x32_bf16 a[68:71], a[224:227], v[196:199], a[68:71]
s_waitcnt vmcnt(19) lgkmcnt(0)
v_cvt_pk_bf16_f32 v40, v172, v173
v_mfma_f32_16x16x32_bf16 a[72:75], a[224:227], v[200:203], a[72:75]
s_barrier
v_exp_f32 v176, v176
v_mfma_f32_16x16x32_bf16 a[72:75], a[228:231], v[216:219], a[72:75]
s_add_u32 m0, s52, 40960
v_mfma_f32_16x16x32_bf16 a[76:79], a[228:231], v[220:223], a[76:79]
buffer_load_dwordx4 v3, s[12:15], s50 offen offset:0 sc1 lds
v_add_f32 v243, v243, v174
v_mfma_f32_16x16x32_bf16 a[76:79], a[224:227], v[204:207], a[76:79]
v_mfma_f32_16x16x32_bf16 a[80:83], a[232:235], v[192:195], a[80:83]
v_exp_f32 v177, v177
v_mfma_f32_16x16x32_bf16 a[80:83], a[236:239], v[208:211], a[80:83]
v_add_f32 v243, v243, v175
v_cvt_pk_bf16_f32 v41, v174, v175
v_mfma_f32_16x16x32_bf16 a[84:87], a[236:239], v[212:215], a[84:87]
v_exp_f32 v178, v178
v_mfma_f32_16x16x32_bf16 a[84:87], a[232:235], v[196:199], a[84:87]
buffer_load_dwordx4 v3, s[12:15], s50 offen offset:1024 sc1 lds
v_mfma_f32_16x16x32_bf16 a[88:91], a[232:235], v[200:203], a[88:91]
ds_read_b128 a[192:195], v4 offset:36864
v_add_f32 v240, v240, v176
v_mfma_f32_16x16x32_bf16 a[88:91], a[236:239], v[216:219], a[88:91]
v_exp_f32 v179, v179
v_mfma_f32_16x16x32_bf16 a[92:95], a[236:239], v[220:223], a[92:95]
ds_read_b128 a[196:199], v5 offset:36864
v_add_f32 v240, v240, v177
v_mfma_f32_16x16x32_bf16 a[92:95], a[232:235], v[204:207], a[92:95]
buffer_load_dwordx4 v3, s[12:15], s50 offen offset:2048 sc1 lds
v_mfma_f32_16x16x32_bf16 a[96:99], a[240:243], v[192:195], a[96:99]
ds_read_b128 a[200:203], v4 offset:40960
v_cvt_pk_bf16_f32 v30, v176, v177
v_mfma_f32_16x16x32_bf16 a[96:99], a[244:247], v[208:211], a[96:99]
v_exp_f32 v180, v180
v_mfma_f32_16x16x32_bf16 a[100:103], a[244:247], v[212:215], a[100:103]
ds_read_b128 a[204:207], v5 offset:40960
v_add_f32 v240, v240, v178
v_mfma_f32_16x16x32_bf16 a[100:103], a[240:243], v[196:199], a[100:103]
v_exp_f32 v181, v181
v_mfma_f32_16x16x32_bf16 a[104:107], a[240:243], v[200:203], a[104:107]
ds_read_b128 a[208:211], v4 offset:45056
v_add_f32 v240, v240, v179
v_mfma_f32_16x16x32_bf16 a[104:107], a[244:247], v[216:219], a[104:107]
buffer_load_dwordx4 v3, s[12:15], s50 offen offset:3072 sc1 lds
v_cvt_pk_bf16_f32 v31, v178, v179
v_mfma_f32_16x16x32_bf16 a[108:111], a[244:247], v[220:223], a[108:111]
ds_read_b128 a[212:215], v5 offset:45056
v_add_f32 v241, v241, v180
v_mfma_f32_16x16x32_bf16 a[108:111], a[240:243], v[204:207], a[108:111]
v_mfma_f32_16x16x32_bf16 a[112:115], a[248:251], v[192:195], a[112:115]
v_exp_f32 v182, v182
v_mfma_f32_16x16x32_bf16 a[112:115], a[252:255], v[208:211], a[112:115]
s_add_u32 m0, s52, 41984
v_exp_f32 v183, v183
v_mfma_f32_16x16x32_bf16 a[116:119], a[252:255], v[212:215], a[116:119]
buffer_load_dwordx4 v1, s[12:15], s50 offen offset:3072 sc1 lds
v_add_f32 v241, v241, v181
v_mfma_f32_16x16x32_bf16 a[116:119], a[248:251], v[196:199], a[116:119]
s_add_u32 s50, s50, 10240
v_cvt_pk_bf16_f32 v34, v180, v181
v_add_f32 v241, v241, v182
v_mfma_f32_16x16x32_bf16 a[120:123], a[248:251], v[200:203], a[120:123]
v_exp_f32 v184, v184
v_mfma_f32_16x16x32_bf16 a[120:123], a[252:255], v[216:219], a[120:123]
v_mfma_f32_16x16x32_bf16 a[124:127], a[252:255], v[220:223], a[124:127]
v_mfma_f32_16x16x32_bf16 a[124:127], a[248:251], v[204:207], a[124:127]
s_waitcnt lgkmcnt(3)
v_exp_f32 v185, v185
v_mfma_f32_16x16x32_bf16 v[160:163], a[192:195], v[64:67], v[224:227]
v_add_f32 v241, v241, v183
v_mfma_f32_16x16x32_bf16 v[160:163], a[196:199], v[80:83], v[160:163]
v_cvt_pk_bf16_f32 v35, v182, v183
v_add_f32 v242, v242, v184
v_mfma_f32_16x16x32_bf16 v[160:163], a[200:203], v[96:99], v[160:163]
s_waitcnt lgkmcnt(0)
s_add_u32 m0, s52, 61440
v_exp_f32 v186, v186
v_mfma_f32_16x16x32_bf16 v[160:163], a[204:207], v[112:115], v[160:163]
buffer_load_dwordx4 v3, s[12:15], s50 offen offset:0 sc1 lds
v_mfma_f32_16x16x32_bf16 v[160:163], a[208:211], v[128:131], v[160:163]
ds_read_b128 a[216:219], v4 offset:38912
v_add_f32 v242, v242, v185
v_mfma_f32_16x16x32_bf16 v[160:163], a[212:215], v[144:147], v[160:163]
v_mfma_f32_16x16x32_bf16 v[164:167], a[212:215], v[148:151], v[228:231]
ds_read_b128 a[220:223], v5 offset:38912
v_cvt_pk_bf16_f32 v38, v184, v185
v_mfma_f32_16x16x32_bf16 v[164:167], a[208:211], v[132:135], v[164:167]
v_exp_f32 v187, v187
v_mfma_f32_16x16x32_bf16 v[164:167], a[204:207], v[116:119], v[164:167]
ds_read_b128 a[224:227], v4 offset:43008
v_add_f32 v242, v242, v186
v_mfma_f32_16x16x32_bf16 v[164:167], a[200:203], v[100:103], v[164:167]
v_exp_f32 v188, v188
v_mfma_f32_16x16x32_bf16 v[164:167], a[196:199], v[84:87], v[164:167]
ds_read_b128 a[228:231], v5 offset:43008
v_add_f32 v242, v242, v187
v_mfma_f32_16x16x32_bf16 v[164:167], a[192:195], v[68:71], v[164:167]
v_exp_f32 v189, v189
v_mfma_f32_16x16x32_bf16 v[168:171], a[192:195], v[72:75], v[232:235]
ds_read_b128 a[232:235], v4 offset:47104
v_cvt_pk_bf16_f32 v39, v186, v187
v_mfma_f32_16x16x32_bf16 v[168:171], a[196:199], v[88:91], v[168:171]
buffer_load_dwordx4 v3, s[12:15], s50 offen offset:1024 sc1 lds
v_mfma_f32_16x16x32_bf16 v[168:171], a[200:203], v[104:107], v[168:171]
ds_read_b128 a[236:239], v5 offset:47104
v_add_f32 v243, v243, v188
v_mfma_f32_16x16x32_bf16 v[168:171], a[204:207], v[120:123], v[168:171]
v_exp_f32 v190, v190
v_mfma_f32_16x16x32_bf16 v[168:171], a[208:211], v[136:139], v[168:171]
v_exp_f32 v191, v191
v_mfma_f32_16x16x32_bf16 v[168:171], a[212:215], v[152:155], v[168:171]
ds_read_b64_tr_b16 a[240:241], v6 offset:16384
v_add_f32 v243, v243, v189
v_mfma_f32_16x16x32_bf16 v[172:175], a[212:215], v[156:159], v[236:239]
ds_read_b64_tr_b16 a[242:243], v6 offset:18432
v_cvt_pk_bf16_f32 v42, v188, v189
v_mfma_f32_16x16x32_bf16 v[172:175], a[208:211], v[140:143], v[172:175]
buffer_load_dwordx4 v3, s[12:15], s50 offen offset:2048 sc1 lds
v_add_f32 v243, v243, v190
v_mfma_f32_16x16x32_bf16 v[172:175], a[204:207], v[124:127], v[172:175]
v_mfma_f32_16x16x32_bf16 v[172:175], a[200:203], v[108:111], v[172:175]
ds_read_b64_tr_b16 a[244:245], v6 offset:20480
v_add_f32 v243, v243, v191
v_mfma_f32_16x16x32_bf16 v[172:175], a[196:199], v[92:95], v[172:175]
ds_read_b64_tr_b16 a[246:247], v6 offset:22528
v_cvt_pk_bf16_f32 v43, v190, v191
v_mfma_f32_16x16x32_bf16 v[172:175], a[192:195], v[76:79], v[172:175]
s_waitcnt lgkmcnt(7)
buffer_load_dwordx4 v3, s[12:15], s50 offen offset:3072 sc1 lds
v_mfma_f32_16x16x32_bf16 v[176:179], a[216:219], v[64:67], v[224:227]
v_exp_f32 v160, v160
v_mfma_f32_16x16x32_bf16 v[176:179], a[220:223], v[80:83], v[176:179]
ds_read_b64_tr_b16 a[248:249], v7 offset:16384
v_mfma_f32_16x16x32_bf16 v[176:179], a[224:227], v[96:99], v[176:179]
s_waitcnt lgkmcnt(5)
ds_read_b64_tr_b16 a[250:251], v7 offset:18432
v_mfma_f32_16x16x32_bf16 v[176:179], a[228:231], v[112:115], v[176:179]
v_exp_f32 v161, v161
v_mfma_f32_16x16x32_bf16 v[176:179], a[232:235], v[128:131], v[176:179]
v_exp_f32 v162, v162
v_mfma_f32_16x16x32_bf16 v[176:179], a[236:239], v[144:147], v[176:179]
ds_read_b64_tr_b16 a[252:253], v7 offset:20480
v_add_f32 v240, v240, v160
v_mfma_f32_16x16x32_bf16 v[180:183], a[236:239], v[148:151], v[228:231]
ds_read_b64_tr_b16 a[254:255], v7 offset:22528
v_add_f32 v240, v240, v161
v_mfma_f32_16x16x32_bf16 v[180:183], a[232:235], v[132:135], v[180:183]
s_add_u32 m0, s52, 62464
v_exp_f32 v163, v163
v_mfma_f32_16x16x32_bf16 v[180:183], a[228:231], v[116:119], v[180:183]
buffer_load_dwordx4 v1, s[12:15], s50 offen offset:3072 sc1 lds
v_cvt_pk_bf16_f32 v44, v160, v161
v_mfma_f32_16x16x32_bf16 v[180:183], a[224:227], v[100:103], v[180:183]
s_add_u32 s50, s50, 10240
ds_read_b64_tr_b16 a[192:193], v8 offset:16384
v_add_f32 v240, v240, v162
v_mfma_f32_16x16x32_bf16 v[180:183], a[220:223], v[84:87], v[180:183]
ds_read_b64_tr_b16 a[194:195], v8 offset:18432
v_mfma_f32_16x16x32_bf16 v[180:183], a[216:219], v[68:71], v[180:183]
v_exp_f32 v164, v164
v_mfma_f32_16x16x32_bf16 v[184:187], a[216:219], v[72:75], v[232:235]
v_exp_f32 v165, v165
v_mfma_f32_16x16x32_bf16 v[184:187], a[220:223], v[88:91], v[184:187]
ds_read_b64_tr_b16 a[196:197], v8 offset:20480
v_add_f32 v240, v240, v163
v_mfma_f32_16x16x32_bf16 v[184:187], a[224:227], v[104:107], v[184:187]
ds_read_b64_tr_b16 a[198:199], v8 offset:22528
v_cvt_pk_bf16_f32 v45, v162, v163
v_mfma_f32_16x16x32_bf16 v[184:187], a[228:231], v[120:123], v[184:187]
s_add_u32 m0, s52, 122880
v_exp_f32 v166, v166
v_mfma_f32_16x16x32_bf16 v[184:187], a[232:235], v[136:139], v[184:187]
buffer_load_dwordx4 v3, s[12:15], s50 offen offset:0 sc1 lds
v_add_f32 v241, v241, v164
v_mfma_f32_16x16x32_bf16 v[184:187], a[236:239], v[152:155], v[184:187]
ds_read_b64_tr_b16 a[200:201], v9 offset:16384
v_add_f32 v241, v241, v165
v_mfma_f32_16x16x32_bf16 v[188:191], a[236:239], v[156:159], v[236:239]
ds_read_b64_tr_b16 a[202:203], v9 offset:18432
v_cvt_pk_bf16_f32 v48, v164, v165
v_mfma_f32_16x16x32_bf16 v[188:191], a[232:235], v[140:143], v[188:191]
v_exp_f32 v167, v167
v_mfma_f32_16x16x32_bf16 v[188:191], a[228:231], v[124:127], v[188:191]
v_exp_f32 v168, v168
v_mfma_f32_16x16x32_bf16 v[188:191], a[224:227], v[108:111], v[188:191]
ds_read_b64_tr_b16 a[204:205], v9 offset:20480
buffer_load_dwordx4 v3, s[12:15], s50 offen offset:1024 sc1 lds
v_mfma_f32_16x16x32_bf16 v[188:191], a[220:223], v[92:95], v[188:191]
ds_read_b64_tr_b16 a[206:207], v9 offset:22528
v_add_f32 v241, v241, v166
v_mfma_f32_16x16x32_bf16 v[188:191], a[216:219], v[76:79], v[188:191]
s_waitcnt lgkmcnt(9)
v_exp_f32 v169, v169
v_mfma_f32_16x16x32_bf16 a[128:131], a[240:243], v[192:195], a[128:131]
v_mfma_f32_16x16x32_bf16 a[128:131], a[244:247], v[208:211], a[128:131]
buffer_load_dwordx4 v3, s[12:15], s50 offen offset:2048 sc1 lds
v_add_f32 v241, v241, v167
v_mfma_f32_16x16x32_bf16 a[132:135], a[244:247], v[212:215], a[132:135]
v_cvt_pk_bf16_f32 v49, v166, v167
v_add_f32 v242, v242, v168
v_mfma_f32_16x16x32_bf16 a[132:135], a[240:243], v[196:199], a[132:135]
v_exp_f32 v170, v170
v_mfma_f32_16x16x32_bf16 a[136:139], a[240:243], v[200:203], a[136:139]
v_mfma_f32_16x16x32_bf16 a[136:139], a[244:247], v[216:219], a[136:139]
v_exp_f32 v171, v171
v_mfma_f32_16x16x32_bf16 a[140:143], a[244:247], v[220:223], a[140:143]
v_mfma_f32_16x16x32_bf16 a[140:143], a[240:243], v[204:207], a[140:143]
s_waitcnt vmcnt(25) lgkmcnt(0)
v_add_f32 v242, v242, v169
v_cvt_pk_bf16_f32 v52, v168, v169
v_mfma_f32_16x16x32_bf16 a[144:147], a[248:251], v[192:195], a[144:147]
s_barrier
v_exp_f32 v172, v172
v_mfma_f32_16x16x32_bf16 a[144:147], a[252:255], v[208:211], a[144:147]
v_mfma_f32_16x16x32_bf16 a[148:151], a[252:255], v[212:215], a[148:151]
buffer_load_dwordx4 v3, s[12:15], s50 offen offset:3072 sc1 lds
v_add_f32 v242, v242, v170
v_mfma_f32_16x16x32_bf16 a[148:151], a[248:251], v[196:199], a[148:151]
v_mfma_f32_16x16x32_bf16 a[152:155], a[248:251], v[200:203], a[152:155]
v_add_f32 v242, v242, v171
v_mfma_f32_16x16x32_bf16 a[152:155], a[252:255], v[216:219], a[152:155]
s_add_u32 m0, s52, 123904
v_exp_f32 v173, v173
v_mfma_f32_16x16x32_bf16 a[156:159], a[252:255], v[220:223], a[156:159]
buffer_load_dwordx4 v1, s[12:15], s50 offen offset:3072 sc1 lds
v_cvt_pk_bf16_f32 v53, v170, v171
v_mfma_f32_16x16x32_bf16 a[156:159], a[248:251], v[204:207], a[156:159]
s_add_u32 s50, s50, 10240
v_exp_f32 v174, v174
v_mfma_f32_16x16x32_bf16 a[160:163], a[192:195], v[192:195], a[160:163]
v_add_f32 v243, v243, v172
v_mfma_f32_16x16x32_bf16 a[160:163], a[196:199], v[208:211], a[160:163]
s_add_u32 m0, s52, 143360
v_exp_f32 v175, v175
v_mfma_f32_16x16x32_bf16 a[164:167], a[196:199], v[212:215], a[164:167]
buffer_load_dwordx4 v3, s[12:15], s50 offen offset:0 sc1 lds
v_add_f32 v243, v243, v173
v_mfma_f32_16x16x32_bf16 a[164:167], a[192:195], v[196:199], a[164:167]
v_mfma_f32_16x16x32_bf16 a[168:171], a[192:195], v[200:203], a[168:171]
v_cvt_pk_bf16_f32 v56, v172, v173
v_mfma_f32_16x16x32_bf16 a[168:171], a[196:199], v[216:219], a[168:171]
v_exp_f32 v176, v176
v_mfma_f32_16x16x32_bf16 a[172:175], a[196:199], v[220:223], a[172:175]
buffer_load_dwordx4 v3, s[12:15], s50 offen offset:1024 sc1 lds
v_add_f32 v243, v243, v174
v_mfma_f32_16x16x32_bf16 a[172:175], a[192:195], v[204:207], a[172:175]
v_exp_f32 v177, v177
v_mfma_f32_16x16x32_bf16 a[176:179], a[200:203], v[192:195], a[176:179]
v_add_f32 v243, v243, v175
v_mfma_f32_16x16x32_bf16 a[176:179], a[204:207], v[208:211], a[176:179]
buffer_load_dwordx4 v3, s[12:15], s50 offen offset:2048 sc1 lds
v_cvt_pk_bf16_f32 v57, v174, v175
v_mfma_f32_16x16x32_bf16 a[180:183], a[204:207], v[212:215], a[180:183]
v_mfma_f32_16x16x32_bf16 a[180:183], a[200:203], v[196:199], a[180:183]
v_exp_f32 v178, v178
v_mfma_f32_16x16x32_bf16 a[184:187], a[200:203], v[200:203], a[184:187]
v_add_f32 v240, v240, v176
v_add_f32 v240, v240, v177
v_mfma_f32_16x16x32_bf16 a[184:187], a[204:207], v[216:219], a[184:187]
v_exp_f32 v179, v179
v_mfma_f32_16x16x32_bf16 a[188:191], a[204:207], v[220:223], a[188:191]
buffer_load_dwordx4 v3, s[12:15], s50 offen offset:3072 sc1 lds
v_mfma_f32_16x16x32_bf16 a[188:191], a[200:203], v[204:207], a[188:191]
v_cvt_pk_bf16_f32 v46, v176, v177
v_exp_f32 v180, v180
v_add_f32 v240, v240, v178
v_add_f32 v240, v240, v179
v_exp_f32 v181, v181
v_cvt_pk_bf16_f32 v47, v178, v179
v_add_f32 v241, v241, v180
v_exp_f32 v182, v182
v_add_f32 v241, v241, v181
v_cvt_pk_bf16_f32 v50, v180, v181
v_exp_f32 v183, v183
v_add_f32 v241, v241, v182
v_exp_f32 v184, v184
v_add_f32 v241, v241, v183
v_exp_f32 v185, v185
ds_read_b64_tr_b16 a[192:193], v6 offset:24576
ds_read_b64_tr_b16 a[194:195], v6 offset:26624
v_cvt_pk_bf16_f32 v51, v182, v183
ds_read_b64_tr_b16 a[196:197], v6 offset:28672
v_add_f32 v242, v242, v184
ds_read_b64_tr_b16 a[198:199], v6 offset:30720
v_exp_f32 v186, v186
ds_read_b64_tr_b16 a[200:201], v7 offset:24576
v_add_f32 v242, v242, v185
ds_read_b64_tr_b16 a[202:203], v7 offset:26624
v_cvt_pk_bf16_f32 v54, v184, v185
v_exp_f32 v187, v187
v_exp_f32 v188, v188
ds_read_b64_tr_b16 a[204:205], v7 offset:28672
v_add_f32 v242, v242, v186
ds_read_b64_tr_b16 a[206:207], v7 offset:30720
v_add_f32 v242, v242, v187
v_exp_f32 v189, v189
v_cvt_pk_bf16_f32 v55, v186, v187
s_add_u32 m0, s52, 144384
ds_read_b64_tr_b16 a[208:209], v8 offset:24576
v_add_f32 v243, v243, v188
ds_read_b64_tr_b16 a[210:211], v8 offset:26624
buffer_load_dwordx4 v1, s[12:15], s50 offen offset:3072 sc1 lds
s_add_u32 s50, s50, 10240
v_exp_f32 v190, v190
v_exp_f32 v191, v191
ds_read_b64_tr_b16 a[212:213], v8 offset:28672
v_add_f32 v243, v243, v189
ds_read_b64_tr_b16 a[214:215], v8 offset:30720
v_cvt_pk_bf16_f32 v58, v188, v189
buffer_load_dwordx4 v[224:227], v15, s[24:27], s51 offen sc1
v_add_f32 v243, v243, v190
v_add_f32 v243, v243, v191
ds_read_b64_tr_b16 a[216:217], v9 offset:24576
v_cvt_pk_bf16_f32 v59, v190, v191
ds_read_b64_tr_b16 a[218:219], v9 offset:26624
buffer_load_dwordx4 v[228:231], v16, s[24:27], s51 offen sc1
ds_read_b64_tr_b16 a[220:221], v9 offset:28672
buffer_load_dwordx4 v[232:235], v17, s[24:27], s51 offen sc1
ds_read_b64_tr_b16 a[222:223], v9 offset:30720
buffer_load_dwordx4 v[236:239], v18, s[24:27], s51 offen sc1
s_add_u32 s51, s51, 8192
ds_read_b64_tr_b16 a[224:225], v6 offset:32768
ds_read_b64_tr_b16 a[226:227], v6 offset:34816
s_waitcnt lgkmcnt(9)
buffer_load_dwordx4 v[192:195], v15, s[24:27], s51 offen sc1
v_mfma_f32_16x16x32_bf16 a[0:3], a[192:195], v[28:31], a[0:3]
v_mov_b32 v248, v240
v_mov_b32 v249, v241
v_mfma_f32_16x16x32_bf16 a[0:3], a[196:199], v[44:47], a[0:3]
ds_read_b64_tr_b16 a[228:229], v6 offset:36864
v_mov_b32 v250, v242
v_mfma_f32_16x16x32_bf16 a[4:7], a[196:199], v[48:51], a[4:7]
ds_read_b64_tr_b16 a[230:231], v6 offset:38912
v_mov_b32 v251, v243
v_mfma_f32_16x16x32_bf16 a[4:7], a[192:195], v[32:35], a[4:7]
v_permlane32_swap_b32 v240, v248
v_mfma_f32_16x16x32_bf16 a[8:11], a[192:195], v[36:39], a[8:11]
v_permlane32_swap_b32 v241, v249
v_mfma_f32_16x16x32_bf16 a[8:11], a[196:199], v[52:55], a[8:11]
ds_read_b64_tr_b16 a[232:233], v7 offset:32768
buffer_load_dwordx4 v[196:199], v16, s[24:27], s51 offen sc1
v_mfma_f32_16x16x32_bf16 a[12:15], a[196:199], v[56:59], a[12:15]
ds_read_b64_tr_b16 a[234:235], v7 offset:34816
v_mfma_f32_16x16x32_bf16 a[12:15], a[192:195], v[40:43], a[12:15]
s_waitcnt lgkmcnt(9)
v_permlane32_swap_b32 v242, v250
v_mfma_f32_16x16x32_bf16 a[16:19], a[200:203], v[28:31], a[16:19]
v_permlane32_swap_b32 v243, v251
v_mfma_f32_16x16x32_bf16 a[16:19], a[204:207], v[44:47], a[16:19]
ds_read_b64_tr_b16 a[236:237], v7 offset:36864
v_add_f32 v240, v240, v248
v_mfma_f32_16x16x32_bf16 a[20:23], a[204:207], v[48:51], a[20:23]
ds_read_b64_tr_b16 a[238:239], v7 offset:38912
v_add_f32 v241, v241, v249
v_mfma_f32_16x16x32_bf16 a[20:23], a[200:203], v[32:35], a[20:23]
v_add_f32 v242, v242, v250
v_add_f32 v243, v243, v251
v_mfma_f32_16x16x32_bf16 a[24:27], a[200:203], v[36:39], a[24:27]
v_mov_b32 v248, v240
v_mov_b32 v249, v241
v_mfma_f32_16x16x32_bf16 a[24:27], a[204:207], v[52:55], a[24:27]
ds_read_b64_tr_b16 a[240:241], v8 offset:32768
v_mov_b32 v250, v242
v_mfma_f32_16x16x32_bf16 a[28:31], a[204:207], v[56:59], a[28:31]
ds_read_b64_tr_b16 a[242:243], v8 offset:34816
v_mov_b32 v251, v243
v_mfma_f32_16x16x32_bf16 a[28:31], a[200:203], v[40:43], a[28:31]
s_waitcnt lgkmcnt(9)
v_permlane16_swap_b32 v240, v248
v_mfma_f32_16x16x32_bf16 a[32:35], a[208:211], v[28:31], a[32:35]
v_permlane16_swap_b32 v241, v249
v_mfma_f32_16x16x32_bf16 a[32:35], a[212:215], v[44:47], a[32:35]
ds_read_b64_tr_b16 a[244:245], v8 offset:36864
buffer_load_dwordx4 v[200:203], v17, s[24:27], s51 offen sc1
v_mfma_f32_16x16x32_bf16 a[36:39], a[212:215], v[48:51], a[36:39]
ds_read_b64_tr_b16 a[246:247], v8 offset:38912
v_mfma_f32_16x16x32_bf16 a[36:39], a[208:211], v[32:35], a[36:39]
v_permlane16_swap_b32 v242, v250
v_mfma_f32_16x16x32_bf16 a[40:43], a[208:211], v[36:39], a[40:43]
v_permlane16_swap_b32 v243, v251
v_mfma_f32_16x16x32_bf16 a[40:43], a[212:215], v[52:55], a[40:43]
ds_read_b64_tr_b16 a[248:249], v9 offset:32768
v_add_f32 v240, v240, v248
v_mfma_f32_16x16x32_bf16 a[44:47], a[212:215], v[56:59], a[44:47]
ds_read_b64_tr_b16 a[250:251], v9 offset:34816
v_add_f32 v241, v241, v249
v_mfma_f32_16x16x32_bf16 a[44:47], a[208:211], v[40:43], a[44:47]
s_waitcnt lgkmcnt(9)
v_add_f32 v242, v242, v250
v_add_f32 v243, v243, v251
s_mov_b32 s40, 0x5d800000
v_mfma_f32_16x16x32_bf16 a[48:51], a[216:219], v[28:31], a[48:51]
v_cmp_nle_f32 s[42:43], v240, s40
v_cmp_nle_f32 vcc, v241, s40
v_mfma_f32_16x16x32_bf16 a[48:51], a[220:223], v[44:47], a[48:51]
ds_read_b64_tr_b16 a[252:253], v9 offset:36864
s_or_b64 s[42:43], s[42:43], vcc
v_cmp_nle_f32 vcc, v242, s40
v_mfma_f32_16x16x32_bf16 a[52:55], a[220:223], v[48:51], a[52:55]
ds_read_b64_tr_b16 a[254:255], v9 offset:38912
s_or_b64 s[42:43], s[42:43], vcc
v_cmp_nle_f32 vcc, v243, s40
v_mfma_f32_16x16x32_bf16 a[52:55], a[216:219], v[32:35], a[52:55]
buffer_load_dwordx4 v[204:207], v18, s[24:27], s51 offen sc1
s_or_b64 s[42:43], s[42:43], vcc
s_or_b32 s42, s42, s43
v_mfma_f32_16x16x32_bf16 a[56:59], a[216:219], v[36:39], a[56:59]
s_add_u32 s51, s51, 8192
v_mov_b32 v248, s42
v_mov_b32 v249, s49
v_mfma_f32_16x16x32_bf16 a[56:59], a[220:223], v[52:55], a[56:59]
ds_write_b32 v249, v248
v_mfma_f32_16x16x32_bf16 a[60:63], a[220:223], v[56:59], a[60:63]
v_rcp_f32 v240, v240
v_mfma_f32_16x16x32_bf16 a[60:63], a[216:219], v[40:43], a[60:63]
s_waitcnt lgkmcnt(9)
v_rcp_f32 v241, v241
v_mfma_f32_16x16x32_bf16 a[64:67], a[224:227], v[28:31], a[64:67]
v_rcp_f32 v242, v242
v_mfma_f32_16x16x32_bf16 a[64:67], a[228:231], v[44:47], a[64:67]
v_rcp_f32 v243, v243
v_mfma_f32_16x16x32_bf16 a[68:71], a[228:231], v[48:51], a[68:71]
v_mov_b32 v4, 118784
v_mfma_f32_16x16x32_bf16 a[68:71], a[224:227], v[32:35], a[68:71]
s_waitcnt vmcnt(38) lgkmcnt(0)
v_accvgpr_read_b32 v248, a8
v_accvgpr_read_b32 v249, a9
v_mfma_f32_16x16x32_bf16 a[72:75], a[224:227], v[36:39], a[72:75]
s_barrier
v_accvgpr_read_b32 v250, a10
v_accvgpr_read_b32 v251, a11
v_mfma_f32_16x16x32_bf16 a[72:75], a[228:231], v[52:55], a[72:75]
v_accvgpr_read_b32 v252, a24
v_accvgpr_read_b32 v253, a25
v_mfma_f32_16x16x32_bf16 a[76:79], a[228:231], v[56:59], a[76:79]
ds_read_b64_tr_b16 a[192:193], v6 offset:40960
v_accvgpr_read_b32 v254, a26
v_mfma_f32_16x16x32_bf16 a[76:79], a[224:227], v[40:43], a[76:79]
ds_read_b64_tr_b16 a[194:195], v6 offset:43008
v_accvgpr_read_b32 v255, a27
s_xor_b32 s43, s100, 2048
v_mfma_f32_16x16x32_bf16 a[80:83], a[232:235], v[28:31], a[80:83]
ds_read_b64_tr_b16 a[196:197], v6 offset:45056
v_mul_f32 v248, v248, v242
v_mfma_f32_16x16x32_bf16 a[80:83], a[236:239], v[44:47], a[80:83]
ds_read_b64_tr_b16 a[198:199], v6 offset:47104
v_mul_f32 v249, v249, v242
v_mfma_f32_16x16x32_bf16 a[84:87], a[236:239], v[48:51], a[84:87]
v_mul_f32 v250, v250, v242
v_mul_f32 v251, v251, v242
v_mfma_f32_16x16x32_bf16 a[84:87], a[232:235], v[32:35], a[84:87]
ds_read_b64_tr_b16 a[200:201], v7 offset:40960
v_mul_f32 v252, v252, v242
v_mfma_f32_16x16x32_bf16 a[88:91], a[232:235], v[36:39], a[88:91]
ds_read_b64_tr_b16 a[202:203], v7 offset:43008
v_mul_f32 v253, v253, v242
v_mfma_f32_16x16x32_bf16 a[88:91], a[236:239], v[52:55], a[88:91]
ds_read_b64_tr_b16 a[204:205], v7 offset:45056
v_mul_f32 v254, v254, v242
v_mfma_f32_16x16x32_bf16 a[92:95], a[236:239], v[56:59], a[92:95]
ds_read_b64_tr_b16 a[206:207], v7 offset:47104
v_mul_f32 v255, v255, v242
v_mfma_f32_16x16x32_bf16 a[92:95], a[232:235], v[40:43], a[92:95]
v_cvt_pk_bf16_f32 v248, v248, v249
v_cvt_pk_bf16_f32 v249, v250, v251
v_mfma_f32_16x16x32_bf16 a[96:99], a[240:243], v[28:31], a[96:99]
ds_read_b64_tr_b16 a[208:209], v8 offset:40960
v_cvt_pk_bf16_f32 v250, v252, v253
v_mfma_f32_16x16x32_bf16 a[96:99], a[244:247], v[44:47], a[96:99]
ds_read_b64_tr_b16 a[210:211], v8 offset:43008
v_cvt_pk_bf16_f32 v251, v254, v255
v_mfma_f32_16x16x32_bf16 a[100:103], a[244:247], v[48:51], a[100:103]
ds_read_b64_tr_b16 a[212:213], v8 offset:45056
buffer_load_dwordx4 v[208:211], v15, s[24:27], s51 offen sc1
v_mfma_f32_16x16x32_bf16 a[100:103], a[240:243], v[32:35], a[100:103]
ds_read_b64_tr_b16 a[214:215], v8 offset:47104
v_mfma_f32_16x16x32_bf16 a[104:107], a[240:243], v[36:39], a[104:107]
buffer_store_dwordx4 v[248:251], v3, s[24:27], s43 offen sc1
v_mfma_f32_16x16x32_bf16 a[104:107], a[244:247], v[52:55], a[104:107]
ds_read_b64_tr_b16 a[216:217], v9 offset:40960
buffer_load_dwordx4 v[212:215], v16, s[24:27], s51 offen sc1
v_mfma_f32_16x16x32_bf16 a[108:111], a[244:247], v[56:59], a[108:111]
ds_read_b64_tr_b16 a[218:219], v9 offset:43008
v_accvgpr_read_b32 v248, a12
v_mfma_f32_16x16x32_bf16 a[108:111], a[240:243], v[40:43], a[108:111]
ds_read_b64_tr_b16 a[220:221], v9 offset:45056
v_accvgpr_read_b32 v249, a13
v_mfma_f32_16x16x32_bf16 a[112:115], a[248:251], v[28:31], a[112:115]
ds_read_b64_tr_b16 a[222:223], v9 offset:47104
v_accvgpr_read_b32 v250, a14
v_mfma_f32_16x16x32_bf16 a[112:115], a[252:255], v[44:47], a[112:115]
v_accvgpr_read_b32 v251, a15
v_accvgpr_read_b32 v252, a28
v_mfma_f32_16x16x32_bf16 a[116:119], a[252:255], v[48:51], a[116:119]
v_accvgpr_read_b32 v253, a29
v_accvgpr_read_b32 v254, a30
v_mfma_f32_16x16x32_bf16 a[116:119], a[248:251], v[32:35], a[116:119]
buffer_load_dwordx4 v[216:219], v17, s[24:27], s51 offen sc1
v_accvgpr_read_b32 v255, a31
s_xor_b32 s43, s100, 3072
v_mfma_f32_16x16x32_bf16 a[120:123], a[248:251], v[36:39], a[120:123]
v_mul_f32 v248, v248, v243
v_mul_f32 v249, v249, v243
v_mfma_f32_16x16x32_bf16 a[120:123], a[252:255], v[52:55], a[120:123]
v_mul_f32 v250, v250, v243
v_mul_f32 v251, v251, v243
v_mfma_f32_16x16x32_bf16 a[124:127], a[252:255], v[56:59], a[124:127]
v_mul_f32 v252, v252, v243
v_mul_f32 v253, v253, v243
v_mfma_f32_16x16x32_bf16 a[124:127], a[248:251], v[40:43], a[124:127]
v_mul_f32 v254, v254, v243
v_mul_f32 v255, v255, v243
s_waitcnt lgkmcnt(9)
v_mfma_f32_16x16x32_bf16 a[128:131], a[192:195], v[28:31], a[128:131]
v_cvt_pk_bf16_f32 v248, v248, v249
v_cvt_pk_bf16_f32 v249, v250, v251
v_mfma_f32_16x16x32_bf16 a[128:131], a[196:199], v[44:47], a[128:131]
v_cvt_pk_bf16_f32 v250, v252, v253
v_cvt_pk_bf16_f32 v251, v254, v255
v_mfma_f32_16x16x32_bf16 a[132:135], a[196:199], v[48:51], a[132:135]
buffer_store_dwordx4 v[248:251], v3, s[24:27], s43 offen sc1
buffer_load_dwordx4 v[220:223], v18, s[24:27], s51 offen sc1
ds_read_b128 v[244:247], v4
v_mfma_f32_16x16x32_bf16 a[132:135], a[192:195], v[32:35], a[132:135]
s_add_u32 s51, s51, 8192
v_mfma_f32_16x16x32_bf16 a[136:139], a[192:195], v[36:39], a[136:139]
v_accvgpr_read_b32 v248, a40
v_accvgpr_read_b32 v249, a41
v_mfma_f32_16x16x32_bf16 a[136:139], a[196:199], v[52:55], a[136:139]
v_accvgpr_read_b32 v250, a42
v_accvgpr_read_b32 v251, a43
v_mfma_f32_16x16x32_bf16 a[140:143], a[196:199], v[56:59], a[140:143]
v_accvgpr_read_b32 v252, a56
v_accvgpr_read_b32 v253, a57
v_mfma_f32_16x16x32_bf16 a[140:143], a[192:195], v[40:43], a[140:143]
s_waitcnt lgkmcnt(0)
v_accvgpr_read_b32 v254, a58
v_accvgpr_read_b32 v255, a59
s_xor_b32 s43, s100, 2048
v_mfma_f32_16x16x32_bf16 a[144:147], a[200:203], v[28:31], a[144:147]
s_add_u32 s43, s43, 4096
v_mfma_f32_16x16x32_bf16 a[144:147], a[204:207], v[44:47], a[144:147]
v_mul_f32 v248, v248, v242
v_mul_f32 v249, v249, v242
v_mfma_f32_16x16x32_bf16 a[148:151], a[204:207], v[48:51], a[148:151]
v_mul_f32 v250, v250, v242
v_mul_f32 v251, v251, v242
v_mfma_f32_16x16x32_bf16 a[148:151], a[200:203], v[32:35], a[148:151]
v_mul_f32 v252, v252, v242
v_mul_f32 v253, v253, v242
v_mfma_f32_16x16x32_bf16 a[152:155], a[200:203], v[36:39], a[152:155]
v_mul_f32 v254, v254, v242
v_mul_f32 v255, v255, v242
v_mfma_f32_16x16x32_bf16 a[152:155], a[204:207], v[52:55], a[152:155]
v_cvt_pk_bf16_f32 v248, v248, v249
v_cvt_pk_bf16_f32 v249, v250, v251
v_mfma_f32_16x16x32_bf16 a[156:159], a[204:207], v[56:59], a[156:159]
v_cvt_pk_bf16_f32 v250, v252, v253
v_cvt_pk_bf16_f32 v251, v254, v255
v_mfma_f32_16x16x32_bf16 a[156:159], a[200:203], v[40:43], a[156:159]
buffer_store_dwordx4 v[248:251], v3, s[24:27], s43 offen sc1
v_mfma_f32_16x16x32_bf16 a[160:163], a[208:211], v[28:31], a[160:163]
v_mfma_f32_16x16x32_bf16 a[160:163], a[212:215], v[44:47], a[160:163]
v_mfma_f32_16x16x32_bf16 a[164:167], a[212:215], v[48:51], a[164:167]
v_mfma_f32_16x16x32_bf16 a[164:167], a[208:211], v[32:35], a[164:167]
v_mfma_f32_16x16x32_bf16 a[168:171], a[208:211], v[36:39], a[168:171]
v_mfma_f32_16x16x32_bf16 a[168:171], a[212:215], v[52:55], a[168:171]
v_mfma_f32_16x16x32_bf16 a[172:175], a[212:215], v[56:59], a[172:175]
v_mfma_f32_16x16x32_bf16 a[172:175], a[208:211], v[40:43], a[172:175]
v_mfma_f32_16x16x32_bf16 a[176:179], a[216:219], v[28:31], a[176:179]
v_mfma_f32_16x16x32_bf16 a[176:179], a[220:223], v[44:47], a[176:179]
v_mfma_f32_16x16x32_bf16 a[180:183], a[220:223], v[48:51], a[180:183]
v_mfma_f32_16x16x32_bf16 a[180:183], a[216:219], v[32:35], a[180:183]
v_mfma_f32_16x16x32_bf16 a[184:187], a[216:219], v[36:39], a[184:187]
v_mfma_f32_16x16x32_bf16 a[184:187], a[220:223], v[52:55], a[184:187]
v_mfma_f32_16x16x32_bf16 a[188:191], a[220:223], v[56:59], a[188:191]
v_mfma_f32_16x16x32_bf16 a[188:191], a[216:219], v[40:43], a[188:191]
v_or_b32 v244, v244, v245
v_or3_b32 v244, v244, v246, v247
s_nop 0
v_readfirstlane_b32 s40, v244
s_cmp_eq_u32 s40, 0
s_cbranch_scc1 K_epi
s_cmp_eq_u32 s35, 0
s_cbranch_scc1 K_fb
K_epi:
s_waitcnt vmcnt(25)
v_mov_b32 v4, v240
v_mov_b32 v5, v240
v_mov_b32 v6, v241
v_mov_b32 v7, v241
v_mov_b32 v8, v242
v_mov_b32 v9, v242
v_mov_b32 v10, v243
v_mov_b32 v11, v243
buffer_load_dwordx4 v[160:163], v15, s[24:27], s51 offen sc1
v_accvgpr_read_b32 v28, a44
v_accvgpr_read_b32 v29, a45
v_accvgpr_read_b32 v30, a46
v_accvgpr_read_b32 v31, a47
v_accvgpr_read_b32 v32, a60
v_accvgpr_read_b32 v33, a61
v_accvgpr_read_b32 v34, a62
v_accvgpr_read_b32 v35, a63
v_pk_mul_f32 v[28:29], v[28:29], v[10:11]
v_pk_mul_f32 v[30:31], v[30:31], v[10:11]
v_pk_mul_f32 v[32:33], v[32:33], v[10:11]
v_pk_mul_f32 v[34:35], v[34:35], v[10:11]
v_cvt_pk_bf16_f32 v92, v28, v29
v_cvt_pk_bf16_f32 v93, v30, v31
v_cvt_pk_bf16_f32 v94, v32, v33
v_cvt_pk_bf16_f32 v95, v34, v35
s_xor_b32 s43, s100, 3072
s_add_u32 s43, s43, 4096
buffer_store_dwordx4 v[92:95], v3, s[24:27], s43 offen sc1
buffer_load_dwordx4 v[164:167], v16, s[24:27], s51 offen sc1
v_accvgpr_read_b32 v36, a72
v_accvgpr_read_b32 v37, a73
v_accvgpr_read_b32 v38, a74
v_accvgpr_read_b32 v39, a75
v_accvgpr_read_b32 v40, a88
v_accvgpr_read_b32 v41, a89
v_accvgpr_read_b32 v42, a90
v_accvgpr_read_b32 v43, a91
v_pk_mul_f32 v[36:37], v[36:37], v[8:9]
v_pk_mul_f32 v[38:39], v[38:39], v[8:9]
v_pk_mul_f32 v[40:41], v[40:41], v[8:9]
v_pk_mul_f32 v[42:43], v[42:43], v[8:9]
v_cvt_pk_bf16_f32 v104, v36, v37
v_cvt_pk_bf16_f32 v105, v38, v39
v_cvt_pk_bf16_f32 v106, v40, v41
v_cvt_pk_bf16_f32 v107, v42, v43
buffer_load_dwordx4 v[168:171], v17, s[24:27], s51 offen sc1
v_accvgpr_read_b32 v28, a76
v_accvgpr_read_b32 v29, a77
v_accvgpr_read_b32 v30, a78
v_accvgpr_read_b32 v31, a79
v_accvgpr_read_b32 v32, a92
v_accvgpr_read_b32 v33, a93
v_accvgpr_read_b32 v34, a94
v_accvgpr_read_b32 v35, a95
v_pk_mul_f32 v[28:29], v[28:29], v[10:11]
v_pk_mul_f32 v[30:31], v[30:31], v[10:11]
v_pk_mul_f32 v[32:33], v[32:33], v[10:11]
v_pk_mul_f32 v[34:35], v[34:35], v[10:11]
v_cvt_pk_bf16_f32 v108, v28, v29
v_cvt_pk_bf16_f32 v109, v30, v31
v_cvt_pk_bf16_f32 v110, v32, v33
v_cvt_pk_bf16_f32 v111, v34, v35
s_xor_b32 s43, s100, 2048
s_add_u32 s43, s43, 8192
buffer_store_dwordx4 v[104:107], v3, s[24:27], s43 offen sc1
buffer_load_dwordx4 v[172:175], v18, s[24:27], s51 offen sc1
s_add_u32 s51, s51, 8192
v_accvgpr_read_b32 v36, a0
v_accvgpr_read_b32 v37, a1
v_accvgpr_read_b32 v38, a2
v_accvgpr_read_b32 v39, a3
v_accvgpr_read_b32 v40, a16
v_accvgpr_read_b32 v41, a17
v_accvgpr_read_b32 v42, a18
v_accvgpr_read_b32 v43, a19
v_pk_mul_f32 v[36:37], v[36:37], v[4:5]
v_pk_mul_f32 v[38:39], v[38:39], v[4:5]
v_pk_mul_f32 v[40:41], v[40:41], v[4:5]
v_pk_mul_f32 v[42:43], v[42:43], v[4:5]
v_cvt_pk_bf16_f32 v64, v36, v37
v_cvt_pk_bf16_f32 v65, v38, v39
v_cvt_pk_bf16_f32 v66, v40, v41
v_cvt_pk_bf16_f32 v67, v42, v43
buffer_load_dwordx4 v[176:179], v15, s[24:27], s51 offen sc1
v_accvgpr_read_b32 v28, a4
v_accvgpr_read_b32 v29, a5
v_accvgpr_read_b32 v30, a6
v_accvgpr_read_b32 v31, a7
v_accvgpr_read_b32 v32, a20
v_accvgpr_read_b32 v33, a21
v_accvgpr_read_b32 v34, a22
v_accvgpr_read_b32 v35, a23
v_pk_mul_f32 v[28:29], v[28:29], v[6:7]
v_pk_mul_f32 v[30:31], v[30:31], v[6:7]
v_pk_mul_f32 v[32:33], v[32:33], v[6:7]
v_pk_mul_f32 v[34:35], v[34:35], v[6:7]
v_cvt_pk_bf16_f32 v68, v28, v29
v_cvt_pk_bf16_f32 v69, v30, v31
v_cvt_pk_bf16_f32 v70, v32, v33
v_cvt_pk_bf16_f32 v71, v34, v35
s_xor_b32 s43, s100, 3072
s_add_u32 s43, s43, 8192
buffer_store_dwordx4 v[108:111], v3, s[24:27], s43 offen sc1
buffer_load_dwordx4 v[180:183], v16, s[24:27], s51 offen sc1
v_accvgpr_read_b32 v36, a32
v_accvgpr_read_b32 v37, a33
v_accvgpr_read_b32 v38, a34
v_accvgpr_read_b32 v39, a35
v_accvgpr_read_b32 v40, a48
v_accvgpr_read_b32 v41, a49
v_accvgpr_read_b32 v42, a50
v_accvgpr_read_b32 v43, a51
v_pk_mul_f32 v[36:37], v[36:37], v[4:5]
v_pk_mul_f32 v[38:39], v[38:39], v[4:5]
v_pk_mul_f32 v[40:41], v[40:41], v[4:5]
v_pk_mul_f32 v[42:43], v[42:43], v[4:5]
v_cvt_pk_bf16_f32 v80, v36, v37
v_cvt_pk_bf16_f32 v81, v38, v39
v_cvt_pk_bf16_f32 v82, v40, v41
v_cvt_pk_bf16_f32 v83, v42, v43
buffer_load_dwordx4 v[184:187], v17, s[24:27], s51 offen sc1
v_accvgpr_read_b32 v28, a36
v_accvgpr_read_b32 v29, a37
v_accvgpr_read_b32 v30, a38
v_accvgpr_read_b32 v31, a39
v_accvgpr_read_b32 v32, a52
v_accvgpr_read_b32 v33, a53
v_accvgpr_read_b32 v34, a54
v_accvgpr_read_b32 v35, a55
v_pk_mul_f32 v[28:29], v[28:29], v[6:7]
v_pk_mul_f32 v[30:31], v[30:31], v[6:7]
v_pk_mul_f32 v[32:33], v[32:33], v[6:7]
v_pk_mul_f32 v[34:35], v[34:35], v[6:7]
v_cvt_pk_bf16_f32 v84, v28, v29
v_cvt_pk_bf16_f32 v85, v30, v31
v_cvt_pk_bf16_f32 v86, v32, v33
v_cvt_pk_bf16_f32 v87, v34, v35
s_xor_b32 s43, s100, 0
buffer_store_dwordx4 v[64:67], v3, s[24:27], s43 offen sc1
buffer_load_dwordx4 v[188:191], v18, s[24:27], s51 offen sc1
s_add_u32 s51, s51, 8192
v_accvgpr_read_b32 v36, a64
v_accvgpr_read_b32 v37, a65
v_accvgpr_read_b32 v38, a66
v_accvgpr_read_b32 v39, a67
v_accvgpr_read_b32 v40, a80
v_accvgpr_read_b32 v41, a81
v_accvgpr_read_b32 v42, a82
v_accvgpr_read_b32 v43, a83
v_pk_mul_f32 v[36:37], v[36:37], v[4:5]
v_pk_mul_f32 v[38:39], v[38:39], v[4:5]
v_pk_mul_f32 v[40:41], v[40:41], v[4:5]
v_pk_mul_f32 v[42:43], v[42:43], v[4:5]
v_cvt_pk_bf16_f32 v96, v36, v37
v_cvt_pk_bf16_f32 v97, v38, v39
v_cvt_pk_bf16_f32 v98, v40, v41
v_cvt_pk_bf16_f32 v99, v42, v43
buffer_load_dwordx4 v[44:47], v15, s[24:27], s51 offen sc1
v_accvgpr_read_b32 v28, a68
v_accvgpr_read_b32 v29, a69
v_accvgpr_read_b32 v30, a70
v_accvgpr_read_b32 v31, a71
v_accvgpr_read_b32 v32, a84
v_accvgpr_read_b32 v33, a85
v_accvgpr_read_b32 v34, a86
v_accvgpr_read_b32 v35, a87
v_pk_mul_f32 v[28:29], v[28:29], v[6:7]
v_pk_mul_f32 v[30:31], v[30:31], v[6:7]
v_pk_mul_f32 v[32:33], v[32:33], v[6:7]
v_pk_mul_f32 v[34:35], v[34:35], v[6:7]
v_cvt_pk_bf16_f32 v100, v28, v29
v_cvt_pk_bf16_f32 v101, v30, v31
v_cvt_pk_bf16_f32 v102, v32, v33
v_cvt_pk_bf16_f32 v103, v34, v35
s_xor_b32 s43, s100, 1024
buffer_store_dwordx4 v[68:71], v3, s[24:27], s43 offen sc1
buffer_load_dwordx4 v[48:51], v16, s[24:27], s51 offen sc1
v_accvgpr_read_b32 v36, a96
v_accvgpr_read_b32 v37, a97
v_accvgpr_read_b32 v38, a98
v_accvgpr_read_b32 v39, a99
v_accvgpr_read_b32 v40, a112
v_accvgpr_read_b32 v41, a113
v_accvgpr_read_b32 v42, a114
v_accvgpr_read_b32 v43, a115
v_pk_mul_f32 v[36:37], v[36:37], v[4:5]
v_pk_mul_f32 v[38:39], v[38:39], v[4:5]
v_pk_mul_f32 v[40:41], v[40:41], v[4:5]
v_pk_mul_f32 v[42:43], v[42:43], v[4:5]
v_cvt_pk_bf16_f32 v112, v36, v37
v_cvt_pk_bf16_f32 v113, v38, v39
v_cvt_pk_bf16_f32 v114, v40, v41
v_cvt_pk_bf16_f32 v115, v42, v43
buffer_load_dwordx4 v[52:55], v17, s[24:27], s51 offen sc1
v_accvgpr_read_b32 v28, a100
v_accvgpr_read_b32 v29, a101
v_accvgpr_read_b32 v30, a102
v_accvgpr_read_b32 v31, a103
v_accvgpr_read_b32 v32, a116
v_accvgpr_read_b32 v33, a117
v_accvgpr_read_b32 v34, a118
v_accvgpr_read_b32 v35, a119
v_pk_mul_f32 v[28:29], v[28:29], v[6:7]
v_pk_mul_f32 v[30:31], v[30:31], v[6:7]
v_pk_mul_f32 v[32:33], v[32:33], v[6:7]
v_pk_mul_f32 v[34:35], v[34:35], v[6:7]
v_cvt_pk_bf16_f32 v116, v28, v29
v_cvt_pk_bf16_f32 v117, v30, v31
v_cvt_pk_bf16_f32 v118, v32, v33
v_cvt_pk_bf16_f32 v119, v34, v35
s_xor_b32 s43, s100, 0
s_add_u32 s43, s43, 4096
buffer_store_dwordx4 v[80:83], v3, s[24:27], s43 offen sc1
buffer_load_dwordx4 v[56:59], v18, s[24:27], s51 offen sc1
s_add_u32 s51, s51, 8192
v_accvgpr_read_b32 v36, a104
v_accvgpr_read_b32 v37, a105
v_accvgpr_read_b32 v38, a106
v_accvgpr_read_b32 v39, a107
v_accvgpr_read_b32 v40, a120
v_accvgpr_read_b32 v41, a121
v_accvgpr_read_b32 v42, a122
v_accvgpr_read_b32 v43, a123
v_pk_mul_f32 v[36:37], v[36:37], v[8:9]
v_pk_mul_f32 v[38:39], v[38:39], v[8:9]
v_pk_mul_f32 v[40:41], v[40:41], v[8:9]
v_pk_mul_f32 v[42:43], v[42:43], v[8:9]
v_cvt_pk_bf16_f32 v120, v36, v37
v_cvt_pk_bf16_f32 v121, v38, v39
v_cvt_pk_bf16_f32 v122, v40, v41
v_cvt_pk_bf16_f32 v123, v42, v43
v_accvgpr_read_b32 v28, a108
v_accvgpr_read_b32 v29, a109
v_accvgpr_read_b32 v30, a110
v_accvgpr_read_b32 v31, a111
v_accvgpr_read_b32 v32, a124
v_accvgpr_read_b32 v33, a125
v_accvgpr_read_b32 v34, a126
v_accvgpr_read_b32 v35, a127
v_pk_mul_f32 v[28:29], v[28:29], v[10:11]
v_pk_mul_f32 v[30:31], v[30:31], v[10:11]
v_pk_mul_f32 v[32:33], v[32:33], v[10:11]
v_pk_mul_f32 v[34:35], v[34:35], v[10:11]
v_cvt_pk_bf16_f32 v124, v28, v29
v_cvt_pk_bf16_f32 v125, v30, v31
v_cvt_pk_bf16_f32 v126, v32, v33
v_cvt_pk_bf16_f32 v127, v34, v35
s_xor_b32 s43, s100, 1024
s_add_u32 s43, s43, 4096
buffer_store_dwordx4 v[84:87], v3, s[24:27], s43 offen sc1
v_accvgpr_read_b32 v36, a128
v_accvgpr_read_b32 v37, a129
v_accvgpr_read_b32 v38, a130
v_accvgpr_read_b32 v39, a131
v_accvgpr_read_b32 v40, a144
v_accvgpr_read_b32 v41, a145
v_accvgpr_read_b32 v42, a146
v_accvgpr_read_b32 v43, a147
v_pk_mul_f32 v[36:37], v[36:37], v[4:5]
v_pk_mul_f32 v[38:39], v[38:39], v[4:5]
v_pk_mul_f32 v[40:41], v[40:41], v[4:5]
v_pk_mul_f32 v[42:43], v[42:43], v[4:5]
v_cvt_pk_bf16_f32 v128, v36, v37
v_cvt_pk_bf16_f32 v129, v38, v39
v_cvt_pk_bf16_f32 v130, v40, v41
v_cvt_pk_bf16_f32 v131, v42, v43
v_accvgpr_read_b32 v28, a132
v_accvgpr_read_b32 v29, a133
v_accvgpr_read_b32 v30, a134
v_accvgpr_read_b32 v31, a135
v_accvgpr_read_b32 v32, a148
v_accvgpr_read_b32 v33, a149
v_accvgpr_read_b32 v34, a150
v_accvgpr_read_b32 v35, a151
v_pk_mul_f32 v[28:29], v[28:29], v[6:7]
v_pk_mul_f32 v[30:31], v[30:31], v[6:7]
v_pk_mul_f32 v[32:33], v[32:33], v[6:7]
v_pk_mul_f32 v[34:35], v[34:35], v[6:7]
v_cvt_pk_bf16_f32 v132, v28, v29
v_cvt_pk_bf16_f32 v133, v30, v31
v_cvt_pk_bf16_f32 v134, v32, v33
v_cvt_pk_bf16_f32 v135, v34, v35
s_xor_b32 s43, s100, 0
s_add_u32 s43, s43, 8192
buffer_store_dwordx4 v[96:99], v3, s[24:27], s43 offen sc1
v_accvgpr_read_b32 v36, a136
v_accvgpr_read_b32 v37, a137
v_accvgpr_read_b32 v38, a138
v_accvgpr_read_b32 v39, a139
v_accvgpr_read_b32 v40, a152
v_accvgpr_read_b32 v41, a153
v_accvgpr_read_b32 v42, a154
v_accvgpr_read_b32 v43, a155
v_pk_mul_f32 v[36:37], v[36:37], v[8:9]
v_pk_mul_f32 v[38:39], v[38:39], v[8:9]
v_pk_mul_f32 v[40:41], v[40:41], v[8:9]
v_pk_mul_f32 v[42:43], v[42:43], v[8:9]
v_cvt_pk_bf16_f32 v136, v36, v37
v_cvt_pk_bf16_f32 v137, v38, v39
v_cvt_pk_bf16_f32 v138, v40, v41
v_cvt_pk_bf16_f32 v139, v42, v43
v_accvgpr_read_b32 v28, a140
v_accvgpr_read_b32 v29, a141
v_accvgpr_read_b32 v30, a142
v_accvgpr_read_b32 v31, a143
v_accvgpr_read_b32 v32, a156
v_accvgpr_read_b32 v33, a157
v_accvgpr_read_b32 v34, a158
v_accvgpr_read_b32 v35, a159
v_pk_mul_f32 v[28:29], v[28:29], v[10:11]
v_pk_mul_f32 v[30:31], v[30:31], v[10:11]
v_pk_mul_f32 v[32:33], v[32:33], v[10:11]
v_pk_mul_f32 v[34:35], v[34:35], v[10:11]
v_cvt_pk_bf16_f32 v140, v28, v29
v_cvt_pk_bf16_f32 v141, v30, v31
v_cvt_pk_bf16_f32 v142, v32, v33
v_cvt_pk_bf16_f32 v143, v34, v35
s_xor_b32 s43, s100, 1024
s_add_u32 s43, s43, 8192
buffer_store_dwordx4 v[100:103], v3, s[24:27], s43 offen sc1
v_accvgpr_read_b32 v36, a160
v_accvgpr_read_b32 v37, a161
v_accvgpr_read_b32 v38, a162
v_accvgpr_read_b32 v39, a163
v_accvgpr_read_b32 v40, a176
v_accvgpr_read_b32 v41, a177
v_accvgpr_read_b32 v42, a178
v_accvgpr_read_b32 v43, a179
v_pk_mul_f32 v[36:37], v[36:37], v[4:5]
v_pk_mul_f32 v[38:39], v[38:39], v[4:5]
v_pk_mul_f32 v[40:41], v[40:41], v[4:5]
v_pk_mul_f32 v[42:43], v[42:43], v[4:5]
v_cvt_pk_bf16_f32 v144, v36, v37
v_cvt_pk_bf16_f32 v145, v38, v39
v_cvt_pk_bf16_f32 v146, v40, v41
v_cvt_pk_bf16_f32 v147, v42, v43
v_accvgpr_read_b32 v28, a164
v_accvgpr_read_b32 v29, a165
v_accvgpr_read_b32 v30, a166
v_accvgpr_read_b32 v31, a167
v_accvgpr_read_b32 v32, a180
v_accvgpr_read_b32 v33, a181
v_accvgpr_read_b32 v34, a182
v_accvgpr_read_b32 v35, a183
v_pk_mul_f32 v[28:29], v[28:29], v[6:7]
v_pk_mul_f32 v[30:31], v[30:31], v[6:7]
v_pk_mul_f32 v[32:33], v[32:33], v[6:7]
v_pk_mul_f32 v[34:35], v[34:35], v[6:7]
v_cvt_pk_bf16_f32 v148, v28, v29
v_cvt_pk_bf16_f32 v149, v30, v31
v_cvt_pk_bf16_f32 v150, v32, v33
v_cvt_pk_bf16_f32 v151, v34, v35
s_xor_b32 s43, s100, 0
s_add_u32 s43, s43, 12288
buffer_store_dwordx4 v[112:115], v3, s[24:27], s43 offen sc1
v_accvgpr_read_b32 v36, a168
v_accvgpr_read_b32 v37, a169
v_accvgpr_read_b32 v38, a170
v_accvgpr_read_b32 v39, a171
v_accvgpr_read_b32 v40, a184
v_accvgpr_read_b32 v41, a185
v_accvgpr_read_b32 v42, a186
v_accvgpr_read_b32 v43, a187
v_pk_mul_f32 v[36:37], v[36:37], v[8:9]
v_pk_mul_f32 v[38:39], v[38:39], v[8:9]
v_pk_mul_f32 v[40:41], v[40:41], v[8:9]
v_pk_mul_f32 v[42:43], v[42:43], v[8:9]
v_cvt_pk_bf16_f32 v152, v36, v37
v_cvt_pk_bf16_f32 v153, v38, v39
v_cvt_pk_bf16_f32 v154, v40, v41
v_cvt_pk_bf16_f32 v155, v42, v43
v_accvgpr_read_b32 v28, a172
v_accvgpr_read_b32 v29, a173
v_accvgpr_read_b32 v30, a174
v_accvgpr_read_b32 v31, a175
v_accvgpr_read_b32 v32, a188
v_accvgpr_read_b32 v33, a189
v_accvgpr_read_b32 v34, a190
v_accvgpr_read_b32 v35, a191
v_pk_mul_f32 v[28:29], v[28:29], v[10:11]
v_pk_mul_f32 v[30:31], v[30:31], v[10:11]
v_pk_mul_f32 v[32:33], v[32:33], v[10:11]
v_pk_mul_f32 v[34:35], v[34:35], v[10:11]
v_cvt_pk_bf16_f32 v156, v28, v29
v_cvt_pk_bf16_f32 v157, v30, v31
v_cvt_pk_bf16_f32 v158, v32, v33
v_cvt_pk_bf16_f32 v159, v34, v35
s_xor_b32 s43, s100, 1024
s_add_u32 s43, s43, 12288
buffer_store_dwordx4 v[116:119], v3, s[24:27], s43 offen sc1
s_waitcnt vmcnt(34)
s_barrier
ds_read_b128 a[160:163], v12 offset:0
ds_read_b128 a[164:167], v12 offset:5120
ds_read_b128 a[168:171], v12 offset:1024
ds_read_b128 a[172:175], v12 offset:6144
ds_read_b128 a[176:179], v12 offset:2048
ds_read_b128 a[180:183], v12 offset:7168
s_mov_b32 s4, s72
s_mov_b32 s5, s73
s_mov_b32 s6, 2621440
s_mov_b32 s7, 0x20000
s_mov_b32 s8, s90
s_mov_b32 s9, s91
s_mov_b32 s10, 2621440
s_mov_b32 s11, 0x20000
s_and_b32 s40, s29, 7
s_lshl_b32 s16, s40, 3
s_add_u32 s16, s16, s46
s_lshl_b32 s17, s39, 3
s_add_u32 s17, s17, s48
s_add_u32 s18, s17, 8192
s_add_u32 s19, s48, 8192
s_mul_i32 s50, s29, 30720
s_add_u32 s50, s50, s68
s_waitcnt lgkmcnt(4)
v_mfma_f32_16x16x32_bf16 a[80:83], a[160:163], v[224:227], 0
s_xor_b32 s43, s100, 2048
ds_read_b128 a[184:187], v12 offset:3072
v_mfma_f32_16x16x32_bf16 a[80:83], a[164:167], v[232:235], a[80:83]
s_add_u32 s43, s43, 12288
v_mfma_f32_16x16x32_bf16 a[84:87], a[164:167], v[236:239], 0
s_waitcnt lgkmcnt(3)
ds_read_b128 a[188:191], v12 offset:8192
v_mfma_f32_16x16x32_bf16 a[84:87], a[160:163], v[228:231], a[84:87]
buffer_store_dwordx4 v[120:123], v3, s[24:27], s43 offen sc1
v_mfma_f32_16x16x32_bf16 a[88:91], a[168:171], v[224:227], 0
ds_read_b128 a[192:195], v12 offset:4096
v_mfma_f32_16x16x32_bf16 a[88:91], a[172:175], v[232:235], a[88:91]
v_mfma_f32_16x16x32_bf16 a[92:95], a[172:175], v[236:239], 0
s_waitcnt lgkmcnt(3)
ds_read_b128 a[196:199], v12 offset:9216
v_mfma_f32_16x16x32_bf16 a[92:95], a[168:171], v[228:231], a[92:95]
v_mfma_f32_16x16x32_bf16 a[96:99], a[176:179], v[224:227], 0
s_xor_b32 s43, s100, 3072
ds_read_b128 a[160:163], v12 offset:10240
v_mfma_f32_16x16x32_bf16 a[96:99], a[180:183], v[232:235], a[96:99]
s_add_u32 s43, s43, 12288
v_mfma_f32_16x16x32_bf16 a[100:103], a[180:183], v[236:239], 0
s_waitcnt lgkmcnt(3)
ds_read_b128 a[164:167], v12 offset:15360
v_mfma_f32_16x16x32_bf16 a[100:103], a[176:179], v[228:231], a[100:103]
buffer_store_dwordx4 v[124:127], v3, s[24:27], s43 offen sc1
v_mfma_f32_16x16x32_bf16 a[104:107], a[184:187], v[224:227], 0
ds_read_b128 a[168:171], v12 offset:11264
v_mfma_f32_16x16x32_bf16 a[104:107], a[188:191], v[232:235], a[104:107]
v_mfma_f32_16x16x32_bf16 a[108:111], a[188:191], v[236:239], 0
s_waitcnt lgkmcnt(3)
ds_read_b128 a[172:175], v12 offset:16384
v_mfma_f32_16x16x32_bf16 a[108:111], a[184:187], v[228:231], a[108:111]
v_mfma_f32_16x16x32_bf16 a[112:115], a[192:195], v[224:227], 0
s_xor_b32 s43, s100, 0
ds_read_b128 a[176:179], v12 offset:12288
v_mfma_f32_16x16x32_bf16 a[112:115], a[196:199], v[232:235], a[112:115]
s_add_u32 s43, s43, 16384
v_mfma_f32_16x16x32_bf16 a[116:119], a[196:199], v[236:239], 0
s_waitcnt lgkmcnt(3)
ds_read_b128 a[180:183], v12 offset:17408
v_mfma_f32_16x16x32_bf16 a[116:119], a[192:195], v[228:231], a[116:119]
buffer_store_dwordx4 v[128:131], v3, s[24:27], s43 offen sc1
v_mfma_f32_16x16x32_bf16 a[120:123], a[160:163], v[224:227], 0
ds_read_b128 a[184:187], v12 offset:13312
v_mfma_f32_16x16x32_bf16 a[120:123], a[164:167], v[232:235], a[120:123]
v_mfma_f32_16x16x32_bf16 a[124:127], a[164:167], v[236:239], 0
s_waitcnt lgkmcnt(3)
ds_read_b128 a[188:191], v12 offset:18432
v_mfma_f32_16x16x32_bf16 a[124:127], a[160:163], v[228:231], a[124:127]
s_xor_b32 s43, s100, 1024
v_mfma_f32_16x16x32_bf16 a[128:131], a[168:171], v[224:227], 0
s_add_u32 s43, s43, 16384
ds_read_b128 a[192:195], v12 offset:14336
v_mfma_f32_16x16x32_bf16 a[128:131], a[172:175], v[232:235], a[128:131]
s_waitcnt lgkmcnt(3)
buffer_store_dwordx4 v[132:135], v3, s[24:27], s43 offen sc1
v_mfma_f32_16x16x32_bf16 a[132:135], a[172:175], v[236:239], 0
s_waitcnt vmcnt(48)
ds_read_b128 a[196:199], v12 offset:19456
v_mfma_f32_16x16x32_bf16 a[132:135], a[168:171], v[228:231], a[132:135]
s_barrier
v_mfma_f32_16x16x32_bf16 a[136:139], a[176:179], v[224:227], 0
ds_read_b128 a[160:163], v12 offset:20480
v_mfma_f32_16x16x32_bf16 a[136:139], a[180:183], v[232:235], a[136:139]
v_mfma_f32_16x16x32_bf16 a[140:143], a[180:183], v[236:239], 0
s_waitcnt lgkmcnt(3)
ds_read_b128 a[164:167], v12 offset:25600
v_mfma_f32_16x16x32_bf16 a[140:143], a[176:179], v[228:231], a[140:143]
v_mfma_f32_16x16x32_bf16 a[144:147], a[184:187], v[224:227], 0
s_xor_b32 s43, s100, 2048
ds_read_b128 a[168:171], v12 offset:21504
v_mfma_f32_16x16x32_bf16 a[144:147], a[188:191], v[232:235], a[144:147]
s_add_u32 s43, s43, 16384
v_mfma_f32_16x16x32_bf16 a[148:151], a[188:191], v[236:239], 0
s_waitcnt lgkmcnt(3)
ds_read_b128 a[172:175], v12 offset:26624
v_mfma_f32_16x16x32_bf16 a[148:151], a[184:187], v[228:231], a[148:151]
buffer_store_dwordx4 v[136:139], v3, s[24:27], s43 offen sc1
v_mfma_f32_16x16x32_bf16 a[152:155], a[192:195], v[224:227], 0
ds_read_b128 a[176:179], v12 offset:22528
v_mfma_f32_16x16x32_bf16 a[152:155], a[196:199], v[232:235], a[152:155]
v_mfma_f32_16x16x32_bf16 a[156:159], a[196:199], v[236:239], 0
s_waitcnt lgkmcnt(3)
ds_read_b128 a[180:183], v12 offset:27648
v_mfma_f32_16x16x32_bf16 a[156:159], a[192:195], v[228:231], a[156:159]
s_waitcnt vmcnt(35)
v_mfma_f32_16x16x32_bf16 a[80:83], a[160:163], v[192:195], a[80:83]
s_xor_b32 s43, s100, 3072
ds_read_b128 a[184:187], v12 offset:23552
v_mfma_f32_16x16x32_bf16 a[80:83], a[164:167], v[200:203], a[80:83]
s_add_u32 s43, s43, 16384
v_mfma_f32_16x16x32_bf16 a[84:87], a[164:167], v[204:207], a[84:87]
s_waitcnt lgkmcnt(3)
ds_read_b128 a[188:191], v12 offset:28672
v_mfma_f32_16x16x32_bf16 a[84:87], a[160:163], v[196:199], a[84:87]
buffer_store_dwordx4 v[140:143], v3, s[24:27], s43 offen sc1
v_mfma_f32_16x16x32_bf16 a[88:91], a[168:171], v[192:195], a[88:91]
ds_read_b128 a[192:195], v12 offset:24576
v_mfma_f32_16x16x32_bf16 a[88:91], a[172:175], v[200:203], a[88:91]
v_mfma_f32_16x16x32_bf16 a[92:95], a[172:175], v[204:207], a[92:95]
s_waitcnt lgkmcnt(3)
ds_read_b128 a[196:199], v12 offset:29696
v_mfma_f32_16x16x32_bf16 a[92:95], a[168:171], v[196:199], a[92:95]
v_mfma_f32_16x16x32_bf16 a[96:99], a[176:179], v[192:195], a[96:99]
s_xor_b32 s43, s100, 0
ds_read_b128 a[160:163], v12 offset:30720
v_mfma_f32_16x16x32_bf16 a[96:99], a[180:183], v[200:203], a[96:99]
s_add_u32 s43, s43, 20480
v_mfma_f32_16x16x32_bf16 a[100:103], a[180:183], v[204:207], a[100:103]
s_waitcnt lgkmcnt(3)
ds_read_b128 a[164:167], v12 offset:35840
v_mfma_f32_16x16x32_bf16 a[100:103], a[176:179], v[196:199], a[100:103]
buffer_store_dwordx4 v[144:147], v3, s[24:27], s43 offen sc1
v_mfma_f32_16x16x32_bf16 a[104:107], a[184:187], v[192:195], a[104:107]
ds_read_b128 a[168:171], v12 offset:31744
v_mfma_f32_16x16x32_bf16 a[104:107], a[188:191], v[200:203], a[104:107]
v_mfma_f32_16x16x32_bf16 a[108:111], a[188:191], v[204:207], a[108:111]
s_waitcnt lgkmcnt(3)
ds_read_b128 a[172:175], v12 offset:36864
v_mfma_f32_16x16x32_bf16 a[108:111], a[184:187], v[196:199], a[108:111]
v_mfma_f32_16x16x32_bf16 a[112:115], a[192:195], v[192:195], a[112:115]
s_xor_b32 s43, s100, 1024
ds_read_b128 a[176:179], v12 offset:32768
v_mfma_f32_16x16x32_bf16 a[112:115], a[196:199], v[200:203], a[112:115]
s_add_u32 s43, s43, 20480
v_mfma_f32_16x16x32_bf16 a[116:119], a[196:199], v[204:207], a[116:119]
s_waitcnt lgkmcnt(3)
ds_read_b128 a[180:183], v12 offset:37888
v_mfma_f32_16x16x32_bf16 a[116:119], a[192:195], v[196:199], a[116:119]
buffer_store_dwordx4 v[148:151], v3, s[24:27], s43 offen sc1
v_mfma_f32_16x16x32_bf16 a[120:123], a[160:163], v[192:195], a[120:123]
ds_read_b128 a[184:187], v12 offset:33792
v_mfma_f32_16x16x32_bf16 a[120:123], a[164:167], v[200:203], a[120:123]
v_mfma_f32_16x16x32_bf16 a[124:127], a[164:167], v[204:207], a[124:127]
s_waitcnt lgkmcnt(3)
ds_read_b128 a[188:191], v12 offset:38912
v_mfma_f32_16x16x32_bf16 a[124:127], a[160:163], v[196:199], a[124:127]
s_xor_b32 s43, s100, 2048
v_mfma_f32_16x16x32_bf16 a[128:131], a[168:171], v[192:195], a[128:131]
s_add_u32 s43, s43, 20480
ds_read_b128 a[192:195], v12 offset:34816
v_mfma_f32_16x16x32_bf16 a[128:131], a[172:175], v[200:203], a[128:131]
s_waitcnt lgkmcnt(3)
buffer_store_dwordx4 v[152:155], v3, s[24:27], s43 offen sc1
v_mfma_f32_16x16x32_bf16 a[132:135], a[172:175], v[204:207], a[132:135]
s_waitcnt vmcnt(48)
ds_read_b128 a[196:199], v12 offset:39936
v_mfma_f32_16x16x32_bf16 a[132:135], a[168:171], v[196:199], a[132:135]
s_barrier
v_mfma_f32_16x16x32_bf16 a[136:139], a[176:179], v[192:195], a[136:139]
ds_read_b128 a[160:163], v12 offset:40960
v_mfma_f32_16x16x32_bf16 a[136:139], a[180:183], v[200:203], a[136:139]
v_mfma_f32_16x16x32_bf16 a[140:143], a[180:183], v[204:207], a[140:143]
s_waitcnt lgkmcnt(3)
ds_read_b128 a[164:167], v12 offset:46080
v_mfma_f32_16x16x32_bf16 a[140:143], a[176:179], v[196:199], a[140:143]
v_mfma_f32_16x16x32_bf16 a[144:147], a[184:187], v[192:195], a[144:147]
s_xor_b32 s43, s100, 3072
ds_read_b128 a[168:171], v12 offset:41984
v_mfma_f32_16x16x32_bf16 a[144:147], a[188:191], v[200:203], a[144:147]
s_add_u32 s43, s43, 20480
v_mfma_f32_16x16x32_bf16 a[148:151], a[188:191], v[204:207], a[148:151]
s_waitcnt lgkmcnt(3)
ds_read_b128 a[172:175], v12 offset:47104
v_mfma_f32_16x16x32_bf16 a[148:151], a[184:187], v[196:199], a[148:151]
buffer_store_dwordx4 v[156:159], v3, s[24:27], s43 offen sc1
v_mfma_f32_16x16x32_bf16 a[152:155], a[192:195], v[192:195], a[152:155]
ds_read_b128 a[176:179], v12 offset:43008
v_mfma_f32_16x16x32_bf16 a[152:155], a[196:199], v[200:203], a[152:155]
v_mfma_f32_16x16x32_bf16 a[156:159], a[196:199], v[204:207], a[156:159]
s_waitcnt lgkmcnt(3)
ds_read_b128 a[180:183], v12 offset:48128
v_mfma_f32_16x16x32_bf16 a[156:159], a[192:195], v[196:199], a[156:159]
s_waitcnt vmcnt(34)
v_mfma_f32_16x16x32_bf16 a[80:83], a[160:163], v[208:211], a[80:83]
ds_read_b128 a[184:187], v12 offset:44032
v_mfma_f32_16x16x32_bf16 a[80:83], a[164:167], v[216:219], a[80:83]
s_add_u32 m0, s52, 81920
v_mfma_f32_16x16x32_bf16 a[84:87], a[164:167], v[220:223], a[84:87]
s_waitcnt lgkmcnt(3)
ds_read_b128 a[188:191], v12 offset:49152
v_mfma_f32_16x16x32_bf16 a[84:87], a[160:163], v[212:215], a[84:87]
buffer_load_dwordx4 v3, s[12:15], s50 offen offset:0 sc1 lds
v_mfma_f32_16x16x32_bf16 a[88:91], a[168:171], v[208:211], a[88:91]
ds_read_b128 a[192:195], v12 offset:45056
v_mfma_f32_16x16x32_bf16 a[88:91], a[172:175], v[216:219], a[88:91]
v_mfma_f32_16x16x32_bf16 a[92:95], a[172:175], v[220:223], a[92:95]
s_waitcnt lgkmcnt(3)
ds_read_b128 a[196:199], v12 offset:50176
v_mfma_f32_16x16x32_bf16 a[92:95], a[168:171], v[212:215], a[92:95]
v_mfma_f32_16x16x32_bf16 a[96:99], a[176:179], v[208:211], a[96:99]
ds_read_b128 a[160:163], v12 offset:51200
v_mfma_f32_16x16x32_bf16 a[96:99], a[180:183], v[216:219], a[96:99]
v_mfma_f32_16x16x32_bf16 a[100:103], a[180:183], v[220:223], a[100:103]
s_waitcnt lgkmcnt(3)
ds_read_b128 a[164:167], v12 offset:56320
v_mfma_f32_16x16x32_bf16 a[100:103], a[176:179], v[212:215], a[100:103]
buffer_load_dwordx4 v3, s[12:15], s50 offen offset:1024 sc1 lds
v_mfma_f32_16x16x32_bf16 a[104:107], a[184:187], v[208:211], a[104:107]
ds_read_b128 a[168:171], v12 offset:52224
v_mfma_f32_16x16x32_bf16 a[104:107], a[188:191], v[216:219], a[104:107]
v_mfma_f32_16x16x32_bf16 a[108:111], a[188:191], v[220:223], a[108:111]
s_waitcnt lgkmcnt(3)
ds_read_b128 a[172:175], v12 offset:57344
v_mfma_f32_16x16x32_bf16 a[108:111], a[184:187], v[212:215], a[108:111]
v_mfma_f32_16x16x32_bf16 a[112:115], a[192:195], v[208:211], a[112:115]
ds_read_b128 a[176:179], v12 offset:53248
v_mfma_f32_16x16x32_bf16 a[112:115], a[196:199], v[216:219], a[112:115]
v_mfma_f32_16x16x32_bf16 a[116:119], a[196:199], v[220:223], a[116:119]
s_waitcnt lgkmcnt(3)
ds_read_b128 a[180:183], v12 offset:58368
v_mfma_f32_16x16x32_bf16 a[116:119], a[192:195], v[212:215], a[116:119]
buffer_load_dwordx4 v3, s[12:15], s50 offen offset:2048 sc1 lds
v_mfma_f32_16x16x32_bf16 a[120:123], a[160:163], v[208:211], a[120:123]
ds_read_b128 a[184:187], v12 offset:54272
v_mfma_f32_16x16x32_bf16 a[120:123], a[164:167], v[216:219], a[120:123]
v_mfma_f32_16x16x32_bf16 a[124:127], a[164:167], v[220:223], a[124:127]
s_waitcnt lgkmcnt(3)
ds_read_b128 a[188:191], v12 offset:59392
v_mfma_f32_16x16x32_bf16 a[124:127], a[160:163], v[212:215], a[124:127]
v_mfma_f32_16x16x32_bf16 a[128:131], a[168:171], v[208:211], a[128:131]
ds_read_b128 a[192:195], v12 offset:55296
v_mfma_f32_16x16x32_bf16 a[128:131], a[172:175], v[216:219], a[128:131]
s_waitcnt lgkmcnt(3)
buffer_load_dwordx4 v3, s[12:15], s50 offen offset:3072 sc1 lds
v_mfma_f32_16x16x32_bf16 a[132:135], a[172:175], v[220:223], a[132:135]
s_waitcnt vmcnt(48)
ds_read_b128 a[196:199], v12 offset:60416
v_mfma_f32_16x16x32_bf16 a[132:135], a[168:171], v[212:215], a[132:135]
s_barrier
v_mfma_f32_16x16x32_bf16 a[136:139], a[176:179], v[208:211], a[136:139]
ds_read_b128 a[160:163], v13 offset:0
v_mfma_f32_16x16x32_bf16 a[136:139], a[180:183], v[216:219], a[136:139]
v_mfma_f32_16x16x32_bf16 a[140:143], a[180:183], v[220:223], a[140:143]
s_waitcnt lgkmcnt(3)
ds_read_b128 a[164:167], v13 offset:5120
v_mfma_f32_16x16x32_bf16 a[140:143], a[176:179], v[212:215], a[140:143]
v_mfma_f32_16x16x32_bf16 a[144:147], a[184:187], v[208:211], a[144:147]
ds_read_b128 a[168:171], v13 offset:1024
v_mfma_f32_16x16x32_bf16 a[144:147], a[188:191], v[216:219], a[144:147]
s_add_u32 m0, s52, 82944
v_mfma_f32_16x16x32_bf16 a[148:151], a[188:191], v[220:223], a[148:151]
s_waitcnt lgkmcnt(3)
ds_read_b128 a[172:175], v13 offset:6144
v_mfma_f32_16x16x32_bf16 a[148:151], a[184:187], v[212:215], a[148:151]
buffer_load_dwordx4 v1, s[12:15], s50 offen offset:3072 sc1 lds
v_mfma_f32_16x16x32_bf16 a[152:155], a[192:195], v[208:211], a[152:155]
ds_read_b128 a[176:179], v13 offset:2048
v_mfma_f32_16x16x32_bf16 a[152:155], a[196:199], v[216:219], a[152:155]
s_add_u32 s50, s50, 10240
v_mfma_f32_16x16x32_bf16 a[156:159], a[196:199], v[220:223], a[156:159]
s_waitcnt lgkmcnt(3)
ds_read_b128 a[180:183], v13 offset:7168
v_mfma_f32_16x16x32_bf16 a[156:159], a[192:195], v[212:215], a[156:159]
s_waitcnt vmcnt(32)
v_mfma_f32_16x16x32_bf16 a[80:83], a[160:163], v[160:163], a[80:83]
ds_read_b128 a[184:187], v13 offset:3072
v_mfma_f32_16x16x32_bf16 a[80:83], a[164:167], v[168:171], a[80:83]
s_add_u32 m0, s52, 102400
v_mfma_f32_16x16x32_bf16 a[84:87], a[164:167], v[172:175], a[84:87]
s_waitcnt lgkmcnt(3)
ds_read_b128 a[188:191], v13 offset:8192
v_mfma_f32_16x16x32_bf16 a[84:87], a[160:163], v[164:167], a[84:87]
buffer_load_dwordx4 v3, s[12:15], s50 offen offset:0 sc1 lds
v_mfma_f32_16x16x32_bf16 a[88:91], a[168:171], v[160:163], a[88:91]
ds_read_b128 a[192:195], v13 offset:4096
v_mfma_f32_16x16x32_bf16 a[88:91], a[172:175], v[168:171], a[88:91]
v_mfma_f32_16x16x32_bf16 a[92:95], a[172:175], v[172:175], a[92:95]
s_waitcnt lgkmcnt(3)
ds_read_b128 a[196:199], v13 offset:9216
v_mfma_f32_16x16x32_bf16 a[92:95], a[168:171], v[164:167], a[92:95]
v_mfma_f32_16x16x32_bf16 a[96:99], a[176:179], v[160:163], a[96:99]
ds_read_b128 a[160:163], v13 offset:10240
v_mfma_f32_16x16x32_bf16 a[96:99], a[180:183], v[168:171], a[96:99]
v_mfma_f32_16x16x32_bf16 a[100:103], a[180:183], v[172:175], a[100:103]
s_waitcnt lgkmcnt(3)
ds_read_b128 a[164:167], v13 offset:15360
v_mfma_f32_16x16x32_bf16 a[100:103], a[176:179], v[164:167], a[100:103]
buffer_load_dwordx4 v3, s[12:15], s50 offen offset:1024 sc1 lds
v_mfma_f32_16x16x32_bf16 a[104:107], a[184:187], v[160:163], a[104:107]
ds_read_b128 a[168:171], v13 offset:11264
v_mfma_f32_16x16x32_bf16 a[104:107], a[188:191], v[168:171], a[104:107]
v_mfma_f32_16x16x32_bf16 a[108:111], a[188:191], v[172:175], a[108:111]
s_waitcnt lgkmcnt(3)
ds_read_b128 a[172:175], v13 offset:16384
v_mfma_f32_16x16x32_bf16 a[108:111], a[184:187], v[164:167], a[108:111]
v_mfma_f32_16x16x32_bf16 a[112:115], a[192:195], v[160:163], a[112:115]
ds_read_b128 a[176:179], v13 offset:12288
v_mfma_f32_16x16x32_bf16 a[112:115], a[196:199], v[168:171], a[112:115]
v_mfma_f32_16x16x32_bf16 a[116:119], a[196:199], v[172:175], a[116:119]
s_waitcnt lgkmcnt(3)
ds_read_b128 a[180:183], v13 offset:17408
v_mfma_f32_16x16x32_bf16 a[116:119], a[192:195], v[164:167], a[116:119]
buffer_load_dwordx4 v3, s[12:15], s50 offen offset:2048 sc1 lds
v_mfma_f32_16x16x32_bf16 a[120:123], a[160:163], v[160:163], a[120:123]
ds_read_b128 a[184:187], v13 offset:13312
v_mfma_f32_16x16x32_bf16 a[120:123], a[164:167], v[168:171], a[120:123]
v_mfma_f32_16x16x32_bf16 a[124:127], a[164:167], v[172:175], a[124:127]
s_waitcnt lgkmcnt(3)
ds_read_b128 a[188:191], v13 offset:18432
v_mfma_f32_16x16x32_bf16 a[124:127], a[160:163], v[164:167], a[124:127]
v_mfma_f32_16x16x32_bf16 a[128:131], a[168:171], v[160:163], a[128:131]
ds_read_b128 a[192:195], v13 offset:14336
v_mfma_f32_16x16x32_bf16 a[128:131], a[172:175], v[168:171], a[128:131]
s_waitcnt lgkmcnt(3)
buffer_load_dwordx4 v3, s[12:15], s50 offen offset:3072 sc1 lds
v_mfma_f32_16x16x32_bf16 a[132:135], a[172:175], v[172:175], a[132:135]
s_waitcnt vmcnt(48)
ds_read_b128 a[196:199], v13 offset:19456
v_mfma_f32_16x16x32_bf16 a[132:135], a[168:171], v[164:167], a[132:135]
s_barrier
v_mfma_f32_16x16x32_bf16 a[136:139], a[176:179], v[160:163], a[136:139]
ds_read_b128 a[160:163], v14 offset:0
v_mfma_f32_16x16x32_bf16 a[136:139], a[180:183], v[168:171], a[136:139]
v_mfma_f32_16x16x32_bf16 a[140:143], a[180:183], v[172:175], a[140:143]
s_waitcnt lgkmcnt(3)
ds_read_b128 a[164:167], v14 offset:5120
v_mfma_f32_16x16x32_bf16 a[140:143], a[176:179], v[164:167], a[140:143]
v_mfma_f32_16x16x32_bf16 a[144:147], a[184:187], v[160:163], a[144:147]
ds_read_b128 a[168:171], v14 offset:1024
v_mfma_f32_16x16x32_bf16 a[144:147], a[188:191], v[168:171], a[144:147]
s_add_u32 m0, s52, 103424
v_mfma_f32_16x16x32_bf16 a[148:151], a[188:191], v[172:175], a[148:151]
s_waitcnt lgkmcnt(3)
ds_read_b128 a[172:175], v14 offset:6144
v_mfma_f32_16x16x32_bf16 a[148:151], a[184:187], v[164:167], a[148:151]
buffer_load_dwordx4 v1, s[12:15], s50 offen offset:3072 sc1 lds
v_mfma_f32_16x16x32_bf16 a[152:155], a[192:195], v[160:163], a[152:155]
ds_read_b128 a[176:179], v14 offset:2048
v_mfma_f32_16x16x32_bf16 a[152:155], a[196:199], v[168:171], a[152:155]
s_add_u32 s50, s50, 10240
v_mfma_f32_16x16x32_bf16 a[156:159], a[196:199], v[172:175], a[156:159]
s_waitcnt lgkmcnt(3)
ds_read_b128 a[180:183], v14 offset:7168
v_mfma_f32_16x16x32_bf16 a[156:159], a[192:195], v[164:167], a[156:159]
s_waitcnt vmcnt(31)
v_mfma_f32_16x16x32_bf16 a[80:83], a[160:163], v[176:179], a[80:83]
ds_read_b128 a[184:187], v14 offset:3072
v_mfma_f32_16x16x32_bf16 a[80:83], a[164:167], v[184:187], a[80:83]
s_add_u32 m0, s52, 0
v_mfma_f32_16x16x32_bf16 a[84:87], a[164:167], v[188:191], a[84:87]
s_waitcnt lgkmcnt(3)
ds_read_b128 a[188:191], v14 offset:8192
v_mfma_f32_16x16x32_bf16 a[84:87], a[160:163], v[180:183], a[84:87]
buffer_load_dwordx4 v3, s[12:15], s50 offen offset:0 sc1 lds
v_mfma_f32_16x16x32_bf16 a[88:91], a[168:171], v[176:179], a[88:91]
ds_read_b128 a[192:195], v14 offset:4096
v_mfma_f32_16x16x32_bf16 a[88:91], a[172:175], v[184:187], a[88:91]
v_mfma_f32_16x16x32_bf16 a[92:95], a[172:175], v[188:191], a[92:95]
s_waitcnt lgkmcnt(3)
ds_read_b128 a[196:199], v14 offset:9216
v_mfma_f32_16x16x32_bf16 a[92:95], a[168:171], v[180:183], a[92:95]
v_mfma_f32_16x16x32_bf16 a[96:99], a[176:179], v[176:179], a[96:99]
ds_read_b128 a[160:163], v14 offset:10240
v_mfma_f32_16x16x32_bf16 a[96:99], a[180:183], v[184:187], a[96:99]
v_mfma_f32_16x16x32_bf16 a[100:103], a[180:183], v[188:191], a[100:103]
s_waitcnt lgkmcnt(3)
ds_read_b128 a[164:167], v14 offset:15360
v_mfma_f32_16x16x32_bf16 a[100:103], a[176:179], v[180:183], a[100:103]
buffer_load_dwordx4 v3, s[12:15], s50 offen offset:1024 sc1 lds
v_mfma_f32_16x16x32_bf16 a[104:107], a[184:187], v[176:179], a[104:107]
ds_read_b128 a[168:171], v14 offset:11264
v_mfma_f32_16x16x32_bf16 a[104:107], a[188:191], v[184:187], a[104:107]
v_mfma_f32_16x16x32_bf16 a[108:111], a[188:191], v[188:191], a[108:111]
s_waitcnt lgkmcnt(3)
ds_read_b128 a[172:175], v14 offset:16384
v_mfma_f32_16x16x32_bf16 a[108:111], a[184:187], v[180:183], a[108:111]
v_mfma_f32_16x16x32_bf16 a[112:115], a[192:195], v[176:179], a[112:115]
ds_read_b128 a[176:179], v14 offset:12288
v_mfma_f32_16x16x32_bf16 a[112:115], a[196:199], v[184:187], a[112:115]
buffer_load_dwordx4 v3, s[12:15], s50 offen offset:2048 sc1 lds
v_mfma_f32_16x16x32_bf16 a[116:119], a[196:199], v[188:191], a[116:119]
s_waitcnt lgkmcnt(3)
ds_read_b128 a[180:183], v14 offset:17408
v_mfma_f32_16x16x32_bf16 a[116:119], a[192:195], v[180:183], a[116:119]
v_mfma_f32_16x16x32_bf16 a[120:123], a[160:163], v[176:179], a[120:123]
ds_read_b128 a[184:187], v14 offset:13312
v_mfma_f32_16x16x32_bf16 a[120:123], a[164:167], v[184:187], a[120:123]
v_mfma_f32_16x16x32_bf16 a[124:127], a[164:167], v[188:191], a[124:127]
s_waitcnt lgkmcnt(3)
ds_read_b128 a[188:191], v14 offset:18432
v_mfma_f32_16x16x32_bf16 a[124:127], a[160:163], v[180:183], a[124:127]
buffer_load_dwordx4 v3, s[12:15], s50 offen offset:3072 sc1 lds
v_mfma_f32_16x16x32_bf16 a[128:131], a[168:171], v[176:179], a[128:131]
ds_read_b128 a[192:195], v14 offset:14336
v_mfma_f32_16x16x32_bf16 a[128:131], a[172:175], v[184:187], a[128:131]
s_waitcnt lgkmcnt(3)
v_mfma_f32_16x16x32_bf16 a[132:135], a[172:175], v[188:191], a[132:135]
s_waitcnt vmcnt(14)
ds_read_b128 a[196:199], v14 offset:19456
v_mfma_f32_16x16x32_bf16 a[132:135], a[168:171], v[180:183], a[132:135]
s_barrier
v_mfma_f32_16x16x32_bf16 a[136:139], a[176:179], v[176:179], a[136:139]
ds_read_b128 a[160:163], v14 offset:20480
v_mfma_f32_16x16x32_bf16 a[136:139], a[180:183], v[184:187], a[136:139]
buffer_store_dwordx2 v[26:27], v25, s[56:59], s16 offen sc1
v_mfma_f32_16x16x32_bf16 a[140:143], a[180:183], v[188:191], a[140:143]
s_waitcnt lgkmcnt(3)
ds_read_b128 a[164:167], v14 offset:25600
v_mfma_f32_16x16x32_bf16 a[140:143], a[176:179], v[180:183], a[140:143]
v_mfma_f32_16x16x32_bf16 a[144:147], a[184:187], v[176:179], a[144:147]
ds_read_b128 a[168:171], v14 offset:21504
v_mfma_f32_16x16x32_bf16 a[144:147], a[188:191], v[184:187], a[144:147]
s_add_u32 m0, s52, 1024
v_mfma_f32_16x16x32_bf16 a[148:151], a[188:191], v[188:191], a[148:151]
s_waitcnt lgkmcnt(3)
ds_read_b128 a[172:175], v14 offset:26624
v_mfma_f32_16x16x32_bf16 a[148:151], a[184:187], v[180:183], a[148:151]
buffer_load_dwordx4 v1, s[12:15], s50 offen offset:3072 sc1 lds
v_mfma_f32_16x16x32_bf16 a[152:155], a[192:195], v[176:179], a[152:155]
s_mul_i32 s50, s78, 30720
ds_read_b128 a[176:179], v14 offset:22528
v_mfma_f32_16x16x32_bf16 a[152:155], a[196:199], v[184:187], a[152:155]
s_add_u32 s50, s50, s68
v_mfma_f32_16x16x32_bf16 a[156:159], a[196:199], v[188:191], a[156:159]
s_waitcnt lgkmcnt(3)
ds_read_b128 a[180:183], v14 offset:27648
v_mfma_f32_16x16x32_bf16 a[156:159], a[192:195], v[180:183], a[156:159]
s_waitcnt vmcnt(31)
v_mfma_f32_16x16x32_bf16 a[80:83], a[160:163], v[44:47], a[80:83]
s_add_u32 m0, s52, 20480
ds_read_b128 a[184:187], v14 offset:23552
v_mfma_f32_16x16x32_bf16 a[80:83], a[164:167], v[52:55], a[80:83]
buffer_load_dwordx4 v3, s[12:15], s50 offen offset:0 sc1 lds
v_mfma_f32_16x16x32_bf16 a[84:87], a[164:167], v[56:59], a[84:87]
s_waitcnt lgkmcnt(3)
ds_read_b128 a[188:191], v14 offset:28672
v_mfma_f32_16x16x32_bf16 a[84:87], a[160:163], v[48:51], a[84:87]
v_mfma_f32_16x16x32_bf16 a[88:91], a[168:171], v[44:47], a[88:91]
ds_read_b128 a[192:195], v14 offset:24576
v_mfma_f32_16x16x32_bf16 a[88:91], a[172:175], v[52:55], a[88:91]
buffer_load_dwordx4 v3, s[12:15], s50 offen offset:1024 sc1 lds
v_mfma_f32_16x16x32_bf16 a[92:95], a[172:175], v[56:59], a[92:95]
s_waitcnt lgkmcnt(3)
ds_read_b128 a[196:199], v14 offset:29696
v_mfma_f32_16x16x32_bf16 a[92:95], a[168:171], v[48:51], a[92:95]
v_mfma_f32_16x16x32_bf16 a[96:99], a[176:179], v[44:47], a[96:99]
ds_read_b128 a[160:163], v14 offset:30720
v_mfma_f32_16x16x32_bf16 a[96:99], a[180:183], v[52:55], a[96:99]
buffer_load_dwordx4 v3, s[12:15], s50 offen offset:2048 sc1 lds
v_mfma_f32_16x16x32_bf16 a[100:103], a[180:183], v[56:59], a[100:103]
s_waitcnt lgkmcnt(3)
ds_read_b128 a[164:167], v14 offset:35840
v_mfma_f32_16x16x32_bf16 a[100:103], a[176:179], v[48:51], a[100:103]
v_mfma_f32_16x16x32_bf16 a[104:107], a[184:187], v[44:47], a[104:107]
ds_read_b128 a[168:171], v14 offset:31744
v_mfma_f32_16x16x32_bf16 a[104:107], a[188:191], v[52:55], a[104:107]
buffer_load_dwordx4 v3, s[12:15], s50 offen offset:3072 sc1 lds
v_mfma_f32_16x16x32_bf16 a[108:111], a[188:191], v[56:59], a[108:111]
s_waitcnt lgkmcnt(3)
ds_read_b128 a[172:175], v14 offset:36864
v_mfma_f32_16x16x32_bf16 a[108:111], a[184:187], v[48:51], a[108:111]
v_mfma_f32_16x16x32_bf16 a[112:115], a[192:195], v[44:47], a[112:115]
s_add_u32 m0, s52, 21504
ds_read_b128 a[176:179], v14 offset:32768
v_mfma_f32_16x16x32_bf16 a[112:115], a[196:199], v[52:55], a[112:115]
buffer_load_dwordx4 v1, s[12:15], s50 offen offset:3072 sc1 lds
v_mfma_f32_16x16x32_bf16 a[116:119], a[196:199], v[56:59], a[116:119]
s_waitcnt lgkmcnt(3)
s_add_u32 s50, s50, 10240
s_add_u32 m0, s52, 40960
ds_read_b128 a[180:183], v14 offset:37888
v_mfma_f32_16x16x32_bf16 a[116:119], a[192:195], v[48:51], a[116:119]
buffer_load_dwordx4 v3, s[12:15], s50 offen offset:0 sc1 lds
v_mfma_f32_16x16x32_bf16 a[120:123], a[160:163], v[44:47], a[120:123]
ds_read_b128 a[184:187], v14 offset:33792
v_mfma_f32_16x16x32_bf16 a[120:123], a[164:167], v[52:55], a[120:123]
v_mfma_f32_16x16x32_bf16 a[124:127], a[164:167], v[56:59], a[124:127]
s_waitcnt lgkmcnt(3)
ds_read_b128 a[188:191], v14 offset:38912
v_mfma_f32_16x16x32_bf16 a[124:127], a[160:163], v[48:51], a[124:127]
buffer_load_dwordx4 v3, s[12:15], s50 offen offset:1024 sc1 lds
v_mfma_f32_16x16x32_bf16 a[128:131], a[168:171], v[44:47], a[128:131]
ds_read_b128 a[192:195], v14 offset:34816
v_mfma_f32_16x16x32_bf16 a[128:131], a[172:175], v[52:55], a[128:131]
s_waitcnt lgkmcnt(3)
v_mfma_f32_16x16x32_bf16 a[132:135], a[172:175], v[56:59], a[132:135]
s_waitcnt vmcnt(18)
ds_read_b128 a[196:199], v14 offset:39936
v_mfma_f32_16x16x32_bf16 a[132:135], a[168:171], v[48:51], a[132:135]
s_barrier
v_mfma_f32_16x16x32_bf16 a[136:139], a[176:179], v[44:47], a[136:139]
ds_read_b128 a[160:163], v13 offset:20480
v_mfma_f32_16x16x32_bf16 a[136:139], a[180:183], v[52:55], a[136:139]
buffer_load_dwordx4 v3, s[12:15], s50 offen offset:2048 sc1 lds
v_mfma_f32_16x16x32_bf16 a[140:143], a[180:183], v[56:59], a[140:143]
s_waitcnt lgkmcnt(3)
ds_read_b128 a[164:167], v13 offset:25600
v_mfma_f32_16x16x32_bf16 a[140:143], a[176:179], v[48:51], a[140:143]
v_mfma_f32_16x16x32_bf16 a[144:147], a[184:187], v[44:47], a[144:147]
ds_read_b128 a[168:171], v13 offset:21504
v_mfma_f32_16x16x32_bf16 a[144:147], a[188:191], v[52:55], a[144:147]
buffer_load_dwordx4 v3, s[12:15], s50 offen offset:3072 sc1 lds
v_mfma_f32_16x16x32_bf16 a[148:151], a[188:191], v[56:59], a[148:151]
s_waitcnt lgkmcnt(3)
ds_read_b128 a[172:175], v13 offset:26624
v_mfma_f32_16x16x32_bf16 a[148:151], a[184:187], v[48:51], a[148:151]
v_mfma_f32_16x16x32_bf16 a[152:155], a[192:195], v[44:47], a[152:155]
s_add_u32 m0, s52, 41984
ds_read_b128 a[176:179], v13 offset:22528
v_mfma_f32_16x16x32_bf16 a[152:155], a[196:199], v[52:55], a[152:155]
buffer_load_dwordx4 v1, s[12:15], s50 offen offset:3072 sc1 lds
v_mfma_f32_16x16x32_bf16 a[156:159], a[196:199], v[56:59], a[156:159]
s_waitcnt lgkmcnt(3)
s_add_u32 s50, s50, 10240
ds_read_b128 a[180:183], v13 offset:27648
v_mfma_f32_16x16x32_bf16 a[156:159], a[192:195], v[48:51], a[156:159]
s_waitcnt vmcnt(48)
v_mfma_f32_16x16x32_bf16 a[0:3], a[160:163], v[64:67], 0
ds_read_b128 a[184:187], v13 offset:23552
v_nop
v_mfma_f32_16x16x32_bf16 a[0:3], a[164:167], v[80:83], a[0:3]
buffer_load_dwordx2 v[248:249], v61, s[56:59], s46 offen sc1
v_nop
v_mfma_f32_16x16x32_bf16 a[4:7], a[164:167], v[84:87], 0
s_waitcnt lgkmcnt(3)
ds_read_b128 a[188:191], v13 offset:28672
v_nop
v_mfma_f32_16x16x32_bf16 a[4:7], a[160:163], v[68:71], a[4:7]
v_nop
v_accvgpr_read_b32 v28, a84
v_mfma_f32_16x16x32_bf16 a[8:11], a[168:171], v[64:67], 0
s_add_u32 m0, s52, 61440
ds_read_b128 a[192:195], v13 offset:24576
v_accvgpr_read_b32 v29, a85
v_mfma_f32_16x16x32_bf16 a[8:11], a[172:175], v[80:83], a[8:11]
buffer_load_dwordx4 v3, s[12:15], s50 offen offset:0 sc1 lds
v_accvgpr_read_b32 v30, a86
v_mfma_f32_16x16x32_bf16 a[12:15], a[172:175], v[84:87], 0
s_waitcnt lgkmcnt(3)
ds_read_b128 a[196:199], v13 offset:29696
v_accvgpr_read_b32 v31, a87
v_mfma_f32_16x16x32_bf16 a[12:15], a[168:171], v[68:71], a[12:15]
v_cvt_pk_bf16_f32 v72, v28, v29
v_cvt_pk_bf16_f32 v73, v30, v31
v_mfma_f32_16x16x32_bf16 a[16:19], a[176:179], v[64:67], 0
ds_read_b128 a[160:163], v13 offset:30720
v_accvgpr_read_b32 v32, a92
v_mfma_f32_16x16x32_bf16 a[16:19], a[180:183], v[80:83], a[16:19]
buffer_load_dwordx4 v3, s[12:15], s50 offen offset:1024 sc1 lds
v_accvgpr_read_b32 v33, a93
v_mfma_f32_16x16x32_bf16 a[20:23], a[180:183], v[84:87], 0
s_waitcnt lgkmcnt(3)
ds_read_b128 a[164:167], v13 offset:35840
v_accvgpr_read_b32 v34, a94
v_mfma_f32_16x16x32_bf16 a[20:23], a[176:179], v[68:71], a[20:23]
buffer_load_dwordx4 v3, s[12:15], s50 offen offset:2048 sc1 lds
v_accvgpr_read_b32 v35, a95
v_mfma_f32_16x16x32_bf16 a[24:27], a[184:187], v[64:67], 0
ds_read_b128 a[168:171], v13 offset:31744
v_cvt_pk_bf16_f32 v74, v32, v33
v_mfma_f32_16x16x32_bf16 a[24:27], a[188:191], v[80:83], a[24:27]
v_cvt_pk_bf16_f32 v75, v34, v35
v_accvgpr_read_b32 v28, a100
v_mfma_f32_16x16x32_bf16 a[28:31], a[188:191], v[84:87], 0
s_waitcnt lgkmcnt(3)
ds_read_b128 a[172:175], v13 offset:36864
v_accvgpr_read_b32 v29, a101
v_mfma_f32_16x16x32_bf16 a[28:31], a[184:187], v[68:71], a[28:31]
buffer_load_dwordx4 v3, s[12:15], s50 offen offset:3072 sc1 lds
v_accvgpr_read_b32 v30, a102
v_mfma_f32_16x16x32_bf16 a[32:35], a[192:195], v[64:67], 0
ds_read_b128 a[176:179], v13 offset:32768
v_accvgpr_read_b32 v31, a103
v_mfma_f32_16x16x32_bf16 a[32:35], a[196:199], v[80:83], a[32:35]
s_add_u32 m0, s52, 62464
v_cvt_pk_bf16_f32 v76, v28, v29
v_cvt_pk_bf16_f32 v77, v30, v31
v_mfma_f32_16x16x32_bf16 a[36:39], a[196:199], v[84:87], 0
s_waitcnt lgkmcnt(3)
ds_read_b128 a[180:183], v13 offset:37888
v_accvgpr_read_b32 v32, a108
v_mfma_f32_16x16x32_bf16 a[36:39], a[192:195], v[68:71], a[36:39]
buffer_load_dwordx4 v1, s[12:15], s50 offen offset:3072 sc1 lds
v_accvgpr_read_b32 v33, a109
v_mfma_f32_16x16x32_bf16 a[40:43], a[160:163], v[64:67], 0
s_mul_i32 s50, s79, 30720
s_add_u32 s50, s50, s68
s_add_u32 m0, s52, 122880
ds_read_b128 a[184:187], v13 offset:33792
v_accvgpr_read_b32 v34, a110
v_mfma_f32_16x16x32_bf16 a[40:43], a[164:167], v[80:83], a[40:43]
buffer_load_dwordx4 v3, s[12:15], s50 offen offset:0 sc1 lds
v_accvgpr_read_b32 v35, a111
v_mfma_f32_16x16x32_bf16 a[44:47], a[164:167], v[84:87], 0
s_waitcnt lgkmcnt(3)
ds_read_b128 a[188:191], v13 offset:38912
v_cvt_pk_bf16_f32 v78, v32, v33
v_mfma_f32_16x16x32_bf16 a[44:47], a[160:163], v[68:71], a[44:47]
v_cvt_pk_bf16_f32 v79, v34, v35
v_accvgpr_read_b32 v28, a116
v_mfma_f32_16x16x32_bf16 a[48:51], a[168:171], v[64:67], 0
ds_read_b128 a[192:195], v13 offset:34816
v_accvgpr_read_b32 v29, a117
v_mfma_f32_16x16x32_bf16 a[48:51], a[172:175], v[80:83], a[48:51]
s_waitcnt lgkmcnt(3)
buffer_load_dwordx4 v3, s[12:15], s50 offen offset:1024 sc1 lds
v_accvgpr_read_b32 v30, a118
v_mfma_f32_16x16x32_bf16 a[52:55], a[172:175], v[84:87], 0
s_waitcnt vmcnt(24)
ds_read_b128 a[196:199], v13 offset:39936
v_accvgpr_read_b32 v31, a119
v_mfma_f32_16x16x32_bf16 a[52:55], a[168:171], v[68:71], a[52:55]
s_barrier
v_cvt_pk_bf16_f32 v120, v28, v29
v_cvt_pk_bf16_f32 v121, v30, v31
v_mfma_f32_16x16x32_bf16 a[56:59], a[176:179], v[64:67], 0
ds_read_b128 a[160:163], v13 offset:40960
v_accvgpr_read_b32 v28, a120
v_mfma_f32_16x16x32_bf16 a[56:59], a[180:183], v[80:83], a[56:59]
buffer_load_dwordx4 v3, s[12:15], s50 offen offset:2048 sc1 lds
v_accvgpr_read_b32 v29, a121
v_mfma_f32_16x16x32_bf16 a[60:63], a[180:183], v[84:87], 0
s_waitcnt lgkmcnt(3)
ds_read_b128 a[164:167], v13 offset:46080
v_accvgpr_read_b32 v30, a122
v_mfma_f32_16x16x32_bf16 a[60:63], a[176:179], v[68:71], a[60:63]
v_accvgpr_read_b32 v31, a123
v_cvt_pk_bf16_f32 v88, v28, v29
v_mfma_f32_16x16x32_bf16 a[64:67], a[184:187], v[64:67], 0
ds_read_b128 a[168:171], v13 offset:41984
v_cvt_pk_bf16_f32 v89, v30, v31
v_mfma_f32_16x16x32_bf16 a[64:67], a[188:191], v[80:83], a[64:67]
buffer_load_dwordx4 v3, s[12:15], s50 offen offset:3072 sc1 lds
v_accvgpr_read_b32 v32, a128
v_mfma_f32_16x16x32_bf16 a[68:71], a[188:191], v[84:87], 0
s_waitcnt lgkmcnt(3)
ds_read_b128 a[172:175], v13 offset:47104
v_accvgpr_read_b32 v33, a129
v_mfma_f32_16x16x32_bf16 a[68:71], a[184:187], v[68:71], a[68:71]
v_accvgpr_read_b32 v34, a130
v_accvgpr_read_b32 v35, a131
v_mfma_f32_16x16x32_bf16 a[72:75], a[192:195], v[64:67], 0
s_add_u32 m0, s52, 123904
ds_read_b128 a[176:179], v13 offset:43008
v_cvt_pk_bf16_f32 v90, v32, v33
v_mfma_f32_16x16x32_bf16 a[72:75], a[196:199], v[80:83], a[72:75]
buffer_load_dwordx4 v1, s[12:15], s50 offen offset:3072 sc1 lds
v_cvt_pk_bf16_f32 v91, v34, v35
v_mfma_f32_16x16x32_bf16 a[76:79], a[196:199], v[84:87], 0
s_waitcnt lgkmcnt(3)
s_add_u32 s50, s50, 10240
ds_read_b128 a[180:183], v13 offset:48128
v_accvgpr_read_b32 v28, a136
v_mfma_f32_16x16x32_bf16 a[76:79], a[192:195], v[68:71], a[76:79]
s_waitcnt vmcnt(48)
v_accvgpr_read_b32 v29, a137
v_accvgpr_read_b32 v30, a138
s_waitcnt vmcnt(10)
s_mov_b32 s42, 0
s_branch C_po_chk
C_po:
buffer_load_dwordx2 v[248:249], v61, s[56:59], s46 offen sc1
s_waitcnt vmcnt(0)
C_po_chk:
v_cmp_ne_u64 vcc, v[26:27], v[248:249]
s_nop 4
s_cbranch_vccz C_po_ok
s_sleep 2
s_add_u32 s42, s42, 1
s_cmp_lt_u32 s42, 0x40000
s_cbranch_scc1 C_po
C_po_ok:
s_mul_i32 s51, s78, 24576
v_mfma_f32_16x16x32_bf16 a[0:3], a[160:163], v[96:99], a[0:3]
ds_read_b128 a[184:187], v13 offset:44032
v_accvgpr_read_b32 v31, a139
v_mfma_f32_16x16x32_bf16 a[0:3], a[164:167], v[112:115], a[0:3]
buffer_load_dwordx4 v[192:195], v15, s[24:27], s51 offen sc1
v_cvt_pk_bf16_f32 v92, v28, v29
v_mfma_f32_16x16x32_bf16 a[4:7], a[164:167], v[116:119], a[4:7]
s_waitcnt lgkmcnt(3)
ds_read_b128 a[188:191], v13 offset:49152
v_cvt_pk_bf16_f32 v93, v30, v31
v_mfma_f32_16x16x32_bf16 a[4:7], a[160:163], v[100:103], a[4:7]
buffer_load_dwordx4 v[196:199], v16, s[24:27], s51 offen sc1
v_accvgpr_read_b32 v32, a144
v_mfma_f32_16x16x32_bf16 a[8:11], a[168:171], v[96:99], a[8:11]
ds_read_b128 a[192:195], v13 offset:45056
v_accvgpr_read_b32 v33, a145
v_mfma_f32_16x16x32_bf16 a[8:11], a[172:175], v[112:115], a[8:11]
v_accvgpr_read_b32 v34, a146
v_accvgpr_read_b32 v35, a147
v_mfma_f32_16x16x32_bf16 a[12:15], a[172:175], v[116:119], a[12:15]
s_waitcnt lgkmcnt(3)
ds_read_b128 a[196:199], v13 offset:50176
v_cvt_pk_bf16_f32 v94, v32, v33
v_mfma_f32_16x16x32_bf16 a[12:15], a[168:171], v[100:103], a[12:15]
buffer_load_dwordx4 v[200:203], v17, s[24:27], s51 offen sc1
v_cvt_pk_bf16_f32 v95, v34, v35
v_mfma_f32_16x16x32_bf16 a[16:19], a[176:179], v[96:99], a[16:19]
ds_read_b128 a[160:163], v13 offset:51200
v_accvgpr_read_b32 v28, a152
v_mfma_f32_16x16x32_bf16 a[16:19], a[180:183], v[112:115], a[16:19]
buffer_load_dwordx4 v[204:207], v18, s[24:27], s51 offen sc1
v_accvgpr_read_b32 v29, a153
v_mfma_f32_16x16x32_bf16 a[20:23], a[180:183], v[116:119], a[20:23]
s_waitcnt lgkmcnt(3)
s_add_u32 s51, s51, 8192
ds_read_b128 a[164:167], v13 offset:56320
v_accvgpr_read_b32 v30, a154
v_mfma_f32_16x16x32_bf16 a[20:23], a[176:179], v[100:103], a[20:23]
buffer_load_dwordx4 v[208:211], v15, s[24:27], s51 offen sc1
v_accvgpr_read_b32 v31, a155
v_mfma_f32_16x16x32_bf16 a[24:27], a[184:187], v[96:99], a[24:27]
ds_read_b128 a[168:171], v13 offset:52224
v_cvt_pk_bf16_f32 v136, v28, v29
v_mfma_f32_16x16x32_bf16 a[24:27], a[188:191], v[112:115], a[24:27]
buffer_load_dwordx4 v[212:215], v16, s[24:27], s51 offen sc1
v_cvt_pk_bf16_f32 v137, v30, v31
v_mfma_f32_16x16x32_bf16 a[28:31], a[188:191], v[116:119], a[28:31]
s_waitcnt lgkmcnt(3)
ds_read_b128 a[172:175], v13 offset:57344
v_accvgpr_read_b32 v28, a124
v_mfma_f32_16x16x32_bf16 a[28:31], a[184:187], v[100:103], a[28:31]
buffer_load_dwordx4 v[216:219], v17, s[24:27], s51 offen sc1
v_accvgpr_read_b32 v29, a125
v_mfma_f32_16x16x32_bf16 a[32:35], a[192:195], v[96:99], a[32:35]
ds_read_b128 a[176:179], v13 offset:53248
v_accvgpr_read_b32 v30, a126
v_mfma_f32_16x16x32_bf16 a[32:35], a[196:199], v[112:115], a[32:35]
v_accvgpr_read_b32 v31, a127
v_cvt_pk_bf16_f32 v104, v28, v29
v_mfma_f32_16x16x32_bf16 a[36:39], a[196:199], v[116:119], a[36:39]
s_waitcnt lgkmcnt(3)
ds_read_b128 a[180:183], v13 offset:58368
v_cvt_pk_bf16_f32 v105, v30, v31
v_mfma_f32_16x16x32_bf16 a[36:39], a[192:195], v[100:103], a[36:39]
buffer_load_dwordx4 v[220:223], v18, s[24:27], s51 offen sc1
v_accvgpr_read_b32 v32, a132
v_mfma_f32_16x16x32_bf16 a[40:43], a[160:163], v[96:99], a[40:43]
s_add_u32 s51, s51, 8192
ds_read_b128 a[184:187], v13 offset:54272
v_accvgpr_read_b32 v33, a133
v_mfma_f32_16x16x32_bf16 a[40:43], a[164:167], v[112:115], a[40:43]
buffer_load_dwordx4 v[160:163], v15, s[24:27], s51 offen sc1
v_accvgpr_read_b32 v34, a134
v_mfma_f32_16x16x32_bf16 a[44:47], a[164:167], v[116:119], a[44:47]
s_waitcnt lgkmcnt(3)
ds_read_b128 a[188:191], v13 offset:59392
v_accvgpr_read_b32 v35, a135
v_mfma_f32_16x16x32_bf16 a[44:47], a[160:163], v[100:103], a[44:47]
buffer_load_dwordx4 v[164:167], v16, s[24:27], s51 offen sc1
v_cvt_pk_bf16_f32 v106, v32, v33
v_mfma_f32_16x16x32_bf16 a[48:51], a[168:171], v[96:99], a[48:51]
ds_read_b128 a[192:195], v13 offset:55296
v_cvt_pk_bf16_f32 v107, v34, v35
v_mfma_f32_16x16x32_bf16 a[48:51], a[172:175], v[112:115], a[48:51]
s_waitcnt lgkmcnt(3)
buffer_load_dwordx4 v[168:171], v17, s[24:27], s51 offen sc1
v_accvgpr_read_b32 v28, a140
v_mfma_f32_16x16x32_bf16 a[52:55], a[172:175], v[116:119], a[52:55]
s_waitcnt vmcnt(32)
ds_read_b128 a[196:199], v13 offset:60416
v_accvgpr_read_b32 v29, a141
v_mfma_f32_16x16x32_bf16 a[52:55], a[168:171], v[100:103], a[52:55]
s_barrier
v_accvgpr_read_b32 v30, a142
v_accvgpr_read_b32 v31, a143
v_mfma_f32_16x16x32_bf16 a[56:59], a[176:179], v[96:99], a[56:59]
ds_read_b128 a[160:163], v12 offset:0
v_cvt_pk_bf16_f32 v108, v28, v29
v_mfma_f32_16x16x32_bf16 a[56:59], a[180:183], v[112:115], a[56:59]
buffer_load_dwordx4 v[172:175], v18, s[24:27], s51 offen sc1
v_cvt_pk_bf16_f32 v109, v30, v31
v_mfma_f32_16x16x32_bf16 a[60:63], a[180:183], v[116:119], a[60:63]
s_waitcnt lgkmcnt(3)
ds_read_b128 a[164:167], v12 offset:5120
v_accvgpr_read_b32 v32, a148
v_mfma_f32_16x16x32_bf16 a[60:63], a[176:179], v[100:103], a[60:63]
v_accvgpr_read_b32 v33, a149
v_accvgpr_read_b32 v34, a150
v_mfma_f32_16x16x32_bf16 a[64:67], a[184:187], v[96:99], a[64:67]
s_mul_i32 s51, s79, 24576
s_xor_b32 s40, s39, 1
s_mul_i32 s40, s40, 61440
s_add_u32 s40, s40, s54
s_add_u32 s40, s40, 10240
ds_read_b128 a[168:171], v12 offset:1024
v_accvgpr_read_b32 v35, a151
v_mfma_f32_16x16x32_bf16 a[64:67], a[188:191], v[112:115], a[64:67]
buffer_store_dwordx4 v[72:75], v3, s[20:23], s40 offen sc1
v_cvt_pk_bf16_f32 v110, v32, v33
v_mfma_f32_16x16x32_bf16 a[68:71], a[188:191], v[116:119], a[68:71]
s_waitcnt lgkmcnt(3)
ds_read_b128 a[172:175], v12 offset:6144
v_cvt_pk_bf16_f32 v111, v34, v35
v_mfma_f32_16x16x32_bf16 a[68:71], a[184:187], v[100:103], a[68:71]
buffer_store_dwordx4 v[76:79], v3, s[20:23], s40 offen offset:1024 sc1
v_accvgpr_read_b32 v28, a156
v_mfma_f32_16x16x32_bf16 a[72:75], a[192:195], v[96:99], a[72:75]
ds_read_b128 a[176:179], v12 offset:2048
v_accvgpr_read_b32 v29, a157
v_mfma_f32_16x16x32_bf16 a[72:75], a[196:199], v[112:115], a[72:75]
buffer_store_dwordx2 v[120:121], v22, s[20:23], s40 offen offset:2048 sc1
v_accvgpr_read_b32 v30, a158
v_mfma_f32_16x16x32_bf16 a[76:79], a[196:199], v[116:119], a[76:79]
s_waitcnt lgkmcnt(3)
ds_read_b128 a[180:183], v12 offset:7168
v_accvgpr_read_b32 v31, a159
v_mfma_f32_16x16x32_bf16 a[76:79], a[192:195], v[100:103], a[76:79]
s_waitcnt vmcnt(48)
v_cvt_pk_bf16_f32 v152, v28, v29
v_cvt_pk_bf16_f32 v153, v30, v31
v_mfma_f32_16x16x32_bf16 a[0:3], a[160:163], v[128:131], a[0:3]
ds_read_b128 a[184:187], v12 offset:3072
v_mfma_f32_16x16x32_bf16 a[0:3], a[164:167], v[144:147], a[0:3]
buffer_load_dwordx4 v[176:179], v15, s[24:27], s51 offen sc1
v_mfma_f32_16x16x32_bf16 a[4:7], a[164:167], v[148:151], a[4:7]
s_waitcnt lgkmcnt(3)
ds_read_b128 a[188:191], v12 offset:8192
v_mfma_f32_16x16x32_bf16 a[4:7], a[160:163], v[132:135], a[4:7]
buffer_load_dwordx4 v[180:183], v16, s[24:27], s51 offen sc1
v_mfma_f32_16x16x32_bf16 a[8:11], a[168:171], v[128:131], a[8:11]
ds_read_b128 a[192:195], v12 offset:4096
v_mfma_f32_16x16x32_bf16 a[8:11], a[172:175], v[144:147], a[8:11]
v_mfma_f32_16x16x32_bf16 a[12:15], a[172:175], v[148:151], a[12:15]
s_waitcnt lgkmcnt(3)
ds_read_b128 a[196:199], v12 offset:9216
v_mfma_f32_16x16x32_bf16 a[12:15], a[168:171], v[132:135], a[12:15]
buffer_load_dwordx4 v[184:187], v17, s[24:27], s51 offen sc1
v_mfma_f32_16x16x32_bf16 a[16:19], a[176:179], v[128:131], a[16:19]
ds_read_b128 a[160:163], v12 offset:10240
v_mfma_f32_16x16x32_bf16 a[16:19], a[180:183], v[144:147], a[16:19]
buffer_load_dwordx4 v[188:191], v18, s[24:27], s51 offen sc1
v_mfma_f32_16x16x32_bf16 a[20:23], a[180:183], v[148:151], a[20:23]
s_waitcnt lgkmcnt(3)
s_add_u32 s51, s51, 8192
ds_read_b128 a[164:167], v12 offset:15360
v_mfma_f32_16x16x32_bf16 a[20:23], a[176:179], v[132:135], a[20:23]
buffer_load_dwordx4 v[44:47], v15, s[24:27], s51 offen sc1
v_mfma_f32_16x16x32_bf16 a[24:27], a[184:187], v[128:131], a[24:27]
ds_read_b128 a[168:171], v12 offset:11264
v_mfma_f32_16x16x32_bf16 a[24:27], a[188:191], v[144:147], a[24:27]
v_mfma_f32_16x16x32_bf16 a[28:31], a[188:191], v[148:151], a[28:31]
s_waitcnt lgkmcnt(3)
ds_read_b128 a[172:175], v12 offset:16384
v_mfma_f32_16x16x32_bf16 a[28:31], a[184:187], v[132:135], a[28:31]
buffer_load_dwordx4 v[48:51], v16, s[24:27], s51 offen sc1
v_mfma_f32_16x16x32_bf16 a[32:35], a[192:195], v[128:131], a[32:35]
ds_read_b128 a[176:179], v12 offset:12288
v_mfma_f32_16x16x32_bf16 a[32:35], a[196:199], v[144:147], a[32:35]
buffer_load_dwordx4 v[52:55], v17, s[24:27], s51 offen sc1
v_mfma_f32_16x16x32_bf16 a[36:39], a[196:199], v[148:151], a[36:39]
s_waitcnt lgkmcnt(3)
ds_read_b128 a[180:183], v12 offset:17408
v_mfma_f32_16x16x32_bf16 a[36:39], a[192:195], v[132:135], a[36:39]
buffer_load_dwordx4 v[56:59], v18, s[24:27], s51 offen sc1
v_mfma_f32_16x16x32_bf16 a[40:43], a[160:163], v[128:131], a[40:43]
s_add_u32 s51, s51, 8192
s_xor_b32 s40, s39, 2
s_mul_i32 s40, s40, 61440
s_add_u32 s40, s40, s54
s_add_u32 s40, s40, 30720
ds_read_b128 a[184:187], v12 offset:13312
v_mfma_f32_16x16x32_bf16 a[40:43], a[164:167], v[144:147], a[40:43]
buffer_store_dwordx4 v[88:91], v3, s[20:23], s40 offen sc1
v_mfma_f32_16x16x32_bf16 a[44:47], a[164:167], v[148:151], a[44:47]
s_waitcnt lgkmcnt(3)
ds_read_b128 a[188:191], v12 offset:18432
v_mfma_f32_16x16x32_bf16 a[44:47], a[160:163], v[132:135], a[44:47]
v_mfma_f32_16x16x32_bf16 a[48:51], a[168:171], v[128:131], a[48:51]
ds_read_b128 a[192:195], v12 offset:14336
v_mfma_f32_16x16x32_bf16 a[48:51], a[172:175], v[144:147], a[48:51]
s_waitcnt lgkmcnt(3)
buffer_store_dwordx4 v[92:95], v3, s[20:23], s40 offen offset:1024 sc1
v_mfma_f32_16x16x32_bf16 a[52:55], a[172:175], v[148:151], a[52:55]
s_waitcnt vmcnt(41)
ds_read_b128 a[196:199], v12 offset:19456
v_mfma_f32_16x16x32_bf16 a[52:55], a[168:171], v[132:135], a[52:55]
s_barrier
v_mfma_f32_16x16x32_bf16 a[56:59], a[176:179], v[128:131], a[56:59]
ds_read_b128 a[160:163], v12 offset:20480
v_mfma_f32_16x16x32_bf16 a[56:59], a[180:183], v[144:147], a[56:59]
buffer_store_dwordx2 v[136:137], v22, s[20:23], s40 offen offset:2048 sc1
v_mfma_f32_16x16x32_bf16 a[60:63], a[180:183], v[148:151], a[60:63]
s_waitcnt lgkmcnt(3)
s_xor_b32 s40, s39, 3
s_mul_i32 s40, s40, 61440
s_add_u32 s40, s40, s54
s_add_u32 s40, s40, 51200
ds_read_b128 a[164:167], v12 offset:25600
v_mfma_f32_16x16x32_bf16 a[60:63], a[176:179], v[132:135], a[60:63]
buffer_store_dwordx4 v[104:107], v3, s[20:23], s40 offen sc1
v_mfma_f32_16x16x32_bf16 a[64:67], a[184:187], v[128:131], a[64:67]
ds_read_b128 a[168:171], v12 offset:21504
v_mfma_f32_16x16x32_bf16 a[64:67], a[188:191], v[144:147], a[64:67]
v_mfma_f32_16x16x32_bf16 a[68:71], a[188:191], v[148:151], a[68:71]
s_waitcnt lgkmcnt(3)
ds_read_b128 a[172:175], v12 offset:26624
v_mfma_f32_16x16x32_bf16 a[68:71], a[184:187], v[132:135], a[68:71]
buffer_store_dwordx4 v[108:111], v3, s[20:23], s40 offen offset:1024 sc1
v_mfma_f32_16x16x32_bf16 a[72:75], a[192:195], v[128:131], a[72:75]
ds_read_b128 a[176:179], v12 offset:22528
v_mfma_f32_16x16x32_bf16 a[72:75], a[196:199], v[144:147], a[72:75]
buffer_store_dwordx2 v[152:153], v22, s[20:23], s40 offen offset:2048 sc1
v_mfma_f32_16x16x32_bf16 a[76:79], a[196:199], v[148:151], a[76:79]
s_waitcnt lgkmcnt(3)
ds_read_b128 a[180:183], v12 offset:27648
v_mfma_f32_16x16x32_bf16 a[76:79], a[192:195], v[132:135], a[76:79]
s_waitcnt vmcnt(25)
v_mfma_f32_16x16x32_bf16 a[0:3], a[160:163], v[192:195], a[0:3]
ds_read_b128 a[184:187], v12 offset:23552
v_accvgpr_read_b32 v128, a80
v_mfma_f32_16x16x32_bf16 a[0:3], a[164:167], v[200:203], a[0:3]
s_add_u32 m0, s52, 143360
v_accvgpr_read_b32 v129, a81
v_accvgpr_read_b32 v130, a82
v_mfma_f32_16x16x32_bf16 a[4:7], a[164:167], v[204:207], a[4:7]
s_waitcnt lgkmcnt(3)
ds_read_b128 a[188:191], v12 offset:28672
v_accvgpr_read_b32 v131, a83
v_mfma_f32_16x16x32_bf16 a[4:7], a[160:163], v[196:199], a[4:7]
buffer_load_dwordx4 v3, s[12:15], s50 offen offset:0 sc1 lds
v_accvgpr_read_b32 v132, a88
v_mfma_f32_16x16x32_bf16 a[8:11], a[168:171], v[192:195], a[8:11]
ds_read_b128 a[192:195], v12 offset:24576
v_accvgpr_read_b32 v133, a89
v_mfma_f32_16x16x32_bf16 a[8:11], a[172:175], v[200:203], a[8:11]
v_accvgpr_read_b32 v134, a90
v_accvgpr_read_b32 v135, a91
v_mfma_f32_16x16x32_bf16 a[12:15], a[172:175], v[204:207], a[12:15]
s_waitcnt lgkmcnt(3)
ds_read_b128 a[196:199], v12 offset:29696
v_accvgpr_read_b32 v136, a96
v_mfma_f32_16x16x32_bf16 a[12:15], a[168:171], v[196:199], a[12:15]
buffer_load_dwordx4 v3, s[12:15], s50 offen offset:1024 sc1 lds
v_accvgpr_read_b32 v137, a97
v_mfma_f32_16x16x32_bf16 a[16:19], a[176:179], v[192:195], a[16:19]
ds_read_b128 a[160:163], v12 offset:30720
v_accvgpr_read_b32 v138, a98
v_mfma_f32_16x16x32_bf16 a[16:19], a[180:183], v[200:203], a[16:19]
v_accvgpr_read_b32 v139, a99
v_accvgpr_read_b32 v140, a104
v_mfma_f32_16x16x32_bf16 a[20:23], a[180:183], v[204:207], a[20:23]
s_waitcnt lgkmcnt(3)
ds_read_b128 a[164:167], v12 offset:35840
v_accvgpr_read_b32 v141, a105
v_mfma_f32_16x16x32_bf16 a[20:23], a[176:179], v[196:199], a[20:23]
buffer_load_dwordx4 v3, s[12:15], s50 offen offset:2048 sc1 lds
v_accvgpr_read_b32 v142, a106
v_mfma_f32_16x16x32_bf16 a[24:27], a[184:187], v[192:195], a[24:27]
ds_read_b128 a[168:171], v12 offset:31744
v_accvgpr_read_b32 v143, a107
v_mfma_f32_16x16x32_bf16 a[24:27], a[188:191], v[200:203], a[24:27]
v_accvgpr_read_b32 v144, a112
v_accvgpr_read_b32 v145, a113
v_mfma_f32_16x16x32_bf16 a[28:31], a[188:191], v[204:207], a[28:31]
s_waitcnt lgkmcnt(3)
ds_read_b128 a[172:175], v12 offset:36864
v_accvgpr_read_b32 v146, a114
v_mfma_f32_16x16x32_bf16 a[28:31], a[184:187], v[196:199], a[28:31]
buffer_load_dwordx4 v3, s[12:15], s50 offen offset:3072 sc1 lds
v_accvgpr_read_b32 v147, a115
v_mfma_f32_16x16x32_bf16 a[32:35], a[192:195], v[192:195], a[32:35]
ds_read_b128 a[176:179], v12 offset:32768
v_and_b32 v4, 15, v2
v_mfma_f32_16x16x32_bf16 a[32:35], a[196:199], v[200:203], a[32:35]
s_add_u32 m0, s52, 144384
v_lshrrev_b32 v5, 4, v2
v_mul_u32_u24 v4, 1280, v4
v_mfma_f32_16x16x32_bf16 a[36:39], a[196:199], v[204:207], a[36:39]
s_waitcnt lgkmcnt(3)
ds_read_b128 a[180:183], v12 offset:37888
v_lshl_add_u32 v4, v5, 3, v4
v_mfma_f32_16x16x32_bf16 a[36:39], a[192:195], v[196:199], a[36:39]
buffer_load_dwordx4 v1, s[12:15], s50 offen offset:3072 sc1 lds
v_mfma_f32_16x16x32_bf16 a[40:43], a[160:163], v[192:195], a[40:43]
ds_read_b128 a[184:187], v12 offset:33792
v_mfma_f32_16x16x32_bf16 a[40:43], a[164:167], v[200:203], a[40:43]
s_add_u32 s50, s50, 10240
v_mfma_f32_16x16x32_bf16 a[44:47], a[164:167], v[204:207], a[44:47]
s_waitcnt lgkmcnt(3)
ds_read_b128 a[188:191], v12 offset:38912
v_mfma_f32_16x16x32_bf16 a[44:47], a[160:163], v[196:199], a[44:47]
buffer_load_dwordx4 a[224:227], v15, s[24:27], s51 offen sc1
v_mfma_f32_16x16x32_bf16 a[48:51], a[168:171], v[192:195], a[48:51]
ds_read_b128 a[192:195], v12 offset:34816
v_mfma_f32_16x16x32_bf16 a[48:51], a[172:175], v[200:203], a[48:51]
s_waitcnt lgkmcnt(3)
v_mfma_f32_16x16x32_bf16 a[52:55], a[172:175], v[204:207], a[52:55]
s_waitcnt vmcnt(46)
ds_read_b128 a[196:199], v12 offset:39936
v_mfma_f32_16x16x32_bf16 a[52:55], a[168:171], v[196:199], a[52:55]
s_barrier
v_mfma_f32_16x16x32_bf16 a[56:59], a[176:179], v[192:195], a[56:59]
ds_read_b128 a[160:163], v12 offset:40960
v_mfma_f32_16x16x32_bf16 a[56:59], a[180:183], v[200:203], a[56:59]
buffer_load_dwordx4 a[228:231], v16, s[24:27], s51 offen sc1
v_mfma_f32_16x16x32_bf16 a[60:63], a[180:183], v[204:207], a[60:63]
s_waitcnt lgkmcnt(3)
ds_read_b128 a[164:167], v12 offset:46080
v_mfma_f32_16x16x32_bf16 a[60:63], a[176:179], v[196:199], a[60:63]
v_mfma_f32_16x16x32_bf16 a[64:67], a[184:187], v[192:195], a[64:67]
ds_read_b128 a[168:171], v12 offset:41984
v_mfma_f32_16x16x32_bf16 a[64:67], a[188:191], v[200:203], a[64:67]
buffer_load_dwordx4 a[232:235], v17, s[24:27], s51 offen sc1
v_mfma_f32_16x16x32_bf16 a[68:71], a[188:191], v[204:207], a[68:71]
s_waitcnt lgkmcnt(3)
ds_read_b128 a[172:175], v12 offset:47104
v_mfma_f32_16x16x32_bf16 a[68:71], a[184:187], v[196:199], a[68:71]
v_mfma_f32_16x16x32_bf16 a[72:75], a[192:195], v[192:195], a[72:75]
ds_read_b128 a[176:179], v12 offset:43008
v_mfma_f32_16x16x32_bf16 a[72:75], a[196:199], v[200:203], a[72:75]
buffer_load_dwordx4 a[236:239], v18, s[24:27], s51 offen sc1
v_mfma_f32_16x16x32_bf16 a[76:79], a[196:199], v[204:207], a[76:79]
s_waitcnt lgkmcnt(3)
s_mul_i32 s51, s80, 24576
ds_read_b128 a[180:183], v12 offset:48128
v_mfma_f32_16x16x32_bf16 a[76:79], a[192:195], v[196:199], a[76:79]
s_waitcnt vmcnt(30)
v_mfma_f32_16x16x32_bf16 a[0:3], a[160:163], v[208:211], a[0:3]
ds_read_b128 a[184:187], v12 offset:44032
v_mfma_f32_16x16x32_bf16 a[0:3], a[164:167], v[216:219], a[0:3]
s_add_u32 m0, s52, 81920
v_mfma_f32_16x16x32_bf16 a[4:7], a[164:167], v[220:223], a[4:7]
s_waitcnt lgkmcnt(3)
ds_read_b128 a[188:191], v12 offset:49152
v_mfma_f32_16x16x32_bf16 a[4:7], a[160:163], v[212:215], a[4:7]
buffer_load_dwordx4 v3, s[12:15], s50 offen offset:0 sc1 lds
v_mfma_f32_16x16x32_bf16 a[8:11], a[168:171], v[208:211], a[8:11]
ds_read_b128 a[192:195], v12 offset:45056
v_mfma_f32_16x16x32_bf16 a[8:11], a[172:175], v[216:219], a[8:11]
v_mfma_f32_16x16x32_bf16 a[12:15], a[172:175], v[220:223], a[12:15]
s_waitcnt lgkmcnt(3)
ds_read_b128 a[196:199], v12 offset:50176
v_mfma_f32_16x16x32_bf16 a[12:15], a[168:171], v[212:215], a[12:15]
buffer_load_dwordx4 v3, s[12:15], s50 offen offset:1024 sc1 lds
v_mfma_f32_16x16x32_bf16 a[16:19], a[176:179], v[208:211], a[16:19]
ds_read_b128 a[160:163], v12 offset:51200
v_mfma_f32_16x16x32_bf16 a[16:19], a[180:183], v[216:219], a[16:19]
v_mfma_f32_16x16x32_bf16 a[20:23], a[180:183], v[220:223], a[20:23]
s_waitcnt lgkmcnt(3)
ds_read_b128 a[164:167], v12 offset:56320
v_mfma_f32_16x16x32_bf16 a[20:23], a[176:179], v[212:215], a[20:23]
buffer_load_dwordx4 v3, s[12:15], s50 offen offset:2048 sc1 lds
v_mfma_f32_16x16x32_bf16 a[24:27], a[184:187], v[208:211], a[24:27]
ds_read_b128 a[168:171], v12 offset:52224
v_mfma_f32_16x16x32_bf16 a[24:27], a[188:191], v[216:219], a[24:27]
v_mfma_f32_16x16x32_bf16 a[28:31], a[188:191], v[220:223], a[28:31]
s_waitcnt lgkmcnt(3)
ds_read_b128 a[172:175], v12 offset:57344
v_mfma_f32_16x16x32_bf16 a[28:31], a[184:187], v[212:215], a[28:31]
buffer_load_dwordx4 v3, s[12:15], s50 offen offset:3072 sc1 lds
v_mfma_f32_16x16x32_bf16 a[32:35], a[192:195], v[208:211], a[32:35]
ds_read_b128 a[176:179], v12 offset:53248
v_mfma_f32_16x16x32_bf16 a[32:35], a[196:199], v[216:219], a[32:35]
s_add_u32 m0, s52, 82944
v_mfma_f32_16x16x32_bf16 a[36:39], a[196:199], v[220:223], a[36:39]
s_waitcnt lgkmcnt(3)
ds_read_b128 a[180:183], v12 offset:58368
v_mfma_f32_16x16x32_bf16 a[36:39], a[192:195], v[212:215], a[36:39]
buffer_load_dwordx4 v1, s[12:15], s50 offen offset:3072 sc1 lds
v_mfma_f32_16x16x32_bf16 a[40:43], a[160:163], v[208:211], a[40:43]
s_mul_i32 s50, s80, 30720
ds_read_b128 a[184:187], v12 offset:54272
v_mfma_f32_16x16x32_bf16 a[40:43], a[164:167], v[216:219], a[40:43]
s_add_u32 s50, s50, s68
v_mfma_f32_16x16x32_bf16 a[44:47], a[164:167], v[220:223], a[44:47]
s_waitcnt lgkmcnt(3)
ds_read_b128 a[188:191], v12 offset:59392
v_mfma_f32_16x16x32_bf16 a[44:47], a[160:163], v[212:215], a[44:47]
buffer_load_dwordx4 a[240:243], v15, s[24:27], s51 offen sc1
v_mfma_f32_16x16x32_bf16 a[48:51], a[168:171], v[208:211], a[48:51]
ds_read_b128 a[192:195], v12 offset:55296
v_mfma_f32_16x16x32_bf16 a[48:51], a[172:175], v[216:219], a[48:51]
s_waitcnt lgkmcnt(3)
v_mfma_f32_16x16x32_bf16 a[52:55], a[172:175], v[220:223], a[52:55]
s_waitcnt vmcnt(48)
ds_read_b128 a[196:199], v12 offset:60416
v_mfma_f32_16x16x32_bf16 a[52:55], a[168:171], v[212:215], a[52:55]
s_barrier
v_mfma_f32_16x16x32_bf16 a[56:59], a[176:179], v[208:211], a[56:59]
ds_read_b128 a[160:163], v13 offset:0
v_mfma_f32_16x16x32_bf16 a[56:59], a[180:183], v[216:219], a[56:59]
buffer_load_dwordx4 a[244:247], v16, s[24:27], s51 offen sc1
v_mfma_f32_16x16x32_bf16 a[60:63], a[180:183], v[220:223], a[60:63]
s_waitcnt lgkmcnt(3)
ds_read_b128 a[164:167], v13 offset:5120
v_mfma_f32_16x16x32_bf16 a[60:63], a[176:179], v[212:215], a[60:63]
v_mfma_f32_16x16x32_bf16 a[64:67], a[184:187], v[208:211], a[64:67]
ds_read_b128 a[168:171], v13 offset:1024
v_mfma_f32_16x16x32_bf16 a[64:67], a[188:191], v[216:219], a[64:67]
buffer_load_dwordx4 a[248:251], v17, s[24:27], s51 offen sc1
v_mfma_f32_16x16x32_bf16 a[68:71], a[188:191], v[220:223], a[68:71]
s_waitcnt lgkmcnt(3)
ds_read_b128 a[172:175], v13 offset:6144
v_mfma_f32_16x16x32_bf16 a[68:71], a[184:187], v[212:215], a[68:71]
v_mfma_f32_16x16x32_bf16 a[72:75], a[192:195], v[208:211], a[72:75]
ds_read_b128 a[176:179], v13 offset:2048
v_mfma_f32_16x16x32_bf16 a[72:75], a[196:199], v[216:219], a[72:75]
buffer_load_dwordx4 a[252:255], v18, s[24:27], s51 offen sc1
v_mfma_f32_16x16x32_bf16 a[76:79], a[196:199], v[220:223], a[76:79]
s_waitcnt lgkmcnt(3)
s_add_u32 s51, s51, 8192
ds_read_b128 a[180:183], v13 offset:7168
v_mfma_f32_16x16x32_bf16 a[76:79], a[192:195], v[212:215], a[76:79]
s_waitcnt vmcnt(35)
v_mfma_f32_16x16x32_bf16 a[0:3], a[160:163], v[160:163], a[0:3]
ds_read_b128 a[184:187], v13 offset:3072
v_mfma_f32_16x16x32_bf16 a[0:3], a[164:167], v[168:171], a[0:3]
s_add_u32 m0, s52, 102400
v_mfma_f32_16x16x32_bf16 a[4:7], a[164:167], v[172:175], a[4:7]
s_waitcnt lgkmcnt(3)
ds_read_b128 a[188:191], v13 offset:8192
v_mfma_f32_16x16x32_bf16 a[4:7], a[160:163], v[164:167], a[4:7]
buffer_load_dwordx4 v3, s[12:15], s50 offen offset:0 sc1 lds
v_mfma_f32_16x16x32_bf16 a[8:11], a[168:171], v[160:163], a[8:11]
ds_read_b128 a[192:195], v13 offset:4096
v_mfma_f32_16x16x32_bf16 a[8:11], a[172:175], v[168:171], a[8:11]
v_mfma_f32_16x16x32_bf16 a[12:15], a[172:175], v[172:175], a[12:15]
s_waitcnt lgkmcnt(3)
ds_read_b128 a[196:199], v13 offset:9216
v_mfma_f32_16x16x32_bf16 a[12:15], a[168:171], v[164:167], a[12:15]
buffer_load_dwordx4 v3, s[12:15], s50 offen offset:1024 sc1 lds
v_mfma_f32_16x16x32_bf16 a[16:19], a[176:179], v[160:163], a[16:19]
ds_read_b128 a[160:163], v13 offset:10240
v_mfma_f32_16x16x32_bf16 a[16:19], a[180:183], v[168:171], a[16:19]
v_mfma_f32_16x16x32_bf16 a[20:23], a[180:183], v[172:175], a[20:23]
s_waitcnt lgkmcnt(3)
ds_read_b128 a[164:167], v13 offset:15360
v_mfma_f32_16x16x32_bf16 a[20:23], a[176:179], v[164:167], a[20:23]
buffer_load_dwordx4 v3, s[12:15], s50 offen offset:2048 sc1 lds
v_mfma_f32_16x16x32_bf16 a[24:27], a[184:187], v[160:163], a[24:27]
ds_read_b128 a[168:171], v13 offset:11264
v_mfma_f32_16x16x32_bf16 a[24:27], a[188:191], v[168:171], a[24:27]
v_mfma_f32_16x16x32_bf16 a[28:31], a[188:191], v[172:175], a[28:31]
s_waitcnt lgkmcnt(3)
ds_read_b128 a[172:175], v13 offset:16384
v_mfma_f32_16x16x32_bf16 a[28:31], a[184:187], v[164:167], a[28:31]
buffer_load_dwordx4 v3, s[12:15], s50 offen offset:3072 sc1 lds
v_mfma_f32_16x16x32_bf16 a[32:35], a[192:195], v[160:163], a[32:35]
ds_read_b128 a[176:179], v13 offset:12288
v_mfma_f32_16x16x32_bf16 a[32:35], a[196:199], v[168:171], a[32:35]
s_add_u32 m0, s52, 103424
v_mfma_f32_16x16x32_bf16 a[36:39], a[196:199], v[172:175], a[36:39]
s_waitcnt lgkmcnt(3)
ds_read_b128 a[180:183], v13 offset:17408
v_mfma_f32_16x16x32_bf16 a[36:39], a[192:195], v[164:167], a[36:39]
buffer_load_dwordx4 v1, s[12:15], s50 offen offset:3072 sc1 lds
v_mfma_f32_16x16x32_bf16 a[40:43], a[160:163], v[160:163], a[40:43]
ds_read_b128 a[184:187], v13 offset:13312
v_mfma_f32_16x16x32_bf16 a[40:43], a[164:167], v[168:171], a[40:43]
s_add_u32 s50, s50, 10240
v_mfma_f32_16x16x32_bf16 a[44:47], a[164:167], v[172:175], a[44:47]
s_waitcnt lgkmcnt(3)
ds_read_b128 a[188:191], v13 offset:18432
v_mfma_f32_16x16x32_bf16 a[44:47], a[160:163], v[164:167], a[44:47]
buffer_load_dwordx4 v[224:227], v15, s[24:27], s51 offen sc1
v_mfma_f32_16x16x32_bf16 a[48:51], a[168:171], v[160:163], a[48:51]
ds_read_b128 a[192:195], v13 offset:14336
v_mfma_f32_16x16x32_bf16 a[48:51], a[172:175], v[168:171], a[48:51]
s_waitcnt lgkmcnt(3)
v_mfma_f32_16x16x32_bf16 a[52:55], a[172:175], v[172:175], a[52:55]
s_waitcnt vmcnt(48)
ds_read_b128 a[196:199], v13 offset:19456
v_mfma_f32_16x16x32_bf16 a[52:55], a[168:171], v[164:167], a[52:55]
s_barrier
v_mfma_f32_16x16x32_bf16 a[56:59], a[176:179], v[160:163], a[56:59]
ds_read_b128 a[160:163], v14 offset:0
v_mfma_f32_16x16x32_bf16 a[56:59], a[180:183], v[168:171], a[56:59]
buffer_load_dwordx4 v[228:231], v16, s[24:27], s51 offen sc1
v_mfma_f32_16x16x32_bf16 a[60:63], a[180:183], v[172:175], a[60:63]
s_waitcnt lgkmcnt(3)
ds_read_b128 a[164:167], v14 offset:5120
v_mfma_f32_16x16x32_bf16 a[60:63], a[176:179], v[164:167], a[60:63]
v_mfma_f32_16x16x32_bf16 a[64:67], a[184:187], v[160:163], a[64:67]
ds_read_b128 a[168:171], v14 offset:1024
v_mfma_f32_16x16x32_bf16 a[64:67], a[188:191], v[168:171], a[64:67]
buffer_load_dwordx4 v[232:235], v17, s[24:27], s51 offen sc1
v_mfma_f32_16x16x32_bf16 a[68:71], a[188:191], v[172:175], a[68:71]
s_waitcnt lgkmcnt(3)
ds_read_b128 a[172:175], v14 offset:6144
v_mfma_f32_16x16x32_bf16 a[68:71], a[184:187], v[164:167], a[68:71]
v_mfma_f32_16x16x32_bf16 a[72:75], a[192:195], v[160:163], a[72:75]
ds_read_b128 a[176:179], v14 offset:2048
v_mfma_f32_16x16x32_bf16 a[72:75], a[196:199], v[168:171], a[72:75]
buffer_load_dwordx4 v[236:239], v18, s[24:27], s51 offen sc1
v_mfma_f32_16x16x32_bf16 a[76:79], a[196:199], v[172:175], a[76:79]
s_waitcnt lgkmcnt(3)
s_add_u32 s51, s51, 8192
ds_read_b128 a[180:183], v14 offset:7168
v_mfma_f32_16x16x32_bf16 a[76:79], a[192:195], v[164:167], a[76:79]
s_waitcnt vmcnt(37)
v_mfma_f32_16x16x32_bf16 a[0:3], a[160:163], v[176:179], a[0:3]
ds_read_b128 a[184:187], v14 offset:3072
v_mfma_f32_16x16x32_bf16 a[0:3], a[164:167], v[184:187], a[0:3]
s_add_u32 m0, s52, 0
v_mfma_f32_16x16x32_bf16 a[4:7], a[164:167], v[188:191], a[4:7]
s_waitcnt lgkmcnt(3)
ds_read_b128 a[188:191], v14 offset:8192
v_mfma_f32_16x16x32_bf16 a[4:7], a[160:163], v[180:183], a[4:7]
buffer_load_dwordx4 v3, s[12:15], s50 offen offset:0 sc1 lds
v_mfma_f32_16x16x32_bf16 a[8:11], a[168:171], v[176:179], a[8:11]
ds_read_b128 a[192:195], v14 offset:4096
v_mfma_f32_16x16x32_bf16 a[8:11], a[172:175], v[184:187], a[8:11]
v_mfma_f32_16x16x32_bf16 a[12:15], a[172:175], v[188:191], a[12:15]
s_waitcnt lgkmcnt(3)
ds_read_b128 a[196:199], v14 offset:9216
v_mfma_f32_16x16x32_bf16 a[12:15], a[168:171], v[180:183], a[12:15]
buffer_load_dwordx4 v3, s[12:15], s50 offen offset:1024 sc1 lds
v_mfma_f32_16x16x32_bf16 a[16:19], a[176:179], v[176:179], a[16:19]
ds_read_b128 a[160:163], v14 offset:10240
v_mfma_f32_16x16x32_bf16 a[16:19], a[180:183], v[184:187], a[16:19]
v_mfma_f32_16x16x32_bf16 a[20:23], a[180:183], v[188:191], a[20:23]
s_waitcnt lgkmcnt(3)
ds_read_b128 a[164:167], v14 offset:15360
v_mfma_f32_16x16x32_bf16 a[20:23], a[176:179], v[180:183], a[20:23]
buffer_load_dwordx4 v3, s[12:15], s50 offen offset:2048 sc1 lds
v_mfma_f32_16x16x32_bf16 a[24:27], a[184:187], v[176:179], a[24:27]
ds_read_b128 a[168:171], v14 offset:11264
v_mfma_f32_16x16x32_bf16 a[24:27], a[188:191], v[184:187], a[24:27]
v_mfma_f32_16x16x32_bf16 a[28:31], a[188:191], v[188:191], a[28:31]
s_waitcnt lgkmcnt(3)
ds_read_b128 a[172:175], v14 offset:16384
v_mfma_f32_16x16x32_bf16 a[28:31], a[184:187], v[180:183], a[28:31]
buffer_load_dwordx4 v3, s[12:15], s50 offen offset:3072 sc1 lds
v_mfma_f32_16x16x32_bf16 a[32:35], a[192:195], v[176:179], a[32:35]
ds_read_b128 a[176:179], v14 offset:12288
v_mfma_f32_16x16x32_bf16 a[32:35], a[196:199], v[184:187], a[32:35]
s_add_u32 m0, s52, 1024
v_mfma_f32_16x16x32_bf16 a[36:39], a[196:199], v[188:191], a[36:39]
s_waitcnt lgkmcnt(3)
ds_read_b128 a[180:183], v14 offset:17408
v_mfma_f32_16x16x32_bf16 a[36:39], a[192:195], v[180:183], a[36:39]
buffer_load_dwordx4 v1, s[12:15], s50 offen offset:3072 sc1 lds
v_mfma_f32_16x16x32_bf16 a[40:43], a[160:163], v[176:179], a[40:43]
ds_read_b128 a[184:187], v14 offset:13312
v_mfma_f32_16x16x32_bf16 a[40:43], a[164:167], v[184:187], a[40:43]
s_add_u32 s50, s50, 10240
v_mfma_f32_16x16x32_bf16 a[44:47], a[164:167], v[188:191], a[44:47]
s_waitcnt lgkmcnt(3)
ds_read_b128 a[188:191], v14 offset:18432
v_mfma_f32_16x16x32_bf16 a[44:47], a[160:163], v[180:183], a[44:47]
buffer_load_dwordx4 v[192:195], v15, s[24:27], s51 offen sc1
v_mfma_f32_16x16x32_bf16 a[48:51], a[168:171], v[176:179], a[48:51]
ds_read_b128 a[192:195], v14 offset:14336
v_mfma_f32_16x16x32_bf16 a[48:51], a[172:175], v[184:187], a[48:51]
s_waitcnt lgkmcnt(3)
v_mfma_f32_16x16x32_bf16 a[52:55], a[172:175], v[188:191], a[52:55]
s_waitcnt vmcnt(28)
ds_read_b128 a[196:199], v14 offset:19456
v_mfma_f32_16x16x32_bf16 a[52:55], a[168:171], v[180:183], a[52:55]
s_barrier
v_mfma_f32_16x16x32_bf16 a[56:59], a[176:179], v[176:179], a[56:59]
ds_read_b128 a[160:163], v14 offset:20480
v_mfma_f32_16x16x32_bf16 a[56:59], a[180:183], v[184:187], a[56:59]
buffer_load_dwordx4 v[196:199], v16, s[24:27], s51 offen sc1
v_mfma_f32_16x16x32_bf16 a[60:63], a[180:183], v[188:191], a[60:63]
s_waitcnt lgkmcnt(3)
ds_read_b128 a[164:167], v14 offset:25600
v_mfma_f32_16x16x32_bf16 a[60:63], a[176:179], v[180:183], a[60:63]
v_mfma_f32_16x16x32_bf16 a[64:67], a[184:187], v[176:179], a[64:67]
ds_read_b128 a[168:171], v14 offset:21504
v_mfma_f32_16x16x32_bf16 a[64:67], a[188:191], v[184:187], a[64:67]
buffer_load_dwordx4 v[200:203], v17, s[24:27], s51 offen sc1
v_mfma_f32_16x16x32_bf16 a[68:71], a[188:191], v[188:191], a[68:71]
s_waitcnt lgkmcnt(3)
ds_read_b128 a[172:175], v14 offset:26624
v_mfma_f32_16x16x32_bf16 a[68:71], a[184:187], v[180:183], a[68:71]
v_mfma_f32_16x16x32_bf16 a[72:75], a[192:195], v[176:179], a[72:75]
ds_read_b128 a[176:179], v14 offset:22528
v_mfma_f32_16x16x32_bf16 a[72:75], a[196:199], v[184:187], a[72:75]
buffer_load_dwordx4 v[204:207], v18, s[24:27], s51 offen sc1
v_mfma_f32_16x16x32_bf16 a[76:79], a[196:199], v[188:191], a[76:79]
s_waitcnt lgkmcnt(3)
s_mul_i32 s51, s81, 24576
ds_read_b128 a[180:183], v14 offset:27648
v_mfma_f32_16x16x32_bf16 a[76:79], a[192:195], v[180:183], a[76:79]
s_waitcnt vmcnt(42)
v_mfma_f32_16x16x32_bf16 a[0:3], a[160:163], v[44:47], a[0:3]
ds_read_b128 a[184:187], v14 offset:23552
v_mfma_f32_16x16x32_bf16 a[0:3], a[164:167], v[52:55], a[0:3]
s_add_u32 m0, s52, 20480
v_mfma_f32_16x16x32_bf16 a[4:7], a[164:167], v[56:59], a[4:7]
s_waitcnt lgkmcnt(3)
ds_read_b128 a[188:191], v14 offset:28672
v_mfma_f32_16x16x32_bf16 a[4:7], a[160:163], v[48:51], a[4:7]
buffer_load_dwordx4 v3, s[12:15], s50 offen offset:0 sc1 lds
v_mfma_f32_16x16x32_bf16 a[8:11], a[168:171], v[44:47], a[8:11]
ds_read_b128 a[192:195], v14 offset:24576
v_mfma_f32_16x16x32_bf16 a[8:11], a[172:175], v[52:55], a[8:11]
v_mfma_f32_16x16x32_bf16 a[12:15], a[172:175], v[56:59], a[12:15]
s_waitcnt lgkmcnt(3)
ds_read_b128 a[196:199], v14 offset:29696
v_mfma_f32_16x16x32_bf16 a[12:15], a[168:171], v[48:51], a[12:15]
buffer_load_dwordx4 v3, s[12:15], s50 offen offset:1024 sc1 lds
v_mfma_f32_16x16x32_bf16 a[16:19], a[176:179], v[44:47], a[16:19]
ds_read_b128 a[160:163], v14 offset:30720
v_mfma_f32_16x16x32_bf16 a[16:19], a[180:183], v[52:55], a[16:19]
v_mfma_f32_16x16x32_bf16 a[20:23], a[180:183], v[56:59], a[20:23]
s_waitcnt lgkmcnt(3)
ds_read_b128 a[164:167], v14 offset:35840
v_mfma_f32_16x16x32_bf16 a[20:23], a[176:179], v[48:51], a[20:23]
buffer_load_dwordx4 v3, s[12:15], s50 offen offset:2048 sc1 lds
v_mfma_f32_16x16x32_bf16 a[24:27], a[184:187], v[44:47], a[24:27]
ds_read_b128 a[168:171], v14 offset:31744
v_mfma_f32_16x16x32_bf16 a[24:27], a[188:191], v[52:55], a[24:27]
v_mfma_f32_16x16x32_bf16 a[28:31], a[188:191], v[56:59], a[28:31]
s_waitcnt lgkmcnt(3)
ds_read_b128 a[172:175], v14 offset:36864
v_mfma_f32_16x16x32_bf16 a[28:31], a[184:187], v[48:51], a[28:31]
buffer_load_dwordx4 v3, s[12:15], s50 offen offset:3072 sc1 lds
v_mfma_f32_16x16x32_bf16 a[32:35], a[192:195], v[44:47], a[32:35]
ds_read_b128 a[176:179], v14 offset:32768
v_mfma_f32_16x16x32_bf16 a[32:35], a[196:199], v[52:55], a[32:35]
s_add_u32 m0, s52, 21504
v_mfma_f32_16x16x32_bf16 a[36:39], a[196:199], v[56:59], a[36:39]
s_waitcnt lgkmcnt(3)
ds_read_b128 a[180:183], v14 offset:37888
v_mfma_f32_16x16x32_bf16 a[36:39], a[192:195], v[48:51], a[36:39]
buffer_load_dwordx4 v1, s[12:15], s50 offen offset:3072 sc1 lds
v_mfma_f32_16x16x32_bf16 a[40:43], a[160:163], v[44:47], a[40:43]
s_mul_i32 s50, s81, 30720
ds_read_b128 a[184:187], v14 offset:33792
v_mfma_f32_16x16x32_bf16 a[40:43], a[164:167], v[52:55], a[40:43]
s_add_u32 s50, s50, s68
v_mfma_f32_16x16x32_bf16 a[44:47], a[164:167], v[56:59], a[44:47]
s_waitcnt lgkmcnt(3)
ds_read_b128 a[188:191], v14 offset:38912
v_mfma_f32_16x16x32_bf16 a[44:47], a[160:163], v[48:51], a[44:47]
buffer_load_dwordx4 v[208:211], v15, s[24:27], s51 offen sc1
v_mfma_f32_16x16x32_bf16 a[48:51], a[168:171], v[44:47], a[48:51]
ds_read_b128 a[192:195], v14 offset:34816
v_mfma_f32_16x16x32_bf16 a[48:51], a[172:175], v[52:55], a[48:51]
s_waitcnt lgkmcnt(3)
v_mfma_f32_16x16x32_bf16 a[52:55], a[172:175], v[56:59], a[52:55]
s_waitcnt vmcnt(28)
ds_read_b128 a[196:199], v14 offset:39936
v_mfma_f32_16x16x32_bf16 a[52:55], a[168:171], v[48:51], a[52:55]
s_barrier
v_mfma_f32_16x16x32_bf16 a[56:59], a[176:179], v[44:47], a[56:59]
ds_read_b128 a[160:163], v13 offset:20480
v_mfma_f32_16x16x32_bf16 a[56:59], a[180:183], v[52:55], a[56:59]
buffer_load_dwordx4 v[212:215], v16, s[24:27], s51 offen sc1
v_mfma_f32_16x16x32_bf16 a[60:63], a[180:183], v[56:59], a[60:63]
s_waitcnt lgkmcnt(3)
ds_read_b128 a[164:167], v13 offset:25600
v_mfma_f32_16x16x32_bf16 a[60:63], a[176:179], v[48:51], a[60:63]
v_mfma_f32_16x16x32_bf16 a[64:67], a[184:187], v[44:47], a[64:67]
ds_read_b128 a[168:171], v13 offset:21504
v_mfma_f32_16x16x32_bf16 a[64:67], a[188:191], v[52:55], a[64:67]
buffer_load_dwordx4 v[216:219], v17, s[24:27], s51 offen sc1
v_mfma_f32_16x16x32_bf16 a[68:71], a[188:191], v[56:59], a[68:71]
s_waitcnt lgkmcnt(3)
ds_read_b128 a[172:175], v13 offset:26624
v_mfma_f32_16x16x32_bf16 a[68:71], a[184:187], v[48:51], a[68:71]
v_mfma_f32_16x16x32_bf16 a[72:75], a[192:195], v[44:47], a[72:75]
ds_read_b128 a[176:179], v13 offset:22528
v_mfma_f32_16x16x32_bf16 a[72:75], a[196:199], v[52:55], a[72:75]
buffer_load_dwordx4 v[220:223], v18, s[24:27], s51 offen sc1
v_mfma_f32_16x16x32_bf16 a[76:79], a[196:199], v[56:59], a[76:79]
s_waitcnt lgkmcnt(3)
s_add_u32 s51, s51, 8192
ds_read_b128 a[180:183], v13 offset:27648
v_mfma_f32_16x16x32_bf16 a[76:79], a[192:195], v[48:51], a[76:79]
s_waitcnt vmcnt(36)
v_mfma_f32_16x16x32_bf16 a[0:3], a[160:163], a[224:227], a[0:3]
ds_read_b128 a[184:187], v13 offset:23552
v_mfma_f32_16x16x32_bf16 a[0:3], a[164:167], a[232:235], a[0:3]
s_add_u32 m0, s52, 40960
v_mfma_f32_16x16x32_bf16 a[4:7], a[164:167], a[236:239], a[4:7]
s_waitcnt lgkmcnt(3)
ds_read_b128 a[188:191], v13 offset:28672
v_mfma_f32_16x16x32_bf16 a[4:7], a[160:163], a[228:231], a[4:7]
buffer_load_dwordx4 v3, s[12:15], s50 offen offset:0 sc1 lds
v_mfma_f32_16x16x32_bf16 a[8:11], a[168:171], a[224:227], a[8:11]
ds_read_b128 a[192:195], v13 offset:24576
v_mfma_f32_16x16x32_bf16 a[8:11], a[172:175], a[232:235], a[8:11]
v_mfma_f32_16x16x32_bf16 a[12:15], a[172:175], a[236:239], a[12:15]
s_waitcnt lgkmcnt(3)
ds_read_b128 a[196:199], v13 offset:29696
v_mfma_f32_16x16x32_bf16 a[12:15], a[168:171], a[228:231], a[12:15]
buffer_load_dwordx4 v3, s[12:15], s50 offen offset:1024 sc1 lds
v_mfma_f32_16x16x32_bf16 a[16:19], a[176:179], a[224:227], a[16:19]
ds_read_b128 a[160:163], v13 offset:30720
v_mfma_f32_16x16x32_bf16 a[16:19], a[180:183], a[232:235], a[16:19]
v_mfma_f32_16x16x32_bf16 a[20:23], a[180:183], a[236:239], a[20:23]
s_waitcnt lgkmcnt(3)
ds_read_b128 a[164:167], v13 offset:35840
v_mfma_f32_16x16x32_bf16 a[20:23], a[176:179], a[228:231], a[20:23]
buffer_load_dwordx4 v3, s[12:15], s50 offen offset:2048 sc1 lds
v_mfma_f32_16x16x32_bf16 a[24:27], a[184:187], a[224:227], a[24:27]
ds_read_b128 a[168:171], v13 offset:31744
v_mfma_f32_16x16x32_bf16 a[24:27], a[188:191], a[232:235], a[24:27]
v_mfma_f32_16x16x32_bf16 a[28:31], a[188:191], a[236:239], a[28:31]
s_waitcnt lgkmcnt(3)
ds_read_b128 a[172:175], v13 offset:36864
v_mfma_f32_16x16x32_bf16 a[28:31], a[184:187], a[228:231], a[28:31]
buffer_load_dwordx4 v3, s[12:15], s50 offen offset:3072 sc1 lds
v_mfma_f32_16x16x32_bf16 a[32:35], a[192:195], a[224:227], a[32:35]
ds_read_b128 a[176:179], v13 offset:32768
v_mfma_f32_16x16x32_bf16 a[32:35], a[196:199], a[232:235], a[32:35]
s_add_u32 m0, s52, 41984
v_mfma_f32_16x16x32_bf16 a[36:39], a[196:199], a[236:239], a[36:39]
s_waitcnt lgkmcnt(3)
ds_read_b128 a[180:183], v13 offset:37888
v_mfma_f32_16x16x32_bf16 a[36:39], a[192:195], a[228:231], a[36:39]
buffer_load_dwordx4 v1, s[12:15], s50 offen offset:3072 sc1 lds
v_mfma_f32_16x16x32_bf16 a[40:43], a[160:163], a[224:227], a[40:43]
ds_read_b128 a[184:187], v13 offset:33792
v_mfma_f32_16x16x32_bf16 a[40:43], a[164:167], a[232:235], a[40:43]
s_add_u32 s50, s50, 10240
v_mfma_f32_16x16x32_bf16 a[44:47], a[164:167], a[236:239], a[44:47]
s_waitcnt lgkmcnt(3)
ds_read_b128 a[188:191], v13 offset:38912
v_mfma_f32_16x16x32_bf16 a[44:47], a[160:163], a[228:231], a[44:47]
buffer_load_dwordx4 v[160:163], v15, s[24:27], s51 offen sc1
v_mfma_f32_16x16x32_bf16 a[48:51], a[168:171], a[224:227], a[48:51]
ds_read_b128 a[192:195], v13 offset:34816
v_mfma_f32_16x16x32_bf16 a[48:51], a[172:175], a[232:235], a[48:51]
s_waitcnt lgkmcnt(3)
v_mfma_f32_16x16x32_bf16 a[52:55], a[172:175], a[236:239], a[52:55]
s_waitcnt vmcnt(28)
ds_read_b128 a[196:199], v13 offset:39936
v_mfma_f32_16x16x32_bf16 a[52:55], a[168:171], a[228:231], a[52:55]
s_barrier
v_mfma_f32_16x16x32_bf16 a[56:59], a[176:179], a[224:227], a[56:59]
ds_read_b128 a[160:163], v13 offset:40960
v_mfma_f32_16x16x32_bf16 a[56:59], a[180:183], a[232:235], a[56:59]
buffer_load_dwordx4 v[164:167], v16, s[24:27], s51 offen sc1
v_mfma_f32_16x16x32_bf16 a[60:63], a[180:183], a[236:239], a[60:63]
s_waitcnt lgkmcnt(3)
ds_read_b128 a[164:167], v13 offset:46080
v_mfma_f32_16x16x32_bf16 a[60:63], a[176:179], a[228:231], a[60:63]
v_mfma_f32_16x16x32_bf16 a[64:67], a[184:187], a[224:227], a[64:67]
ds_read_b128 a[168:171], v13 offset:41984
v_mfma_f32_16x16x32_bf16 a[64:67], a[188:191], a[232:235], a[64:67]
buffer_load_dwordx4 v[168:171], v17, s[24:27], s51 offen sc1
v_mfma_f32_16x16x32_bf16 a[68:71], a[188:191], a[236:239], a[68:71]
s_waitcnt lgkmcnt(3)
ds_read_b128 a[172:175], v13 offset:47104
v_mfma_f32_16x16x32_bf16 a[68:71], a[184:187], a[228:231], a[68:71]
v_mfma_f32_16x16x32_bf16 a[72:75], a[192:195], a[224:227], a[72:75]
ds_read_b128 a[176:179], v13 offset:43008
v_mfma_f32_16x16x32_bf16 a[72:75], a[196:199], a[232:235], a[72:75]
buffer_load_dwordx4 v[172:175], v18, s[24:27], s51 offen sc1
v_mfma_f32_16x16x32_bf16 a[76:79], a[196:199], a[236:239], a[76:79]
s_waitcnt lgkmcnt(3)
s_add_u32 s51, s51, 8192
ds_read_b128 a[180:183], v13 offset:48128
v_mfma_f32_16x16x32_bf16 a[76:79], a[192:195], a[228:231], a[76:79]
s_waitcnt vmcnt(36)
v_mfma_f32_16x16x32_bf16 a[0:3], a[160:163], a[240:243], a[0:3]
ds_read_b128 a[184:187], v13 offset:44032
v_mfma_f32_16x16x32_bf16 a[0:3], a[164:167], a[248:251], a[0:3]
s_add_u32 m0, s52, 61440
v_mfma_f32_16x16x32_bf16 a[4:7], a[164:167], a[252:255], a[4:7]
s_waitcnt lgkmcnt(3)
ds_read_b128 a[188:191], v13 offset:49152
v_mfma_f32_16x16x32_bf16 a[4:7], a[160:163], a[244:247], a[4:7]
buffer_load_dwordx4 v3, s[12:15], s50 offen offset:0 sc1 lds
v_mfma_f32_16x16x32_bf16 a[8:11], a[168:171], a[240:243], a[8:11]
ds_read_b128 a[192:195], v13 offset:45056
v_mfma_f32_16x16x32_bf16 a[8:11], a[172:175], a[248:251], a[8:11]
v_mfma_f32_16x16x32_bf16 a[12:15], a[172:175], a[252:255], a[12:15]
s_waitcnt lgkmcnt(3)
ds_read_b128 a[196:199], v13 offset:50176
v_mfma_f32_16x16x32_bf16 a[12:15], a[168:171], a[244:247], a[12:15]
buffer_load_dwordx4 v3, s[12:15], s50 offen offset:1024 sc1 lds
v_mfma_f32_16x16x32_bf16 a[16:19], a[176:179], a[240:243], a[16:19]
ds_read_b128 a[160:163], v13 offset:51200
v_mfma_f32_16x16x32_bf16 a[16:19], a[180:183], a[248:251], a[16:19]
v_mfma_f32_16x16x32_bf16 a[20:23], a[180:183], a[252:255], a[20:23]
s_waitcnt lgkmcnt(3)
ds_read_b128 a[164:167], v13 offset:56320
v_mfma_f32_16x16x32_bf16 a[20:23], a[176:179], a[244:247], a[20:23]
buffer_load_dwordx4 v3, s[12:15], s50 offen offset:2048 sc1 lds
v_mfma_f32_16x16x32_bf16 a[24:27], a[184:187], a[240:243], a[24:27]
ds_read_b128 a[168:171], v13 offset:52224
v_mfma_f32_16x16x32_bf16 a[24:27], a[188:191], a[248:251], a[24:27]
v_mfma_f32_16x16x32_bf16 a[28:31], a[188:191], a[252:255], a[28:31]
s_waitcnt lgkmcnt(3)
ds_read_b128 a[172:175], v13 offset:57344
v_mfma_f32_16x16x32_bf16 a[28:31], a[184:187], a[244:247], a[28:31]
buffer_load_dwordx4 v3, s[12:15], s50 offen offset:3072 sc1 lds
v_mfma_f32_16x16x32_bf16 a[32:35], a[192:195], a[240:243], a[32:35]
ds_read_b128 a[176:179], v13 offset:53248
v_mfma_f32_16x16x32_bf16 a[32:35], a[196:199], a[248:251], a[32:35]
s_add_u32 m0, s52, 62464
v_mfma_f32_16x16x32_bf16 a[36:39], a[196:199], a[252:255], a[36:39]
s_waitcnt lgkmcnt(3)
ds_read_b128 a[180:183], v13 offset:58368
v_mfma_f32_16x16x32_bf16 a[36:39], a[192:195], a[244:247], a[36:39]
buffer_load_dwordx4 v1, s[12:15], s50 offen offset:3072 sc1 lds
v_mfma_f32_16x16x32_bf16 a[40:43], a[160:163], a[240:243], a[40:43]
ds_read_b128 a[184:187], v13 offset:54272
v_mfma_f32_16x16x32_bf16 a[40:43], a[164:167], a[248:251], a[40:43]
s_add_u32 s50, s50, 10240
v_mfma_f32_16x16x32_bf16 a[44:47], a[164:167], a[252:255], a[44:47]
s_waitcnt lgkmcnt(3)
ds_read_b128 a[188:191], v13 offset:59392
v_mfma_f32_16x16x32_bf16 a[44:47], a[160:163], a[244:247], a[44:47]
buffer_load_dwordx4 v[176:179], v15, s[24:27], s51 offen sc1
v_mfma_f32_16x16x32_bf16 a[48:51], a[168:171], a[240:243], a[48:51]
ds_read_b128 a[192:195], v13 offset:55296
v_mfma_f32_16x16x32_bf16 a[48:51], a[172:175], a[248:251], a[48:51]
s_waitcnt lgkmcnt(3)
v_mfma_f32_16x16x32_bf16 a[52:55], a[172:175], a[252:255], a[52:55]
s_waitcnt vmcnt(28)
ds_read_b128 a[196:199], v13 offset:60416
v_mfma_f32_16x16x32_bf16 a[52:55], a[168:171], a[244:247], a[52:55]
s_barrier
v_mfma_f32_16x16x32_bf16 a[56:59], a[176:179], a[240:243], a[56:59]
ds_read_b128 a[160:163], v12 offset:0
v_mfma_f32_16x16x32_bf16 a[56:59], a[180:183], a[248:251], a[56:59]
buffer_load_dwordx4 v[180:183], v16, s[24:27], s51 offen sc1
v_mfma_f32_16x16x32_bf16 a[60:63], a[180:183], a[252:255], a[60:63]
s_waitcnt lgkmcnt(3)
ds_read_b128 a[164:167], v12 offset:5120
v_mfma_f32_16x16x32_bf16 a[60:63], a[176:179], a[244:247], a[60:63]
v_mfma_f32_16x16x32_bf16 a[64:67], a[184:187], a[240:243], a[64:67]
ds_read_b128 a[168:171], v12 offset:1024
v_mfma_f32_16x16x32_bf16 a[64:67], a[188:191], a[248:251], a[64:67]
buffer_load_dwordx4 v[184:187], v17, s[24:27], s51 offen sc1
v_mfma_f32_16x16x32_bf16 a[68:71], a[188:191], a[252:255], a[68:71]
s_waitcnt lgkmcnt(3)
ds_read_b128 a[172:175], v12 offset:6144
v_mfma_f32_16x16x32_bf16 a[68:71], a[184:187], a[244:247], a[68:71]
v_mfma_f32_16x16x32_bf16 a[72:75], a[192:195], a[240:243], a[72:75]
ds_read_b128 a[176:179], v12 offset:2048
v_mfma_f32_16x16x32_bf16 a[72:75], a[196:199], a[248:251], a[72:75]
buffer_load_dwordx4 v[188:191], v18, s[24:27], s51 offen sc1
v_mfma_f32_16x16x32_bf16 a[76:79], a[196:199], a[252:255], a[76:79]
s_waitcnt lgkmcnt(3)
s_mul_i32 s51, s84, 24576
ds_read_b128 a[180:183], v12 offset:7168
v_mfma_f32_16x16x32_bf16 a[76:79], a[192:195], a[244:247], a[76:79]
s_waitcnt vmcnt(36)
v_mfma_f32_16x16x32_bf16 a[0:3], a[160:163], v[224:227], a[0:3]
s_add_u32 m0, s52, 122880
ds_read_b128 a[184:187], v12 offset:3072
v_mfma_f32_16x16x32_bf16 a[0:3], a[164:167], v[232:235], a[0:3]
buffer_load_dwordx4 v3, s[12:15], s50 offen offset:0 sc1 lds
v_mfma_f32_16x16x32_bf16 a[4:7], a[164:167], v[236:239], a[4:7]
s_waitcnt lgkmcnt(3)
ds_read_b128 a[188:191], v12 offset:8192
v_mfma_f32_16x16x32_bf16 a[4:7], a[160:163], v[228:231], a[4:7]
v_mfma_f32_16x16x32_bf16 a[8:11], a[168:171], v[224:227], a[8:11]
ds_read_b128 a[192:195], v12 offset:4096
v_mfma_f32_16x16x32_bf16 a[8:11], a[172:175], v[232:235], a[8:11]
buffer_load_dwordx4 v3, s[12:15], s50 offen offset:1024 sc1 lds
v_mfma_f32_16x16x32_bf16 a[12:15], a[172:175], v[236:239], a[12:15]
s_waitcnt lgkmcnt(3)
ds_read_b128 a[196:199], v12 offset:9216
v_mfma_f32_16x16x32_bf16 a[12:15], a[168:171], v[228:231], a[12:15]
v_mfma_f32_16x16x32_bf16 a[16:19], a[176:179], v[224:227], a[16:19]
ds_read_b128 a[160:163], v12 offset:10240
v_mfma_f32_16x16x32_bf16 a[16:19], a[180:183], v[232:235], a[16:19]
buffer_load_dwordx4 v3, s[12:15], s50 offen offset:2048 sc1 lds
v_mfma_f32_16x16x32_bf16 a[20:23], a[180:183], v[236:239], a[20:23]
s_waitcnt lgkmcnt(3)
ds_read_b128 a[164:167], v12 offset:15360
v_mfma_f32_16x16x32_bf16 a[20:23], a[176:179], v[228:231], a[20:23]
v_mfma_f32_16x16x32_bf16 a[24:27], a[184:187], v[224:227], a[24:27]
ds_read_b128 a[168:171], v12 offset:11264
v_mfma_f32_16x16x32_bf16 a[24:27], a[188:191], v[232:235], a[24:27]
buffer_load_dwordx4 v3, s[12:15], s50 offen offset:3072 sc1 lds
v_mfma_f32_16x16x32_bf16 a[28:31], a[188:191], v[236:239], a[28:31]
s_waitcnt lgkmcnt(3)
ds_read_b128 a[172:175], v12 offset:16384
v_mfma_f32_16x16x32_bf16 a[28:31], a[184:187], v[228:231], a[28:31]
v_mfma_f32_16x16x32_bf16 a[32:35], a[192:195], v[224:227], a[32:35]
s_add_u32 m0, s52, 123904
ds_read_b128 a[176:179], v12 offset:12288
v_mfma_f32_16x16x32_bf16 a[32:35], a[196:199], v[232:235], a[32:35]
buffer_load_dwordx4 v1, s[12:15], s50 offen offset:3072 sc1 lds
v_mfma_f32_16x16x32_bf16 a[36:39], a[196:199], v[236:239], a[36:39]
s_waitcnt lgkmcnt(3)
ds_read_b128 a[180:183], v12 offset:17408
v_mfma_f32_16x16x32_bf16 a[36:39], a[192:195], v[228:231], a[36:39]
s_mul_i32 s50, s84, 30720
v_mfma_f32_16x16x32_bf16 a[40:43], a[160:163], v[224:227], a[40:43]
s_add_u32 s50, s50, s68
ds_read_b128 a[184:187], v12 offset:13312
v_mfma_f32_16x16x32_bf16 a[40:43], a[164:167], v[232:235], a[40:43]
buffer_load_dwordx4 v[44:47], v15, s[24:27], s51 offen sc1
v_mfma_f32_16x16x32_bf16 a[44:47], a[164:167], v[236:239], a[44:47]
s_waitcnt lgkmcnt(3)
ds_read_b128 a[188:191], v12 offset:18432
v_mfma_f32_16x16x32_bf16 a[44:47], a[160:163], v[228:231], a[44:47]
v_mfma_f32_16x16x32_bf16 a[48:51], a[168:171], v[224:227], a[48:51]
ds_read_b128 a[192:195], v12 offset:14336
v_mfma_f32_16x16x32_bf16 a[48:51], a[172:175], v[232:235], a[48:51]
s_waitcnt lgkmcnt(3)
buffer_load_dwordx4 v[48:51], v16, s[24:27], s51 offen sc1
v_mfma_f32_16x16x32_bf16 a[52:55], a[172:175], v[236:239], a[52:55]
s_waitcnt vmcnt(29)
ds_read_b128 a[196:199], v12 offset:19456
v_mfma_f32_16x16x32_bf16 a[52:55], a[168:171], v[228:231], a[52:55]
s_barrier
v_mfma_f32_16x16x32_bf16 a[56:59], a[176:179], v[224:227], a[56:59]
ds_read_b128 a[160:163], v12 offset:20480
v_mfma_f32_16x16x32_bf16 a[56:59], a[180:183], v[232:235], a[56:59]
buffer_store_dwordx2 v[26:27], v25, s[56:59], s18 offen sc1
v_mfma_f32_16x16x32_bf16 a[60:63], a[180:183], v[236:239], a[60:63]
s_waitcnt lgkmcnt(3)
ds_read_b128 a[164:167], v12 offset:25600
v_mfma_f32_16x16x32_bf16 a[60:63], a[176:179], v[228:231], a[60:63]
v_mfma_f32_16x16x32_bf16 a[64:67], a[184:187], v[224:227], a[64:67]
ds_read_b128 a[168:171], v12 offset:21504
v_mfma_f32_16x16x32_bf16 a[64:67], a[188:191], v[232:235], a[64:67]
buffer_load_dwordx4 v[52:55], v17, s[24:27], s51 offen sc1
v_mfma_f32_16x16x32_bf16 a[68:71], a[188:191], v[236:239], a[68:71]
s_waitcnt lgkmcnt(3)
ds_read_b128 a[172:175], v12 offset:26624
v_mfma_f32_16x16x32_bf16 a[68:71], a[184:187], v[228:231], a[68:71]
v_mfma_f32_16x16x32_bf16 a[72:75], a[192:195], v[224:227], a[72:75]
ds_read_b128 a[176:179], v12 offset:22528
v_mfma_f32_16x16x32_bf16 a[72:75], a[196:199], v[232:235], a[72:75]
buffer_load_dwordx4 v[56:59], v18, s[24:27], s51 offen sc1
v_mfma_f32_16x16x32_bf16 a[76:79], a[196:199], v[236:239], a[76:79]
s_waitcnt lgkmcnt(3)
s_add_u32 s51, s51, 8192
ds_read_b128 a[180:183], v12 offset:27648
v_mfma_f32_16x16x32_bf16 a[76:79], a[192:195], v[228:231], a[76:79]
s_waitcnt vmcnt(37)
v_mfma_f32_16x16x32_bf16 a[0:3], a[160:163], v[192:195], a[0:3]
ds_read_b128 a[184:187], v12 offset:23552
v_mfma_f32_16x16x32_bf16 a[0:3], a[164:167], v[200:203], a[0:3]
s_add_u32 m0, s52, 143360
v_mfma_f32_16x16x32_bf16 a[4:7], a[164:167], v[204:207], a[4:7]
s_waitcnt lgkmcnt(3)
ds_read_b128 a[188:191], v12 offset:28672
v_mfma_f32_16x16x32_bf16 a[4:7], a[160:163], v[196:199], a[4:7]
buffer_load_dwordx4 v3, s[12:15], s50 offen offset:0 sc1 lds
v_mfma_f32_16x16x32_bf16 a[8:11], a[168:171], v[192:195], a[8:11]
ds_read_b128 a[192:195], v12 offset:24576
v_mfma_f32_16x16x32_bf16 a[8:11], a[172:175], v[200:203], a[8:11]
v_mfma_f32_16x16x32_bf16 a[12:15], a[172:175], v[204:207], a[12:15]
s_waitcnt lgkmcnt(3)
ds_read_b128 a[196:199], v12 offset:29696
v_mfma_f32_16x16x32_bf16 a[12:15], a[168:171], v[196:199], a[12:15]
buffer_load_dwordx4 v3, s[12:15], s50 offen offset:1024 sc1 lds
v_mfma_f32_16x16x32_bf16 a[16:19], a[176:179], v[192:195], a[16:19]
ds_read_b128 a[160:163], v12 offset:30720
v_mfma_f32_16x16x32_bf16 a[16:19], a[180:183], v[200:203], a[16:19]
v_mfma_f32_16x16x32_bf16 a[20:23], a[180:183], v[204:207], a[20:23]
s_waitcnt lgkmcnt(3)
ds_read_b128 a[164:167], v12 offset:35840
v_mfma_f32_16x16x32_bf16 a[20:23], a[176:179], v[196:199], a[20:23]
buffer_load_dwordx4 v3, s[12:15], s50 offen offset:2048 sc1 lds
v_mfma_f32_16x16x32_bf16 a[24:27], a[184:187], v[192:195], a[24:27]
ds_read_b128 a[168:171], v12 offset:31744
v_mfma_f32_16x16x32_bf16 a[24:27], a[188:191], v[200:203], a[24:27]
v_mfma_f32_16x16x32_bf16 a[28:31], a[188:191], v[204:207], a[28:31]
s_waitcnt lgkmcnt(3)
ds_read_b128 a[172:175], v12 offset:36864
v_mfma_f32_16x16x32_bf16 a[28:31], a[184:187], v[196:199], a[28:31]
buffer_load_dwordx4 v3, s[12:15], s50 offen offset:3072 sc1 lds
v_mfma_f32_16x16x32_bf16 a[32:35], a[192:195], v[192:195], a[32:35]
ds_read_b128 a[176:179], v12 offset:32768
v_mfma_f32_16x16x32_bf16 a[32:35], a[196:199], v[200:203], a[32:35]
s_add_u32 m0, s52, 144384
v_mfma_f32_16x16x32_bf16 a[36:39], a[196:199], v[204:207], a[36:39]
s_waitcnt lgkmcnt(3)
ds_read_b128 a[180:183], v12 offset:37888
v_mfma_f32_16x16x32_bf16 a[36:39], a[192:195], v[196:199], a[36:39]
buffer_load_dwordx4 v1, s[12:15], s50 offen offset:3072 sc1 lds
v_mfma_f32_16x16x32_bf16 a[40:43], a[160:163], v[192:195], a[40:43]
ds_read_b128 a[184:187], v12 offset:33792
v_mfma_f32_16x16x32_bf16 a[40:43], a[164:167], v[200:203], a[40:43]
s_add_u32 s50, s50, 10240
v_mfma_f32_16x16x32_bf16 a[44:47], a[164:167], v[204:207], a[44:47]
s_waitcnt lgkmcnt(3)
ds_read_b128 a[188:191], v12 offset:38912
v_mfma_f32_16x16x32_bf16 a[44:47], a[160:163], v[196:199], a[44:47]
buffer_load_dwordx4 a[224:227], v15, s[24:27], s51 offen sc1
v_mfma_f32_16x16x32_bf16 a[48:51], a[168:171], v[192:195], a[48:51]
ds_read_b128 a[192:195], v12 offset:34816
v_mfma_f32_16x16x32_bf16 a[48:51], a[172:175], v[200:203], a[48:51]
s_waitcnt lgkmcnt(3)
v_mfma_f32_16x16x32_bf16 a[52:55], a[172:175], v[204:207], a[52:55]
s_waitcnt vmcnt(29)
ds_read_b128 a[196:199], v12 offset:39936
v_mfma_f32_16x16x32_bf16 a[52:55], a[168:171], v[196:199], a[52:55]
s_barrier
v_mfma_f32_16x16x32_bf16 a[56:59], a[176:179], v[192:195], a[56:59]
ds_read_b128 a[160:163], v12 offset:40960
v_mfma_f32_16x16x32_bf16 a[56:59], a[180:183], v[200:203], a[56:59]
buffer_load_dwordx4 a[228:231], v16, s[24:27], s51 offen sc1
v_mfma_f32_16x16x32_bf16 a[60:63], a[180:183], v[204:207], a[60:63]
s_waitcnt lgkmcnt(3)
ds_read_b128 a[164:167], v12 offset:46080
v_mfma_f32_16x16x32_bf16 a[60:63], a[176:179], v[196:199], a[60:63]
v_mfma_f32_16x16x32_bf16 a[64:67], a[184:187], v[192:195], a[64:67]
ds_read_b128 a[168:171], v12 offset:41984
v_mfma_f32_16x16x32_bf16 a[64:67], a[188:191], v[200:203], a[64:67]
buffer_load_dwordx4 a[232:235], v17, s[24:27], s51 offen sc1
v_mfma_f32_16x16x32_bf16 a[68:71], a[188:191], v[204:207], a[68:71]
s_waitcnt lgkmcnt(3)
ds_read_b128 a[172:175], v12 offset:47104
v_mfma_f32_16x16x32_bf16 a[68:71], a[184:187], v[196:199], a[68:71]
v_mfma_f32_16x16x32_bf16 a[72:75], a[192:195], v[192:195], a[72:75]
ds_read_b128 a[176:179], v12 offset:43008
v_mfma_f32_16x16x32_bf16 a[72:75], a[196:199], v[200:203], a[72:75]
buffer_load_dwordx4 a[236:239], v18, s[24:27], s51 offen sc1
v_mfma_f32_16x16x32_bf16 a[76:79], a[196:199], v[204:207], a[76:79]
s_waitcnt lgkmcnt(3)
s_add_u32 s51, s51, 8192
ds_read_b128 a[180:183], v12 offset:48128
v_mfma_f32_16x16x32_bf16 a[76:79], a[192:195], v[196:199], a[76:79]
s_waitcnt vmcnt(37)
v_mfma_f32_16x16x32_bf16 a[0:3], a[160:163], v[208:211], a[0:3]
ds_read_b128 a[184:187], v12 offset:44032
v_mfma_f32_16x16x32_bf16 a[0:3], a[164:167], v[216:219], a[0:3]
s_add_u32 m0, s52, 81920
v_mfma_f32_16x16x32_bf16 a[4:7], a[164:167], v[220:223], a[4:7]
s_waitcnt lgkmcnt(3)
ds_read_b128 a[188:191], v12 offset:49152
v_mfma_f32_16x16x32_bf16 a[4:7], a[160:163], v[212:215], a[4:7]
buffer_load_dwordx4 v3, s[12:15], s50 offen offset:0 sc1 lds
v_mfma_f32_16x16x32_bf16 a[8:11], a[168:171], v[208:211], a[8:11]
ds_read_b128 a[192:195], v12 offset:45056
v_mfma_f32_16x16x32_bf16 a[8:11], a[172:175], v[216:219], a[8:11]
v_mfma_f32_16x16x32_bf16 a[12:15], a[172:175], v[220:223], a[12:15]
s_waitcnt lgkmcnt(3)
ds_read_b128 a[196:199], v12 offset:50176
v_mfma_f32_16x16x32_bf16 a[12:15], a[168:171], v[212:215], a[12:15]
buffer_load_dwordx4 v3, s[12:15], s50 offen offset:1024 sc1 lds
v_mfma_f32_16x16x32_bf16 a[16:19], a[176:179], v[208:211], a[16:19]
ds_read_b128 a[160:163], v12 offset:51200
v_mfma_f32_16x16x32_bf16 a[16:19], a[180:183], v[216:219], a[16:19]
v_mfma_f32_16x16x32_bf16 a[20:23], a[180:183], v[220:223], a[20:23]
s_waitcnt lgkmcnt(3)
ds_read_b128 a[164:167], v12 offset:56320
v_mfma_f32_16x16x32_bf16 a[20:23], a[176:179], v[212:215], a[20:23]
buffer_load_dwordx4 v3, s[12:15], s50 offen offset:2048 sc1 lds
v_mfma_f32_16x16x32_bf16 a[24:27], a[184:187], v[208:211], a[24:27]
ds_read_b128 a[168:171], v12 offset:52224
v_mfma_f32_16x16x32_bf16 a[24:27], a[188:191], v[216:219], a[24:27]
v_mfma_f32_16x16x32_bf16 a[28:31], a[188:191], v[220:223], a[28:31]
s_waitcnt lgkmcnt(3)
ds_read_b128 a[172:175], v12 offset:57344
v_mfma_f32_16x16x32_bf16 a[28:31], a[184:187], v[212:215], a[28:31]
buffer_load_dwordx4 v3, s[12:15], s50 offen offset:3072 sc1 lds
v_mfma_f32_16x16x32_bf16 a[32:35], a[192:195], v[208:211], a[32:35]
ds_read_b128 a[176:179], v12 offset:53248
v_mfma_f32_16x16x32_bf16 a[32:35], a[196:199], v[216:219], a[32:35]
s_add_u32 m0, s52, 82944
v_mfma_f32_16x16x32_bf16 a[36:39], a[196:199], v[220:223], a[36:39]
s_waitcnt lgkmcnt(3)
ds_read_b128 a[180:183], v12 offset:58368
v_mfma_f32_16x16x32_bf16 a[36:39], a[192:195], v[212:215], a[36:39]
buffer_load_dwordx4 v1, s[12:15], s50 offen offset:3072 sc1 lds
v_mfma_f32_16x16x32_bf16 a[40:43], a[160:163], v[208:211], a[40:43]
ds_read_b128 a[184:187], v12 offset:54272
v_mfma_f32_16x16x32_bf16 a[40:43], a[164:167], v[216:219], a[40:43]
s_add_u32 s50, s50, 10240
v_mfma_f32_16x16x32_bf16 a[44:47], a[164:167], v[220:223], a[44:47]
s_waitcnt lgkmcnt(3)
ds_read_b128 a[188:191], v12 offset:59392
v_mfma_f32_16x16x32_bf16 a[44:47], a[160:163], v[212:215], a[44:47]
buffer_load_dwordx4 a[240:243], v15, s[24:27], s51 offen sc1
v_mfma_f32_16x16x32_bf16 a[48:51], a[168:171], v[208:211], a[48:51]
ds_read_b128 a[192:195], v12 offset:55296
v_mfma_f32_16x16x32_bf16 a[48:51], a[172:175], v[216:219], a[48:51]
s_waitcnt lgkmcnt(3)
v_mfma_f32_16x16x32_bf16 a[52:55], a[172:175], v[220:223], a[52:55]
s_waitcnt vmcnt(29)
ds_read_b128 a[196:199], v12 offset:60416
v_mfma_f32_16x16x32_bf16 a[52:55], a[168:171], v[212:215], a[52:55]
s_barrier
v_mfma_f32_16x16x32_bf16 a[56:59], a[176:179], v[208:211], a[56:59]
ds_read_b128 a[160:163], v13 offset:0
v_mfma_f32_16x16x32_bf16 a[56:59], a[180:183], v[216:219], a[56:59]
buffer_load_dwordx4 a[244:247], v16, s[24:27], s51 offen sc1
v_mfma_f32_16x16x32_bf16 a[60:63], a[180:183], v[220:223], a[60:63]
s_waitcnt lgkmcnt(3)
ds_read_b128 a[164:167], v13 offset:5120
v_mfma_f32_16x16x32_bf16 a[60:63], a[176:179], v[212:215], a[60:63]
v_mfma_f32_16x16x32_bf16 a[64:67], a[184:187], v[208:211], a[64:67]
ds_read_b128 a[168:171], v13 offset:1024
v_mfma_f32_16x16x32_bf16 a[64:67], a[188:191], v[216:219], a[64:67]
buffer_load_dwordx4 a[248:251], v17, s[24:27], s51 offen sc1
v_mfma_f32_16x16x32_bf16 a[68:71], a[188:191], v[220:223], a[68:71]
s_waitcnt lgkmcnt(3)
ds_read_b128 a[172:175], v13 offset:6144
v_mfma_f32_16x16x32_bf16 a[68:71], a[184:187], v[212:215], a[68:71]
v_mfma_f32_16x16x32_bf16 a[72:75], a[192:195], v[208:211], a[72:75]
ds_read_b128 a[176:179], v13 offset:2048
v_mfma_f32_16x16x32_bf16 a[72:75], a[196:199], v[216:219], a[72:75]
buffer_load_dwordx4 a[252:255], v18, s[24:27], s51 offen sc1
v_mfma_f32_16x16x32_bf16 a[76:79], a[196:199], v[220:223], a[76:79]
s_waitcnt lgkmcnt(3)
s_mul_i32 s51, s85, 24576
ds_read_b128 a[180:183], v13 offset:7168
v_mfma_f32_16x16x32_bf16 a[76:79], a[192:195], v[212:215], a[76:79]
s_waitcnt vmcnt(37)
v_mfma_f32_16x16x32_bf16 a[0:3], a[160:163], v[160:163], a[0:3]
ds_read_b128 a[184:187], v13 offset:3072
v_mfma_f32_16x16x32_bf16 a[0:3], a[164:167], v[168:171], a[0:3]
s_add_u32 m0, s52, 102400
v_mfma_f32_16x16x32_bf16 a[4:7], a[164:167], v[172:175], a[4:7]
s_waitcnt lgkmcnt(3)
ds_read_b128 a[188:191], v13 offset:8192
v_mfma_f32_16x16x32_bf16 a[4:7], a[160:163], v[164:167], a[4:7]
buffer_load_dwordx4 v3, s[12:15], s50 offen offset:0 sc1 lds
v_mfma_f32_16x16x32_bf16 a[8:11], a[168:171], v[160:163], a[8:11]
ds_read_b128 a[192:195], v13 offset:4096
v_mfma_f32_16x16x32_bf16 a[8:11], a[172:175], v[168:171], a[8:11]
v_mfma_f32_16x16x32_bf16 a[12:15], a[172:175], v[172:175], a[12:15]
s_waitcnt lgkmcnt(3)
ds_read_b128 a[196:199], v13 offset:9216
v_mfma_f32_16x16x32_bf16 a[12:15], a[168:171], v[164:167], a[12:15]
buffer_load_dwordx4 v3, s[12:15], s50 offen offset:1024 sc1 lds
v_mfma_f32_16x16x32_bf16 a[16:19], a[176:179], v[160:163], a[16:19]
ds_read_b128 a[160:163], v13 offset:10240
v_mfma_f32_16x16x32_bf16 a[16:19], a[180:183], v[168:171], a[16:19]
v_mfma_f32_16x16x32_bf16 a[20:23], a[180:183], v[172:175], a[20:23]
s_waitcnt lgkmcnt(3)
ds_read_b128 a[164:167], v13 offset:15360
v_mfma_f32_16x16x32_bf16 a[20:23], a[176:179], v[164:167], a[20:23]
buffer_load_dwordx4 v3, s[12:15], s50 offen offset:2048 sc1 lds
v_mfma_f32_16x16x32_bf16 a[24:27], a[184:187], v[160:163], a[24:27]
ds_read_b128 a[168:171], v13 offset:11264
v_mfma_f32_16x16x32_bf16 a[24:27], a[188:191], v[168:171], a[24:27]
v_mfma_f32_16x16x32_bf16 a[28:31], a[188:191], v[172:175], a[28:31]
s_waitcnt lgkmcnt(3)
ds_read_b128 a[172:175], v13 offset:16384
v_mfma_f32_16x16x32_bf16 a[28:31], a[184:187], v[164:167], a[28:31]
buffer_load_dwordx4 v3, s[12:15], s50 offen offset:3072 sc1 lds
v_mfma_f32_16x16x32_bf16 a[32:35], a[192:195], v[160:163], a[32:35]
ds_read_b128 a[176:179], v13 offset:12288
v_mfma_f32_16x16x32_bf16 a[32:35], a[196:199], v[168:171], a[32:35]
s_add_u32 m0, s52, 103424
v_mfma_f32_16x16x32_bf16 a[36:39], a[196:199], v[172:175], a[36:39]
s_waitcnt lgkmcnt(3)
ds_read_b128 a[180:183], v13 offset:17408
v_mfma_f32_16x16x32_bf16 a[36:39], a[192:195], v[164:167], a[36:39]
buffer_load_dwordx4 v1, s[12:15], s50 offen offset:3072 sc1 lds
v_mfma_f32_16x16x32_bf16 a[40:43], a[160:163], v[160:163], a[40:43]
s_mul_i32 s50, s85, 30720
ds_read_b128 a[184:187], v13 offset:13312
v_mfma_f32_16x16x32_bf16 a[40:43], a[164:167], v[168:171], a[40:43]
s_add_u32 s50, s50, s68
v_mfma_f32_16x16x32_bf16 a[44:47], a[164:167], v[172:175], a[44:47]
s_waitcnt lgkmcnt(3)
ds_read_b128 a[188:191], v13 offset:18432
v_mfma_f32_16x16x32_bf16 a[44:47], a[160:163], v[164:167], a[44:47]
buffer_load_dwordx4 v[224:227], v15, s[24:27], s51 offen sc1
v_mfma_f32_16x16x32_bf16 a[48:51], a[168:171], v[160:163], a[48:51]
ds_read_b128 a[192:195], v13 offset:14336
v_mfma_f32_16x16x32_bf16 a[48:51], a[172:175], v[168:171], a[48:51]
s_waitcnt lgkmcnt(3)
v_mfma_f32_16x16x32_bf16 a[52:55], a[172:175], v[172:175], a[52:55]
s_waitcnt vmcnt(29)
ds_read_b128 a[196:199], v13 offset:19456
v_mfma_f32_16x16x32_bf16 a[52:55], a[168:171], v[164:167], a[52:55]
s_barrier
v_mfma_f32_16x16x32_bf16 a[56:59], a[176:179], v[160:163], a[56:59]
ds_read_b128 a[160:163], v14 offset:0
v_mfma_f32_16x16x32_bf16 a[56:59], a[180:183], v[168:171], a[56:59]
buffer_load_dwordx4 v[228:231], v16, s[24:27], s51 offen sc1
v_mfma_f32_16x16x32_bf16 a[60:63], a[180:183], v[172:175], a[60:63]
s_waitcnt lgkmcnt(3)
ds_read_b128 a[164:167], v14 offset:5120
v_mfma_f32_16x16x32_bf16 a[60:63], a[176:179], v[164:167], a[60:63]
v_mfma_f32_16x16x32_bf16 a[64:67], a[184:187], v[160:163], a[64:67]
ds_read_b128 a[168:171], v14 offset:1024
v_mfma_f32_16x16x32_bf16 a[64:67], a[188:191], v[168:171], a[64:67]
buffer_load_dwordx4 v[232:235], v17, s[24:27], s51 offen sc1
v_mfma_f32_16x16x32_bf16 a[68:71], a[188:191], v[172:175], a[68:71]
s_waitcnt lgkmcnt(3)
ds_read_b128 a[172:175], v14 offset:6144
v_mfma_f32_16x16x32_bf16 a[68:71], a[184:187], v[164:167], a[68:71]
v_mfma_f32_16x16x32_bf16 a[72:75], a[192:195], v[160:163], a[72:75]
ds_read_b128 a[176:179], v14 offset:2048
v_mfma_f32_16x16x32_bf16 a[72:75], a[196:199], v[168:171], a[72:75]
buffer_load_dwordx4 v[236:239], v18, s[24:27], s51 offen sc1
v_mfma_f32_16x16x32_bf16 a[76:79], a[196:199], v[172:175], a[76:79]
s_waitcnt lgkmcnt(3)
s_add_u32 s51, s51, 8192
ds_read_b128 a[180:183], v14 offset:7168
v_mfma_f32_16x16x32_bf16 a[76:79], a[192:195], v[164:167], a[76:79]
s_waitcnt vmcnt(37)
v_mfma_f32_16x16x32_bf16 a[0:3], a[160:163], v[176:179], a[0:3]
ds_read_b128 a[184:187], v14 offset:3072
v_mfma_f32_16x16x32_bf16 a[0:3], a[164:167], v[184:187], a[0:3]
s_add_u32 m0, s52, 0
v_mfma_f32_16x16x32_bf16 a[4:7], a[164:167], v[188:191], a[4:7]
s_waitcnt lgkmcnt(3)
ds_read_b128 a[188:191], v14 offset:8192
v_mfma_f32_16x16x32_bf16 a[4:7], a[160:163], v[180:183], a[4:7]
buffer_load_dwordx4 v3, s[12:15], s50 offen offset:0 sc1 lds
v_mfma_f32_16x16x32_bf16 a[8:11], a[168:171], v[176:179], a[8:11]
ds_read_b128 a[192:195], v14 offset:4096
v_mfma_f32_16x16x32_bf16 a[8:11], a[172:175], v[184:187], a[8:11]
v_mfma_f32_16x16x32_bf16 a[12:15], a[172:175], v[188:191], a[12:15]
s_waitcnt lgkmcnt(3)
ds_read_b128 a[196:199], v14 offset:9216
v_mfma_f32_16x16x32_bf16 a[12:15], a[168:171], v[180:183], a[12:15]
buffer_load_dwordx4 v3, s[12:15], s50 offen offset:1024 sc1 lds
v_mfma_f32_16x16x32_bf16 a[16:19], a[176:179], v[176:179], a[16:19]
ds_read_b128 a[160:163], v14 offset:10240
v_mfma_f32_16x16x32_bf16 a[16:19], a[180:183], v[184:187], a[16:19]
v_mfma_f32_16x16x32_bf16 a[20:23], a[180:183], v[188:191], a[20:23]
s_waitcnt lgkmcnt(3)
ds_read_b128 a[164:167], v14 offset:15360
v_mfma_f32_16x16x32_bf16 a[20:23], a[176:179], v[180:183], a[20:23]
buffer_load_dwordx4 v3, s[12:15], s50 offen offset:2048 sc1 lds
v_mfma_f32_16x16x32_bf16 a[24:27], a[184:187], v[176:179], a[24:27]
ds_read_b128 a[168:171], v14 offset:11264
v_mfma_f32_16x16x32_bf16 a[24:27], a[188:191], v[184:187], a[24:27]
v_mfma_f32_16x16x32_bf16 a[28:31], a[188:191], v[188:191], a[28:31]
s_waitcnt lgkmcnt(3)
ds_read_b128 a[172:175], v14 offset:16384
v_mfma_f32_16x16x32_bf16 a[28:31], a[184:187], v[180:183], a[28:31]
buffer_load_dwordx4 v3, s[12:15], s50 offen offset:3072 sc1 lds
v_mfma_f32_16x16x32_bf16 a[32:35], a[192:195], v[176:179], a[32:35]
ds_read_b128 a[176:179], v14 offset:12288
v_mfma_f32_16x16x32_bf16 a[32:35], a[196:199], v[184:187], a[32:35]
s_add_u32 m0, s52, 1024
v_mfma_f32_16x16x32_bf16 a[36:39], a[196:199], v[188:191], a[36:39]
s_waitcnt lgkmcnt(3)
ds_read_b128 a[180:183], v14 offset:17408
v_mfma_f32_16x16x32_bf16 a[36:39], a[192:195], v[180:183], a[36:39]
buffer_load_dwordx4 v1, s[12:15], s50 offen offset:3072 sc1 lds
v_mfma_f32_16x16x32_bf16 a[40:43], a[160:163], v[176:179], a[40:43]
ds_read_b128 a[184:187], v14 offset:13312
v_mfma_f32_16x16x32_bf16 a[40:43], a[164:167], v[184:187], a[40:43]
s_add_u32 s50, s50, 10240
v_mfma_f32_16x16x32_bf16 a[44:47], a[164:167], v[188:191], a[44:47]
s_waitcnt lgkmcnt(3)
ds_read_b128 a[188:191], v14 offset:18432
v_mfma_f32_16x16x32_bf16 a[44:47], a[160:163], v[180:183], a[44:47]
buffer_load_dwordx4 v[192:195], v15, s[24:27], s51 offen sc1
v_mfma_f32_16x16x32_bf16 a[48:51], a[168:171], v[176:179], a[48:51]
ds_read_b128 a[192:195], v14 offset:14336
v_mfma_f32_16x16x32_bf16 a[48:51], a[172:175], v[184:187], a[48:51]
s_waitcnt lgkmcnt(3)
v_mfma_f32_16x16x32_bf16 a[52:55], a[172:175], v[188:191], a[52:55]
s_waitcnt vmcnt(28)
ds_read_b128 a[196:199], v14 offset:19456
v_mfma_f32_16x16x32_bf16 a[52:55], a[168:171], v[180:183], a[52:55]
s_barrier
v_mfma_f32_16x16x32_bf16 a[56:59], a[176:179], v[176:179], a[56:59]
ds_read_b128 a[160:163], v14 offset:20480
v_mfma_f32_16x16x32_bf16 a[56:59], a[180:183], v[184:187], a[56:59]
buffer_load_dwordx4 v[196:199], v16, s[24:27], s51 offen sc1
v_mfma_f32_16x16x32_bf16 a[60:63], a[180:183], v[188:191], a[60:63]
s_waitcnt lgkmcnt(3)
ds_read_b128 a[164:167], v14 offset:25600
v_mfma_f32_16x16x32_bf16 a[60:63], a[176:179], v[180:183], a[60:63]
v_mfma_f32_16x16x32_bf16 a[64:67], a[184:187], v[176:179], a[64:67]
ds_read_b128 a[168:171], v14 offset:21504
v_mfma_f32_16x16x32_bf16 a[64:67], a[188:191], v[184:187], a[64:67]
buffer_load_dwordx4 v[200:203], v17, s[24:27], s51 offen sc1
v_mfma_f32_16x16x32_bf16 a[68:71], a[188:191], v[188:191], a[68:71]
s_waitcnt lgkmcnt(3)
ds_read_b128 a[172:175], v14 offset:26624
v_mfma_f32_16x16x32_bf16 a[68:71], a[184:187], v[180:183], a[68:71]
v_mfma_f32_16x16x32_bf16 a[72:75], a[192:195], v[176:179], a[72:75]
ds_read_b128 a[176:179], v14 offset:22528
v_mfma_f32_16x16x32_bf16 a[72:75], a[196:199], v[184:187], a[72:75]
buffer_load_dwordx4 v[204:207], v18, s[24:27], s51 offen sc1
v_mfma_f32_16x16x32_bf16 a[76:79], a[196:199], v[188:191], a[76:79]
s_waitcnt lgkmcnt(3)
s_add_u32 s51, s51, 8192
ds_read_b128 a[180:183], v14 offset:27648
v_mfma_f32_16x16x32_bf16 a[76:79], a[192:195], v[180:183], a[76:79]
s_waitcnt vmcnt(36)
v_mfma_f32_16x16x32_bf16 a[0:3], a[160:163], v[44:47], a[0:3]
ds_read_b128 a[184:187], v14 offset:23552
v_mfma_f32_16x16x32_bf16 a[0:3], a[164:167], v[52:55], a[0:3]
s_add_u32 m0, s52, 20480
v_mfma_f32_16x16x32_bf16 a[4:7], a[164:167], v[56:59], a[4:7]
s_waitcnt lgkmcnt(3)
ds_read_b128 a[188:191], v14 offset:28672
v_mfma_f32_16x16x32_bf16 a[4:7], a[160:163], v[48:51], a[4:7]
buffer_load_dwordx4 v3, s[12:15], s50 offen offset:0 sc1 lds
v_mfma_f32_16x16x32_bf16 a[8:11], a[168:171], v[44:47], a[8:11]
ds_read_b128 a[192:195], v14 offset:24576
v_mfma_f32_16x16x32_bf16 a[8:11], a[172:175], v[52:55], a[8:11]
v_mfma_f32_16x16x32_bf16 a[12:15], a[172:175], v[56:59], a[12:15]
s_waitcnt lgkmcnt(3)
ds_read_b128 a[196:199], v14 offset:29696
v_mfma_f32_16x16x32_bf16 a[12:15], a[168:171], v[48:51], a[12:15]
buffer_load_dwordx4 v3, s[12:15], s50 offen offset:1024 sc1 lds
v_mfma_f32_16x16x32_bf16 a[16:19], a[176:179], v[44:47], a[16:19]
ds_read_b128 a[160:163], v14 offset:30720
v_mfma_f32_16x16x32_bf16 a[16:19], a[180:183], v[52:55], a[16:19]
v_mfma_f32_16x16x32_bf16 a[20:23], a[180:183], v[56:59], a[20:23]
s_waitcnt lgkmcnt(3)
ds_read_b128 a[164:167], v14 offset:35840
v_mfma_f32_16x16x32_bf16 a[20:23], a[176:179], v[48:51], a[20:23]
buffer_load_dwordx4 v3, s[12:15], s50 offen offset:2048 sc1 lds
v_mfma_f32_16x16x32_bf16 a[24:27], a[184:187], v[44:47], a[24:27]
ds_read_b128 a[168:171], v14 offset:31744
v_mfma_f32_16x16x32_bf16 a[24:27], a[188:191], v[52:55], a[24:27]
v_mfma_f32_16x16x32_bf16 a[28:31], a[188:191], v[56:59], a[28:31]
s_waitcnt lgkmcnt(3)
ds_read_b128 a[172:175], v14 offset:36864
v_mfma_f32_16x16x32_bf16 a[28:31], a[184:187], v[48:51], a[28:31]
buffer_load_dwordx4 v3, s[12:15], s50 offen offset:3072 sc1 lds
v_mfma_f32_16x16x32_bf16 a[32:35], a[192:195], v[44:47], a[32:35]
ds_read_b128 a[176:179], v14 offset:32768
v_mfma_f32_16x16x32_bf16 a[32:35], a[196:199], v[52:55], a[32:35]
s_add_u32 m0, s52, 21504
v_mfma_f32_16x16x32_bf16 a[36:39], a[196:199], v[56:59], a[36:39]
s_waitcnt lgkmcnt(3)
ds_read_b128 a[180:183], v14 offset:37888
v_mfma_f32_16x16x32_bf16 a[36:39], a[192:195], v[48:51], a[36:39]
buffer_load_dwordx4 v1, s[12:15], s50 offen offset:3072 sc1 lds
v_mfma_f32_16x16x32_bf16 a[40:43], a[160:163], v[44:47], a[40:43]
ds_read_b128 a[184:187], v14 offset:33792
v_mfma_f32_16x16x32_bf16 a[40:43], a[164:167], v[52:55], a[40:43]
s_add_u32 s50, s50, 10240
v_mfma_f32_16x16x32_bf16 a[44:47], a[164:167], v[56:59], a[44:47]
s_waitcnt lgkmcnt(3)
ds_read_b128 a[188:191], v14 offset:38912
v_mfma_f32_16x16x32_bf16 a[44:47], a[160:163], v[48:51], a[44:47]
buffer_load_dwordx4 v[208:211], v15, s[24:27], s51 offen sc1
v_mfma_f32_16x16x32_bf16 a[48:51], a[168:171], v[44:47], a[48:51]
ds_read_b128 a[192:195], v14 offset:34816
v_mfma_f32_16x16x32_bf16 a[48:51], a[172:175], v[52:55], a[48:51]
s_waitcnt lgkmcnt(3)
v_mfma_f32_16x16x32_bf16 a[52:55], a[172:175], v[56:59], a[52:55]
s_waitcnt vmcnt(28)
ds_read_b128 a[196:199], v14 offset:39936
v_mfma_f32_16x16x32_bf16 a[52:55], a[168:171], v[48:51], a[52:55]
s_barrier
v_mfma_f32_16x16x32_bf16 a[56:59], a[176:179], v[44:47], a[56:59]
ds_read_b128 a[160:163], v13 offset:20480
v_mfma_f32_16x16x32_bf16 a[56:59], a[180:183], v[52:55], a[56:59]
buffer_load_dwordx4 v[212:215], v16, s[24:27], s51 offen sc1
v_mfma_f32_16x16x32_bf16 a[60:63], a[180:183], v[56:59], a[60:63]
s_waitcnt lgkmcnt(3)
ds_read_b128 a[164:167], v13 offset:25600
v_mfma_f32_16x16x32_bf16 a[60:63], a[176:179], v[48:51], a[60:63]
v_mfma_f32_16x16x32_bf16 a[64:67], a[184:187], v[44:47], a[64:67]
ds_read_b128 a[168:171], v13 offset:21504
v_mfma_f32_16x16x32_bf16 a[64:67], a[188:191], v[52:55], a[64:67]
buffer_load_dwordx4 v[216:219], v17, s[24:27], s51 offen sc1
v_mfma_f32_16x16x32_bf16 a[68:71], a[188:191], v[56:59], a[68:71]
s_waitcnt lgkmcnt(3)
ds_read_b128 a[172:175], v13 offset:26624
v_mfma_f32_16x16x32_bf16 a[68:71], a[184:187], v[48:51], a[68:71]
v_mfma_f32_16x16x32_bf16 a[72:75], a[192:195], v[44:47], a[72:75]
ds_read_b128 a[176:179], v13 offset:22528
v_mfma_f32_16x16x32_bf16 a[72:75], a[196:199], v[52:55], a[72:75]
buffer_load_dwordx4 v[220:223], v18, s[24:27], s51 offen sc1
v_mfma_f32_16x16x32_bf16 a[76:79], a[196:199], v[56:59], a[76:79]
s_waitcnt lgkmcnt(3)
s_mul_i32 s51, s86, 24576
ds_read_b128 a[180:183], v13 offset:27648
v_mfma_f32_16x16x32_bf16 a[76:79], a[192:195], v[48:51], a[76:79]
s_waitcnt vmcnt(36)
v_mfma_f32_16x16x32_bf16 a[0:3], a[160:163], a[224:227], a[0:3]
ds_read_b128 a[184:187], v13 offset:23552
v_mfma_f32_16x16x32_bf16 a[0:3], a[164:167], a[232:235], a[0:3]
s_add_u32 m0, s52, 40960
v_mfma_f32_16x16x32_bf16 a[4:7], a[164:167], a[236:239], a[4:7]
s_waitcnt lgkmcnt(3)
ds_read_b128 a[188:191], v13 offset:28672
v_mfma_f32_16x16x32_bf16 a[4:7], a[160:163], a[228:231], a[4:7]
buffer_load_dwordx4 v3, s[12:15], s50 offen offset:0 sc1 lds
v_mfma_f32_16x16x32_bf16 a[8:11], a[168:171], a[224:227], a[8:11]
ds_read_b128 a[192:195], v13 offset:24576
v_mfma_f32_16x16x32_bf16 a[8:11], a[172:175], a[232:235], a[8:11]
v_mfma_f32_16x16x32_bf16 a[12:15], a[172:175], a[236:239], a[12:15]
s_waitcnt lgkmcnt(3)
ds_read_b128 a[196:199], v13 offset:29696
v_mfma_f32_16x16x32_bf16 a[12:15], a[168:171], a[228:231], a[12:15]
buffer_load_dwordx4 v3, s[12:15], s50 offen offset:1024 sc1 lds
v_mfma_f32_16x16x32_bf16 a[16:19], a[176:179], a[224:227], a[16:19]
ds_read_b128 a[160:163], v13 offset:30720
v_mfma_f32_16x16x32_bf16 a[16:19], a[180:183], a[232:235], a[16:19]
v_mfma_f32_16x16x32_bf16 a[20:23], a[180:183], a[236:239], a[20:23]
s_waitcnt lgkmcnt(3)
ds_read_b128 a[164:167], v13 offset:35840
v_mfma_f32_16x16x32_bf16 a[20:23], a[176:179], a[228:231], a[20:23]
buffer_load_dwordx4 v3, s[12:15], s50 offen offset:2048 sc1 lds
v_mfma_f32_16x16x32_bf16 a[24:27], a[184:187], a[224:227], a[24:27]
ds_read_b128 a[168:171], v13 offset:31744
v_mfma_f32_16x16x32_bf16 a[24:27], a[188:191], a[232:235], a[24:27]
v_mfma_f32_16x16x32_bf16 a[28:31], a[188:191], a[236:239], a[28:31]
s_waitcnt lgkmcnt(3)
ds_read_b128 a[172:175], v13 offset:36864
v_mfma_f32_16x16x32_bf16 a[28:31], a[184:187], a[228:231], a[28:31]
buffer_load_dwordx4 v3, s[12:15], s50 offen offset:3072 sc1 lds
v_mfma_f32_16x16x32_bf16 a[32:35], a[192:195], a[224:227], a[32:35]
ds_read_b128 a[176:179], v13 offset:32768
v_mfma_f32_16x16x32_bf16 a[32:35], a[196:199], a[232:235], a[32:35]
s_add_u32 m0, s52, 41984
v_mfma_f32_16x16x32_bf16 a[36:39], a[196:199], a[236:239], a[36:39]
s_waitcnt lgkmcnt(3)
ds_read_b128 a[180:183], v13 offset:37888
v_mfma_f32_16x16x32_bf16 a[36:39], a[192:195], a[228:231], a[36:39]
buffer_load_dwordx4 v1, s[12:15], s50 offen offset:3072 sc1 lds
v_mfma_f32_16x16x32_bf16 a[40:43], a[160:163], a[224:227], a[40:43]
s_mul_i32 s50, s86, 30720
ds_read_b128 a[184:187], v13 offset:33792
v_mfma_f32_16x16x32_bf16 a[40:43], a[164:167], a[232:235], a[40:43]
s_add_u32 s50, s50, s68
v_mfma_f32_16x16x32_bf16 a[44:47], a[164:167], a[236:239], a[44:47]
s_waitcnt lgkmcnt(3)
ds_read_b128 a[188:191], v13 offset:38912
v_mfma_f32_16x16x32_bf16 a[44:47], a[160:163], a[228:231], a[44:47]
buffer_load_dwordx4 v[160:163], v15, s[24:27], s51 offen sc1
v_mfma_f32_16x16x32_bf16 a[48:51], a[168:171], a[224:227], a[48:51]
ds_read_b128 a[192:195], v13 offset:34816
v_mfma_f32_16x16x32_bf16 a[48:51], a[172:175], a[232:235], a[48:51]
s_waitcnt lgkmcnt(3)
v_mfma_f32_16x16x32_bf16 a[52:55], a[172:175], a[236:239], a[52:55]
s_waitcnt vmcnt(28)
ds_read_b128 a[196:199], v13 offset:39936
v_mfma_f32_16x16x32_bf16 a[52:55], a[168:171], a[228:231], a[52:55]
s_barrier
v_mfma_f32_16x16x32_bf16 a[56:59], a[176:179], a[224:227], a[56:59]
ds_read_b128 a[160:163], v13 offset:40960
v_mfma_f32_16x16x32_bf16 a[56:59], a[180:183], a[232:235], a[56:59]
buffer_load_dwordx4 v[164:167], v16, s[24:27], s51 offen sc1
v_mfma_f32_16x16x32_bf16 a[60:63], a[180:183], a[236:239], a[60:63]
s_waitcnt lgkmcnt(3)
ds_read_b128 a[164:167], v13 offset:46080
v_mfma_f32_16x16x32_bf16 a[60:63], a[176:179], a[228:231], a[60:63]
v_mfma_f32_16x16x32_bf16 a[64:67], a[184:187], a[224:227], a[64:67]
ds_read_b128 a[168:171], v13 offset:41984
v_mfma_f32_16x16x32_bf16 a[64:67], a[188:191], a[232:235], a[64:67]
buffer_load_dwordx4 v[168:171], v17, s[24:27], s51 offen sc1
v_mfma_f32_16x16x32_bf16 a[68:71], a[188:191], a[236:239], a[68:71]
s_waitcnt lgkmcnt(3)
ds_read_b128 a[172:175], v13 offset:47104
v_mfma_f32_16x16x32_bf16 a[68:71], a[184:187], a[228:231], a[68:71]
v_mfma_f32_16x16x32_bf16 a[72:75], a[192:195], a[224:227], a[72:75]
ds_read_b128 a[176:179], v13 offset:43008
v_mfma_f32_16x16x32_bf16 a[72:75], a[196:199], a[232:235], a[72:75]
buffer_load_dwordx4 v[172:175], v18, s[24:27], s51 offen sc1
v_mfma_f32_16x16x32_bf16 a[76:79], a[196:199], a[236:239], a[76:79]
s_waitcnt lgkmcnt(3)
s_add_u32 s51, s51, 8192
ds_read_b128 a[180:183], v13 offset:48128
v_mfma_f32_16x16x32_bf16 a[76:79], a[192:195], a[228:231], a[76:79]
s_waitcnt vmcnt(36)
v_mfma_f32_16x16x32_bf16 a[0:3], a[160:163], a[240:243], a[0:3]
ds_read_b128 a[184:187], v13 offset:44032
v_mfma_f32_16x16x32_bf16 a[0:3], a[164:167], a[248:251], a[0:3]
s_add_u32 m0, s52, 61440
v_mfma_f32_16x16x32_bf16 a[4:7], a[164:167], a[252:255], a[4:7]
s_waitcnt lgkmcnt(3)
ds_read_b128 a[188:191], v13 offset:49152
v_mfma_f32_16x16x32_bf16 a[4:7], a[160:163], a[244:247], a[4:7]
buffer_load_dwordx4 v3, s[12:15], s50 offen offset:0 sc1 lds
v_mfma_f32_16x16x32_bf16 a[8:11], a[168:171], a[240:243], a[8:11]
ds_read_b128 a[192:195], v13 offset:45056
v_mfma_f32_16x16x32_bf16 a[8:11], a[172:175], a[248:251], a[8:11]
v_mfma_f32_16x16x32_bf16 a[12:15], a[172:175], a[252:255], a[12:15]
s_waitcnt lgkmcnt(3)
ds_read_b128 a[196:199], v13 offset:50176
v_mfma_f32_16x16x32_bf16 a[12:15], a[168:171], a[244:247], a[12:15]
buffer_load_dwordx4 v3, s[12:15], s50 offen offset:1024 sc1 lds
v_mfma_f32_16x16x32_bf16 a[16:19], a[176:179], a[240:243], a[16:19]
ds_read_b128 a[160:163], v13 offset:51200
v_mfma_f32_16x16x32_bf16 a[16:19], a[180:183], a[248:251], a[16:19]
v_mfma_f32_16x16x32_bf16 a[20:23], a[180:183], a[252:255], a[20:23]
s_waitcnt lgkmcnt(3)
ds_read_b128 a[164:167], v13 offset:56320
v_mfma_f32_16x16x32_bf16 a[20:23], a[176:179], a[244:247], a[20:23]
buffer_load_dwordx4 v3, s[12:15], s50 offen offset:2048 sc1 lds
v_mfma_f32_16x16x32_bf16 a[24:27], a[184:187], a[240:243], a[24:27]
ds_read_b128 a[168:171], v13 offset:52224
v_mfma_f32_16x16x32_bf16 a[24:27], a[188:191], a[248:251], a[24:27]
v_mfma_f32_16x16x32_bf16 a[28:31], a[188:191], a[252:255], a[28:31]
s_waitcnt lgkmcnt(3)
ds_read_b128 a[172:175], v13 offset:57344
v_mfma_f32_16x16x32_bf16 a[28:31], a[184:187], a[244:247], a[28:31]
buffer_load_dwordx4 v3, s[12:15], s50 offen offset:3072 sc1 lds
v_mfma_f32_16x16x32_bf16 a[32:35], a[192:195], a[240:243], a[32:35]
ds_read_b128 a[176:179], v13 offset:53248
v_mfma_f32_16x16x32_bf16 a[32:35], a[196:199], a[248:251], a[32:35]
s_add_u32 m0, s52, 62464
v_mfma_f32_16x16x32_bf16 a[36:39], a[196:199], a[252:255], a[36:39]
s_waitcnt lgkmcnt(3)
ds_read_b128 a[180:183], v13 offset:58368
v_mfma_f32_16x16x32_bf16 a[36:39], a[192:195], a[244:247], a[36:39]
buffer_load_dwordx4 v1, s[12:15], s50 offen offset:3072 sc1 lds
v_mfma_f32_16x16x32_bf16 a[40:43], a[160:163], a[240:243], a[40:43]
ds_read_b128 a[184:187], v13 offset:54272
v_mfma_f32_16x16x32_bf16 a[40:43], a[164:167], a[248:251], a[40:43]
s_add_u32 s50, s50, 10240
v_mfma_f32_16x16x32_bf16 a[44:47], a[164:167], a[252:255], a[44:47]
s_waitcnt lgkmcnt(3)
ds_read_b128 a[188:191], v13 offset:59392
v_mfma_f32_16x16x32_bf16 a[44:47], a[160:163], a[244:247], a[44:47]
buffer_load_dwordx4 v[176:179], v15, s[24:27], s51 offen sc1
v_mfma_f32_16x16x32_bf16 a[48:51], a[168:171], a[240:243], a[48:51]
ds_read_b128 a[192:195], v13 offset:55296
v_mfma_f32_16x16x32_bf16 a[48:51], a[172:175], a[248:251], a[48:51]
s_waitcnt lgkmcnt(3)
v_mfma_f32_16x16x32_bf16 a[52:55], a[172:175], a[252:255], a[52:55]
s_waitcnt vmcnt(28)
ds_read_b128 a[196:199], v13 offset:60416
v_mfma_f32_16x16x32_bf16 a[52:55], a[168:171], a[244:247], a[52:55]
s_barrier
v_mfma_f32_16x16x32_bf16 a[56:59], a[176:179], a[240:243], a[56:59]
ds_read_b128 a[160:163], v12 offset:0
v_mfma_f32_16x16x32_bf16 a[56:59], a[180:183], a[248:251], a[56:59]
buffer_load_dwordx4 v[180:183], v16, s[24:27], s51 offen sc1
v_mfma_f32_16x16x32_bf16 a[60:63], a[180:183], a[252:255], a[60:63]
s_waitcnt lgkmcnt(3)
ds_read_b128 a[164:167], v12 offset:5120
v_mfma_f32_16x16x32_bf16 a[60:63], a[176:179], a[244:247], a[60:63]
v_mfma_f32_16x16x32_bf16 a[64:67], a[184:187], a[240:243], a[64:67]
ds_read_b128 a[168:171], v12 offset:1024
v_mfma_f32_16x16x32_bf16 a[64:67], a[188:191], a[248:251], a[64:67]
buffer_load_dwordx4 v[184:187], v17, s[24:27], s51 offen sc1
v_mfma_f32_16x16x32_bf16 a[68:71], a[188:191], a[252:255], a[68:71]
s_waitcnt lgkmcnt(3)
ds_read_b128 a[172:175], v12 offset:6144
v_mfma_f32_16x16x32_bf16 a[68:71], a[184:187], a[244:247], a[68:71]
v_mfma_f32_16x16x32_bf16 a[72:75], a[192:195], a[240:243], a[72:75]
ds_read_b128 a[176:179], v12 offset:2048
v_mfma_f32_16x16x32_bf16 a[72:75], a[196:199], a[248:251], a[72:75]
buffer_load_dwordx4 v[188:191], v18, s[24:27], s51 offen sc1
v_mfma_f32_16x16x32_bf16 a[76:79], a[196:199], a[252:255], a[76:79]
s_waitcnt lgkmcnt(3)
s_add_u32 s51, s51, 8192
ds_read_b128 a[180:183], v12 offset:7168
v_mfma_f32_16x16x32_bf16 a[76:79], a[192:195], a[244:247], a[76:79]
s_waitcnt vmcnt(36)
v_mfma_f32_16x16x32_bf16 a[0:3], a[160:163], v[224:227], a[0:3]
ds_read_b128 a[184:187], v12 offset:3072
v_mfma_f32_16x16x32_bf16 a[0:3], a[164:167], v[232:235], a[0:3]
buffer_load_dwordx2 v[248:249], v60, s[56:59], s19 offen sc1
v_mfma_f32_16x16x32_bf16 a[4:7], a[164:167], v[236:239], a[4:7]
s_waitcnt lgkmcnt(3)
ds_read_b128 a[188:191], v12 offset:8192
v_mfma_f32_16x16x32_bf16 a[4:7], a[160:163], v[228:231], a[4:7]
v_mfma_f32_16x16x32_bf16 a[8:11], a[168:171], v[224:227], a[8:11]
s_add_u32 m0, s52, 122880
ds_read_b128 a[192:195], v12 offset:4096
v_mfma_f32_16x16x32_bf16 a[8:11], a[172:175], v[232:235], a[8:11]
buffer_load_dwordx4 v3, s[12:15], s50 offen offset:0 sc1 lds
v_mfma_f32_16x16x32_bf16 a[12:15], a[172:175], v[236:239], a[12:15]
s_waitcnt lgkmcnt(3)
ds_read_b128 a[196:199], v12 offset:9216
v_mfma_f32_16x16x32_bf16 a[12:15], a[168:171], v[228:231], a[12:15]
v_mfma_f32_16x16x32_bf16 a[16:19], a[176:179], v[224:227], a[16:19]
ds_read_b128 a[160:163], v12 offset:10240
v_mfma_f32_16x16x32_bf16 a[16:19], a[180:183], v[232:235], a[16:19]
buffer_load_dwordx4 v3, s[12:15], s50 offen offset:1024 sc1 lds
v_mfma_f32_16x16x32_bf16 a[20:23], a[180:183], v[236:239], a[20:23]
s_waitcnt lgkmcnt(3)
ds_read_b128 a[164:167], v12 offset:15360
v_mfma_f32_16x16x32_bf16 a[20:23], a[176:179], v[228:231], a[20:23]
v_mfma_f32_16x16x32_bf16 a[24:27], a[184:187], v[224:227], a[24:27]
ds_read_b128 a[168:171], v12 offset:11264
v_mfma_f32_16x16x32_bf16 a[24:27], a[188:191], v[232:235], a[24:27]
buffer_load_dwordx4 v3, s[12:15], s50 offen offset:2048 sc1 lds
v_mfma_f32_16x16x32_bf16 a[28:31], a[188:191], v[236:239], a[28:31]
s_waitcnt lgkmcnt(3)
ds_read_b128 a[172:175], v12 offset:16384
v_mfma_f32_16x16x32_bf16 a[28:31], a[184:187], v[228:231], a[28:31]
v_mfma_f32_16x16x32_bf16 a[32:35], a[192:195], v[224:227], a[32:35]
ds_read_b128 a[176:179], v12 offset:12288
v_mfma_f32_16x16x32_bf16 a[32:35], a[196:199], v[232:235], a[32:35]
buffer_load_dwordx4 v3, s[12:15], s50 offen offset:3072 sc1 lds
v_mfma_f32_16x16x32_bf16 a[36:39], a[196:199], v[236:239], a[36:39]
s_waitcnt lgkmcnt(3)
s_add_u32 m0, s52, 123904
ds_read_b128 a[180:183], v12 offset:17408
v_mfma_f32_16x16x32_bf16 a[36:39], a[192:195], v[228:231], a[36:39]
buffer_load_dwordx4 v1, s[12:15], s50 offen offset:3072 sc1 lds
v_mfma_f32_16x16x32_bf16 a[40:43], a[160:163], v[224:227], a[40:43]
ds_read_b128 a[184:187], v12 offset:13312
v_mfma_f32_16x16x32_bf16 a[40:43], a[164:167], v[232:235], a[40:43]
s_add_u32 s50, s50, 10240
v_mfma_f32_16x16x32_bf16 a[44:47], a[164:167], v[236:239], a[44:47]
s_waitcnt lgkmcnt(3)
ds_read_b128 a[188:191], v12 offset:18432
v_mfma_f32_16x16x32_bf16 a[44:47], a[160:163], v[228:231], a[44:47]
buffer_load_dwordx4 v[44:47], v15, s[24:27], s51 offen sc1
v_mfma_f32_16x16x32_bf16 a[48:51], a[168:171], v[224:227], a[48:51]
ds_read_b128 a[192:195], v12 offset:14336
v_mfma_f32_16x16x32_bf16 a[48:51], a[172:175], v[232:235], a[48:51]
s_waitcnt lgkmcnt(3)
v_mfma_f32_16x16x32_bf16 a[52:55], a[172:175], v[236:239], a[52:55]
s_waitcnt vmcnt(29)
ds_read_b128 a[196:199], v12 offset:19456
v_mfma_f32_16x16x32_bf16 a[52:55], a[168:171], v[228:231], a[52:55]
s_barrier
v_mfma_f32_16x16x32_bf16 a[56:59], a[176:179], v[224:227], a[56:59]
ds_read_b128 a[160:163], v12 offset:20480
v_mfma_f32_16x16x32_bf16 a[56:59], a[180:183], v[232:235], a[56:59]
buffer_load_dwordx4 v[48:51], v16, s[24:27], s51 offen sc1
v_mfma_f32_16x16x32_bf16 a[60:63], a[180:183], v[236:239], a[60:63]
s_waitcnt lgkmcnt(3)
ds_read_b128 a[164:167], v12 offset:25600
v_mfma_f32_16x16x32_bf16 a[60:63], a[176:179], v[228:231], a[60:63]
v_mfma_f32_16x16x32_bf16 a[64:67], a[184:187], v[224:227], a[64:67]
ds_read_b128 a[168:171], v12 offset:21504
v_mfma_f32_16x16x32_bf16 a[64:67], a[188:191], v[232:235], a[64:67]
buffer_load_dwordx4 v[52:55], v17, s[24:27], s51 offen sc1
v_mfma_f32_16x16x32_bf16 a[68:71], a[188:191], v[236:239], a[68:71]
s_waitcnt lgkmcnt(3)
ds_read_b128 a[172:175], v12 offset:26624
v_mfma_f32_16x16x32_bf16 a[68:71], a[184:187], v[228:231], a[68:71]
v_mfma_f32_16x16x32_bf16 a[72:75], a[192:195], v[224:227], a[72:75]
ds_read_b128 a[176:179], v12 offset:22528
v_mfma_f32_16x16x32_bf16 a[72:75], a[196:199], v[232:235], a[72:75]
buffer_load_dwordx4 v[56:59], v18, s[24:27], s51 offen sc1
v_mfma_f32_16x16x32_bf16 a[76:79], a[196:199], v[236:239], a[76:79]
s_waitcnt lgkmcnt(3)
s_mul_i32 s51, s87, 24576
ds_read_b128 a[180:183], v12 offset:27648
v_mfma_f32_16x16x32_bf16 a[76:79], a[192:195], v[228:231], a[76:79]
s_waitcnt vmcnt(37)
s_waitcnt vmcnt(9)
v_cmp_ne_u64 vcc, v[26:27], v[248:249]
s_cmp_eq_u64 vcc, 0
s_cselect_b32 s18, 0, 0x10000000
v_mfma_f32_16x16x32_bf16 a[0:3], a[160:163], v[192:195], a[0:3]
s_add_u32 m0, s52, 143360
ds_read_b128 a[184:187], v12 offset:23552
v_mfma_f32_16x16x32_bf16 a[0:3], a[164:167], v[200:203], a[0:3]
buffer_load_dwordx4 v3, s[12:15], s50 offen offset:0 sc1 lds
v_mfma_f32_16x16x32_bf16 a[4:7], a[164:167], v[204:207], a[4:7]
s_waitcnt lgkmcnt(3)
ds_read_b128 a[188:191], v12 offset:28672
v_mfma_f32_16x16x32_bf16 a[4:7], a[160:163], v[196:199], a[4:7]
buffer_load_dwordx4 v3, s[12:15], s50 offen offset:1024 sc1 lds
v_mfma_f32_16x16x32_bf16 a[8:11], a[168:171], v[192:195], a[8:11]
ds_read_b128 a[192:195], v12 offset:24576
v_mfma_f32_16x16x32_bf16 a[8:11], a[172:175], v[200:203], a[8:11]
v_mfma_f32_16x16x32_bf16 a[12:15], a[172:175], v[204:207], a[12:15]
s_waitcnt lgkmcnt(3)
ds_read_b128 a[196:199], v12 offset:29696
v_mfma_f32_16x16x32_bf16 a[12:15], a[168:171], v[196:199], a[12:15]
buffer_load_dwordx4 v3, s[12:15], s50 offen offset:2048 sc1 lds
v_mfma_f32_16x16x32_bf16 a[16:19], a[176:179], v[192:195], a[16:19]
ds_read_b128 a[160:163], v12 offset:30720
v_mfma_f32_16x16x32_bf16 a[16:19], a[180:183], v[200:203], a[16:19]
buffer_load_dwordx4 v3, s[12:15], s50 offen offset:3072 sc1 lds
v_mfma_f32_16x16x32_bf16 a[20:23], a[180:183], v[204:207], a[20:23]
s_waitcnt lgkmcnt(3)
s_add_u32 m0, s52, 144384
ds_read_b128 a[164:167], v12 offset:35840
v_mfma_f32_16x16x32_bf16 a[20:23], a[176:179], v[196:199], a[20:23]
buffer_load_dwordx4 v1, s[12:15], s50 offen offset:3072 sc1 lds
v_mfma_f32_16x16x32_bf16 a[24:27], a[184:187], v[192:195], a[24:27]
s_mul_i32 s50, s87, 30720
ds_read_b128 a[168:171], v12 offset:31744
v_mfma_f32_16x16x32_bf16 a[24:27], a[188:191], v[200:203], a[24:27]
s_add_u32 s50, s50, s68
s_mul_i32 s40, s39, 61440
s_add_u32 s40, s40, s54
s_add_u32 s40, s40, 10240
s_add_u32 s40, s40, s18
v_mfma_f32_16x16x32_bf16 a[28:31], a[188:191], v[204:207], a[28:31]
s_waitcnt lgkmcnt(3)
ds_read_b128 a[172:175], v12 offset:36864
v_mfma_f32_16x16x32_bf16 a[28:31], a[184:187], v[196:199], a[28:31]
buffer_load_dwordx4 v[64:67], v3, s[20:23], s40 offen sc1
v_mfma_f32_16x16x32_bf16 a[32:35], a[192:195], v[192:195], a[32:35]
ds_read_b128 a[176:179], v12 offset:32768
v_mfma_f32_16x16x32_bf16 a[32:35], a[196:199], v[200:203], a[32:35]
buffer_load_dwordx4 v[68:71], v3, s[20:23], s40 offen offset:1024 sc1
v_mfma_f32_16x16x32_bf16 a[36:39], a[196:199], v[204:207], a[36:39]
s_waitcnt lgkmcnt(3)
ds_read_b128 a[180:183], v12 offset:37888
v_mfma_f32_16x16x32_bf16 a[36:39], a[192:195], v[196:199], a[36:39]
buffer_load_dwordx2 v[72:73], v22, s[20:23], s40 offen offset:2048 sc1
v_mfma_f32_16x16x32_bf16 a[40:43], a[160:163], v[192:195], a[40:43]
s_add_u32 s40, s40, 20480
ds_read_b128 a[184:187], v12 offset:33792
v_mfma_f32_16x16x32_bf16 a[40:43], a[164:167], v[200:203], a[40:43]
buffer_load_dwordx4 v[76:79], v3, s[20:23], s40 offen sc1
v_mfma_f32_16x16x32_bf16 a[44:47], a[164:167], v[204:207], a[44:47]
s_waitcnt lgkmcnt(3)
ds_read_b128 a[188:191], v12 offset:38912
v_mfma_f32_16x16x32_bf16 a[44:47], a[160:163], v[196:199], a[44:47]
v_mfma_f32_16x16x32_bf16 a[48:51], a[168:171], v[192:195], a[48:51]
ds_read_b128 a[192:195], v12 offset:34816
v_mfma_f32_16x16x32_bf16 a[48:51], a[172:175], v[200:203], a[48:51]
s_waitcnt lgkmcnt(3)
buffer_load_dwordx4 v[80:83], v3, s[20:23], s40 offen offset:1024 sc1
v_mfma_f32_16x16x32_bf16 a[52:55], a[172:175], v[204:207], a[52:55]
s_waitcnt vmcnt(33)
ds_read_b128 a[196:199], v12 offset:39936
v_mfma_f32_16x16x32_bf16 a[52:55], a[168:171], v[196:199], a[52:55]
s_barrier
v_mfma_f32_16x16x32_bf16 a[56:59], a[176:179], v[192:195], a[56:59]
ds_read_b128 a[160:163], v12 offset:40960
v_mfma_f32_16x16x32_bf16 a[56:59], a[180:183], v[200:203], a[56:59]
buffer_load_dwordx2 v[84:85], v22, s[20:23], s40 offen offset:2048 sc1
v_mfma_f32_16x16x32_bf16 a[60:63], a[180:183], v[204:207], a[60:63]
s_waitcnt lgkmcnt(3)
s_add_u32 s40, s40, 20480
ds_read_b128 a[164:167], v12 offset:46080
v_mfma_f32_16x16x32_bf16 a[60:63], a[176:179], v[196:199], a[60:63]
buffer_load_dwordx4 v[88:91], v3, s[20:23], s40 offen sc1
v_mfma_f32_16x16x32_bf16 a[64:67], a[184:187], v[192:195], a[64:67]
ds_read_b128 a[168:171], v12 offset:41984
v_mfma_f32_16x16x32_bf16 a[64:67], a[188:191], v[200:203], a[64:67]
v_mfma_f32_16x16x32_bf16 a[68:71], a[188:191], v[204:207], a[68:71]
s_waitcnt lgkmcnt(3)
ds_read_b128 a[172:175], v12 offset:47104
v_mfma_f32_16x16x32_bf16 a[68:71], a[184:187], v[196:199], a[68:71]
buffer_load_dwordx4 v[92:95], v3, s[20:23], s40 offen offset:1024 sc1
v_mfma_f32_16x16x32_bf16 a[72:75], a[192:195], v[192:195], a[72:75]
ds_read_b128 a[176:179], v12 offset:43008
v_mfma_f32_16x16x32_bf16 a[72:75], a[196:199], v[200:203], a[72:75]
buffer_load_dwordx2 v[96:97], v22, s[20:23], s40 offen offset:2048 sc1
v_mfma_f32_16x16x32_bf16 a[76:79], a[196:199], v[204:207], a[76:79]
s_waitcnt lgkmcnt(3)
ds_read_b128 a[180:183], v12 offset:48128
v_mfma_f32_16x16x32_bf16 a[76:79], a[192:195], v[196:199], a[76:79]
s_waitcnt vmcnt(42)
v_mfma_f32_16x16x32_bf16 a[4:7], a[164:167], v[220:223], a[4:7]
ds_read_b128 a[184:187], v12 offset:44032
v_mfma_f32_16x16x32_bf16 a[4:7], a[160:163], v[212:215], a[4:7]
s_waitcnt lgkmcnt(3)
ds_read_b128 a[188:191], v12 offset:49152
v_mfma_f32_16x16x32_bf16 a[12:15], a[172:175], v[220:223], a[12:15]
ds_read_b128 a[192:195], v12 offset:45056
v_mfma_f32_16x16x32_bf16 a[12:15], a[168:171], v[212:215], a[12:15]
s_waitcnt lgkmcnt(3)
ds_read_b128 a[196:199], v12 offset:50176
v_mfma_f32_16x16x32_bf16 a[20:23], a[180:183], v[220:223], a[20:23]
ds_read_b128 a[160:163], v12 offset:51200
v_mfma_f32_16x16x32_bf16 a[20:23], a[176:179], v[212:215], a[20:23]
s_waitcnt lgkmcnt(3)
ds_read_b128 a[164:167], v12 offset:56320
v_mfma_f32_16x16x32_bf16 a[28:31], a[188:191], v[220:223], a[28:31]
ds_read_b128 a[168:171], v12 offset:52224
v_mfma_f32_16x16x32_bf16 a[28:31], a[184:187], v[212:215], a[28:31]
s_waitcnt lgkmcnt(3)
ds_read_b128 a[172:175], v12 offset:57344
v_mfma_f32_16x16x32_bf16 a[36:39], a[196:199], v[220:223], a[36:39]
ds_read_b128 a[176:179], v12 offset:53248
v_mfma_f32_16x16x32_bf16 a[36:39], a[192:195], v[212:215], a[36:39]
s_waitcnt lgkmcnt(3)
ds_read_b128 a[180:183], v12 offset:58368
v_mfma_f32_16x16x32_bf16 a[40:43], a[160:163], v[208:211], a[40:43]
ds_read_b128 a[184:187], v12 offset:54272
v_mfma_f32_16x16x32_bf16 a[40:43], a[164:167], v[216:219], a[40:43]
buffer_load_dwordx2 v[100:101], v4, s[4:7], s53 offen offset:0
v_mfma_f32_16x16x32_bf16 a[44:47], a[164:167], v[220:223], a[44:47]
s_waitcnt lgkmcnt(3)
ds_read_b128 a[188:191], v12 offset:59392
v_mfma_f32_16x16x32_bf16 a[44:47], a[160:163], v[212:215], a[44:47]
v_mfma_f32_16x16x32_bf16 a[48:51], a[168:171], v[208:211], a[48:51]
ds_read_b128 a[192:195], v12 offset:55296
v_mfma_f32_16x16x32_bf16 a[48:51], a[172:175], v[216:219], a[48:51]
s_waitcnt lgkmcnt(3)
buffer_load_dwordx2 v[102:103], v4, s[4:7], s53 offen offset:32
v_mfma_f32_16x16x32_bf16 a[52:55], a[172:175], v[220:223], a[52:55]
s_waitcnt vmcnt(30)
ds_read_b128 a[196:199], v12 offset:60416
v_mfma_f32_16x16x32_bf16 a[52:55], a[168:171], v[212:215], a[52:55]
s_barrier
v_mfma_f32_16x16x32_bf16 a[56:59], a[176:179], v[208:211], a[56:59]
ds_read_b128 a[160:163], v13 offset:0
v_mfma_f32_16x16x32_bf16 a[56:59], a[180:183], v[216:219], a[56:59]
v_mfma_f32_16x16x32_bf16 a[60:63], a[180:183], v[220:223], a[60:63]
s_waitcnt lgkmcnt(3)
ds_read_b128 a[164:167], v13 offset:5120
v_mfma_f32_16x16x32_bf16 a[60:63], a[176:179], v[212:215], a[60:63]
buffer_load_dwordx2 v[104:105], v4, s[4:7], s53 offen offset:64
v_mfma_f32_16x16x32_bf16 a[64:67], a[184:187], v[208:211], a[64:67]
ds_read_b128 a[168:171], v13 offset:1024
v_mfma_f32_16x16x32_bf16 a[64:67], a[188:191], v[216:219], a[64:67]
buffer_load_dwordx2 v[106:107], v4, s[4:7], s53 offen offset:96
v_mfma_f32_16x16x32_bf16 a[68:71], a[188:191], v[220:223], a[68:71]
s_waitcnt lgkmcnt(3)
ds_read_b128 a[172:175], v13 offset:6144
v_mfma_f32_16x16x32_bf16 a[68:71], a[184:187], v[212:215], a[68:71]
v_mfma_f32_16x16x32_bf16 a[72:75], a[192:195], v[208:211], a[72:75]
ds_read_b128 a[176:179], v13 offset:2048
v_mfma_f32_16x16x32_bf16 a[72:75], a[196:199], v[216:219], a[72:75]
buffer_load_dwordx2 v[108:109], v4, s[4:7], s53 offen offset:128
v_mfma_f32_16x16x32_bf16 a[76:79], a[196:199], v[220:223], a[76:79]
s_waitcnt lgkmcnt(3)
ds_read_b128 a[180:183], v13 offset:7168
v_mfma_f32_16x16x32_bf16 a[76:79], a[192:195], v[212:215], a[76:79]
s_waitcnt vmcnt(38)
v_mfma_f32_16x16x32_bf16 a[4:7], a[164:167], v[172:175], a[4:7]
ds_read_b128 a[184:187], v13 offset:3072
v_mfma_f32_16x16x32_bf16 a[4:7], a[160:163], v[164:167], a[4:7]
s_waitcnt lgkmcnt(3)
ds_read_b128 a[188:191], v13 offset:8192
v_mfma_f32_16x16x32_bf16 a[12:15], a[172:175], v[172:175], a[12:15]
ds_read_b128 a[192:195], v13 offset:4096
v_mfma_f32_16x16x32_bf16 a[12:15], a[168:171], v[164:167], a[12:15]
s_waitcnt lgkmcnt(3)
ds_read_b128 a[196:199], v13 offset:9216
v_mfma_f32_16x16x32_bf16 a[20:23], a[180:183], v[172:175], a[20:23]
ds_read_b128 a[160:163], v13 offset:10240
v_mfma_f32_16x16x32_bf16 a[20:23], a[176:179], v[164:167], a[20:23]
s_waitcnt lgkmcnt(3)
ds_read_b128 a[164:167], v13 offset:15360
v_mfma_f32_16x16x32_bf16 a[28:31], a[188:191], v[172:175], a[28:31]
ds_read_b128 a[168:171], v13 offset:11264
v_mfma_f32_16x16x32_bf16 a[28:31], a[184:187], v[164:167], a[28:31]
s_waitcnt lgkmcnt(3)
ds_read_b128 a[172:175], v13 offset:16384
v_mfma_f32_16x16x32_bf16 a[36:39], a[196:199], v[172:175], a[36:39]
ds_read_b128 a[176:179], v13 offset:12288
v_mfma_f32_16x16x32_bf16 a[36:39], a[192:195], v[164:167], a[36:39]
s_waitcnt lgkmcnt(3)
ds_read_b128 a[180:183], v13 offset:17408
v_mfma_f32_16x16x32_bf16 a[40:43], a[160:163], v[160:163], a[40:43]
ds_read_b128 a[184:187], v13 offset:13312
v_mfma_f32_16x16x32_bf16 a[40:43], a[164:167], v[168:171], a[40:43]
v_mfma_f32_16x16x32_bf16 a[44:47], a[164:167], v[172:175], a[44:47]
s_waitcnt lgkmcnt(3)
ds_read_b128 a[188:191], v13 offset:18432
v_mfma_f32_16x16x32_bf16 a[44:47], a[160:163], v[164:167], a[44:47]
v_mfma_f32_16x16x32_bf16 a[48:51], a[168:171], v[160:163], a[48:51]
ds_read_b128 a[192:195], v13 offset:14336
v_mfma_f32_16x16x32_bf16 a[48:51], a[172:175], v[168:171], a[48:51]
s_waitcnt lgkmcnt(3)
v_mfma_f32_16x16x32_bf16 a[52:55], a[172:175], v[172:175], a[52:55]
s_waitcnt vmcnt(23)
ds_read_b128 a[196:199], v13 offset:19456
v_mfma_f32_16x16x32_bf16 a[52:55], a[168:171], v[164:167], a[52:55]
s_barrier
v_mfma_f32_16x16x32_bf16 a[56:59], a[176:179], v[160:163], a[56:59]
ds_read_b128 a[160:163], v14 offset:0
v_mfma_f32_16x16x32_bf16 a[56:59], a[180:183], v[168:171], a[56:59]
v_mfma_f32_16x16x32_bf16 a[60:63], a[180:183], v[172:175], a[60:63]
s_waitcnt lgkmcnt(3)
ds_read_b128 a[164:167], v14 offset:5120
v_mfma_f32_16x16x32_bf16 a[60:63], a[176:179], v[164:167], a[60:63]
v_mfma_f32_16x16x32_bf16 a[64:67], a[184:187], v[160:163], a[64:67]
ds_read_b128 a[168:171], v14 offset:1024
v_mfma_f32_16x16x32_bf16 a[64:67], a[188:191], v[168:171], a[64:67]
v_mfma_f32_16x16x32_bf16 a[68:71], a[188:191], v[172:175], a[68:71]
s_waitcnt lgkmcnt(3)
ds_read_b128 a[172:175], v14 offset:6144
v_mfma_f32_16x16x32_bf16 a[68:71], a[184:187], v[164:167], a[68:71]
v_mfma_f32_16x16x32_bf16 a[72:75], a[192:195], v[160:163], a[72:75]
ds_read_b128 a[176:179], v14 offset:2048
v_mfma_f32_16x16x32_bf16 a[72:75], a[196:199], v[168:171], a[72:75]
v_mfma_f32_16x16x32_bf16 a[76:79], a[196:199], v[172:175], a[76:79]
s_waitcnt lgkmcnt(3)
ds_read_b128 a[180:183], v14 offset:7168
v_mfma_f32_16x16x32_bf16 a[76:79], a[192:195], v[164:167], a[76:79]
s_waitcnt vmcnt(29)
v_mfma_f32_16x16x32_bf16 a[4:7], a[164:167], v[188:191], a[4:7]
ds_read_b128 a[184:187], v14 offset:3072
v_mfma_f32_16x16x32_bf16 a[4:7], a[160:163], v[180:183], a[4:7]
s_waitcnt lgkmcnt(3)
ds_read_b128 a[188:191], v14 offset:8192
v_mfma_f32_16x16x32_bf16 a[12:15], a[172:175], v[188:191], a[12:15]
ds_read_b128 a[192:195], v14 offset:4096
v_mfma_f32_16x16x32_bf16 a[12:15], a[168:171], v[180:183], a[12:15]
s_waitcnt lgkmcnt(3)
ds_read_b128 a[196:199], v14 offset:9216
v_mfma_f32_16x16x32_bf16 a[20:23], a[180:183], v[188:191], a[20:23]
ds_read_b128 a[160:163], v14 offset:10240
v_mfma_f32_16x16x32_bf16 a[20:23], a[176:179], v[180:183], a[20:23]
s_waitcnt lgkmcnt(3)
ds_read_b128 a[164:167], v14 offset:15360
v_mfma_f32_16x16x32_bf16 a[28:31], a[188:191], v[188:191], a[28:31]
ds_read_b128 a[168:171], v14 offset:11264
v_mfma_f32_16x16x32_bf16 a[28:31], a[184:187], v[180:183], a[28:31]
s_waitcnt lgkmcnt(3)
ds_read_b128 a[172:175], v14 offset:16384
v_mfma_f32_16x16x32_bf16 a[36:39], a[196:199], v[188:191], a[36:39]
ds_read_b128 a[176:179], v14 offset:12288
v_mfma_f32_16x16x32_bf16 a[36:39], a[192:195], v[180:183], a[36:39]
s_waitcnt lgkmcnt(3)
ds_read_b128 a[180:183], v14 offset:17408
v_mfma_f32_16x16x32_bf16 a[40:43], a[160:163], v[176:179], a[40:43]
ds_read_b128 a[184:187], v14 offset:13312
v_mfma_f32_16x16x32_bf16 a[40:43], a[164:167], v[184:187], a[40:43]
v_mfma_f32_16x16x32_bf16 a[44:47], a[164:167], v[188:191], a[44:47]
s_waitcnt lgkmcnt(3)
ds_read_b128 a[188:191], v14 offset:18432
v_mfma_f32_16x16x32_bf16 a[44:47], a[160:163], v[180:183], a[44:47]
v_mfma_f32_16x16x32_bf16 a[48:51], a[168:171], v[176:179], a[48:51]
ds_read_b128 a[192:195], v14 offset:14336
v_mfma_f32_16x16x32_bf16 a[48:51], a[172:175], v[184:187], a[48:51]
s_waitcnt lgkmcnt(3)
v_mfma_f32_16x16x32_bf16 a[52:55], a[172:175], v[188:191], a[52:55]
s_waitcnt vmcnt(14)
ds_read_b128 a[196:199], v14 offset:19456
v_mfma_f32_16x16x32_bf16 a[52:55], a[168:171], v[180:183], a[52:55]
s_barrier
v_mfma_f32_16x16x32_bf16 a[56:59], a[176:179], v[176:179], a[56:59]
ds_read_b128 a[160:163], v14 offset:20480
v_mfma_f32_16x16x32_bf16 a[56:59], a[180:183], v[184:187], a[56:59]
v_mfma_f32_16x16x32_bf16 a[60:63], a[180:183], v[188:191], a[60:63]
s_waitcnt lgkmcnt(3)
ds_read_b128 a[164:167], v14 offset:25600
v_mfma_f32_16x16x32_bf16 a[60:63], a[176:179], v[180:183], a[60:63]
v_mfma_f32_16x16x32_bf16 a[64:67], a[184:187], v[176:179], a[64:67]
ds_read_b128 a[168:171], v14 offset:21504
v_mfma_f32_16x16x32_bf16 a[64:67], a[188:191], v[184:187], a[64:67]
v_mfma_f32_16x16x32_bf16 a[68:71], a[188:191], v[188:191], a[68:71]
s_waitcnt lgkmcnt(3)
ds_read_b128 a[172:175], v14 offset:26624
v_mfma_f32_16x16x32_bf16 a[68:71], a[184:187], v[180:183], a[68:71]
v_mfma_f32_16x16x32_bf16 a[72:75], a[192:195], v[176:179], a[72:75]
ds_read_b128 a[176:179], v14 offset:22528
v_mfma_f32_16x16x32_bf16 a[72:75], a[196:199], v[184:187], a[72:75]
v_mfma_f32_16x16x32_bf16 a[76:79], a[196:199], v[188:191], a[76:79]
s_waitcnt lgkmcnt(3)
ds_read_b128 a[180:183], v14 offset:27648
v_mfma_f32_16x16x32_bf16 a[76:79], a[192:195], v[180:183], a[76:79]
s_waitcnt vmcnt(19)
v_mfma_f32_16x16x32_bf16 a[4:7], a[164:167], v[56:59], a[4:7]
ds_read_b128 a[184:187], v14 offset:23552
v_mfma_f32_16x16x32_bf16 a[4:7], a[160:163], v[48:51], a[4:7]
s_waitcnt lgkmcnt(3)
ds_read_b128 a[188:191], v14 offset:28672
v_mfma_f32_16x16x32_bf16 a[12:15], a[172:175], v[56:59], a[12:15]
ds_read_b128 a[192:195], v14 offset:24576
v_mfma_f32_16x16x32_bf16 a[12:15], a[168:171], v[48:51], a[12:15]
s_waitcnt lgkmcnt(3)
ds_read_b128 a[196:199], v14 offset:29696
v_mfma_f32_16x16x32_bf16 a[20:23], a[180:183], v[56:59], a[20:23]
ds_read_b128 a[160:163], v14 offset:30720
v_mfma_f32_16x16x32_bf16 a[20:23], a[176:179], v[48:51], a[20:23]
s_waitcnt lgkmcnt(3)
ds_read_b128 a[164:167], v14 offset:35840
v_mfma_f32_16x16x32_bf16 a[28:31], a[188:191], v[56:59], a[28:31]
ds_read_b128 a[168:171], v14 offset:31744
v_mfma_f32_16x16x32_bf16 a[28:31], a[184:187], v[48:51], a[28:31]
s_waitcnt lgkmcnt(3)
ds_read_b128 a[172:175], v14 offset:36864
v_mfma_f32_16x16x32_bf16 a[36:39], a[196:199], v[56:59], a[36:39]
ds_read_b128 a[176:179], v14 offset:32768
v_mfma_f32_16x16x32_bf16 a[36:39], a[192:195], v[48:51], a[36:39]
s_waitcnt lgkmcnt(3)
ds_read_b128 a[180:183], v14 offset:37888
v_mfma_f32_16x16x32_bf16 a[40:43], a[160:163], v[44:47], a[40:43]
ds_read_b128 a[184:187], v14 offset:33792
v_mfma_f32_16x16x32_bf16 a[40:43], a[164:167], v[52:55], a[40:43]
v_mfma_f32_16x16x32_bf16 a[44:47], a[164:167], v[56:59], a[44:47]
s_waitcnt lgkmcnt(3)
ds_read_b128 a[188:191], v14 offset:38912
v_mfma_f32_16x16x32_bf16 a[44:47], a[160:163], v[48:51], a[44:47]
v_mfma_f32_16x16x32_bf16 a[48:51], a[168:171], v[44:47], a[48:51]
ds_read_b128 a[192:195], v14 offset:34816
v_mfma_f32_16x16x32_bf16 a[48:51], a[172:175], v[52:55], a[48:51]
s_waitcnt lgkmcnt(3)
v_mfma_f32_16x16x32_bf16 a[52:55], a[172:175], v[56:59], a[52:55]
ds_read_b128 a[196:199], v14 offset:39936
v_mfma_f32_16x16x32_bf16 a[52:55], a[168:171], v[48:51], a[52:55]
v_mfma_f32_16x16x32_bf16 a[56:59], a[176:179], v[44:47], a[56:59]
v_mfma_f32_16x16x32_bf16 a[56:59], a[180:183], v[52:55], a[56:59]
v_mfma_f32_16x16x32_bf16 a[60:63], a[180:183], v[56:59], a[60:63]
s_waitcnt lgkmcnt(2)
v_mfma_f32_16x16x32_bf16 a[60:63], a[176:179], v[48:51], a[60:63]
v_mfma_f32_16x16x32_bf16 a[64:67], a[184:187], v[44:47], a[64:67]
v_mfma_f32_16x16x32_bf16 a[64:67], a[188:191], v[52:55], a[64:67]
v_mfma_f32_16x16x32_bf16 a[68:71], a[188:191], v[56:59], a[68:71]
s_waitcnt lgkmcnt(0)
v_mfma_f32_16x16x32_bf16 a[68:71], a[184:187], v[48:51], a[68:71]
v_mfma_f32_16x16x32_bf16 a[72:75], a[192:195], v[44:47], a[72:75]
v_mfma_f32_16x16x32_bf16 a[72:75], a[196:199], v[52:55], a[72:75]
v_mfma_f32_16x16x32_bf16 a[76:79], a[196:199], v[56:59], a[76:79]
v_mfma_f32_16x16x32_bf16 a[76:79], a[192:195], v[48:51], a[76:79]
ds_read_b128 a[160:163], v12 offset:40960
ds_read_b128 a[164:167], v12 offset:46080
ds_read_b128 a[168:171], v13 offset:0
ds_read_b128 a[172:175], v13 offset:5120
ds_read_b128 a[176:179], v14 offset:0
ds_read_b128 a[180:183], v14 offset:5120
ds_read_b128 a[184:187], v14 offset:20480
ds_read_b128 a[188:191], v14 offset:25600
v_accvgpr_read_b32 v28, a4
v_accvgpr_read_b32 v29, a5
v_accvgpr_read_b32 v30, a6
v_accvgpr_read_b32 v31, a7
v_cvt_pk_bf16_f32 v112, v28, v29
v_cvt_pk_bf16_f32 v113, v30, v31
v_accvgpr_read_b32 v32, a12
v_accvgpr_read_b32 v33, a13
v_accvgpr_read_b32 v34, a14
v_accvgpr_read_b32 v35, a15
v_cvt_pk_bf16_f32 v114, v32, v33
v_cvt_pk_bf16_f32 v115, v34, v35
v_accvgpr_read_b32 v28, a20
v_accvgpr_read_b32 v29, a21
v_accvgpr_read_b32 v30, a22
v_accvgpr_read_b32 v31, a23
v_cvt_pk_bf16_f32 v116, v28, v29
v_cvt_pk_bf16_f32 v117, v30, v31
v_accvgpr_read_b32 v32, a28
v_accvgpr_read_b32 v33, a29
v_accvgpr_read_b32 v34, a30
v_accvgpr_read_b32 v35, a31
v_cvt_pk_bf16_f32 v118, v32, v33
v_cvt_pk_bf16_f32 v119, v34, v35
v_accvgpr_read_b32 v28, a36
v_accvgpr_read_b32 v29, a37
v_accvgpr_read_b32 v30, a38
v_accvgpr_read_b32 v31, a39
v_cvt_pk_bf16_f32 v120, v28, v29
v_cvt_pk_bf16_f32 v121, v30, v31
s_xor_b32 s40, s39, 1
s_mul_i32 s40, s40, 61440
s_add_u32 s40, s40, s54
s_add_u32 s40, s40, 0
buffer_store_dwordx4 v[112:115], v3, s[20:23], s40 offen sc1
buffer_store_dwordx4 v[116:119], v3, s[20:23], s40 offen offset:1024 sc1
buffer_store_dwordx2 v[120:121], v22, s[20:23], s40 offen offset:2048 sc1
v_accvgpr_read_b32 v28, a40
v_accvgpr_read_b32 v29, a41
v_accvgpr_read_b32 v30, a42
v_accvgpr_read_b32 v31, a43
v_cvt_pk_bf16_f32 v148, v28, v29
v_cvt_pk_bf16_f32 v149, v30, v31
v_accvgpr_read_b32 v32, a48
v_accvgpr_read_b32 v33, a49
v_accvgpr_read_b32 v34, a50
v_accvgpr_read_b32 v35, a51
v_cvt_pk_bf16_f32 v150, v32, v33
v_cvt_pk_bf16_f32 v151, v34, v35
v_accvgpr_read_b32 v28, a56
v_accvgpr_read_b32 v29, a57
v_accvgpr_read_b32 v30, a58
v_accvgpr_read_b32 v31, a59
v_cvt_pk_bf16_f32 v152, v28, v29
v_cvt_pk_bf16_f32 v153, v30, v31
v_accvgpr_read_b32 v32, a64
v_accvgpr_read_b32 v33, a65
v_accvgpr_read_b32 v34, a66
v_accvgpr_read_b32 v35, a67
v_cvt_pk_bf16_f32 v154, v32, v33
v_cvt_pk_bf16_f32 v155, v34, v35
v_accvgpr_read_b32 v28, a72
v_accvgpr_read_b32 v29, a73
v_accvgpr_read_b32 v30, a74
v_accvgpr_read_b32 v31, a75
v_cvt_pk_bf16_f32 v156, v28, v29
v_cvt_pk_bf16_f32 v157, v30, v31
s_xor_b32 s40, s39, 2
s_mul_i32 s40, s40, 61440
s_add_u32 s40, s40, s54
s_add_u32 s40, s40, 20480
buffer_store_dwordx4 v[148:151], v3, s[20:23], s40 offen sc1
buffer_store_dwordx4 v[152:155], v3, s[20:23], s40 offen offset:1024 sc1
buffer_store_dwordx2 v[156:157], v22, s[20:23], s40 offen offset:2048 sc1
v_accvgpr_read_b32 v28, a44
v_accvgpr_read_b32 v29, a45
v_accvgpr_read_b32 v30, a46
v_accvgpr_read_b32 v31, a47
v_cvt_pk_bf16_f32 v240, v28, v29
v_cvt_pk_bf16_f32 v241, v30, v31
v_accvgpr_read_b32 v32, a52
v_accvgpr_read_b32 v33, a53
v_accvgpr_read_b32 v34, a54
v_accvgpr_read_b32 v35, a55
v_cvt_pk_bf16_f32 v242, v32, v33
v_cvt_pk_bf16_f32 v243, v34, v35
v_accvgpr_read_b32 v28, a60
v_accvgpr_read_b32 v29, a61
v_accvgpr_read_b32 v30, a62
v_accvgpr_read_b32 v31, a63
v_cvt_pk_bf16_f32 v244, v28, v29
v_cvt_pk_bf16_f32 v245, v30, v31
v_accvgpr_read_b32 v32, a68
v_accvgpr_read_b32 v33, a69
v_accvgpr_read_b32 v34, a70
v_accvgpr_read_b32 v35, a71
v_cvt_pk_bf16_f32 v246, v32, v33
v_cvt_pk_bf16_f32 v247, v34, v35
v_accvgpr_read_b32 v28, a76
v_accvgpr_read_b32 v29, a77
v_accvgpr_read_b32 v30, a78
v_accvgpr_read_b32 v31, a79
v_cvt_pk_bf16_f32 v122, v28, v29
v_cvt_pk_bf16_f32 v123, v30, v31
s_xor_b32 s40, s39, 3
s_mul_i32 s40, s40, 61440
s_add_u32 s40, s40, s54
s_add_u32 s40, s40, 40960
buffer_store_dwordx4 v[240:243], v3, s[20:23], s40 offen sc1
buffer_store_dwordx4 v[244:247], v3, s[20:23], s40 offen offset:1024 sc1
buffer_store_dwordx2 v[122:123], v22, s[20:23], s40 offen offset:2048 sc1
s_waitcnt lgkmcnt(6)
v_mfma_f32_16x16x32_bf16 a[0:3], a[160:163], v[208:211], a[0:3]
ds_read_b128 a[192:195], v12 offset:41984
v_mfma_f32_16x16x32_bf16 a[0:3], a[164:167], v[216:219], a[0:3]
s_waitcnt lgkmcnt(5)
ds_read_b128 a[196:199], v12 offset:47104
v_mfma_f32_16x16x32_bf16 a[0:3], a[168:171], v[160:163], a[0:3]
ds_read_b128 a[160:163], v13 offset:1024
v_mfma_f32_16x16x32_bf16 a[0:3], a[172:175], v[168:171], a[0:3]
s_waitcnt lgkmcnt(5)
ds_read_b128 a[164:167], v13 offset:6144
v_mfma_f32_16x16x32_bf16 a[0:3], a[176:179], v[176:179], a[0:3]
ds_read_b128 a[168:171], v14 offset:1024
v_mfma_f32_16x16x32_bf16 a[0:3], a[180:183], v[184:187], a[0:3]
s_waitcnt lgkmcnt(5)
ds_read_b128 a[172:175], v14 offset:6144
v_mfma_f32_16x16x32_bf16 a[0:3], a[184:187], v[44:47], a[0:3]
ds_read_b128 a[176:179], v14 offset:21504
v_mfma_f32_16x16x32_bf16 a[0:3], a[188:191], v[52:55], a[0:3]
s_waitcnt lgkmcnt(5)
ds_read_b128 a[180:183], v14 offset:26624
v_mfma_f32_16x16x32_bf16 a[8:11], a[192:195], v[208:211], a[8:11]
ds_read_b128 a[184:187], v12 offset:43008
v_mfma_f32_16x16x32_bf16 a[8:11], a[196:199], v[216:219], a[8:11]
s_waitcnt lgkmcnt(5)
ds_read_b128 a[188:191], v12 offset:48128
v_mfma_f32_16x16x32_bf16 a[8:11], a[160:163], v[160:163], a[8:11]
ds_read_b128 a[192:195], v13 offset:2048
v_mfma_f32_16x16x32_bf16 a[8:11], a[164:167], v[168:171], a[8:11]
s_waitcnt lgkmcnt(5)
ds_read_b128 a[196:199], v13 offset:7168
v_mfma_f32_16x16x32_bf16 a[8:11], a[168:171], v[176:179], a[8:11]
ds_read_b128 a[160:163], v14 offset:2048
v_mfma_f32_16x16x32_bf16 a[8:11], a[172:175], v[184:187], a[8:11]
s_waitcnt lgkmcnt(5)
ds_read_b128 a[164:167], v14 offset:7168
v_mfma_f32_16x16x32_bf16 a[8:11], a[176:179], v[44:47], a[8:11]
ds_read_b128 a[168:171], v14 offset:22528
v_mfma_f32_16x16x32_bf16 a[8:11], a[180:183], v[52:55], a[8:11]
s_waitcnt lgkmcnt(5)
ds_read_b128 a[172:175], v14 offset:27648
v_mfma_f32_16x16x32_bf16 a[16:19], a[184:187], v[208:211], a[16:19]
ds_read_b128 a[176:179], v12 offset:44032
v_mfma_f32_16x16x32_bf16 a[16:19], a[188:191], v[216:219], a[16:19]
s_waitcnt lgkmcnt(5)
ds_read_b128 a[180:183], v12 offset:49152
v_mfma_f32_16x16x32_bf16 a[16:19], a[192:195], v[160:163], a[16:19]
ds_read_b128 a[184:187], v13 offset:3072
v_mfma_f32_16x16x32_bf16 a[16:19], a[196:199], v[168:171], a[16:19]
s_waitcnt lgkmcnt(5)
ds_read_b128 a[188:191], v13 offset:8192
v_mfma_f32_16x16x32_bf16 a[16:19], a[160:163], v[176:179], a[16:19]
ds_read_b128 a[192:195], v14 offset:3072
v_mfma_f32_16x16x32_bf16 a[16:19], a[164:167], v[184:187], a[16:19]
s_waitcnt lgkmcnt(5)
ds_read_b128 a[196:199], v14 offset:8192
v_mfma_f32_16x16x32_bf16 a[16:19], a[168:171], v[44:47], a[16:19]
ds_read_b128 a[160:163], v14 offset:23552
v_mfma_f32_16x16x32_bf16 a[16:19], a[172:175], v[52:55], a[16:19]
s_waitcnt lgkmcnt(5)
ds_read_b128 a[164:167], v14 offset:28672
v_mfma_f32_16x16x32_bf16 a[24:27], a[176:179], v[208:211], a[24:27]
ds_read_b128 a[168:171], v12 offset:45056
v_mfma_f32_16x16x32_bf16 a[24:27], a[180:183], v[216:219], a[24:27]
s_waitcnt lgkmcnt(5)
ds_read_b128 a[172:175], v12 offset:50176
v_mfma_f32_16x16x32_bf16 a[24:27], a[184:187], v[160:163], a[24:27]
ds_read_b128 a[176:179], v13 offset:4096
v_mfma_f32_16x16x32_bf16 a[24:27], a[188:191], v[168:171], a[24:27]
s_waitcnt lgkmcnt(5)
ds_read_b128 a[180:183], v13 offset:9216
v_mfma_f32_16x16x32_bf16 a[24:27], a[192:195], v[176:179], a[24:27]
ds_read_b128 a[184:187], v14 offset:4096
v_mfma_f32_16x16x32_bf16 a[24:27], a[196:199], v[184:187], a[24:27]
s_waitcnt lgkmcnt(5)
ds_read_b128 a[188:191], v14 offset:9216
v_mfma_f32_16x16x32_bf16 a[24:27], a[160:163], v[44:47], a[24:27]
ds_read_b128 a[192:195], v14 offset:24576
v_mfma_f32_16x16x32_bf16 a[24:27], a[164:167], v[52:55], a[24:27]
s_waitcnt lgkmcnt(5)
ds_read_b128 a[196:199], v14 offset:29696
v_mfma_f32_16x16x32_bf16 a[32:35], a[168:171], v[208:211], a[32:35]
v_mfma_f32_16x16x32_bf16 a[32:35], a[172:175], v[216:219], a[32:35]
s_waitcnt lgkmcnt(4)
v_mfma_f32_16x16x32_bf16 a[32:35], a[176:179], v[160:163], a[32:35]
v_mfma_f32_16x16x32_bf16 a[32:35], a[180:183], v[168:171], a[32:35]
s_waitcnt lgkmcnt(2)
v_mfma_f32_16x16x32_bf16 a[32:35], a[184:187], v[176:179], a[32:35]
v_mfma_f32_16x16x32_bf16 a[32:35], a[188:191], v[184:187], a[32:35]
s_waitcnt lgkmcnt(0)
v_mfma_f32_16x16x32_bf16 a[32:35], a[192:195], v[44:47], a[32:35]
v_mfma_f32_16x16x32_bf16 a[32:35], a[196:199], v[52:55], a[32:35]
s_waitcnt vmcnt(0)
s_barrier
buffer_store_dwordx2 v[26:27], v25, s[56:59], s17 offen sc1
buffer_load_dwordx2 v[248:249], v60, s[56:59], s48 offen sc1
v_accvgpr_read_b32 v200, a0
v_accvgpr_read_b32 v201, a1
v_accvgpr_read_b32 v202, a2
v_accvgpr_read_b32 v203, a3
v_accvgpr_read_b32 v204, a8
v_accvgpr_read_b32 v205, a9
v_accvgpr_read_b32 v206, a10
v_accvgpr_read_b32 v207, a11
v_accvgpr_read_b32 v208, a16
v_accvgpr_read_b32 v209, a17
v_accvgpr_read_b32 v210, a18
v_accvgpr_read_b32 v211, a19
v_accvgpr_read_b32 v212, a24
v_accvgpr_read_b32 v213, a25
v_accvgpr_read_b32 v214, a26
v_accvgpr_read_b32 v215, a27
v_accvgpr_read_b32 v216, a32
v_accvgpr_read_b32 v217, a33
v_accvgpr_read_b32 v218, a34
v_accvgpr_read_b32 v219, a35
s_cmp_eq_u32 s2, 0
s_cselect_b32 s41, 0, 0x10000000
buffer_store_dwordx2 v[26:27], v25, s[56:59], s41 offen sc1
s_waitcnt vmcnt(0)
s_mov_b32 s42, 0
s_cmp_eq_u32 s18, 0
s_cbranch_scc1 C_px_chk
s_mov_b32 s42, 0
C_pf:
buffer_load_dwordx2 v[248:249], v60, s[56:59], s19 offen sc1
s_waitcnt vmcnt(0)
C_pf_chk:
v_cmp_ne_u64 vcc, v[26:27], v[248:249]
s_nop 4
s_cbranch_vccz C_pf_ok
s_sleep 6
s_add_u32 s42, s42, 1
s_cmp_lt_u32 s42, 0x40000
s_cbranch_scc1 C_pf
C_pf_ok:
s_mul_i32 s40, s39, 61440
s_add_u32 s40, s40, s54
s_add_u32 s40, s40, 10240
buffer_load_dwordx4 v[64:67], v3, s[20:23], s40 offen sc1
buffer_load_dwordx4 v[68:71], v3, s[20:23], s40 offen offset:1024 sc1
buffer_load_dwordx2 v[72:73], v22, s[20:23], s40 offen offset:2048 sc1
s_add_u32 s40, s40, 20480
buffer_load_dwordx4 v[76:79], v3, s[20:23], s40 offen sc1
buffer_load_dwordx4 v[80:83], v3, s[20:23], s40 offen offset:1024 sc1
buffer_load_dwordx2 v[84:85], v22, s[20:23], s40 offen offset:2048 sc1
s_add_u32 s40, s40, 20480
buffer_load_dwordx4 v[88:91], v3, s[20:23], s40 offen sc1
buffer_load_dwordx4 v[92:95], v3, s[20:23], s40 offen offset:1024 sc1
buffer_load_dwordx2 v[96:97], v22, s[20:23], s40 offen offset:2048 sc1
s_mov_b32 s42, 0
C_px:
buffer_load_dwordx2 v[248:249], v60, s[56:59], s48 offen sc1
s_waitcnt vmcnt(0)
C_px_chk:
v_cmp_ne_u64 vcc, v[26:27], v[248:249]
s_nop 4
s_cbranch_vccz C_px_ok
s_sleep 2
s_add_u32 s42, s42, 1
s_cmp_lt_u32 s42, 0x40000
s_cbranch_scc1 C_px
C_px_ok:
s_mul_i32 s40, s39, 61440
s_add_u32 s40, s40, s54
buffer_load_dwordx4 v[160:163], v3, s[20:23], s40 offen sc1
buffer_load_dwordx4 v[164:167], v3, s[20:23], s40 offen offset:1024 sc1
buffer_load_dwordx2 v[168:169], v22, s[20:23], s40 offen offset:2048 sc1
s_add_u32 s40, s40, 20480
buffer_load_dwordx4 v[172:175], v3, s[20:23], s40 offen sc1
buffer_load_dwordx4 v[176:179], v3, s[20:23], s40 offen offset:1024 sc1
buffer_load_dwordx2 v[180:181], v22, s[20:23], s40 offen offset:2048 sc1
s_add_u32 s40, s40, 20480
buffer_load_dwordx4 v[184:187], v3, s[20:23], s40 offen sc1
buffer_load_dwordx4 v[188:191], v3, s[20:23], s40 offen offset:1024 sc1
buffer_load_dwordx2 v[192:193], v22, s[20:23], s40 offen offset:2048 sc1
v_lshlrev_b32 v28, 16, v64
v_and_b32 v29, 0xffff0000, v64
v_pk_add_f32 v[128:129], v[128:129], v[28:29]
v_lshlrev_b32 v30, 16, v65
v_and_b32 v31, 0xffff0000, v65
v_pk_add_f32 v[130:131], v[130:131], v[30:31]
v_lshlrev_b32 v28, 16, v66
v_and_b32 v29, 0xffff0000, v66
v_pk_add_f32 v[132:133], v[132:133], v[28:29]
v_lshlrev_b32 v30, 16, v67
v_and_b32 v31, 0xffff0000, v67
v_pk_add_f32 v[134:135], v[134:135], v[30:31]
v_lshlrev_b32 v28, 16, v68
v_and_b32 v29, 0xffff0000, v68
v_pk_add_f32 v[136:137], v[136:137], v[28:29]
v_lshlrev_b32 v30, 16, v69
v_and_b32 v31, 0xffff0000, v69
v_pk_add_f32 v[138:139], v[138:139], v[30:31]
v_lshlrev_b32 v28, 16, v70
v_and_b32 v29, 0xffff0000, v70
v_pk_add_f32 v[140:141], v[140:141], v[28:29]
v_lshlrev_b32 v30, 16, v71
v_and_b32 v31, 0xffff0000, v71
v_pk_add_f32 v[142:143], v[142:143], v[30:31]
v_lshlrev_b32 v28, 16, v72
v_and_b32 v29, 0xffff0000, v72
v_pk_add_f32 v[144:145], v[144:145], v[28:29]
v_lshlrev_b32 v30, 16, v73
v_and_b32 v31, 0xffff0000, v73
v_pk_add_f32 v[146:147], v[146:147], v[30:31]
v_lshlrev_b32 v28, 16, v76
v_and_b32 v29, 0xffff0000, v76
v_pk_add_f32 v[128:129], v[128:129], v[28:29]
v_lshlrev_b32 v30, 16, v77
v_and_b32 v31, 0xffff0000, v77
v_pk_add_f32 v[130:131], v[130:131], v[30:31]
v_lshlrev_b32 v28, 16, v78
v_and_b32 v29, 0xffff0000, v78
v_pk_add_f32 v[132:133], v[132:133], v[28:29]
v_lshlrev_b32 v30, 16, v79
v_and_b32 v31, 0xffff0000, v79
v_pk_add_f32 v[134:135], v[134:135], v[30:31]
v_lshlrev_b32 v28, 16, v80
v_and_b32 v29, 0xffff0000, v80
v_pk_add_f32 v[136:137], v[136:137], v[28:29]
v_lshlrev_b32 v30, 16, v81
v_and_b32 v31, 0xffff0000, v81
v_pk_add_f32 v[138:139], v[138:139], v[30:31]
v_lshlrev_b32 v28, 16, v82
v_and_b32 v29, 0xffff0000, v82
v_pk_add_f32 v[140:141], v[140:141], v[28:29]
v_lshlrev_b32 v30, 16, v83
v_and_b32 v31, 0xffff0000, v83
v_pk_add_f32 v[142:143], v[142:143], v[30:31]
v_lshlrev_b32 v28, 16, v84
v_and_b32 v29, 0xffff0000, v84
v_pk_add_f32 v[144:145], v[144:145], v[28:29]
v_lshlrev_b32 v30, 16, v85
v_and_b32 v31, 0xffff0000, v85
v_pk_add_f32 v[146:147], v[146:147], v[30:31]
v_lshlrev_b32 v28, 16, v88
v_and_b32 v29, 0xffff0000, v88
v_pk_add_f32 v[128:129], v[128:129], v[28:29]
v_lshlrev_b32 v30, 16, v89
v_and_b32 v31, 0xffff0000, v89
v_pk_add_f32 v[130:131], v[130:131], v[30:31]
v_lshlrev_b32 v28, 16, v90
v_and_b32 v29, 0xffff0000, v90
v_pk_add_f32 v[132:133], v[132:133], v[28:29]
v_lshlrev_b32 v30, 16, v91
v_and_b32 v31, 0xffff0000, v91
v_pk_add_f32 v[134:135], v[134:135], v[30:31]
v_lshlrev_b32 v28, 16, v92
v_and_b32 v29, 0xffff0000, v92
v_pk_add_f32 v[136:137], v[136:137], v[28:29]
v_lshlrev_b32 v30, 16, v93
v_and_b32 v31, 0xffff0000, v93
v_pk_add_f32 v[138:139], v[138:139], v[30:31]
v_lshlrev_b32 v28, 16, v94
v_and_b32 v29, 0xffff0000, v94
v_pk_add_f32 v[140:141], v[140:141], v[28:29]
v_lshlrev_b32 v30, 16, v95
v_and_b32 v31, 0xffff0000, v95
v_pk_add_f32 v[142:143], v[142:143], v[30:31]
v_lshlrev_b32 v28, 16, v96
v_and_b32 v29, 0xffff0000, v96
v_pk_add_f32 v[144:145], v[144:145], v[28:29]
v_lshlrev_b32 v30, 16, v97
v_and_b32 v31, 0xffff0000, v97
v_pk_add_f32 v[146:147], v[146:147], v[30:31]
s_mov_b32 s40, 0xbfb8aa3b
v_mul_f32 v28, s40, v128
v_mul_f32 v29, s40, v129
v_mul_f32 v30, s40, v130
v_mul_f32 v31, s40, v131
v_mul_f32 v32, s40, v132
v_mul_f32 v33, s40, v133
v_mul_f32 v34, s40, v134
v_mul_f32 v35, s40, v135
v_mul_f32 v36, s40, v136
v_mul_f32 v37, s40, v137
v_mul_f32 v38, s40, v138
v_mul_f32 v39, s40, v139
v_mul_f32 v40, s40, v140
v_mul_f32 v41, s40, v141
v_mul_f32 v42, s40, v142
v_mul_f32 v43, s40, v143
v_mul_f32 v44, s40, v144
v_mul_f32 v45, s40, v145
v_mul_f32 v46, s40, v146
v_mul_f32 v47, s40, v147
v_exp_f32 v28, v28
v_exp_f32 v29, v29
v_exp_f32 v30, v30
v_exp_f32 v31, v31
v_exp_f32 v32, v32
v_exp_f32 v33, v33
v_exp_f32 v34, v34
v_exp_f32 v35, v35
v_exp_f32 v36, v36
v_exp_f32 v37, v37
v_exp_f32 v38, v38
v_exp_f32 v39, v39
v_exp_f32 v40, v40
v_exp_f32 v41, v41
v_exp_f32 v42, v42
v_exp_f32 v43, v43
v_exp_f32 v44, v44
v_exp_f32 v45, v45
v_exp_f32 v46, v46
v_exp_f32 v47, v47
v_add_f32 v28, 1.0, v28
v_add_f32 v29, 1.0, v29
v_add_f32 v30, 1.0, v30
v_add_f32 v31, 1.0, v31
v_add_f32 v32, 1.0, v32
v_add_f32 v33, 1.0, v33
v_add_f32 v34, 1.0, v34
v_add_f32 v35, 1.0, v35
v_add_f32 v36, 1.0, v36
v_add_f32 v37, 1.0, v37
v_add_f32 v38, 1.0, v38
v_add_f32 v39, 1.0, v39
v_add_f32 v40, 1.0, v40
v_add_f32 v41, 1.0, v41
v_add_f32 v42, 1.0, v42
v_add_f32 v43, 1.0, v43
v_add_f32 v44, 1.0, v44
v_add_f32 v45, 1.0, v45
v_add_f32 v46, 1.0, v46
v_add_f32 v47, 1.0, v47
v_rcp_f32 v28, v28
v_rcp_f32 v29, v29
v_rcp_f32 v30, v30
v_rcp_f32 v31, v31
v_rcp_f32 v32, v32
v_rcp_f32 v33, v33
v_rcp_f32 v34, v34
v_rcp_f32 v35, v35
v_rcp_f32 v36, v36
v_rcp_f32 v37, v37
v_rcp_f32 v38, v38
v_rcp_f32 v39, v39
v_rcp_f32 v40, v40
v_rcp_f32 v41, v41
v_rcp_f32 v42, v42
v_rcp_f32 v43, v43
v_rcp_f32 v44, v44
v_rcp_f32 v45, v45
v_rcp_f32 v46, v46
v_rcp_f32 v47, v47
v_mul_f32 v128, v128, v28
v_mul_f32 v129, v129, v29
v_mul_f32 v130, v130, v30
v_mul_f32 v131, v131, v31
v_mul_f32 v132, v132, v32
v_mul_f32 v133, v133, v33
v_mul_f32 v134, v134, v34
v_mul_f32 v135, v135, v35
v_mul_f32 v136, v136, v36
v_mul_f32 v137, v137, v37
v_mul_f32 v138, v138, v38
v_mul_f32 v139, v139, v39
v_mul_f32 v140, v140, v40
v_mul_f32 v141, v141, v41
v_mul_f32 v142, v142, v42
v_mul_f32 v143, v143, v43
v_mul_f32 v144, v144, v44
v_mul_f32 v145, v145, v45
v_mul_f32 v146, v146, v46
v_mul_f32 v147, v147, v47
v_lshlrev_b32 v28, 16, v100
v_and_b32 v29, 0xffff0000, v100
v_lshlrev_b32 v30, 16, v101
v_and_b32 v31, 0xffff0000, v101
v_lshlrev_b32 v32, 16, v102
v_and_b32 v33, 0xffff0000, v102
v_lshlrev_b32 v34, 16, v103
v_and_b32 v35, 0xffff0000, v103
v_lshlrev_b32 v36, 16, v104
v_and_b32 v37, 0xffff0000, v104
v_lshlrev_b32 v38, 16, v105
v_and_b32 v39, 0xffff0000, v105
v_lshlrev_b32 v40, 16, v106
v_and_b32 v41, 0xffff0000, v106
v_lshlrev_b32 v42, 16, v107
v_and_b32 v43, 0xffff0000, v107
v_lshlrev_b32 v44, 16, v108
v_and_b32 v45, 0xffff0000, v108
v_lshlrev_b32 v46, 16, v109
v_and_b32 v47, 0xffff0000, v109
s_waitcnt vmcnt(0)
v_lshlrev_b32 v52, 16, v160
v_and_b32 v53, 0xffff0000, v160
v_pk_add_f32 v[200:201], v[200:201], v[52:53]
v_lshlrev_b32 v54, 16, v161
v_and_b32 v55, 0xffff0000, v161
v_pk_add_f32 v[202:203], v[202:203], v[54:55]
v_lshlrev_b32 v52, 16, v162
v_and_b32 v53, 0xffff0000, v162
v_pk_add_f32 v[204:205], v[204:205], v[52:53]
v_lshlrev_b32 v54, 16, v163
v_and_b32 v55, 0xffff0000, v163
v_pk_add_f32 v[206:207], v[206:207], v[54:55]
v_lshlrev_b32 v52, 16, v164
v_and_b32 v53, 0xffff0000, v164
v_pk_add_f32 v[208:209], v[208:209], v[52:53]
v_lshlrev_b32 v54, 16, v165
v_and_b32 v55, 0xffff0000, v165
v_pk_add_f32 v[210:211], v[210:211], v[54:55]
v_lshlrev_b32 v52, 16, v166
v_and_b32 v53, 0xffff0000, v166
v_pk_add_f32 v[212:213], v[212:213], v[52:53]
v_lshlrev_b32 v54, 16, v167
v_and_b32 v55, 0xffff0000, v167
v_pk_add_f32 v[214:215], v[214:215], v[54:55]
v_lshlrev_b32 v52, 16, v168
v_and_b32 v53, 0xffff0000, v168
v_pk_add_f32 v[216:217], v[216:217], v[52:53]
v_lshlrev_b32 v54, 16, v169
v_and_b32 v55, 0xffff0000, v169
v_pk_add_f32 v[218:219], v[218:219], v[54:55]
v_lshlrev_b32 v52, 16, v172
v_and_b32 v53, 0xffff0000, v172
v_pk_add_f32 v[200:201], v[200:201], v[52:53]
v_lshlrev_b32 v54, 16, v173
v_and_b32 v55, 0xffff0000, v173
v_pk_add_f32 v[202:203], v[202:203], v[54:55]
v_lshlrev_b32 v52, 16, v174
v_and_b32 v53, 0xffff0000, v174
v_pk_add_f32 v[204:205], v[204:205], v[52:53]
v_lshlrev_b32 v54, 16, v175
v_and_b32 v55, 0xffff0000, v175
v_pk_add_f32 v[206:207], v[206:207], v[54:55]
v_lshlrev_b32 v52, 16, v176
v_and_b32 v53, 0xffff0000, v176
v_pk_add_f32 v[208:209], v[208:209], v[52:53]
v_lshlrev_b32 v54, 16, v177
v_and_b32 v55, 0xffff0000, v177
v_pk_add_f32 v[210:211], v[210:211], v[54:55]
v_lshlrev_b32 v52, 16, v178
v_and_b32 v53, 0xffff0000, v178
v_pk_add_f32 v[212:213], v[212:213], v[52:53]
v_lshlrev_b32 v54, 16, v179
v_and_b32 v55, 0xffff0000, v179
v_pk_add_f32 v[214:215], v[214:215], v[54:55]
v_lshlrev_b32 v52, 16, v180
v_and_b32 v53, 0xffff0000, v180
v_pk_add_f32 v[216:217], v[216:217], v[52:53]
v_lshlrev_b32 v54, 16, v181
v_and_b32 v55, 0xffff0000, v181
v_pk_add_f32 v[218:219], v[218:219], v[54:55]
v_lshlrev_b32 v52, 16, v184
v_and_b32 v53, 0xffff0000, v184
v_pk_add_f32 v[200:201], v[200:201], v[52:53]
v_lshlrev_b32 v54, 16, v185
v_and_b32 v55, 0xffff0000, v185
v_pk_add_f32 v[202:203], v[202:203], v[54:55]
v_lshlrev_b32 v52, 16, v186
v_and_b32 v53, 0xffff0000, v186
v_pk_add_f32 v[204:205], v[204:205], v[52:53]
v_lshlrev_b32 v54, 16, v187
v_and_b32 v55, 0xffff0000, v187
v_pk_add_f32 v[206:207], v[206:207], v[54:55]
v_lshlrev_b32 v52, 16, v188
v_and_b32 v53, 0xffff0000, v188
v_pk_add_f32 v[208:209], v[208:209], v[52:53]
v_lshlrev_b32 v54, 16, v189
v_and_b32 v55, 0xffff0000, v189
v_pk_add_f32 v[210:211], v[210:211], v[54:55]
v_lshlrev_b32 v52, 16, v190
v_and_b32 v53, 0xffff0000, v190
v_pk_add_f32 v[212:213], v[212:213], v[52:53]
v_lshlrev_b32 v54, 16, v191
v_and_b32 v55, 0xffff0000, v191
v_pk_add_f32 v[214:215], v[214:215], v[54:55]
v_lshlrev_b32 v52, 16, v192
v_and_b32 v53, 0xffff0000, v192
v_pk_add_f32 v[216:217], v[216:217], v[52:53]
v_lshlrev_b32 v54, 16, v193
v_and_b32 v55, 0xffff0000, v193
v_pk_add_f32 v[218:219], v[218:219], v[54:55]
v_pk_fma_f32 v[200:201], v[200:201], v[128:129], v[28:29]
v_pk_fma_f32 v[202:203], v[202:203], v[130:131], v[30:31]
v_pk_fma_f32 v[204:205], v[204:205], v[132:133], v[32:33]
v_pk_fma_f32 v[206:207], v[206:207], v[134:135], v[34:35]
v_pk_fma_f32 v[208:209], v[208:209], v[136:137], v[36:37]
v_pk_fma_f32 v[210:211], v[210:211], v[138:139], v[38:39]
v_pk_fma_f32 v[212:213], v[212:213], v[140:141], v[40:41]
v_pk_fma_f32 v[214:215], v[214:215], v[142:143], v[42:43]
v_pk_fma_f32 v[216:217], v[216:217], v[144:145], v[44:45]
v_pk_fma_f32 v[218:219], v[218:219], v[146:147], v[46:47]
v_cvt_pk_bf16_f32 v128, v200, v201
v_cvt_pk_bf16_f32 v129, v202, v203
v_cvt_pk_bf16_f32 v130, v204, v205
v_cvt_pk_bf16_f32 v131, v206, v207
v_cvt_pk_bf16_f32 v132, v208, v209
v_cvt_pk_bf16_f32 v133, v210, v211
v_cvt_pk_bf16_f32 v134, v212, v213
v_cvt_pk_bf16_f32 v135, v214, v215
v_cvt_pk_bf16_f32 v136, v216, v217
v_cvt_pk_bf16_f32 v137, v218, v219
buffer_store_dwordx2 v[128:129], v4, s[8:11], s53 offen offset:0
buffer_store_dwordx2 v[130:131], v4, s[8:11], s53 offen offset:32
buffer_store_dwordx2 v[132:133], v4, s[8:11], s53 offen offset:64
buffer_store_dwordx2 v[134:135], v4, s[8:11], s53 offen offset:96
buffer_store_dwordx2 v[136:137], v4, s[8:11], s53 offen offset:128
K_end:
s_endpgm
K_fb:
s_mov_b32 s35, 1
s_mov_b32 s32, 0
s_mov_b32 s34, 64
v_xor_b32 v4, 64, v5
v_mov_b32 v244, 0xff800000
v_mov_b32 v245, 0xff800000
v_mov_b32 v246, 0xff800000
v_mov_b32 v247, 0xff800000
s_waitcnt vmcnt(0)
s_barrier
K_fbl:
s_add_u32 m0, s30, 0
s_nop 0
buffer_load_dwordx4 v10, s[4:7], s32 offen offset:0 lds
s_add_u32 m0, s30, 3968
s_nop 0
buffer_load_dwordx4 v10, s[4:7], s32 offen offset:128 lds
s_add_u32 m0, s30, 7936
s_nop 0
buffer_load_dwordx4 v10, s[4:7], s32 offen offset:256 lds
s_add_u32 s32, s32, 12288
s_waitcnt vmcnt(0)
s_barrier
ds_read_b128 a[208:211], v4 offset:0
ds_read_b128 a[212:215], v5 offset:0
ds_read_b128 a[216:219], v4 offset:4096
ds_read_b128 a[220:223], v5 offset:4096
ds_read_b128 a[224:227], v4 offset:8192
ds_read_b128 a[228:231], v5 offset:8192
ds_read_b128 a[232:235], v4 offset:2048
ds_read_b128 a[236:239], v5 offset:2048
ds_read_b128 a[240:243], v4 offset:6144
ds_read_b128 a[244:247], v5 offset:6144
ds_read_b128 a[248:251], v4 offset:10240
ds_read_b128 a[252:255], v5 offset:10240
s_waitcnt lgkmcnt(0)
v_mfma_f32_16x16x32_bf16 v[160:163], a[208:211], v[64:67], 0
v_mfma_f32_16x16x32_bf16 v[160:163], a[212:215], v[80:83], v[160:163]
v_mfma_f32_16x16x32_bf16 v[160:163], a[216:219], v[96:99], v[160:163]
v_mfma_f32_16x16x32_bf16 v[160:163], a[220:223], v[112:115], v[160:163]
v_mfma_f32_16x16x32_bf16 v[160:163], a[224:227], v[128:131], v[160:163]
v_mfma_f32_16x16x32_bf16 v[160:163], a[228:231], v[144:147], v[160:163]
v_mfma_f32_16x16x32_bf16 v[164:167], a[228:231], v[148:151], 0
v_mfma_f32_16x16x32_bf16 v[164:167], a[224:227], v[132:135], v[164:167]
v_mfma_f32_16x16x32_bf16 v[164:167], a[220:223], v[116:119], v[164:167]
v_mfma_f32_16x16x32_bf16 v[164:167], a[216:219], v[100:103], v[164:167]
v_mfma_f32_16x16x32_bf16 v[164:167], a[212:215], v[84:87], v[164:167]
v_mfma_f32_16x16x32_bf16 v[164:167], a[208:211], v[68:71], v[164:167]
v_mfma_f32_16x16x32_bf16 v[168:171], a[208:211], v[72:75], 0
v_mfma_f32_16x16x32_bf16 v[168:171], a[212:215], v[88:91], v[168:171]
v_mfma_f32_16x16x32_bf16 v[168:171], a[216:219], v[104:107], v[168:171]
v_mfma_f32_16x16x32_bf16 v[168:171], a[220:223], v[120:123], v[168:171]
v_mfma_f32_16x16x32_bf16 v[168:171], a[224:227], v[136:139], v[168:171]
v_mfma_f32_16x16x32_bf16 v[168:171], a[228:231], v[152:155], v[168:171]
v_mfma_f32_16x16x32_bf16 v[172:175], a[228:231], v[156:159], 0
v_mfma_f32_16x16x32_bf16 v[172:175], a[224:227], v[140:143], v[172:175]
v_mfma_f32_16x16x32_bf16 v[172:175], a[220:223], v[124:127], v[172:175]
v_mfma_f32_16x16x32_bf16 v[172:175], a[216:219], v[108:111], v[172:175]
v_mfma_f32_16x16x32_bf16 v[172:175], a[212:215], v[92:95], v[172:175]
v_mfma_f32_16x16x32_bf16 v[172:175], a[208:211], v[76:79], v[172:175]
v_mfma_f32_16x16x32_bf16 v[176:179], a[232:235], v[64:67], 0
v_mfma_f32_16x16x32_bf16 v[176:179], a[236:239], v[80:83], v[176:179]
v_mfma_f32_16x16x32_bf16 v[176:179], a[240:243], v[96:99], v[176:179]
v_mfma_f32_16x16x32_bf16 v[176:179], a[244:247], v[112:115], v[176:179]
v_mfma_f32_16x16x32_bf16 v[176:179], a[248:251], v[128:131], v[176:179]
v_mfma_f32_16x16x32_bf16 v[176:179], a[252:255], v[144:147], v[176:179]
v_mfma_f32_16x16x32_bf16 v[180:183], a[252:255], v[148:151], 0
v_mfma_f32_16x16x32_bf16 v[180:183], a[248:251], v[132:135], v[180:183]
v_mfma_f32_16x16x32_bf16 v[180:183], a[244:247], v[116:119], v[180:183]
v_mfma_f32_16x16x32_bf16 v[180:183], a[240:243], v[100:103], v[180:183]
v_mfma_f32_16x16x32_bf16 v[180:183], a[236:239], v[84:87], v[180:183]
v_mfma_f32_16x16x32_bf16 v[180:183], a[232:235], v[68:71], v[180:183]
v_mfma_f32_16x16x32_bf16 v[184:187], a[232:235], v[72:75], 0
v_mfma_f32_16x16x32_bf16 v[184:187], a[236:239], v[88:91], v[184:187]
v_mfma_f32_16x16x32_bf16 v[184:187], a[240:243], v[104:107], v[184:187]
v_mfma_f32_16x16x32_bf16 v[184:187], a[244:247], v[120:123], v[184:187]
v_mfma_f32_16x16x32_bf16 v[184:187], a[248:251], v[136:139], v[184:187]
v_mfma_f32_16x16x32_bf16 v[184:187], a[252:255], v[152:155], v[184:187]
v_mfma_f32_16x16x32_bf16 v[188:191], a[252:255], v[156:159], 0
v_mfma_f32_16x16x32_bf16 v[188:191], a[248:251], v[140:143], v[188:191]
v_mfma_f32_16x16x32_bf16 v[188:191], a[244:247], v[124:127], v[188:191]
v_mfma_f32_16x16x32_bf16 v[188:191], a[240:243], v[108:111], v[188:191]
v_mfma_f32_16x16x32_bf16 v[188:191], a[236:239], v[92:95], v[188:191]
v_mfma_f32_16x16x32_bf16 v[188:191], a[232:235], v[76:79], v[188:191]
s_nop 7
v_max3_f32 v244, v160, v161, v244
v_max3_f32 v244, v162, v163, v244
v_max3_f32 v244, v176, v177, v244
v_max3_f32 v244, v178, v179, v244
v_max3_f32 v245, v164, v165, v245
v_max3_f32 v245, v166, v167, v245
v_max3_f32 v245, v180, v181, v245
v_max3_f32 v245, v182, v183, v245
v_max3_f32 v246, v168, v169, v246
v_max3_f32 v246, v170, v171, v246
v_max3_f32 v246, v184, v185, v246
v_max3_f32 v246, v186, v187, v246
v_max3_f32 v247, v172, v173, v247
v_max3_f32 v247, v174, v175, v247
v_max3_f32 v247, v188, v189, v247
v_max3_f32 v247, v190, v191, v247
s_barrier
s_sub_u32 s34, s34, 1
s_cmp_lg_u32 s34, 0
s_cbranch_scc1 K_fbl
s_mov_b32 s32, 0
s_add_u32 m0, s30, 0
s_nop 0
buffer_load_dwordx4 v10, s[4:7], s32 offen offset:0 lds
s_add_u32 m0, s30, 3968
s_nop 0
buffer_load_dwordx4 v10, s[4:7], s32 offen offset:128 lds
s_add_u32 m0, s30, 7936
s_nop 0
buffer_load_dwordx4 v10, s[4:7], s32 offen offset:256 lds
s_mov_b32 s32, 12288
s_add_u32 m0, s30, 12288
s_nop 0
buffer_load_dwordx4 v10, s[4:7], s32 offen offset:0 lds
s_add_u32 m0, s30, 16256
s_nop 0
buffer_load_dwordx4 v10, s[4:7], s32 offen offset:128 lds
s_add_u32 m0, s30, 20224
s_nop 0
buffer_load_dwordx4 v10, s[4:7], s32 offen offset:256 lds
s_mov_b32 s32, 24576
s_add_u32 m0, s30, 24576
s_nop 0
buffer_load_dwordx4 v10, s[4:7], s32 offen offset:0 lds
s_add_u32 m0, s30, 28544
s_nop 0
buffer_load_dwordx4 v10, s[4:7], s32 offen offset:128 lds
s_add_u32 m0, s30, 32512
s_nop 0
buffer_load_dwordx4 v10, s[4:7], s32 offen offset:256 lds
s_mov_b32 s32, 36864
s_add_u32 m0, s30, 36864
s_nop 0
buffer_load_dwordx4 v10, s[4:7], s32 offen offset:0 lds
s_add_u32 m0, s30, 40832
s_nop 0
buffer_load_dwordx4 v10, s[4:7], s32 offen offset:128 lds
s_add_u32 m0, s30, 44800
s_nop 0
buffer_load_dwordx4 v10, s[4:7], s32 offen offset:256 lds
s_mov_b32 s33, 0
s_add_u32 m0, s31, 0
s_nop 0
buffer_load_dwordx4 v11, s[8:11], s33 offen offset:0 lds
s_add_u32 m0, s31, 4096
s_nop 0
buffer_load_dwordx4 v23, s[8:11], s33 offen offset:0 lds
s_add_u32 m0, s31, 8064
s_nop 0
buffer_load_dwordx4 v11, s[8:11], s33 offen offset:128 lds
s_add_u32 m0, s31, 12160
s_nop 0
buffer_load_dwordx4 v23, s[8:11], s33 offen offset:128 lds
s_waitcnt vmcnt(0)
s_branch K_attn
S_redo:
s_and_b32 s42, s29, 3
s_lshl_b32 s43, s42, 7
s_lshl_b32 s42, s42, 6
s_add_u32 s42, s42, 512
s_bitcmp0_b32 s65, 0
s_cselect_b32 s42, s43, s42
s_cselect_b32 s41, 128, 64
s_lshr_b32 s43, s29, 3
s_mul_i32 s43, s43, 768
s_add_u32 s42, s42, s43
s_lshl_b32 s64, s42, 6
s_add_u32 s64, s64, 786432
s_add_u32 s64, s64, s3
s_add_u32 s16, s82, s42
s_addc_u32 s17, s83, 0
s_mov_b32 s19, 0x20000
s_sub_u32 s18, 1966080, s42
v_and_b32 v28, 127, v24
v_mov_b32 v29, 0x10000000
v_cmp_gt_u32 vcc, s41, v28
s_nop 1
v_cndmask_b32 v13, v29, v24, vcc
s_mov_b32 s40, 0
s_add_u32 m0, s37, 24576
s_nop 0
buffer_load_dwordx4 v13, s[16:19], s40 offen lds
s_mov_b32 s40, 49152
s_add_u32 m0, s37, 25600
s_nop 0
buffer_load_dwordx4 v13, s[16:19], s40 offen lds
s_mov_b32 s40, 12288
s_add_u32 m0, s37, 26624
s_nop 0
buffer_load_dwordx4 v13, s[16:19], s40 offen lds
s_mov_b32 s40, 61440
s_add_u32 m0, s37, 27648
s_nop 0
buffer_load_dwordx4 v13, s[16:19], s40 offen lds
s_mov_b32 s40, 196608
s_add_u32 m0, s37, 65536
s_nop 0
buffer_load_dwordx4 v13, s[16:19], s40 offen lds
s_mov_b32 s40, 245760
s_add_u32 m0, s37, 66560
s_nop 0
buffer_load_dwordx4 v13, s[16:19], s40 offen lds
s_mov_b32 s40, 208896
s_add_u32 m0, s37, 67584
s_nop 0
buffer_load_dwordx4 v13, s[16:19], s40 offen lds
s_mov_b32 s40, 258048
s_add_u32 m0, s37, 68608
s_nop 0
buffer_load_dwordx4 v13, s[16:19], s40 offen lds
s_waitcnt vmcnt(0)
s_branch S_rok
K_codeend:
.section .rodata,"a"
.p2align 6
.amdhsa_kernel recurrent_scan__mha_block_cached__swiglu_ffn__prompt_kernel
  .amdhsa_next_free_vgpr 512
  .amdhsa_next_free_sgpr 102
  .amdhsa_accum_offset 256
  .amdhsa_group_segment_fixed_size 0
  .amdhsa_kernarg_size 96
  .amdhsa_user_sgpr_count 2
  .amdhsa_user_sgpr_kernarg_segment_ptr 1
  .amdhsa_system_sgpr_workgroup_id_x 1
.end_amdhsa_kernel
```
